```python
import torch

def _softmax(x, axis=-1):
    return torch.softmax(x, dim=axis)

def _gelu(x):
    return torch.nn.functional.gelu(x, approximate='tanh')

def _silu(x):
    return torch.nn.functional.silu(x)

def _sigmoid(x):
    return torch.sigmoid(x)

def _layernorm(x, axis=-1, eps=1e-05):
    m = x.mean(dim=axis, keepdim=True)
    v = x.var(dim=axis, keepdim=True, unbiased=False)
    return (x - m) / torch.sqrt(v + eps)

def _scatter_add(tgt, idx, src, axis=0):
    return tgt.clone().index_add_(axis, idx, src)

def _segment_sum(src, seg, n):
    out = torch.zeros((n,) + src.shape[1:], dtype=src.dtype)
    return out.index_add_(0, seg, src)

def _pad(x, pw):
    flat = tuple((v for pair in reversed(pw) for v in pair))
    return torch.nn.functional.pad(x, flat)
kernel_name = 'parallel_sum__memory_aug_recurrent_mem_tr__dense_activation_gelu__prompt'

def setup_inputs():

    _w = lambda a: (lambda t: t.to(torch.bfloat16) if t.is_floating_point() else t)(torch.as_tensor(a))

    def _A_setup():
        B, S, Dm = (1, 2048, 640)
        H, Dh = (32, 128)
        M, seg = (8, 32)
        seg = min(seg, S)
        S = S // seg * seg
        return {'x': _w((lambda *s: torch.randn(*s, dtype=torch.bfloat16) * 0.05)(B, S, Dm)), 'mem0': _w((lambda *s: torch.randn(*s, dtype=torch.bfloat16) * 0.2)(B, M, Dm)), 'Wq': _w((lambda *s: torch.randn(*s, dtype=torch.bfloat16) * 1.6)(Dm, H, Dh) * Dm ** (-0.5)), 'Wk': _w((lambda *s: torch.randn(*s, dtype=torch.bfloat16) * 1.6)(Dm, H, Dh) * Dm ** (-0.5)), 'Wv': _w((lambda *s: torch.randn(*s, dtype=torch.bfloat16) * 0.2)(Dm, H, Dh) * Dm ** (-0.5)), 'Wo': _w((lambda *s: torch.randn(*s, dtype=torch.bfloat16) * 0.2)(H, Dh, Dm) * (H * Dh) ** (-0.5)), 'seg_len': seg}
    _A_in = _A_setup()

    def _B_setup():
        B, S, D, F = (1, 2048, 640, 1728)
        return {'x': _w((lambda *s: torch.randn(*s, dtype=torch.bfloat16) * 0.05)(B, S, D)), 'w1': _w((lambda *s: torch.randn(*s, dtype=torch.bfloat16) * 0.4)(D, F) * D ** (-0.5)), 'b1': _w((lambda *s: torch.randn(*s, dtype=torch.bfloat16) * 12.8)(F) * 0.01), 'w2': _w((lambda *s: torch.randn(*s, dtype=torch.bfloat16) * 0.2)(F, D) * F ** (-0.5)), 'b2': _w((lambda *s: torch.randn(*s, dtype=torch.bfloat16) * 1.6)(D) * 0.01)}
    _B_in = _B_setup()
    return {'A_x': _A_in['x'], 'A_mem0': _A_in['mem0'], 'A_Wq': _A_in['Wq'], 'A_Wk': _A_in['Wk'], 'A_Wv': _A_in['Wv'], 'A_Wo': _A_in['Wo'], 'A_seg_len': _A_in['seg_len'], 'B_x': _B_in['x'], 'B_w1': _B_in['w1'], 'B_b1': _B_in['b1'], 'B_w2': _B_in['w2'], 'B_b2': _B_in['b2']}

def reference(A_x, A_mem0, A_Wq, A_Wk, A_Wv, A_Wo, A_seg_len, B_x, B_w1, B_b1, B_w2, B_b2):

    def _A_ref(x, mem0, Wq, Wk, Wv, Wo, seg_len):
        B, S, Dm = x.shape
        H, Dh = (Wq.shape[1], Wq.shape[2])
        M = mem0.shape[1]
        scale = Dh ** (-0.5)
        n_seg = S // seg_len
        L = M + seg_len
        idx = torch.arange(L)
        mask = (idx[:, None] < M) | (idx[:, None] >= idx[None, :])
        mem = mem0
        outs = []
        for s in range(n_seg):
            xs = x[:, s * seg_len:(s + 1) * seg_len, :].clone()
            h = torch.concatenate([mem, xs], axis=1)
            q = torch.einsum('btd,dhe->bhte', h, Wq)
            k = torch.einsum('btd,dhe->bhte', h, Wk)
            v = torch.einsum('btd,dhe->bhte', h, Wv)
            scores = torch.einsum('bhqe,bhke->bhqk', q, k) * scale
            scores = torch.where(mask[None, None], scores, -1000000000.0)
            p = _softmax(scores, axis=-1)
            o = torch.einsum('bhqk,bhke->bhqe', p, v)
            o = torch.einsum('bhte,hed->btd', o, Wo)
            mem = o[:, :M, :].clone()
            outs.append(o[:, M:, :])
        return torch.concatenate(outs, axis=1)

    def _B_ref(x, w1, b1, w2, b2):
        h = torch.einsum('bsd,df->bsf', x, w1) + b1
        h = _gelu(h)
        return torch.einsum('bsf,fd->bsd', h, w2) + b2
    x = A_x
    xn = _layernorm(x, axis=-1)
    return x + _A_ref(xn, A_mem0, A_Wq, A_Wk, A_Wv, A_Wo, A_seg_len) + _B_ref(xn, B_w1, B_b1, B_w2, B_b2)
```

```asm
; @launch grid=(256,1,1) block=(256,1,1) lds=163840
.amdgcn_target "amdgcn-amd-amdhsa--gfx950"
.text
.globl parallel_sum__memory_aug_recurrent_mem_tr__dense_activation_gelu__prompt_kernel
.p2align 8
.type parallel_sum__memory_aug_recurrent_mem_tr__dense_activation_gelu__prompt_kernel,@function
parallel_sum__memory_aug_recurrent_mem_tr__dense_activation_gelu__prompt_kernel:
s_cmp_ge_u32 s2, 256
s_cbranch_scc1 L_end
s_load_dwordx4 s[72:75], s[0:1], 104
s_getreg_b32 s14, hwreg(HW_REG_XCC_ID, 0, 4)
v_lshrrev_b32 v1, 6, v0
v_and_b32 v0, 63, v0
v_readfirstlane_b32 s12, v1
s_waitcnt lgkmcnt(0)
s_mov_b32 s4, s74
s_mov_b32 s5, s75
s_mov_b32 s6, 268435456
s_mov_b32 s7, 0x20000
s_mov_b32 s8, s72
s_mov_b32 s9, s73
s_mov_b32 s10, 256
s_mov_b32 s11, 0x20000
s_cmp_lg_u32 s12, 0
s_cbranch_scc1 L_tk
s_and_b32 s35, s14, 7
s_lshl_b32 s35, s35, 2
s_lshr_b32 s35, 0x76541302, s35
s_and_b32 s35, s35, 7
s_cmp_lt_u32 s35, 2
s_cbranch_scc1 L_tk0
s_sleep 28
s_cmp_lt_u32 s35, 5
s_cbranch_scc1 L_tk0
s_cmp_eq_u32 s35, 6
s_cbranch_scc1 L_tk0
s_sleep 12
L_tk0:
v_mov_b32 v1, 1
s_lshl_b32 s35, s14, 2
s_mov_b64 exec, 1
buffer_atomic_add v1, off, s[8:11], s35 sc0 sc1
s_waitcnt vmcnt(0)
v_readfirstlane_b32 s13, v1
s_mov_b64 exec, -1
s_lshl_b32 s3, s14, 5
s_add_u32 s3, s3, s13
s_cmp_ge_u32 s14, 8
s_cbranch_scc1 L_over
s_cmp_lt_u32 s13, 32
s_cbranch_scc1 L_have
L_over:
v_mov_b32 v1, 1
s_mov_b64 exec, 1
buffer_atomic_add v1, off, s[8:11], 0 offset:64 sc0 sc1
s_waitcnt vmcnt(0)
v_readfirstlane_b32 s39, v1
s_mov_b64 exec, -1
v_lshlrev_b32 v2, 2, v0
s_mov_b32 s38, 0
L_over_w:
buffer_load_dword v1, v2, s[8:11], 0 offen sc1
s_add_u32 s38, s38, 1
s_cmp_ge_u32 s38, 524288
s_cbranch_scc1 L_err
s_waitcnt vmcnt(0)
s_mov_b32 s35, 0
v_readlane_b32 s36, v1, 0
s_nop 0
s_add_u32 s35, s35, s36
v_readlane_b32 s36, v1, 1
s_nop 0
s_add_u32 s35, s35, s36
v_readlane_b32 s36, v1, 2
s_nop 0
s_add_u32 s35, s35, s36
v_readlane_b32 s36, v1, 3
s_nop 0
s_add_u32 s35, s35, s36
v_readlane_b32 s36, v1, 4
s_nop 0
s_add_u32 s35, s35, s36
v_readlane_b32 s36, v1, 5
s_nop 0
s_add_u32 s35, s35, s36
v_readlane_b32 s36, v1, 6
s_nop 0
s_add_u32 s35, s35, s36
v_readlane_b32 s36, v1, 7
s_nop 0
s_add_u32 s35, s35, s36
v_readlane_b32 s36, v1, 8
s_nop 0
s_add_u32 s35, s35, s36
v_readlane_b32 s36, v1, 9
s_nop 0
s_add_u32 s35, s35, s36
v_readlane_b32 s36, v1, 10
s_nop 0
s_add_u32 s35, s35, s36
v_readlane_b32 s36, v1, 11
s_nop 0
s_add_u32 s35, s35, s36
v_readlane_b32 s36, v1, 12
s_nop 0
s_add_u32 s35, s35, s36
v_readlane_b32 s36, v1, 13
s_nop 0
s_add_u32 s35, s35, s36
v_readlane_b32 s36, v1, 14
s_nop 0
s_add_u32 s35, s35, s36
v_readlane_b32 s36, v1, 15
s_nop 0
s_add_u32 s35, s35, s36
s_cmp_lt_u32 s35, 256
s_cbranch_scc1 L_over_w
v_readlane_b32 s36, v1, 0
s_nop 0
s_min_u32 s36, s36, 32
s_add_u32 s35, s36, s39
s_add_u32 s3, s35, 0
s_cmp_lt_u32 s35, 32
s_cbranch_scc1 L_over_f
s_sub_u32 s39, s35, 32
v_readlane_b32 s36, v1, 1
s_nop 0
s_min_u32 s36, s36, 32
s_add_u32 s35, s36, s39
s_add_u32 s3, s35, 32
s_cmp_lt_u32 s35, 32
s_cbranch_scc1 L_over_f
s_sub_u32 s39, s35, 32
v_readlane_b32 s36, v1, 2
s_nop 0
s_min_u32 s36, s36, 32
s_add_u32 s35, s36, s39
s_add_u32 s3, s35, 64
s_cmp_lt_u32 s35, 32
s_cbranch_scc1 L_over_f
s_sub_u32 s39, s35, 32
v_readlane_b32 s36, v1, 3
s_nop 0
s_min_u32 s36, s36, 32
s_add_u32 s35, s36, s39
s_add_u32 s3, s35, 96
s_cmp_lt_u32 s35, 32
s_cbranch_scc1 L_over_f
s_sub_u32 s39, s35, 32
v_readlane_b32 s36, v1, 4
s_nop 0
s_min_u32 s36, s36, 32
s_add_u32 s35, s36, s39
s_add_u32 s3, s35, 128
s_cmp_lt_u32 s35, 32
s_cbranch_scc1 L_over_f
s_sub_u32 s39, s35, 32
v_readlane_b32 s36, v1, 5
s_nop 0
s_min_u32 s36, s36, 32
s_add_u32 s35, s36, s39
s_add_u32 s3, s35, 160
s_cmp_lt_u32 s35, 32
s_cbranch_scc1 L_over_f
s_sub_u32 s39, s35, 32
v_readlane_b32 s36, v1, 6
s_nop 0
s_min_u32 s36, s36, 32
s_add_u32 s35, s36, s39
s_add_u32 s3, s35, 192
s_cmp_lt_u32 s35, 32
s_cbranch_scc1 L_over_f
s_sub_u32 s39, s35, 32
v_readlane_b32 s36, v1, 7
s_nop 0
s_min_u32 s36, s36, 32
s_add_u32 s35, s36, s39
s_add_u32 s3, s35, 224
s_cmp_lt_u32 s35, 32
s_cbranch_scc1 L_over_f
s_sub_u32 s39, s35, 32
s_mov_b32 s3, -1
s_branch L_have
L_over_f:
s_lshr_b32 s35, s3, 5
s_lshl_b32 s35, s35, 2
s_lshr_b32 s35, 0x76541302, s35
s_and_b32 s35, s35, 7
s_cmp_ge_u32 s35, 2
s_cbranch_scc1 L_have
v_mov_b32 v1, 1
s_mov_b64 exec, 1
buffer_atomic_or v1, off, s[8:11], 0 offset:140 sc1
s_waitcnt vmcnt(0)
s_mov_b64 exec, -1
L_have:
v_mov_b32 v1, s3
v_mov_b32 v2, 0
ds_write_b32 v2, v1
s_waitcnt lgkmcnt(0)
L_tk:
s_barrier
v_mov_b32 v2, 0
ds_read_b32 v1, v2
s_waitcnt lgkmcnt(0)
v_readfirstlane_b32 s3, v1
s_barrier
s_cmp_ge_u32 s3, 256
s_cbranch_scc1 L_err
s_lshr_b32 s14, s3, 5
s_and_b32 s13, s3, 31
s_lshl_b32 s35, s14, 2
s_lshr_b32 s14, 0x76541302, s35
s_and_b32 s14, s14, 7
s_lshl_b32 s3, s14, 5
s_add_u32 s3, s3, s13
s_cmp_lt_u32 s14, 2
s_cbranch_scc1 L_role_chain
s_cmp_ge_u32 s14, 4
s_cbranch_scc1 L_role_47
s_sub_u32 s14, s14, 2
s_lshl_b32 s16, s13, 1
s_add_u32 s16, s16, s14
s_load_dwordx2 s[80:81], s[0:1], 0
s_waitcnt lgkmcnt(0)
s_mov_b32 s82, 2621440
s_mov_b32 s83, 0x20000
v_bfe_u32 v2, v0, 0, 5
v_mul_u32_u24 v1, 1280, v2
v_bfe_u32 v2, v0, 5, 1
v_mul_u32_u24 v2, 16, v2
v_add_u32 v1, v1, v2
s_mul_i32 s35, s16, 40960
s_mul_i32 s36, s12, 320
s_add_u32 s35, s35, s36
buffer_load_dwordx4 v[8:11], v1, s[80:83], s35 offen offset:0
buffer_load_dwordx4 v[12:15], v1, s[80:83], s35 offen offset:32
buffer_load_dwordx4 v[16:19], v1, s[80:83], s35 offen offset:64
buffer_load_dwordx4 v[20:23], v1, s[80:83], s35 offen offset:96
buffer_load_dwordx4 v[24:27], v1, s[80:83], s35 offen offset:128
buffer_load_dwordx4 v[28:31], v1, s[80:83], s35 offen offset:160
buffer_load_dwordx4 v[32:35], v1, s[80:83], s35 offen offset:192
buffer_load_dwordx4 v[36:39], v1, s[80:83], s35 offen offset:224
buffer_load_dwordx4 v[40:43], v1, s[80:83], s35 offen offset:256
buffer_load_dwordx4 v[44:47], v1, s[80:83], s35 offen offset:288
v_and_b32 v2, 31, v0
v_lshlrev_b32 v3, 4, v2
s_lshl_b32 s36, s12, 2
v_add_u32 v2, s36, v3
s_waitcnt vmcnt(9)
v_lshlrev_b32 v48, 16, v8
v_and_b32 v49, 0xffff0000, v8
v_lshlrev_b32 v50, 16, v9
v_and_b32 v51, 0xffff0000, v9
v_lshlrev_b32 v52, 16, v10
v_and_b32 v53, 0xffff0000, v10
v_lshlrev_b32 v54, 16, v11
v_and_b32 v55, 0xffff0000, v11
s_waitcnt vmcnt(8)
v_lshlrev_b32 v56, 16, v12
v_and_b32 v57, 0xffff0000, v12
v_lshlrev_b32 v58, 16, v13
v_and_b32 v59, 0xffff0000, v13
v_lshlrev_b32 v60, 16, v14
v_and_b32 v61, 0xffff0000, v14
v_lshlrev_b32 v62, 16, v15
v_and_b32 v63, 0xffff0000, v15
s_waitcnt vmcnt(7)
v_lshlrev_b32 v64, 16, v16
v_and_b32 v65, 0xffff0000, v16
v_lshlrev_b32 v66, 16, v17
v_and_b32 v67, 0xffff0000, v17
v_lshlrev_b32 v68, 16, v18
v_and_b32 v69, 0xffff0000, v18
v_lshlrev_b32 v70, 16, v19
v_and_b32 v71, 0xffff0000, v19
s_waitcnt vmcnt(6)
v_lshlrev_b32 v72, 16, v20
v_and_b32 v73, 0xffff0000, v20
v_lshlrev_b32 v74, 16, v21
v_and_b32 v75, 0xffff0000, v21
v_lshlrev_b32 v76, 16, v22
v_and_b32 v77, 0xffff0000, v22
v_lshlrev_b32 v78, 16, v23
v_and_b32 v79, 0xffff0000, v23
s_waitcnt vmcnt(5)
v_lshlrev_b32 v80, 16, v24
v_and_b32 v81, 0xffff0000, v24
v_lshlrev_b32 v82, 16, v25
v_and_b32 v83, 0xffff0000, v25
v_lshlrev_b32 v84, 16, v26
v_and_b32 v85, 0xffff0000, v26
v_lshlrev_b32 v86, 16, v27
v_and_b32 v87, 0xffff0000, v27
s_waitcnt vmcnt(4)
v_lshlrev_b32 v88, 16, v28
v_and_b32 v89, 0xffff0000, v28
v_lshlrev_b32 v90, 16, v29
v_and_b32 v91, 0xffff0000, v29
v_lshlrev_b32 v92, 16, v30
v_and_b32 v93, 0xffff0000, v30
v_lshlrev_b32 v94, 16, v31
v_and_b32 v95, 0xffff0000, v31
s_waitcnt vmcnt(3)
v_lshlrev_b32 v96, 16, v32
v_and_b32 v97, 0xffff0000, v32
v_lshlrev_b32 v98, 16, v33
v_and_b32 v99, 0xffff0000, v33
v_lshlrev_b32 v100, 16, v34
v_and_b32 v101, 0xffff0000, v34
v_lshlrev_b32 v102, 16, v35
v_and_b32 v103, 0xffff0000, v35
s_waitcnt vmcnt(2)
v_lshlrev_b32 v104, 16, v36
v_and_b32 v105, 0xffff0000, v36
v_lshlrev_b32 v106, 16, v37
v_and_b32 v107, 0xffff0000, v37
v_lshlrev_b32 v108, 16, v38
v_and_b32 v109, 0xffff0000, v38
v_lshlrev_b32 v110, 16, v39
v_and_b32 v111, 0xffff0000, v39
s_waitcnt vmcnt(1)
v_lshlrev_b32 v112, 16, v40
v_and_b32 v113, 0xffff0000, v40
v_lshlrev_b32 v114, 16, v41
v_and_b32 v115, 0xffff0000, v41
v_lshlrev_b32 v116, 16, v42
v_and_b32 v117, 0xffff0000, v42
v_lshlrev_b32 v118, 16, v43
v_and_b32 v119, 0xffff0000, v43
s_waitcnt vmcnt(0)
v_lshlrev_b32 v120, 16, v44
v_and_b32 v121, 0xffff0000, v44
v_lshlrev_b32 v122, 16, v45
v_and_b32 v123, 0xffff0000, v45
v_lshlrev_b32 v124, 16, v46
v_and_b32 v125, 0xffff0000, v46
v_lshlrev_b32 v126, 16, v47
v_and_b32 v127, 0xffff0000, v47
v_pk_add_f32 v[4:5], v[48:49], v[50:51]
v_pk_add_f32 v[4:5], v[4:5], v[52:53]
v_pk_add_f32 v[4:5], v[4:5], v[54:55]
v_pk_add_f32 v[4:5], v[4:5], v[56:57]
v_pk_add_f32 v[4:5], v[4:5], v[58:59]
v_pk_add_f32 v[4:5], v[4:5], v[60:61]
v_pk_add_f32 v[4:5], v[4:5], v[62:63]
v_pk_add_f32 v[4:5], v[4:5], v[64:65]
v_pk_add_f32 v[4:5], v[4:5], v[66:67]
v_pk_add_f32 v[4:5], v[4:5], v[68:69]
v_pk_add_f32 v[4:5], v[4:5], v[70:71]
v_pk_add_f32 v[4:5], v[4:5], v[72:73]
v_pk_add_f32 v[4:5], v[4:5], v[74:75]
v_pk_add_f32 v[4:5], v[4:5], v[76:77]
v_pk_add_f32 v[4:5], v[4:5], v[78:79]
v_pk_add_f32 v[4:5], v[4:5], v[80:81]
v_pk_add_f32 v[4:5], v[4:5], v[82:83]
v_pk_add_f32 v[4:5], v[4:5], v[84:85]
v_pk_add_f32 v[4:5], v[4:5], v[86:87]
v_pk_add_f32 v[4:5], v[4:5], v[88:89]
v_pk_add_f32 v[4:5], v[4:5], v[90:91]
v_pk_add_f32 v[4:5], v[4:5], v[92:93]
v_pk_add_f32 v[4:5], v[4:5], v[94:95]
v_pk_add_f32 v[4:5], v[4:5], v[96:97]
v_pk_add_f32 v[4:5], v[4:5], v[98:99]
v_pk_add_f32 v[4:5], v[4:5], v[100:101]
v_pk_add_f32 v[4:5], v[4:5], v[102:103]
v_pk_add_f32 v[4:5], v[4:5], v[104:105]
v_pk_add_f32 v[4:5], v[4:5], v[106:107]
v_pk_add_f32 v[4:5], v[4:5], v[108:109]
v_pk_add_f32 v[4:5], v[4:5], v[110:111]
v_pk_add_f32 v[4:5], v[4:5], v[112:113]
v_pk_add_f32 v[4:5], v[4:5], v[114:115]
v_pk_add_f32 v[4:5], v[4:5], v[116:117]
v_pk_add_f32 v[4:5], v[4:5], v[118:119]
v_pk_add_f32 v[4:5], v[4:5], v[120:121]
v_pk_add_f32 v[4:5], v[4:5], v[122:123]
v_pk_add_f32 v[4:5], v[4:5], v[124:125]
v_pk_add_f32 v[4:5], v[4:5], v[126:127]
v_add_f32 v4, v4, v5
v_mov_b32 v5, v4
s_nop 1
v_permlane32_swap_b32 v4, v5
v_add_f32 v4, v4, v5
ds_write_b32 v2, v4 offset:0
s_waitcnt lgkmcnt(0)
s_barrier
ds_read_b128 v[4:7], v3 offset:0
s_waitcnt lgkmcnt(0)
v_add_f32 v4, v4, v5
v_add_f32 v6, v6, v7
v_add_f32 v4, v4, v6
v_mul_f32 v4, 0x3acccccd, v4
v_sub_f32 v128, 0, v4
v_mov_b32 v129, v128
v_cvt_pk_bf16_f32 v130, v128, v128
v_and_b32 v130, 0xffff0000, v130
v_mov_b32 v131, v130
v_mov_b32 v4, 0
v_mov_b32 v5, 0
v_pk_add_f32 v[6:7], v[48:49], v[128:129]
v_pk_fma_f32 v[4:5], v[6:7], v[6:7], v[4:5]
v_pk_add_f32 v[6:7], v[50:51], v[128:129]
v_pk_fma_f32 v[4:5], v[6:7], v[6:7], v[4:5]
v_pk_add_f32 v[6:7], v[52:53], v[128:129]
v_pk_fma_f32 v[4:5], v[6:7], v[6:7], v[4:5]
v_pk_add_f32 v[6:7], v[54:55], v[128:129]
v_pk_fma_f32 v[4:5], v[6:7], v[6:7], v[4:5]
v_pk_add_f32 v[6:7], v[56:57], v[128:129]
v_pk_fma_f32 v[4:5], v[6:7], v[6:7], v[4:5]
v_pk_add_f32 v[6:7], v[58:59], v[128:129]
v_pk_fma_f32 v[4:5], v[6:7], v[6:7], v[4:5]
v_pk_add_f32 v[6:7], v[60:61], v[128:129]
v_pk_fma_f32 v[4:5], v[6:7], v[6:7], v[4:5]
v_pk_add_f32 v[6:7], v[62:63], v[128:129]
v_pk_fma_f32 v[4:5], v[6:7], v[6:7], v[4:5]
v_pk_add_f32 v[6:7], v[64:65], v[128:129]
v_pk_fma_f32 v[4:5], v[6:7], v[6:7], v[4:5]
v_pk_add_f32 v[6:7], v[66:67], v[128:129]
v_pk_fma_f32 v[4:5], v[6:7], v[6:7], v[4:5]
v_pk_add_f32 v[6:7], v[68:69], v[128:129]
v_pk_fma_f32 v[4:5], v[6:7], v[6:7], v[4:5]
v_pk_add_f32 v[6:7], v[70:71], v[128:129]
v_pk_fma_f32 v[4:5], v[6:7], v[6:7], v[4:5]
v_pk_add_f32 v[6:7], v[72:73], v[128:129]
v_pk_fma_f32 v[4:5], v[6:7], v[6:7], v[4:5]
v_pk_add_f32 v[6:7], v[74:75], v[128:129]
v_pk_fma_f32 v[4:5], v[6:7], v[6:7], v[4:5]
v_pk_add_f32 v[6:7], v[76:77], v[128:129]
v_pk_fma_f32 v[4:5], v[6:7], v[6:7], v[4:5]
v_pk_add_f32 v[6:7], v[78:79], v[128:129]
v_pk_fma_f32 v[4:5], v[6:7], v[6:7], v[4:5]
v_pk_add_f32 v[6:7], v[80:81], v[128:129]
v_pk_fma_f32 v[4:5], v[6:7], v[6:7], v[4:5]
v_pk_add_f32 v[6:7], v[82:83], v[128:129]
v_pk_fma_f32 v[4:5], v[6:7], v[6:7], v[4:5]
v_pk_add_f32 v[6:7], v[84:85], v[128:129]
v_pk_fma_f32 v[4:5], v[6:7], v[6:7], v[4:5]
v_pk_add_f32 v[6:7], v[86:87], v[128:129]
v_pk_fma_f32 v[4:5], v[6:7], v[6:7], v[4:5]
v_pk_add_f32 v[6:7], v[88:89], v[128:129]
v_pk_fma_f32 v[4:5], v[6:7], v[6:7], v[4:5]
v_pk_add_f32 v[6:7], v[90:91], v[128:129]
v_pk_fma_f32 v[4:5], v[6:7], v[6:7], v[4:5]
v_pk_add_f32 v[6:7], v[92:93], v[128:129]
v_pk_fma_f32 v[4:5], v[6:7], v[6:7], v[4:5]
v_pk_add_f32 v[6:7], v[94:95], v[128:129]
v_pk_fma_f32 v[4:5], v[6:7], v[6:7], v[4:5]
v_pk_add_f32 v[6:7], v[96:97], v[128:129]
v_pk_fma_f32 v[4:5], v[6:7], v[6:7], v[4:5]
v_pk_add_f32 v[6:7], v[98:99], v[128:129]
v_pk_fma_f32 v[4:5], v[6:7], v[6:7], v[4:5]
v_pk_add_f32 v[6:7], v[100:101], v[128:129]
v_pk_fma_f32 v[4:5], v[6:7], v[6:7], v[4:5]
v_pk_add_f32 v[6:7], v[102:103], v[128:129]
v_pk_fma_f32 v[4:5], v[6:7], v[6:7], v[4:5]
v_pk_add_f32 v[6:7], v[104:105], v[128:129]
v_pk_fma_f32 v[4:5], v[6:7], v[6:7], v[4:5]
v_pk_add_f32 v[6:7], v[106:107], v[128:129]
v_pk_fma_f32 v[4:5], v[6:7], v[6:7], v[4:5]
v_pk_add_f32 v[6:7], v[108:109], v[128:129]
v_pk_fma_f32 v[4:5], v[6:7], v[6:7], v[4:5]
v_pk_add_f32 v[6:7], v[110:111], v[128:129]
v_pk_fma_f32 v[4:5], v[6:7], v[6:7], v[4:5]
v_pk_add_f32 v[6:7], v[112:113], v[128:129]
v_pk_fma_f32 v[4:5], v[6:7], v[6:7], v[4:5]
v_pk_add_f32 v[6:7], v[114:115], v[128:129]
v_pk_fma_f32 v[4:5], v[6:7], v[6:7], v[4:5]
v_pk_add_f32 v[6:7], v[116:117], v[128:129]
v_pk_fma_f32 v[4:5], v[6:7], v[6:7], v[4:5]
v_pk_add_f32 v[6:7], v[118:119], v[128:129]
v_pk_fma_f32 v[4:5], v[6:7], v[6:7], v[4:5]
v_pk_add_f32 v[6:7], v[120:121], v[128:129]
v_pk_fma_f32 v[4:5], v[6:7], v[6:7], v[4:5]
v_pk_add_f32 v[6:7], v[122:123], v[128:129]
v_pk_fma_f32 v[4:5], v[6:7], v[6:7], v[4:5]
v_pk_add_f32 v[6:7], v[124:125], v[128:129]
v_pk_fma_f32 v[4:5], v[6:7], v[6:7], v[4:5]
v_pk_add_f32 v[6:7], v[126:127], v[128:129]
v_pk_fma_f32 v[4:5], v[6:7], v[6:7], v[4:5]
v_add_f32 v4, v4, v5
v_mov_b32 v5, v4
s_nop 1
v_permlane32_swap_b32 v4, v5
v_add_f32 v4, v4, v5
ds_write_b32 v2, v4 offset:512
s_waitcnt lgkmcnt(0)
s_barrier
ds_read_b128 v[4:7], v3 offset:512
s_waitcnt lgkmcnt(0)
v_add_f32 v4, v4, v5
v_add_f32 v6, v6, v7
v_add_f32 v4, v4, v6
v_mul_f32 v4, 0x3acccccd, v4
v_cvt_pk_bf16_f32 v4, v4, v4
v_and_b32 v4, 0xffff0000, v4
v_add_f32 v4, 0x3727c5ac, v4
v_cvt_pk_bf16_f32 v4, v4, v4
v_and_b32 v4, 0xffff0000, v4
v_sqrt_f32 v4, v4
s_nop 0
v_cvt_pk_bf16_f32 v4, v4, v4
v_and_b32 v4, 0xffff0000, v4
v_rcp_f32 v132, v4
s_nop 0
v_fma_f32 v5, -v4, v132, 1.0
v_fma_f32 v132, v5, v132, v132
v_mov_b32 v133, v132
s_mul_i32 s35, s16, 40960
s_mul_i32 s36, s12, 10240
s_add_u32 s35, s35, s36
s_add_u32 s35, s35, 109051904
v_lshlrev_b32 v1, 4, v0
v_pk_add_f32 v[48:49], v[48:49], v[130:131]
v_cvt_pk_bf16_f32 v6, v48, v49
v_lshlrev_b32 v48, 16, v6
v_and_b32 v49, 0xffff0000, v6
v_pk_mul_f32 v[48:49], v[48:49], v[132:133]
v_cvt_pk_bf16_f32 v8, v48, v49
v_pk_add_f32 v[50:51], v[50:51], v[130:131]
v_cvt_pk_bf16_f32 v6, v50, v51
v_lshlrev_b32 v50, 16, v6
v_and_b32 v51, 0xffff0000, v6
v_pk_mul_f32 v[50:51], v[50:51], v[132:133]
v_cvt_pk_bf16_f32 v9, v50, v51
v_pk_add_f32 v[52:53], v[52:53], v[130:131]
v_cvt_pk_bf16_f32 v6, v52, v53
v_lshlrev_b32 v52, 16, v6
v_and_b32 v53, 0xffff0000, v6
v_pk_mul_f32 v[52:53], v[52:53], v[132:133]
v_cvt_pk_bf16_f32 v10, v52, v53
v_pk_add_f32 v[54:55], v[54:55], v[130:131]
v_cvt_pk_bf16_f32 v6, v54, v55
v_lshlrev_b32 v54, 16, v6
v_and_b32 v55, 0xffff0000, v6
v_pk_mul_f32 v[54:55], v[54:55], v[132:133]
v_cvt_pk_bf16_f32 v11, v54, v55
buffer_store_dwordx4 v[8:11], v1, s[4:7], s35 offen offset:0 sc1
v_pk_add_f32 v[56:57], v[56:57], v[130:131]
v_cvt_pk_bf16_f32 v6, v56, v57
v_lshlrev_b32 v56, 16, v6
v_and_b32 v57, 0xffff0000, v6
v_pk_mul_f32 v[56:57], v[56:57], v[132:133]
v_cvt_pk_bf16_f32 v12, v56, v57
v_pk_add_f32 v[58:59], v[58:59], v[130:131]
v_cvt_pk_bf16_f32 v6, v58, v59
v_lshlrev_b32 v58, 16, v6
v_and_b32 v59, 0xffff0000, v6
v_pk_mul_f32 v[58:59], v[58:59], v[132:133]
v_cvt_pk_bf16_f32 v13, v58, v59
v_pk_add_f32 v[60:61], v[60:61], v[130:131]
v_cvt_pk_bf16_f32 v6, v60, v61
v_lshlrev_b32 v60, 16, v6
v_and_b32 v61, 0xffff0000, v6
v_pk_mul_f32 v[60:61], v[60:61], v[132:133]
v_cvt_pk_bf16_f32 v14, v60, v61
v_pk_add_f32 v[62:63], v[62:63], v[130:131]
v_cvt_pk_bf16_f32 v6, v62, v63
v_lshlrev_b32 v62, 16, v6
v_and_b32 v63, 0xffff0000, v6
v_pk_mul_f32 v[62:63], v[62:63], v[132:133]
v_cvt_pk_bf16_f32 v15, v62, v63
buffer_store_dwordx4 v[12:15], v1, s[4:7], s35 offen offset:1024 sc1
v_pk_add_f32 v[64:65], v[64:65], v[130:131]
v_cvt_pk_bf16_f32 v6, v64, v65
v_lshlrev_b32 v64, 16, v6
v_and_b32 v65, 0xffff0000, v6
v_pk_mul_f32 v[64:65], v[64:65], v[132:133]
v_cvt_pk_bf16_f32 v16, v64, v65
v_pk_add_f32 v[66:67], v[66:67], v[130:131]
v_cvt_pk_bf16_f32 v6, v66, v67
v_lshlrev_b32 v66, 16, v6
v_and_b32 v67, 0xffff0000, v6
v_pk_mul_f32 v[66:67], v[66:67], v[132:133]
v_cvt_pk_bf16_f32 v17, v66, v67
v_pk_add_f32 v[68:69], v[68:69], v[130:131]
v_cvt_pk_bf16_f32 v6, v68, v69
v_lshlrev_b32 v68, 16, v6
v_and_b32 v69, 0xffff0000, v6
v_pk_mul_f32 v[68:69], v[68:69], v[132:133]
v_cvt_pk_bf16_f32 v18, v68, v69
v_pk_add_f32 v[70:71], v[70:71], v[130:131]
v_cvt_pk_bf16_f32 v6, v70, v71
v_lshlrev_b32 v70, 16, v6
v_and_b32 v71, 0xffff0000, v6
v_pk_mul_f32 v[70:71], v[70:71], v[132:133]
v_cvt_pk_bf16_f32 v19, v70, v71
buffer_store_dwordx4 v[16:19], v1, s[4:7], s35 offen offset:2048 sc1
v_pk_add_f32 v[72:73], v[72:73], v[130:131]
v_cvt_pk_bf16_f32 v6, v72, v73
v_lshlrev_b32 v72, 16, v6
v_and_b32 v73, 0xffff0000, v6
v_pk_mul_f32 v[72:73], v[72:73], v[132:133]
v_cvt_pk_bf16_f32 v20, v72, v73
v_pk_add_f32 v[74:75], v[74:75], v[130:131]
v_cvt_pk_bf16_f32 v6, v74, v75
v_lshlrev_b32 v74, 16, v6
v_and_b32 v75, 0xffff0000, v6
v_pk_mul_f32 v[74:75], v[74:75], v[132:133]
v_cvt_pk_bf16_f32 v21, v74, v75
v_pk_add_f32 v[76:77], v[76:77], v[130:131]
v_cvt_pk_bf16_f32 v6, v76, v77
v_lshlrev_b32 v76, 16, v6
v_and_b32 v77, 0xffff0000, v6
v_pk_mul_f32 v[76:77], v[76:77], v[132:133]
v_cvt_pk_bf16_f32 v22, v76, v77
v_pk_add_f32 v[78:79], v[78:79], v[130:131]
v_cvt_pk_bf16_f32 v6, v78, v79
v_lshlrev_b32 v78, 16, v6
v_and_b32 v79, 0xffff0000, v6
v_pk_mul_f32 v[78:79], v[78:79], v[132:133]
v_cvt_pk_bf16_f32 v23, v78, v79
buffer_store_dwordx4 v[20:23], v1, s[4:7], s35 offen offset:3072 sc1
v_pk_add_f32 v[80:81], v[80:81], v[130:131]
v_cvt_pk_bf16_f32 v6, v80, v81
v_lshlrev_b32 v80, 16, v6
v_and_b32 v81, 0xffff0000, v6
v_pk_mul_f32 v[80:81], v[80:81], v[132:133]
v_cvt_pk_bf16_f32 v24, v80, v81
v_pk_add_f32 v[82:83], v[82:83], v[130:131]
v_cvt_pk_bf16_f32 v6, v82, v83
v_lshlrev_b32 v82, 16, v6
v_and_b32 v83, 0xffff0000, v6
v_pk_mul_f32 v[82:83], v[82:83], v[132:133]
v_cvt_pk_bf16_f32 v25, v82, v83
v_pk_add_f32 v[84:85], v[84:85], v[130:131]
v_cvt_pk_bf16_f32 v6, v84, v85
v_lshlrev_b32 v84, 16, v6
v_and_b32 v85, 0xffff0000, v6
v_pk_mul_f32 v[84:85], v[84:85], v[132:133]
v_cvt_pk_bf16_f32 v26, v84, v85
v_pk_add_f32 v[86:87], v[86:87], v[130:131]
v_cvt_pk_bf16_f32 v6, v86, v87
v_lshlrev_b32 v86, 16, v6
v_and_b32 v87, 0xffff0000, v6
v_pk_mul_f32 v[86:87], v[86:87], v[132:133]
v_cvt_pk_bf16_f32 v27, v86, v87
s_add_u32 s35, s35, 4096
buffer_store_dwordx4 v[24:27], v1, s[4:7], s35 offen offset:0 sc1
v_pk_add_f32 v[88:89], v[88:89], v[130:131]
v_cvt_pk_bf16_f32 v6, v88, v89
v_lshlrev_b32 v88, 16, v6
v_and_b32 v89, 0xffff0000, v6
v_pk_mul_f32 v[88:89], v[88:89], v[132:133]
v_cvt_pk_bf16_f32 v28, v88, v89
v_pk_add_f32 v[90:91], v[90:91], v[130:131]
v_cvt_pk_bf16_f32 v6, v90, v91
v_lshlrev_b32 v90, 16, v6
v_and_b32 v91, 0xffff0000, v6
v_pk_mul_f32 v[90:91], v[90:91], v[132:133]
v_cvt_pk_bf16_f32 v29, v90, v91
v_pk_add_f32 v[92:93], v[92:93], v[130:131]
v_cvt_pk_bf16_f32 v6, v92, v93
v_lshlrev_b32 v92, 16, v6
v_and_b32 v93, 0xffff0000, v6
v_pk_mul_f32 v[92:93], v[92:93], v[132:133]
v_cvt_pk_bf16_f32 v30, v92, v93
v_pk_add_f32 v[94:95], v[94:95], v[130:131]
v_cvt_pk_bf16_f32 v6, v94, v95
v_lshlrev_b32 v94, 16, v6
v_and_b32 v95, 0xffff0000, v6
v_pk_mul_f32 v[94:95], v[94:95], v[132:133]
v_cvt_pk_bf16_f32 v31, v94, v95
buffer_store_dwordx4 v[28:31], v1, s[4:7], s35 offen offset:1024 sc1
v_pk_add_f32 v[96:97], v[96:97], v[130:131]
v_cvt_pk_bf16_f32 v6, v96, v97
v_lshlrev_b32 v96, 16, v6
v_and_b32 v97, 0xffff0000, v6
v_pk_mul_f32 v[96:97], v[96:97], v[132:133]
v_cvt_pk_bf16_f32 v32, v96, v97
v_pk_add_f32 v[98:99], v[98:99], v[130:131]
v_cvt_pk_bf16_f32 v6, v98, v99
v_lshlrev_b32 v98, 16, v6
v_and_b32 v99, 0xffff0000, v6
v_pk_mul_f32 v[98:99], v[98:99], v[132:133]
v_cvt_pk_bf16_f32 v33, v98, v99
v_pk_add_f32 v[100:101], v[100:101], v[130:131]
v_cvt_pk_bf16_f32 v6, v100, v101
v_lshlrev_b32 v100, 16, v6
v_and_b32 v101, 0xffff0000, v6
v_pk_mul_f32 v[100:101], v[100:101], v[132:133]
v_cvt_pk_bf16_f32 v34, v100, v101
v_pk_add_f32 v[102:103], v[102:103], v[130:131]
v_cvt_pk_bf16_f32 v6, v102, v103
v_lshlrev_b32 v102, 16, v6
v_and_b32 v103, 0xffff0000, v6
v_pk_mul_f32 v[102:103], v[102:103], v[132:133]
v_cvt_pk_bf16_f32 v35, v102, v103
buffer_store_dwordx4 v[32:35], v1, s[4:7], s35 offen offset:2048 sc1
v_pk_add_f32 v[104:105], v[104:105], v[130:131]
v_cvt_pk_bf16_f32 v6, v104, v105
v_lshlrev_b32 v104, 16, v6
v_and_b32 v105, 0xffff0000, v6
v_pk_mul_f32 v[104:105], v[104:105], v[132:133]
v_cvt_pk_bf16_f32 v36, v104, v105
v_pk_add_f32 v[106:107], v[106:107], v[130:131]
v_cvt_pk_bf16_f32 v6, v106, v107
v_lshlrev_b32 v106, 16, v6
v_and_b32 v107, 0xffff0000, v6
v_pk_mul_f32 v[106:107], v[106:107], v[132:133]
v_cvt_pk_bf16_f32 v37, v106, v107
v_pk_add_f32 v[108:109], v[108:109], v[130:131]
v_cvt_pk_bf16_f32 v6, v108, v109
v_lshlrev_b32 v108, 16, v6
v_and_b32 v109, 0xffff0000, v6
v_pk_mul_f32 v[108:109], v[108:109], v[132:133]
v_cvt_pk_bf16_f32 v38, v108, v109
v_pk_add_f32 v[110:111], v[110:111], v[130:131]
v_cvt_pk_bf16_f32 v6, v110, v111
v_lshlrev_b32 v110, 16, v6
v_and_b32 v111, 0xffff0000, v6
v_pk_mul_f32 v[110:111], v[110:111], v[132:133]
v_cvt_pk_bf16_f32 v39, v110, v111
buffer_store_dwordx4 v[36:39], v1, s[4:7], s35 offen offset:3072 sc1
v_pk_add_f32 v[112:113], v[112:113], v[130:131]
v_cvt_pk_bf16_f32 v6, v112, v113
v_lshlrev_b32 v112, 16, v6
v_and_b32 v113, 0xffff0000, v6
v_pk_mul_f32 v[112:113], v[112:113], v[132:133]
v_cvt_pk_bf16_f32 v40, v112, v113
v_pk_add_f32 v[114:115], v[114:115], v[130:131]
v_cvt_pk_bf16_f32 v6, v114, v115
v_lshlrev_b32 v114, 16, v6
v_and_b32 v115, 0xffff0000, v6
v_pk_mul_f32 v[114:115], v[114:115], v[132:133]
v_cvt_pk_bf16_f32 v41, v114, v115
v_pk_add_f32 v[116:117], v[116:117], v[130:131]
v_cvt_pk_bf16_f32 v6, v116, v117
v_lshlrev_b32 v116, 16, v6
v_and_b32 v117, 0xffff0000, v6
v_pk_mul_f32 v[116:117], v[116:117], v[132:133]
v_cvt_pk_bf16_f32 v42, v116, v117
v_pk_add_f32 v[118:119], v[118:119], v[130:131]
v_cvt_pk_bf16_f32 v6, v118, v119
v_lshlrev_b32 v118, 16, v6
v_and_b32 v119, 0xffff0000, v6
v_pk_mul_f32 v[118:119], v[118:119], v[132:133]
v_cvt_pk_bf16_f32 v43, v118, v119
s_add_u32 s35, s35, 4096
buffer_store_dwordx4 v[40:43], v1, s[4:7], s35 offen offset:0 sc1
v_pk_add_f32 v[120:121], v[120:121], v[130:131]
v_cvt_pk_bf16_f32 v6, v120, v121
v_lshlrev_b32 v120, 16, v6
v_and_b32 v121, 0xffff0000, v6
v_pk_mul_f32 v[120:121], v[120:121], v[132:133]
v_cvt_pk_bf16_f32 v44, v120, v121
v_pk_add_f32 v[122:123], v[122:123], v[130:131]
v_cvt_pk_bf16_f32 v6, v122, v123
v_lshlrev_b32 v122, 16, v6
v_and_b32 v123, 0xffff0000, v6
v_pk_mul_f32 v[122:123], v[122:123], v[132:133]
v_cvt_pk_bf16_f32 v45, v122, v123
v_pk_add_f32 v[124:125], v[124:125], v[130:131]
v_cvt_pk_bf16_f32 v6, v124, v125
v_lshlrev_b32 v124, 16, v6
v_and_b32 v125, 0xffff0000, v6
v_pk_mul_f32 v[124:125], v[124:125], v[132:133]
v_cvt_pk_bf16_f32 v46, v124, v125
v_pk_add_f32 v[126:127], v[126:127], v[130:131]
v_cvt_pk_bf16_f32 v6, v126, v127
v_lshlrev_b32 v126, 16, v6
v_and_b32 v127, 0xffff0000, v6
v_pk_mul_f32 v[126:127], v[126:127], v[132:133]
v_cvt_pk_bf16_f32 v47, v126, v127
buffer_store_dwordx4 v[44:47], v1, s[4:7], s35 offen offset:1024 sc1
s_waitcnt vmcnt(0)
s_barrier
s_mov_b32 s38, 0
L_ww_lnclr:
buffer_load_dword v4, off, s[8:11], 0 offset:128 sc1
s_add_u32 s38, s38, 1
s_cmp_ge_u32 s38, 524288
s_cbranch_scc1 L_err
s_waitcnt vmcnt(0)
v_cmp_gt_u32 vcc, 1, v4
s_cbranch_vccz L_ww_lnclr_ok
s_sleep 4
s_branch L_ww_lnclr
L_ww_lnclr_ok:
s_cmp_eq_u32 s12, 0
s_cbranch_scc0 L_ln_nf
s_lshl_b32 s35, s16, 7
s_add_u32 s35, s35, 1589248
v_mov_b32 v4, 1
s_mov_b64 exec, 1
buffer_store_dword v4, off, s[4:7], s35 sc1
s_mov_b64 exec, -1
L_ln_nf:
s_cmp_ge_u32 s13, 16
s_cbranch_scc1 L_done
s_lshr_b32 s35, s13, 3
s_lshl_b32 s35, s35, 1
s_add_u32 s14, s14, s35
s_and_b32 s13, s13, 7
s_lshl_b32 s16, s13, 2
s_add_u32 s16, s16, s12
s_lshl_b32 s35, s14, 5
s_add_u32 s35, s35, s16
s_lshl_b32 s18, s35, 14
s_add_u32 s18, s18, 16777216
s_lshl_b32 s19, s35, 13
s_lshl_b32 s20, s35, 12
s_add_u32 s20, s20, 50331648
s_add_u32 s21, s19, 83886080
s_add_u32 s19, s19, 67108864
s_and_b32 s36, s14, 1
s_lshl_b32 s36, s36, 4
s_lshl_b32 s22, s16, 7
s_add_u32 s22, s22, s36
s_add_u32 s22, s22, 1572864
s_lshr_b32 s23, s16, 1
s_lshl_b32 s23, s23, 7
s_add_u32 s23, s23, 1576960
s_lshl_b32 s24, s16, 8
s_add_u32 s24, s24, 1581056
s_lshl_b32 s25, s14, 7
s_lshl_b32 s36, s16, 2
s_add_u32 s25, s25, s36
s_add_u32 s25, s25, 1579264
s_mov_b32 s26, 0
s_mov_b32 s27, 0
s_mov_b32 s17, 0
s_mov_b32 s29, 0x3e0293ee
v_lshlrev_b32 v1, 4, v0
v_lshlrev_b32 v2, 2, v0
v_lshlrev_b32 v3, 7, v0
v_and_b32 v6, 31, v0
v_bfe_u32 v7, v0, 5, 1
v_lshlrev_b32 v7, 2, v7
v_add_u32 v8, 0, v7
v_cmp_le_u32 s[48:49], v8, v6
v_add_u32 v8, 1, v7
v_cmp_le_u32 s[50:51], v8, v6
v_add_u32 v8, 2, v7
v_cmp_le_u32 s[52:53], v8, v6
v_add_u32 v8, 3, v7
v_cmp_le_u32 s[54:55], v8, v6
v_add_u32 v8, 8, v7
v_cmp_le_u32 s[56:57], v8, v6
v_add_u32 v8, 9, v7
v_cmp_le_u32 s[58:59], v8, v6
v_add_u32 v8, 10, v7
v_cmp_le_u32 s[60:61], v8, v6
v_add_u32 v8, 11, v7
v_cmp_le_u32 s[62:63], v8, v6
v_add_u32 v8, 16, v7
v_cmp_le_u32 s[64:65], v8, v6
v_add_u32 v8, 17, v7
v_cmp_le_u32 s[66:67], v8, v6
v_add_u32 v8, 18, v7
v_cmp_le_u32 s[68:69], v8, v6
v_add_u32 v8, 19, v7
v_cmp_le_u32 s[70:71], v8, v6
v_add_u32 v8, 24, v7
v_cmp_le_u32 s[72:73], v8, v6
v_add_u32 v8, 25, v7
v_cmp_le_u32 s[74:75], v8, v6
v_add_u32 v8, 26, v7
v_cmp_le_u32 s[76:77], v8, v6
v_add_u32 v8, 27, v7
v_cmp_le_u32 s[78:79], v8, v6
v_bfe_u32 v8, v0, 0, 4
v_mul_u32_u24 v253, 16, v8
v_bfe_u32 v8, v0, 4, 2
v_mul_u32_u24 v8, 4, v8
v_add_u32 v253, v253, v8
v_bfe_u32 v8, v0, 5, 1
v_mul_u32_u24 v4, 64, v8
v_bfe_u32 v8, v0, 2, 2
v_mul_u32_u24 v8, 16, v8
v_add_u32 v4, v4, v8
v_bfe_u32 v8, v0, 0, 1
v_mul_u32_u24 v8, 8, v8
v_add_u32 v4, v4, v8
s_lshl_b32 s35, s12, 11
v_add_u32 v253, s35, v253
v_add_u32 v4, s35, v4
v_lshlrev_b32 v254, 3, v0
v_bfe_u32 v8, v0, 5, 1
v_mul_u32_u24 v5, 256, v8
v_bfe_u32 v8, v0, 0, 4
v_mul_u32_u24 v8, 8, v8
v_add_u32 v5, v5, v8
v_bfe_u32 v8, v0, 4, 1
v_mul_u32_u24 v8, 4, v8
v_add_u32 v5, v5, v8
s_mov_b32 s38, 0
L_ww_atclr:
buffer_load_dword v8, off, s[8:11], 0 offset:128 sc1
s_add_u32 s38, s38, 1
s_cmp_ge_u32 s38, 524288
s_cbranch_scc1 L_err
s_waitcnt vmcnt(0)
v_cmp_gt_u32 vcc, 1, v8
s_cbranch_vccz L_ww_atclr_ok
s_sleep 4
s_branch L_ww_atclr
L_ww_atclr_ok:
L_at_loop:
s_lshl_b32 s28, s17, 1
s_lshr_b32 s35, s14, 1
s_add_u32 s28, s28, s35
s_add_u32 s28, s28, 1
s_cmp_ge_u32 s26, s28
s_cbranch_scc1 L_wl_atkv_end
s_mov_b32 s38, 0
s_mov_b32 exec_lo, 0xf
s_mov_b32 exec_hi, 0
L_wl_atkv:
buffer_load_dword v252, v2, s[4:7], s22 offen sc1
s_add_u32 s38, s38, 1
s_cmp_ge_u32 s38, 524288
s_cbranch_scc1 L_err
s_waitcnt vmcnt(0)
v_cmp_gt_u32 vcc, s28, v252
s_cbranch_vccz L_wl_atkv_ok
s_sleep 2
s_branch L_wl_atkv
L_wl_atkv_ok:
v_cmp_gt_u32 vcc, 32, v252
s_nop 0
s_cmp_eq_u64 vcc, 0
s_cselect_b32 s26, 32, s26
s_mov_b64 exec, -1
L_wl_atkv_end:
s_lshl_b32 s28, s17, 2
s_add_u32 s28, s28, s14
s_cmp_gt_u32 s27, s28
s_cbranch_scc1 L_wp_atq_end
s_cmp_ge_u32 s28, 48
s_cselect_b32 s36, 16, 0
s_cselect_b32 s37, 48, 0
s_add_u32 s36, s36, s23
s_sub_u32 s37, s28, s37
s_mov_b32 s38, 0
s_mov_b32 exec_lo, 0xf
s_mov_b32 exec_hi, 0
L_wp_atq:
buffer_load_dword v252, v2, s[4:7], s36 offen sc1
s_add_u32 s38, s38, 1
s_cmp_ge_u32 s38, 524288
s_cbranch_scc1 L_err
s_waitcnt vmcnt(0)
v_cmp_ge_u32 vcc, s37, v252
s_cbranch_vccnz L_wp_atq
s_add_u32 s27, s28, 1
s_add_u32 s35, s37, 2
v_cmp_ge_u32 vcc, s35, v252
s_add_u32 s35, s28, 3
s_cmp_eq_u64 vcc, 0
s_cselect_b32 s27, s35, s27
s_add_u32 s35, s37, 4
v_cmp_ge_u32 vcc, s35, v252
s_add_u32 s35, s28, 5
s_cmp_eq_u64 vcc, 0
s_cselect_b32 s27, s35, s27
s_add_u32 s35, s37, 8
v_cmp_ge_u32 vcc, s35, v252
s_add_u32 s35, s28, 9
s_cmp_eq_u64 vcc, 0
s_cselect_b32 s27, s35, s27
s_mov_b64 exec, -1
L_wp_atq_end:
s_add_u32 s35, s19, 0
buffer_load_dwordx4 v[8:11], v1, s[4:7], s35 offen offset:0 sc1
buffer_load_dwordx4 v[12:15], v1, s[4:7], s35 offen offset:1024 sc1
buffer_load_dwordx4 v[16:19], v1, s[4:7], s35 offen offset:2048 sc1
buffer_load_dwordx4 v[20:23], v1, s[4:7], s35 offen offset:3072 sc1
s_add_u32 s35, s19, 4096
buffer_load_dwordx4 v[24:27], v1, s[4:7], s35 offen offset:0 sc1
buffer_load_dwordx4 v[28:31], v1, s[4:7], s35 offen offset:1024 sc1
buffer_load_dwordx4 v[32:35], v1, s[4:7], s35 offen offset:2048 sc1
buffer_load_dwordx4 v[36:39], v1, s[4:7], s35 offen offset:3072 sc1
s_add_u32 s35, s18, 0
buffer_load_dwordx4 v[40:43], v1, s[4:7], s35 offen offset:0 sc1
buffer_load_dwordx4 v[44:47], v1, s[4:7], s35 offen offset:1024 sc1
buffer_load_dwordx4 v[48:51], v1, s[4:7], s35 offen offset:2048 sc1
buffer_load_dwordx4 v[52:55], v1, s[4:7], s35 offen offset:3072 sc1
s_add_u32 s35, s18, 4096
buffer_load_dwordx4 v[56:59], v1, s[4:7], s35 offen offset:0 sc1
buffer_load_dwordx4 v[60:63], v1, s[4:7], s35 offen offset:1024 sc1
buffer_load_dwordx4 v[64:67], v1, s[4:7], s35 offen offset:2048 sc1
buffer_load_dwordx4 v[68:71], v1, s[4:7], s35 offen offset:3072 sc1
s_add_u32 s35, s18, 8192
buffer_load_dwordx4 v[72:75], v1, s[4:7], s35 offen offset:0 sc1
buffer_load_dwordx4 v[76:79], v1, s[4:7], s35 offen offset:1024 sc1
buffer_load_dwordx4 v[80:83], v1, s[4:7], s35 offen offset:2048 sc1
buffer_load_dwordx4 v[84:87], v1, s[4:7], s35 offen offset:3072 sc1
s_add_u32 s35, s18, 12288
buffer_load_dwordx4 v[88:91], v1, s[4:7], s35 offen offset:0 sc1
buffer_load_dwordx4 v[92:95], v1, s[4:7], s35 offen offset:1024 sc1
buffer_load_dwordx4 v[96:99], v1, s[4:7], s35 offen offset:2048 sc1
buffer_load_dwordx4 v[100:103], v1, s[4:7], s35 offen offset:3072 sc1
s_waitcnt vmcnt(15)
v_mfma_f32_32x32x16_bf16 v[144:159], v[40:43], v[8:11], 0
s_waitcnt vmcnt(14)
v_mfma_f32_32x32x16_bf16 v[144:159], v[44:47], v[12:15], v[144:159]
s_waitcnt vmcnt(13)
v_mfma_f32_32x32x16_bf16 v[144:159], v[48:51], v[16:19], v[144:159]
s_waitcnt vmcnt(12)
v_mfma_f32_32x32x16_bf16 v[144:159], v[52:55], v[20:23], v[144:159]
s_waitcnt vmcnt(11)
v_mfma_f32_32x32x16_bf16 v[144:159], v[56:59], v[24:27], v[144:159]
s_waitcnt vmcnt(10)
v_mfma_f32_32x32x16_bf16 v[144:159], v[60:63], v[28:31], v[144:159]
s_waitcnt vmcnt(9)
v_mfma_f32_32x32x16_bf16 v[144:159], v[64:67], v[32:35], v[144:159]
s_waitcnt vmcnt(8)
v_mfma_f32_32x32x16_bf16 v[144:159], v[68:71], v[36:39], v[144:159]
v_mov_b32 v250, 0xff800000
s_nop 10
v_cndmask_b32 v144, v250, v144, s[48:49]
v_cndmask_b32 v145, v250, v145, s[50:51]
v_cndmask_b32 v146, v250, v146, s[52:53]
v_cndmask_b32 v147, v250, v147, s[54:55]
v_cndmask_b32 v148, v250, v148, s[56:57]
v_cndmask_b32 v149, v250, v149, s[58:59]
v_cndmask_b32 v150, v250, v150, s[60:61]
v_cndmask_b32 v151, v250, v151, s[62:63]
v_cndmask_b32 v152, v250, v152, s[64:65]
v_cndmask_b32 v153, v250, v153, s[66:67]
v_cndmask_b32 v154, v250, v154, s[68:69]
v_cndmask_b32 v155, v250, v155, s[70:71]
v_cndmask_b32 v156, v250, v156, s[72:73]
v_cndmask_b32 v157, v250, v157, s[74:75]
v_cndmask_b32 v158, v250, v158, s[76:77]
v_cndmask_b32 v159, v250, v159, s[78:79]
v_max3_f32 v250, v144, v145, v146
v_max3_f32 v250, v250, v147, v148
v_max3_f32 v250, v250, v149, v150
v_max3_f32 v250, v250, v151, v152
v_max3_f32 v250, v250, v153, v154
v_max3_f32 v250, v250, v155, v156
v_max3_f32 v250, v250, v157, v158
v_max_f32 v250, v250, v159
v_mov_b32 v6, v250
s_nop 1
v_permlane32_swap_b32 v250, v6
v_max_f32 v250, v250, v6
v_mul_f32 v250, s29, v250
v_fma_f32 v144, v144, s29, -v250
v_fma_f32 v145, v145, s29, -v250
v_fma_f32 v146, v146, s29, -v250
v_fma_f32 v147, v147, s29, -v250
v_fma_f32 v148, v148, s29, -v250
v_fma_f32 v149, v149, s29, -v250
v_fma_f32 v150, v150, s29, -v250
v_fma_f32 v151, v151, s29, -v250
v_fma_f32 v152, v152, s29, -v250
v_fma_f32 v153, v153, s29, -v250
v_fma_f32 v154, v154, s29, -v250
v_fma_f32 v155, v155, s29, -v250
v_fma_f32 v156, v156, s29, -v250
v_fma_f32 v157, v157, s29, -v250
v_fma_f32 v158, v158, s29, -v250
v_fma_f32 v159, v159, s29, -v250
v_exp_f32 v144, v144
v_exp_f32 v145, v145
v_exp_f32 v146, v146
v_exp_f32 v147, v147
v_exp_f32 v148, v148
v_exp_f32 v149, v149
v_exp_f32 v150, v150
v_exp_f32 v151, v151
v_exp_f32 v152, v152
v_exp_f32 v153, v153
v_exp_f32 v154, v154
v_exp_f32 v155, v155
v_exp_f32 v156, v156
v_exp_f32 v157, v157
v_exp_f32 v158, v158
v_exp_f32 v159, v159
v_add_f32 v251, v144, v145
v_add_f32 v251, v251, v146
v_add_f32 v251, v251, v147
v_add_f32 v251, v251, v148
v_add_f32 v251, v251, v149
v_add_f32 v251, v251, v150
v_add_f32 v251, v251, v151
v_add_f32 v251, v251, v152
v_add_f32 v251, v251, v153
v_add_f32 v251, v251, v154
v_add_f32 v251, v251, v155
v_add_f32 v251, v251, v156
v_add_f32 v251, v251, v157
v_add_f32 v251, v251, v158
v_add_f32 v251, v251, v159
v_cvt_pk_bf16_f32 v240, v144, v145
v_cvt_pk_bf16_f32 v241, v146, v147
v_cvt_pk_bf16_f32 v242, v148, v149
v_cvt_pk_bf16_f32 v243, v150, v151
v_cvt_pk_bf16_f32 v244, v152, v153
v_cvt_pk_bf16_f32 v245, v154, v155
v_cvt_pk_bf16_f32 v246, v156, v157
v_cvt_pk_bf16_f32 v247, v158, v159
s_waitcnt vmcnt(0)
v_mfma_f32_32x32x16_bf16 v[176:191], v[72:75], v[240:243], 0
v_mfma_f32_32x32x16_bf16 v[176:191], v[76:79], v[244:247], v[176:191]
v_mfma_f32_32x32x16_bf16 v[192:207], v[80:83], v[240:243], 0
v_mfma_f32_32x32x16_bf16 v[192:207], v[84:87], v[244:247], v[192:207]
v_mfma_f32_32x32x16_bf16 v[208:223], v[88:91], v[240:243], 0
v_mfma_f32_32x32x16_bf16 v[208:223], v[92:95], v[244:247], v[208:223]
v_mfma_f32_32x32x16_bf16 v[224:239], v[96:99], v[240:243], 0
v_mfma_f32_32x32x16_bf16 v[224:239], v[100:103], v[244:247], v[224:239]
s_lshl_b32 s28, s17, 2
s_add_u32 s28, s28, s14
s_add_u32 s28, s28, 1
s_min_u32 s28, s28, 63
s_mov_b32 s38, 0
s_mov_b32 exec_lo, 0x3
s_mov_b32 exec_hi, 0
L_wl_atex:
buffer_load_dword v252, v3, s[4:7], s24 offen sc1
s_add_u32 s38, s38, 1
s_cmp_ge_u32 s38, 524288
s_cbranch_scc1 L_err
s_waitcnt vmcnt(0)
v_cmp_gt_u32 vcc, s28, v252
s_cbranch_vccz L_wl_atex_ok
s_sleep 2
s_branch L_wl_atex
L_wl_atex_ok:
s_mov_b64 exec, -1
L_wl_atex_end:
s_mov_b32 s38, 0
L_at_ex:
buffer_load_dwordx2 v[144:145], v254, s[4:7], s20 offen offset:0 sc1
buffer_load_dwordx2 v[146:147], v254, s[4:7], s20 offen offset:512 sc1
buffer_load_dwordx2 v[148:149], v254, s[4:7], s20 offen offset:1024 sc1
buffer_load_dwordx2 v[150:151], v254, s[4:7], s20 offen offset:1536 sc1
buffer_load_dword v136, v5, s[4:7], s20 offen offset:2048 sc1
buffer_load_dword v137, v5, s[4:7], s20 offen offset:2176 sc1
buffer_load_dword v138, v5, s[4:7], s20 offen offset:2560 sc1
buffer_load_dword v139, v5, s[4:7], s20 offen offset:2688 sc1
buffer_load_dword v140, v5, s[4:7], s20 offen offset:3072 sc1
buffer_load_dword v141, v5, s[4:7], s20 offen offset:3200 sc1
buffer_load_dword v142, v5, s[4:7], s20 offen offset:3584 sc1
buffer_load_dword v143, v5, s[4:7], s20 offen offset:3712 sc1
s_add_u32 s38, s38, 1
s_cmp_ge_u32 s38, 524288
s_cbranch_scc1 L_err
s_waitcnt vmcnt(8)
v_max3_u32 v6, v144, v145, v146
v_max3_u32 v6, v6, v147, v148
v_max3_u32 v6, v6, v149, v150
v_max_u32 v6, v6, v151
ds_write2_b32 v253, v144, v145 offset0:0 offset1:64
ds_write2_b32 v253, v146, v147 offset0:128 offset1:192
v_add_u32 v253, 1024, v253
ds_write2_b32 v253, v148, v149 offset0:0 offset1:64
ds_write2_b32 v253, v150, v151 offset0:128 offset1:192
v_subrev_u32 v253, 1024, v253
s_waitcnt vmcnt(0)
v_max3_u32 v6, v6, v136, v137
v_max3_u32 v6, v6, v138, v139
v_max3_u32 v6, v6, v140, v141
v_max3_u32 v6, v6, v142, v143
v_cmp_eq_u32 vcc, -1, v6
s_cbranch_vccnz L_at_ex
s_waitcnt lgkmcnt(0)
ds_read_b64_tr_b16 v[104:105], v4 offset:0
ds_read_b64_tr_b16 v[106:107], v4 offset:128
ds_read_b64_tr_b16 v[108:109], v4 offset:256
ds_read_b64_tr_b16 v[110:111], v4 offset:384
ds_read_b64_tr_b16 v[112:113], v4 offset:512
ds_read_b64_tr_b16 v[114:115], v4 offset:640
ds_read_b64_tr_b16 v[116:117], v4 offset:768
ds_read_b64_tr_b16 v[118:119], v4 offset:896
ds_read_b64_tr_b16 v[120:121], v4 offset:1024
ds_read_b64_tr_b16 v[122:123], v4 offset:1152
ds_read_b64_tr_b16 v[124:125], v4 offset:1280
ds_read_b64_tr_b16 v[126:127], v4 offset:1408
ds_read_b64_tr_b16 v[128:129], v4 offset:1536
ds_read_b64_tr_b16 v[130:131], v4 offset:1664
ds_read_b64_tr_b16 v[132:133], v4 offset:1792
ds_read_b64_tr_b16 v[134:135], v4 offset:1920
s_waitcnt lgkmcnt(14)
v_mfma_f32_32x32x16_bf16 v[160:175], v[104:107], v[8:11], 0
s_waitcnt lgkmcnt(12)
v_mfma_f32_32x32x16_bf16 v[160:175], v[108:111], v[12:15], v[160:175]
s_waitcnt lgkmcnt(10)
v_mfma_f32_32x32x16_bf16 v[160:175], v[112:115], v[16:19], v[160:175]
s_waitcnt lgkmcnt(8)
v_mfma_f32_32x32x16_bf16 v[160:175], v[116:119], v[20:23], v[160:175]
s_waitcnt lgkmcnt(6)
v_mfma_f32_32x32x16_bf16 v[160:175], v[120:123], v[24:27], v[160:175]
s_waitcnt lgkmcnt(4)
v_mfma_f32_32x32x16_bf16 v[160:175], v[124:127], v[28:31], v[160:175]
s_waitcnt lgkmcnt(2)
v_mfma_f32_32x32x16_bf16 v[160:175], v[128:131], v[32:35], v[160:175]
s_waitcnt lgkmcnt(0)
v_mfma_f32_32x32x16_bf16 v[160:175], v[132:135], v[36:39], v[160:175]
s_nop 11
v_max3_f32 v6, v160, v161, v162
v_max_f32 v6, v6, v163
v_mov_b32 v7, v6
s_nop 1
v_permlane32_swap_b32 v6, v7
v_max_f32 v6, v6, v7
v_mul_f32 v6, s29, v6
v_max_f32 v6, v6, v250
v_sub_f32 v250, v250, v6
v_exp_f32 v250, v250
v_fma_f32 v160, v160, s29, -v6
v_fma_f32 v161, v161, s29, -v6
v_fma_f32 v162, v162, s29, -v6
v_fma_f32 v163, v163, s29, -v6
v_exp_f32 v160, v160
v_exp_f32 v161, v161
v_exp_f32 v162, v162
v_exp_f32 v163, v163
v_mul_f32 v251, v251, v250
v_add_f32 v6, v160, v161
v_add_f32 v7, v162, v163
v_add_f32 v251, v251, v6
v_add_f32 v251, v251, v7
v_mov_b32 v6, v251
s_nop 1
v_permlane32_swap_b32 v251, v6
v_add_f32 v251, v251, v6
v_rcp_f32 v251, v251
s_nop 0
v_mul_f32 v160, v251, v160
v_mul_f32 v161, v251, v161
v_mul_f32 v162, v251, v162
v_mul_f32 v163, v251, v163
v_mul_f32 v250, v250, v251
v_cvt_pk_bf16_f32 v248, v160, v161
v_cvt_pk_bf16_f32 v249, v162, v163
v_pk_mul_f32 v[176:177], v[176:177], v[250:251] op_sel_hi:[1,0]
v_pk_mul_f32 v[178:179], v[178:179], v[250:251] op_sel_hi:[1,0]
v_pk_mul_f32 v[180:181], v[180:181], v[250:251] op_sel_hi:[1,0]
v_pk_mul_f32 v[182:183], v[182:183], v[250:251] op_sel_hi:[1,0]
v_pk_mul_f32 v[184:185], v[184:185], v[250:251] op_sel_hi:[1,0]
v_pk_mul_f32 v[186:187], v[186:187], v[250:251] op_sel_hi:[1,0]
v_pk_mul_f32 v[188:189], v[188:189], v[250:251] op_sel_hi:[1,0]
v_pk_mul_f32 v[190:191], v[190:191], v[250:251] op_sel_hi:[1,0]
s_nop 1
v_mfma_f32_32x32x8_bf16 v[176:191], v[136:137], v[248:249], v[176:191]
v_pk_mul_f32 v[192:193], v[192:193], v[250:251] op_sel_hi:[1,0]
v_pk_mul_f32 v[194:195], v[194:195], v[250:251] op_sel_hi:[1,0]
v_pk_mul_f32 v[196:197], v[196:197], v[250:251] op_sel_hi:[1,0]
v_pk_mul_f32 v[198:199], v[198:199], v[250:251] op_sel_hi:[1,0]
v_pk_mul_f32 v[200:201], v[200:201], v[250:251] op_sel_hi:[1,0]
v_pk_mul_f32 v[202:203], v[202:203], v[250:251] op_sel_hi:[1,0]
v_pk_mul_f32 v[204:205], v[204:205], v[250:251] op_sel_hi:[1,0]
v_pk_mul_f32 v[206:207], v[206:207], v[250:251] op_sel_hi:[1,0]
s_nop 1
v_mfma_f32_32x32x8_bf16 v[192:207], v[138:139], v[248:249], v[192:207]
v_pk_mul_f32 v[208:209], v[208:209], v[250:251] op_sel_hi:[1,0]
v_pk_mul_f32 v[210:211], v[210:211], v[250:251] op_sel_hi:[1,0]
v_pk_mul_f32 v[212:213], v[212:213], v[250:251] op_sel_hi:[1,0]
v_pk_mul_f32 v[214:215], v[214:215], v[250:251] op_sel_hi:[1,0]
v_pk_mul_f32 v[216:217], v[216:217], v[250:251] op_sel_hi:[1,0]
v_pk_mul_f32 v[218:219], v[218:219], v[250:251] op_sel_hi:[1,0]
v_pk_mul_f32 v[220:221], v[220:221], v[250:251] op_sel_hi:[1,0]
v_pk_mul_f32 v[222:223], v[222:223], v[250:251] op_sel_hi:[1,0]
s_nop 1
v_mfma_f32_32x32x8_bf16 v[208:223], v[140:141], v[248:249], v[208:223]
v_pk_mul_f32 v[224:225], v[224:225], v[250:251] op_sel_hi:[1,0]
v_pk_mul_f32 v[226:227], v[226:227], v[250:251] op_sel_hi:[1,0]
v_pk_mul_f32 v[228:229], v[228:229], v[250:251] op_sel_hi:[1,0]
v_pk_mul_f32 v[230:231], v[230:231], v[250:251] op_sel_hi:[1,0]
v_pk_mul_f32 v[232:233], v[232:233], v[250:251] op_sel_hi:[1,0]
v_pk_mul_f32 v[234:235], v[234:235], v[250:251] op_sel_hi:[1,0]
v_pk_mul_f32 v[236:237], v[236:237], v[250:251] op_sel_hi:[1,0]
v_pk_mul_f32 v[238:239], v[238:239], v[250:251] op_sel_hi:[1,0]
s_nop 1
v_mfma_f32_32x32x8_bf16 v[224:239], v[142:143], v[248:249], v[224:239]
v_cvt_pk_bf16_f32 v40, v176, v177
v_cvt_pk_bf16_f32 v41, v178, v179
v_cvt_pk_bf16_f32 v42, v180, v181
v_cvt_pk_bf16_f32 v43, v182, v183
s_add_u32 s35, s21, 0
buffer_store_dwordx4 v[40:43], v1, s[4:7], s35 offen offset:0 sc1
v_cvt_pk_bf16_f32 v44, v184, v185
v_cvt_pk_bf16_f32 v45, v186, v187
v_cvt_pk_bf16_f32 v46, v188, v189
v_cvt_pk_bf16_f32 v47, v190, v191
buffer_store_dwordx4 v[44:47], v1, s[4:7], s35 offen offset:1024 sc1
v_cvt_pk_bf16_f32 v48, v192, v193
v_cvt_pk_bf16_f32 v49, v194, v195
v_cvt_pk_bf16_f32 v50, v196, v197
v_cvt_pk_bf16_f32 v51, v198, v199
buffer_store_dwordx4 v[48:51], v1, s[4:7], s35 offen offset:2048 sc1
v_cvt_pk_bf16_f32 v52, v200, v201
v_cvt_pk_bf16_f32 v53, v202, v203
v_cvt_pk_bf16_f32 v54, v204, v205
v_cvt_pk_bf16_f32 v55, v206, v207
buffer_store_dwordx4 v[52:55], v1, s[4:7], s35 offen offset:3072 sc1
v_cvt_pk_bf16_f32 v56, v208, v209
v_cvt_pk_bf16_f32 v57, v210, v211
v_cvt_pk_bf16_f32 v58, v212, v213
v_cvt_pk_bf16_f32 v59, v214, v215
s_add_u32 s35, s21, 4096
buffer_store_dwordx4 v[56:59], v1, s[4:7], s35 offen offset:0 sc1
v_cvt_pk_bf16_f32 v60, v216, v217
v_cvt_pk_bf16_f32 v61, v218, v219
v_cvt_pk_bf16_f32 v62, v220, v221
v_cvt_pk_bf16_f32 v63, v222, v223
buffer_store_dwordx4 v[60:63], v1, s[4:7], s35 offen offset:1024 sc1
v_cvt_pk_bf16_f32 v64, v224, v225
v_cvt_pk_bf16_f32 v65, v226, v227
v_cvt_pk_bf16_f32 v66, v228, v229
v_cvt_pk_bf16_f32 v67, v230, v231
buffer_store_dwordx4 v[64:67], v1, s[4:7], s35 offen offset:2048 sc1
v_cvt_pk_bf16_f32 v68, v232, v233
v_cvt_pk_bf16_f32 v69, v234, v235
v_cvt_pk_bf16_f32 v70, v236, v237
v_cvt_pk_bf16_f32 v71, v238, v239
buffer_store_dwordx4 v[68:71], v1, s[4:7], s35 offen offset:3072 sc1
s_add_u32 s17, s17, 1
v_mov_b32 v252, s17
s_add_u32 s18, s18, 2097152
s_add_u32 s19, s19, 1048576
s_add_u32 s20, s20, 524288
s_add_u32 s21, s21, 1048576
s_waitcnt vmcnt(0)
s_mov_b64 exec, 1
buffer_store_dword v252, off, s[4:7], s25 sc1
s_mov_b64 exec, -1
s_cmp_lt_u32 s17, 16
s_cbranch_scc1 L_at_loop
s_waitcnt vmcnt(0)
s_branch L_done
L_role_47:
s_bitcmp0_b32 s14, 0
s_cbranch_scc1 L_role_kv
s_lshr_b32 s14, s14, 1
s_sub_u32 s14, s14, 2
s_cmp_lt_u32 s13, 20
s_cbranch_scc1 L_role_f2
s_sub_u32 s13, s13, 20
s_cmp_eq_u32 s14, 1
s_mov_b32 s14, 0
s_cbranch_scc1 L_role_q
s_cmp_lt_u32 s13, 7
s_cbranch_scc1 L_role_h
s_add_u32 s13, s13, 5
s_cmp_lt_u32 s13, 16
s_cbranch_scc1 L_role_q
v_mov_b64 v[4:5], 0
v_mov_b64 v[6:7], 0
v_lshlrev_b32 v1, 4, v0
s_lshl_b32 s35, s12, 10
s_add_u32 s35, s35, 1572864
buffer_store_dwordx4 v[4:7], v1, s[4:7], s35 offen sc1
s_add_u32 s35, s35, 4096
buffer_store_dwordx4 v[4:7], v1, s[4:7], s35 offen sc1
s_add_u32 s35, s35, 4096
buffer_store_dwordx4 v[4:7], v1, s[4:7], s35 offen sc1
s_add_u32 s35, s35, 4096
buffer_store_dwordx4 v[4:7], v1, s[4:7], s35 offen sc1
s_add_u32 s35, s35, 4096
buffer_store_dwordx4 v[4:7], v1, s[4:7], s35 offen sc1
s_add_u32 s35, s35, 4096
buffer_store_dwordx4 v[4:7], v1, s[4:7], s35 offen sc1
s_add_u32 s35, s35, 4096
s_waitcnt vmcnt(0)
s_barrier
s_cmp_eq_u32 s12, 0
s_cbranch_scc0 L_clrda
v_mov_b32 v1, 1
s_mov_b64 exec, 1
buffer_store_dword v1, off, s[8:11], 0 offset:128 sc1
s_mov_b64 exec, -1
L_clrda:
s_branch L_role_near
L_role_f2:
s_load_dwordx2 s[80:81], s[0:1], 40
s_waitcnt lgkmcnt(0)
s_mov_b32 s82, 5242880
s_mov_b32 s83, 0x20000
s_load_dwordx2 s[84:85], s[0:1], 80
s_waitcnt lgkmcnt(0)
s_mov_b32 s86, 2211840
s_mov_b32 s87, 0x20000
s_load_dwordx2 s[88:89], s[0:1], 0
s_waitcnt lgkmcnt(0)
s_mov_b32 s90, 2621440
s_mov_b32 s91, 0x20000
s_load_dwordx2 s[92:93], s[0:1], 96
s_waitcnt lgkmcnt(0)
s_mov_b32 s94, 2621440
s_mov_b32 s95, 0x20000
s_load_dwordx2 s[72:73], s[0:1], 88
s_waitcnt lgkmcnt(0)
s_mov_b32 s74, 1280
s_mov_b32 s75, 0x20000
s_cmp_ge_u32 s14, 2
s_cbranch_scc1 L_nopf
s_mul_i32 s33, s14, 20
s_add_u32 s33, s33, s13
v_mov_b64 v[4:5], -1
v_mov_b64 v[6:7], -1
v_lshlrev_b32 v1, 4, v0
s_lshl_b32 s36, s33, 2
s_add_u32 s36, s36, s12
s_lshl_b32 s35, s36, 10
s_add_u32 s35, s35, 524288
L_cm1:
buffer_store_dwordx4 v[4:7], v1, s[4:7], s35 offen sc1
s_add_u32 s35, s35, 163840
s_cmp_lt_u32 s35, 1310720
s_cbranch_scc1 L_cm1
s_lshl_b32 s35, s36, 13
s_add_u32 s35, s35, 2097152
L_cm2:
s_add_u32 s37, s35, 4096
buffer_store_dwordx4 v[4:7], v1, s[4:7], s35 offen offset:0 sc1
buffer_store_dwordx4 v[4:7], v1, s[4:7], s35 offen offset:1024 sc1
buffer_store_dwordx4 v[4:7], v1, s[4:7], s35 offen offset:2048 sc1
buffer_store_dwordx4 v[4:7], v1, s[4:7], s35 offen offset:3072 sc1
buffer_store_dwordx4 v[4:7], v1, s[4:7], s37 offen sc1
s_add_u32 s35, s35, 1310720
s_cmp_lt_u32 s35, 4194304
s_cbranch_scc1 L_cm2
s_cmp_lt_u32 s36, 128
s_cbranch_scc0 L_cm4
s_lshl_b32 s35, s36, 10
s_add_u32 s35, s35, 58589184
buffer_store_dwordx4 v[4:7], v1, s[4:7], s35 offen sc1
L_cm4:
s_waitcnt vmcnt(0)
s_barrier
s_cmp_eq_u32 s12, 0
s_cbranch_scc0 L_cm3
v_mov_b32 v4, 1
s_mov_b64 exec, 1
buffer_atomic_add v4, off, s[8:11], 0 offset:132 sc1
s_mov_b64 exec, -1
L_cm3:
L_nopf:
s_mul_i32 s24, s12, 14
s_cmp_eq_u32 s12, 3
s_cselect_b32 s24, 41, s24
s_lshl_b32 s29, s13, 6
s_mul_i32 s36, s24, 40960
s_add_u32 s96, s29, s36
s_add_u32 s98, s96, 532480
s_cmp_ge_u32 s12, 2
s_cselect_b32 s98, 0x7000000, s98
s_mul_i32 s36, s12, 1310720
s_add_u32 s97, s29, s36
s_mul_i32 s25, s13, 1
s_and_b32 s25, s25, 15
s_add_u32 s35, s25, 0
s_and_b32 s35, s35, 15
s_mul_i32 s35, s35, 81920
s_add_u32 s52, s35, s97
s_add_u32 s35, s25, 1
s_and_b32 s35, s35, 15
s_mul_i32 s35, s35, 81920
s_add_u32 s53, s35, s97
s_add_u32 s35, s25, 2
s_and_b32 s35, s35, 15
s_mul_i32 s35, s35, 81920
s_add_u32 s54, s35, s97
s_add_u32 s35, s25, 3
s_and_b32 s35, s35, 15
s_mul_i32 s35, s35, 81920
s_add_u32 s55, s35, s97
s_add_u32 s35, s25, 4
s_and_b32 s35, s35, 15
s_mul_i32 s35, s35, 81920
s_add_u32 s56, s35, s97
s_add_u32 s35, s25, 5
s_and_b32 s35, s35, 15
s_mul_i32 s35, s35, 81920
s_add_u32 s57, s35, s97
s_add_u32 s35, s25, 6
s_and_b32 s35, s35, 15
s_mul_i32 s35, s35, 81920
s_add_u32 s58, s35, s97
s_add_u32 s35, s25, 7
s_and_b32 s35, s35, 15
s_mul_i32 s35, s35, 81920
s_add_u32 s59, s35, s97
s_add_u32 s35, s25, 8
s_and_b32 s35, s35, 15
s_mul_i32 s35, s35, 81920
s_add_u32 s60, s35, s97
s_add_u32 s35, s25, 9
s_and_b32 s35, s35, 15
s_mul_i32 s35, s35, 81920
s_add_u32 s61, s35, s97
s_add_u32 s35, s25, 10
s_and_b32 s35, s35, 15
s_mul_i32 s35, s35, 81920
s_add_u32 s62, s35, s97
s_add_u32 s35, s25, 11
s_and_b32 s35, s35, 15
s_mul_i32 s35, s35, 81920
s_add_u32 s63, s35, s97
s_add_u32 s35, s25, 12
s_and_b32 s35, s35, 15
s_mul_i32 s35, s35, 81920
s_add_u32 s64, s35, s97
s_add_u32 s35, s25, 13
s_and_b32 s35, s35, 15
s_mul_i32 s35, s35, 81920
s_add_u32 s65, s35, s97
s_add_u32 s35, s25, 14
s_and_b32 s35, s35, 15
s_mul_i32 s35, s35, 81920
s_add_u32 s66, s35, s97
s_add_u32 s35, s25, 15
s_and_b32 s35, s35, 15
s_mul_i32 s35, s35, 81920
s_add_u32 s67, s35, s97
s_lshl_b32 s25, s25, 12
v_bfe_u32 v2, v0, 5, 1
v_mul_u32_u24 v3, 20480, v2
v_bfe_u32 v2, v0, 4, 1
v_mul_u32_u24 v2, 5120, v2
v_add_u32 v3, v3, v2
v_bfe_u32 v2, v0, 2, 2
v_mul_u32_u24 v2, 1280, v2
v_add_u32 v3, v3, v2
v_bfe_u32 v2, v0, 0, 1
v_mul_u32_u24 v2, 16, v2
v_add_u32 v3, v3, v2
v_bfe_u32 v2, v0, 1, 1
v_bfe_u32 v4, v0, 4, 1
v_xor_b32 v2, v2, v4
v_lshl_add_u32 v3, v2, 5, v3
v_bfe_u32 v2, v0, 4, 2
v_mul_u32_u24 v5, 256, v2
v_bfe_u32 v2, v0, 2, 2
v_mul_u32_u24 v2, 64, v2
v_add_u32 v5, v5, v2
v_bfe_u32 v2, v0, 4, 1
v_mul_u32_u24 v2, 32, v2
v_add_u32 v5, v5, v2
v_bfe_u32 v2, v0, 0, 2
v_mul_u32_u24 v2, 8, v2
v_add_u32 v5, v5, v2
s_mul_i32 s100, s12, 40960
v_add_u32 v5, s100, v5
v_xor_b32 v6, 32, v5
s_mov_b32 s38, 0
L_ww_f2clr:
buffer_load_dword v4, off, s[8:11], 0 offset:128 sc1
s_add_u32 s38, s38, 1
s_cmp_ge_u32 s38, 524288
s_cbranch_scc1 L_err
s_waitcnt vmcnt(0)
v_cmp_gt_u32 vcc, 1, v4
s_cbranch_vccz L_ww_f2clr_ok
s_sleep 4
s_branch L_ww_f2clr
L_ww_f2clr_ok:
s_mov_b32 s35, 1572864
s_mov_b32 s38, 0
L_ww_f2hold:
buffer_load_dword v4, off, s[4:7], s35 offset:0 sc1
s_add_u32 s38, s38, 1
s_cmp_ge_u32 s38, 524288
s_cbranch_scc1 L_err
s_waitcnt vmcnt(0)
v_cmp_gt_u32 vcc, 1, v4
s_cbranch_vccz L_ww_f2hold_ok
s_sleep 4
s_branch L_ww_f2hold
L_ww_f2hold_ok:
s_barrier
s_add_u32 m0, s100, 0
s_add_u32 s35, s96, 0
buffer_load_dwordx4 v3, s[84:87], s35 offen lds
s_add_u32 m0, s100, 1024
s_add_u32 s35, s96, 10240
buffer_load_dwordx4 v3, s[84:87], s35 offen lds
s_add_u32 m0, s100, 2048
s_add_u32 s35, s96, 40960
buffer_load_dwordx4 v3, s[84:87], s35 offen lds
s_add_u32 m0, s100, 3072
s_add_u32 s35, s96, 51200
buffer_load_dwordx4 v3, s[84:87], s35 offen lds
s_add_u32 m0, s100, 4096
s_add_u32 s35, s96, 81920
buffer_load_dwordx4 v3, s[84:87], s35 offen lds
s_add_u32 m0, s100, 5120
s_add_u32 s35, s96, 92160
buffer_load_dwordx4 v3, s[84:87], s35 offen lds
s_add_u32 m0, s100, 6144
s_add_u32 s35, s96, 122880
buffer_load_dwordx4 v3, s[84:87], s35 offen lds
s_add_u32 m0, s100, 7168
s_add_u32 s35, s96, 133120
buffer_load_dwordx4 v3, s[84:87], s35 offen lds
s_add_u32 m0, s100, 8192
s_add_u32 s35, s96, 163840
buffer_load_dwordx4 v3, s[84:87], s35 offen lds
s_add_u32 m0, s100, 9216
s_add_u32 s35, s96, 174080
buffer_load_dwordx4 v3, s[84:87], s35 offen lds
s_add_u32 m0, s100, 10240
s_add_u32 s35, s96, 204800
buffer_load_dwordx4 v3, s[84:87], s35 offen lds
s_add_u32 m0, s100, 11264
s_add_u32 s35, s96, 215040
buffer_load_dwordx4 v3, s[84:87], s35 offen lds
s_add_u32 m0, s100, 12288
s_add_u32 s35, s96, 245760
buffer_load_dwordx4 v3, s[84:87], s35 offen lds
s_add_u32 m0, s100, 13312
s_add_u32 s35, s96, 256000
buffer_load_dwordx4 v3, s[84:87], s35 offen lds
s_add_u32 m0, s100, 14336
s_add_u32 s35, s96, 286720
buffer_load_dwordx4 v3, s[84:87], s35 offen lds
s_add_u32 m0, s100, 15360
s_add_u32 s35, s96, 296960
buffer_load_dwordx4 v3, s[84:87], s35 offen lds
s_add_u32 m0, s100, 16384
s_add_u32 s35, s96, 327680
buffer_load_dwordx4 v3, s[84:87], s35 offen lds
s_add_u32 m0, s100, 17408
s_add_u32 s35, s96, 337920
buffer_load_dwordx4 v3, s[84:87], s35 offen lds
s_add_u32 m0, s100, 18432
s_add_u32 s35, s96, 368640
buffer_load_dwordx4 v3, s[84:87], s35 offen lds
s_add_u32 m0, s100, 19456
s_add_u32 s35, s96, 378880
buffer_load_dwordx4 v3, s[84:87], s35 offen lds
s_add_u32 m0, s100, 20480
s_add_u32 s35, s96, 409600
buffer_load_dwordx4 v3, s[84:87], s35 offen lds
s_add_u32 m0, s100, 21504
s_add_u32 s35, s96, 419840
buffer_load_dwordx4 v3, s[84:87], s35 offen lds
s_add_u32 m0, s100, 22528
s_add_u32 s35, s96, 450560
buffer_load_dwordx4 v3, s[84:87], s35 offen lds
s_add_u32 m0, s100, 23552
s_add_u32 s35, s96, 460800
buffer_load_dwordx4 v3, s[84:87], s35 offen lds
s_add_u32 m0, s100, 24576
s_add_u32 s35, s96, 491520
buffer_load_dwordx4 v3, s[84:87], s35 offen lds
s_add_u32 m0, s100, 25600
s_add_u32 s35, s96, 501760
buffer_load_dwordx4 v3, s[84:87], s35 offen lds
s_add_u32 m0, s100, 26624
s_add_u32 s35, s98, 0
buffer_load_dwordx4 v3, s[84:87], s35 offen lds
s_add_u32 m0, s100, 27648
s_add_u32 s35, s98, 10240
buffer_load_dwordx4 v3, s[84:87], s35 offen lds
s_add_u32 m0, s100, 28672
s_add_u32 s35, s52, 0
buffer_load_dwordx4 v3, s[80:83], s35 offen lds
s_add_u32 m0, s100, 29696
s_add_u32 s35, s52, 10240
buffer_load_dwordx4 v3, s[80:83], s35 offen lds
s_add_u32 m0, s100, 30720
s_add_u32 s35, s52, 40960
buffer_load_dwordx4 v3, s[80:83], s35 offen lds
s_add_u32 m0, s100, 31744
s_add_u32 s35, s52, 51200
buffer_load_dwordx4 v3, s[80:83], s35 offen lds
s_add_u32 m0, s100, 32768
s_add_u32 s35, s53, 0
buffer_load_dwordx4 v3, s[80:83], s35 offen lds
s_add_u32 m0, s100, 33792
s_add_u32 s35, s53, 10240
buffer_load_dwordx4 v3, s[80:83], s35 offen lds
s_add_u32 m0, s100, 34816
s_add_u32 s35, s53, 40960
buffer_load_dwordx4 v3, s[80:83], s35 offen lds
s_add_u32 m0, s100, 35840
s_add_u32 s35, s53, 51200
buffer_load_dwordx4 v3, s[80:83], s35 offen lds
s_add_u32 m0, s100, 36864
s_add_u32 s35, s54, 0
buffer_load_dwordx4 v3, s[80:83], s35 offen lds
s_add_u32 m0, s100, 37888
s_add_u32 s35, s54, 10240
buffer_load_dwordx4 v3, s[80:83], s35 offen lds
s_add_u32 m0, s100, 38912
s_add_u32 s35, s54, 40960
buffer_load_dwordx4 v3, s[80:83], s35 offen lds
s_add_u32 m0, s100, 39936
s_add_u32 s35, s54, 51200
buffer_load_dwordx4 v3, s[80:83], s35 offen lds
s_waitcnt vmcnt(36)
ds_read_b64_tr_b16 a[0:1], v5 offset:0
ds_read_b64_tr_b16 a[2:3], v5 offset:1024
ds_read_b64_tr_b16 a[4:5], v6 offset:0
ds_read_b64_tr_b16 a[6:7], v6 offset:1024
ds_read_b64_tr_b16 a[8:9], v5 offset:2048
ds_read_b64_tr_b16 a[10:11], v5 offset:3072
ds_read_b64_tr_b16 a[12:13], v6 offset:2048
ds_read_b64_tr_b16 a[14:15], v6 offset:3072
s_waitcnt lgkmcnt(0)
s_add_u32 m0, s100, 0
s_add_u32 s35, s55, 0
buffer_load_dwordx4 v3, s[80:83], s35 offen lds
s_add_u32 m0, s100, 1024
s_add_u32 s35, s55, 10240
buffer_load_dwordx4 v3, s[80:83], s35 offen lds
s_add_u32 m0, s100, 2048
s_add_u32 s35, s55, 40960
buffer_load_dwordx4 v3, s[80:83], s35 offen lds
s_add_u32 m0, s100, 3072
s_add_u32 s35, s55, 51200
buffer_load_dwordx4 v3, s[80:83], s35 offen lds
s_waitcnt vmcnt(36)
ds_read_b64_tr_b16 a[16:17], v5 offset:4096
ds_read_b64_tr_b16 a[18:19], v5 offset:5120
ds_read_b64_tr_b16 a[20:21], v6 offset:4096
ds_read_b64_tr_b16 a[22:23], v6 offset:5120
ds_read_b64_tr_b16 a[24:25], v5 offset:6144
ds_read_b64_tr_b16 a[26:27], v5 offset:7168
ds_read_b64_tr_b16 a[28:29], v6 offset:6144
ds_read_b64_tr_b16 a[30:31], v6 offset:7168
s_waitcnt lgkmcnt(0)
s_add_u32 m0, s100, 4096
s_add_u32 s35, s56, 0
buffer_load_dwordx4 v3, s[80:83], s35 offen lds
s_add_u32 m0, s100, 5120
s_add_u32 s35, s56, 10240
buffer_load_dwordx4 v3, s[80:83], s35 offen lds
s_add_u32 m0, s100, 6144
s_add_u32 s35, s56, 40960
buffer_load_dwordx4 v3, s[80:83], s35 offen lds
s_add_u32 m0, s100, 7168
s_add_u32 s35, s56, 51200
buffer_load_dwordx4 v3, s[80:83], s35 offen lds
s_waitcnt vmcnt(36)
ds_read_b64_tr_b16 a[32:33], v5 offset:8192
ds_read_b64_tr_b16 a[34:35], v5 offset:9216
ds_read_b64_tr_b16 a[36:37], v6 offset:8192
ds_read_b64_tr_b16 a[38:39], v6 offset:9216
ds_read_b64_tr_b16 a[40:41], v5 offset:10240
ds_read_b64_tr_b16 a[42:43], v5 offset:11264
ds_read_b64_tr_b16 a[44:45], v6 offset:10240
ds_read_b64_tr_b16 a[46:47], v6 offset:11264
s_waitcnt lgkmcnt(0)
s_add_u32 m0, s100, 8192
s_add_u32 s35, s57, 0
buffer_load_dwordx4 v3, s[80:83], s35 offen lds
s_add_u32 m0, s100, 9216
s_add_u32 s35, s57, 10240
buffer_load_dwordx4 v3, s[80:83], s35 offen lds
s_add_u32 m0, s100, 10240
s_add_u32 s35, s57, 40960
buffer_load_dwordx4 v3, s[80:83], s35 offen lds
s_add_u32 m0, s100, 11264
s_add_u32 s35, s57, 51200
buffer_load_dwordx4 v3, s[80:83], s35 offen lds
s_waitcnt vmcnt(36)
ds_read_b64_tr_b16 a[48:49], v5 offset:12288
ds_read_b64_tr_b16 a[50:51], v5 offset:13312
ds_read_b64_tr_b16 a[52:53], v6 offset:12288
ds_read_b64_tr_b16 a[54:55], v6 offset:13312
ds_read_b64_tr_b16 a[56:57], v5 offset:14336
ds_read_b64_tr_b16 a[58:59], v5 offset:15360
ds_read_b64_tr_b16 a[60:61], v6 offset:14336
ds_read_b64_tr_b16 a[62:63], v6 offset:15360
s_waitcnt lgkmcnt(0)
s_add_u32 m0, s100, 12288
s_add_u32 s35, s58, 0
buffer_load_dwordx4 v3, s[80:83], s35 offen lds
s_add_u32 m0, s100, 13312
s_add_u32 s35, s58, 10240
buffer_load_dwordx4 v3, s[80:83], s35 offen lds
s_add_u32 m0, s100, 14336
s_add_u32 s35, s58, 40960
buffer_load_dwordx4 v3, s[80:83], s35 offen lds
s_add_u32 m0, s100, 15360
s_add_u32 s35, s58, 51200
buffer_load_dwordx4 v3, s[80:83], s35 offen lds
s_waitcnt vmcnt(36)
ds_read_b64_tr_b16 a[64:65], v5 offset:16384
ds_read_b64_tr_b16 a[66:67], v5 offset:17408
ds_read_b64_tr_b16 a[68:69], v6 offset:16384
ds_read_b64_tr_b16 a[70:71], v6 offset:17408
ds_read_b64_tr_b16 a[72:73], v5 offset:18432
ds_read_b64_tr_b16 a[74:75], v5 offset:19456
ds_read_b64_tr_b16 a[76:77], v6 offset:18432
ds_read_b64_tr_b16 a[78:79], v6 offset:19456
s_waitcnt lgkmcnt(0)
s_add_u32 m0, s100, 16384
s_add_u32 s35, s59, 0
buffer_load_dwordx4 v3, s[80:83], s35 offen lds
s_add_u32 m0, s100, 17408
s_add_u32 s35, s59, 10240
buffer_load_dwordx4 v3, s[80:83], s35 offen lds
s_add_u32 m0, s100, 18432
s_add_u32 s35, s59, 40960
buffer_load_dwordx4 v3, s[80:83], s35 offen lds
s_add_u32 m0, s100, 19456
s_add_u32 s35, s59, 51200
buffer_load_dwordx4 v3, s[80:83], s35 offen lds
s_waitcnt vmcnt(36)
ds_read_b64_tr_b16 a[80:81], v5 offset:20480
ds_read_b64_tr_b16 a[82:83], v5 offset:21504
ds_read_b64_tr_b16 a[84:85], v6 offset:20480
ds_read_b64_tr_b16 a[86:87], v6 offset:21504
ds_read_b64_tr_b16 a[88:89], v5 offset:22528
ds_read_b64_tr_b16 a[90:91], v5 offset:23552
ds_read_b64_tr_b16 a[92:93], v6 offset:22528
ds_read_b64_tr_b16 a[94:95], v6 offset:23552
s_waitcnt lgkmcnt(0)
s_add_u32 m0, s100, 20480
s_add_u32 s35, s60, 0
buffer_load_dwordx4 v3, s[80:83], s35 offen lds
s_add_u32 m0, s100, 21504
s_add_u32 s35, s60, 10240
buffer_load_dwordx4 v3, s[80:83], s35 offen lds
s_add_u32 m0, s100, 22528
s_add_u32 s35, s60, 40960
buffer_load_dwordx4 v3, s[80:83], s35 offen lds
s_add_u32 m0, s100, 23552
s_add_u32 s35, s60, 51200
buffer_load_dwordx4 v3, s[80:83], s35 offen lds
s_waitcnt vmcnt(36)
ds_read_b64_tr_b16 a[96:97], v5 offset:24576
ds_read_b64_tr_b16 a[98:99], v5 offset:25600
ds_read_b64_tr_b16 a[100:101], v6 offset:24576
ds_read_b64_tr_b16 a[102:103], v6 offset:25600
ds_read_b64_tr_b16 a[104:105], v5 offset:26624
ds_read_b64_tr_b16 a[106:107], v5 offset:27648
ds_read_b64_tr_b16 a[108:109], v6 offset:26624
ds_read_b64_tr_b16 a[110:111], v6 offset:27648
s_waitcnt lgkmcnt(0)
s_add_u32 m0, s100, 24576
s_add_u32 s35, s61, 0
buffer_load_dwordx4 v3, s[80:83], s35 offen lds
s_add_u32 m0, s100, 25600
s_add_u32 s35, s61, 10240
buffer_load_dwordx4 v3, s[80:83], s35 offen lds
s_add_u32 m0, s100, 26624
s_add_u32 s35, s61, 40960
buffer_load_dwordx4 v3, s[80:83], s35 offen lds
s_add_u32 m0, s100, 27648
s_add_u32 s35, s61, 51200
buffer_load_dwordx4 v3, s[80:83], s35 offen lds
s_waitcnt vmcnt(36)
ds_read_b64_tr_b16 a[112:113], v5 offset:28672
ds_read_b64_tr_b16 a[114:115], v5 offset:29696
ds_read_b64_tr_b16 a[116:117], v6 offset:28672
ds_read_b64_tr_b16 a[118:119], v6 offset:29696
ds_read_b64_tr_b16 a[120:121], v5 offset:30720
ds_read_b64_tr_b16 a[122:123], v5 offset:31744
ds_read_b64_tr_b16 a[124:125], v6 offset:30720
ds_read_b64_tr_b16 a[126:127], v6 offset:31744
s_waitcnt lgkmcnt(0)
s_add_u32 m0, s100, 28672
s_add_u32 s35, s62, 0
buffer_load_dwordx4 v3, s[80:83], s35 offen lds
s_add_u32 m0, s100, 29696
s_add_u32 s35, s62, 10240
buffer_load_dwordx4 v3, s[80:83], s35 offen lds
s_add_u32 m0, s100, 30720
s_add_u32 s35, s62, 40960
buffer_load_dwordx4 v3, s[80:83], s35 offen lds
s_add_u32 m0, s100, 31744
s_add_u32 s35, s62, 51200
buffer_load_dwordx4 v3, s[80:83], s35 offen lds
s_waitcnt vmcnt(36)
ds_read_b64_tr_b16 a[128:129], v5 offset:32768
ds_read_b64_tr_b16 a[130:131], v5 offset:33792
ds_read_b64_tr_b16 a[132:133], v6 offset:32768
ds_read_b64_tr_b16 a[134:135], v6 offset:33792
ds_read_b64_tr_b16 a[136:137], v5 offset:34816
ds_read_b64_tr_b16 a[138:139], v5 offset:35840
ds_read_b64_tr_b16 a[140:141], v6 offset:34816
ds_read_b64_tr_b16 a[142:143], v6 offset:35840
s_waitcnt lgkmcnt(0)
s_add_u32 m0, s100, 32768
s_add_u32 s35, s63, 0
buffer_load_dwordx4 v3, s[80:83], s35 offen lds
s_add_u32 m0, s100, 33792
s_add_u32 s35, s63, 10240
buffer_load_dwordx4 v3, s[80:83], s35 offen lds
s_add_u32 m0, s100, 34816
s_add_u32 s35, s63, 40960
buffer_load_dwordx4 v3, s[80:83], s35 offen lds
s_add_u32 m0, s100, 35840
s_add_u32 s35, s63, 51200
buffer_load_dwordx4 v3, s[80:83], s35 offen lds
s_waitcnt vmcnt(36)
ds_read_b64_tr_b16 a[144:145], v5 offset:36864
ds_read_b64_tr_b16 a[146:147], v5 offset:37888
ds_read_b64_tr_b16 a[148:149], v6 offset:36864
ds_read_b64_tr_b16 a[150:151], v6 offset:37888
ds_read_b64_tr_b16 a[152:153], v5 offset:38912
ds_read_b64_tr_b16 a[154:155], v5 offset:39936
ds_read_b64_tr_b16 a[156:157], v6 offset:38912
ds_read_b64_tr_b16 a[158:159], v6 offset:39936
s_waitcnt lgkmcnt(0)
s_add_u32 m0, s100, 36864
s_add_u32 s35, s64, 0
buffer_load_dwordx4 v3, s[80:83], s35 offen lds
s_add_u32 m0, s100, 37888
s_add_u32 s35, s64, 10240
buffer_load_dwordx4 v3, s[80:83], s35 offen lds
s_add_u32 m0, s100, 38912
s_add_u32 s35, s64, 40960
buffer_load_dwordx4 v3, s[80:83], s35 offen lds
s_add_u32 m0, s100, 39936
s_add_u32 s35, s64, 51200
buffer_load_dwordx4 v3, s[80:83], s35 offen lds
s_waitcnt vmcnt(36)
ds_read_b64_tr_b16 a[160:161], v5 offset:0
ds_read_b64_tr_b16 a[162:163], v5 offset:1024
ds_read_b64_tr_b16 a[164:165], v6 offset:0
ds_read_b64_tr_b16 a[166:167], v6 offset:1024
ds_read_b64_tr_b16 a[168:169], v5 offset:2048
ds_read_b64_tr_b16 a[170:171], v5 offset:3072
ds_read_b64_tr_b16 a[172:173], v6 offset:2048
ds_read_b64_tr_b16 a[174:175], v6 offset:3072
s_waitcnt lgkmcnt(0)
s_add_u32 m0, s100, 0
s_add_u32 s35, s65, 0
buffer_load_dwordx4 v3, s[80:83], s35 offen lds
s_add_u32 m0, s100, 1024
s_add_u32 s35, s65, 10240
buffer_load_dwordx4 v3, s[80:83], s35 offen lds
s_add_u32 m0, s100, 2048
s_add_u32 s35, s65, 40960
buffer_load_dwordx4 v3, s[80:83], s35 offen lds
s_add_u32 m0, s100, 3072
s_add_u32 s35, s65, 51200
buffer_load_dwordx4 v3, s[80:83], s35 offen lds
s_waitcnt vmcnt(36)
ds_read_b64_tr_b16 a[176:177], v5 offset:4096
ds_read_b64_tr_b16 a[178:179], v5 offset:5120
ds_read_b64_tr_b16 a[180:181], v6 offset:4096
ds_read_b64_tr_b16 a[182:183], v6 offset:5120
ds_read_b64_tr_b16 a[184:185], v5 offset:6144
ds_read_b64_tr_b16 a[186:187], v5 offset:7168
ds_read_b64_tr_b16 a[188:189], v6 offset:6144
ds_read_b64_tr_b16 a[190:191], v6 offset:7168
s_waitcnt lgkmcnt(0)
s_add_u32 m0, s100, 4096
s_add_u32 s35, s66, 0
buffer_load_dwordx4 v3, s[80:83], s35 offen lds
s_add_u32 m0, s100, 5120
s_add_u32 s35, s66, 10240
buffer_load_dwordx4 v3, s[80:83], s35 offen lds
s_add_u32 m0, s100, 6144
s_add_u32 s35, s66, 40960
buffer_load_dwordx4 v3, s[80:83], s35 offen lds
s_add_u32 m0, s100, 7168
s_add_u32 s35, s66, 51200
buffer_load_dwordx4 v3, s[80:83], s35 offen lds
s_waitcnt vmcnt(36)
ds_read_b64_tr_b16 a[192:193], v5 offset:8192
ds_read_b64_tr_b16 a[194:195], v5 offset:9216
ds_read_b64_tr_b16 a[196:197], v6 offset:8192
ds_read_b64_tr_b16 a[198:199], v6 offset:9216
ds_read_b64_tr_b16 a[200:201], v5 offset:10240
ds_read_b64_tr_b16 a[202:203], v5 offset:11264
ds_read_b64_tr_b16 a[204:205], v6 offset:10240
ds_read_b64_tr_b16 a[206:207], v6 offset:11264
s_waitcnt lgkmcnt(0)
s_add_u32 m0, s100, 8192
s_add_u32 s35, s67, 0
buffer_load_dwordx4 v3, s[80:83], s35 offen lds
s_add_u32 m0, s100, 9216
s_add_u32 s35, s67, 10240
buffer_load_dwordx4 v3, s[80:83], s35 offen lds
s_add_u32 m0, s100, 10240
s_add_u32 s35, s67, 40960
buffer_load_dwordx4 v3, s[80:83], s35 offen lds
s_add_u32 m0, s100, 11264
s_add_u32 s35, s67, 51200
buffer_load_dwordx4 v3, s[80:83], s35 offen lds
s_waitcnt vmcnt(36)
ds_read_b64_tr_b16 a[208:209], v5 offset:12288
ds_read_b64_tr_b16 a[210:211], v5 offset:13312
ds_read_b64_tr_b16 a[212:213], v6 offset:12288
ds_read_b64_tr_b16 a[214:215], v6 offset:13312
ds_read_b64_tr_b16 a[216:217], v5 offset:14336
ds_read_b64_tr_b16 a[218:219], v5 offset:15360
ds_read_b64_tr_b16 a[220:221], v6 offset:14336
ds_read_b64_tr_b16 a[222:223], v6 offset:15360
s_waitcnt lgkmcnt(0)
s_waitcnt vmcnt(32)
ds_read_b64_tr_b16 a[224:225], v5 offset:16384
ds_read_b64_tr_b16 a[226:227], v5 offset:17408
ds_read_b64_tr_b16 a[228:229], v6 offset:16384
ds_read_b64_tr_b16 a[230:231], v6 offset:17408
ds_read_b64_tr_b16 a[232:233], v5 offset:18432
ds_read_b64_tr_b16 a[234:235], v5 offset:19456
ds_read_b64_tr_b16 a[236:237], v6 offset:18432
ds_read_b64_tr_b16 a[238:239], v6 offset:19456
s_waitcnt lgkmcnt(0)
s_waitcnt vmcnt(28)
ds_read_b64_tr_b16 a[240:241], v5 offset:20480
ds_read_b64_tr_b16 a[242:243], v5 offset:21504
ds_read_b64_tr_b16 a[244:245], v6 offset:20480
ds_read_b64_tr_b16 a[246:247], v6 offset:21504
ds_read_b64_tr_b16 a[248:249], v5 offset:22528
ds_read_b64_tr_b16 a[250:251], v5 offset:23552
ds_read_b64_tr_b16 a[252:253], v6 offset:22528
ds_read_b64_tr_b16 a[254:255], v6 offset:23552
s_waitcnt lgkmcnt(0)
s_waitcnt vmcnt(24)
ds_read_b64_tr_b16 v[140:141], v5 offset:24576
ds_read_b64_tr_b16 v[142:143], v5 offset:25600
ds_read_b64_tr_b16 v[144:145], v6 offset:24576
ds_read_b64_tr_b16 v[146:147], v6 offset:25600
ds_read_b64_tr_b16 v[148:149], v5 offset:26624
ds_read_b64_tr_b16 v[150:151], v5 offset:27648
ds_read_b64_tr_b16 v[152:153], v6 offset:26624
ds_read_b64_tr_b16 v[154:155], v6 offset:27648
s_waitcnt lgkmcnt(0)
s_waitcnt vmcnt(20)
ds_read_b64_tr_b16 v[156:157], v5 offset:28672
ds_read_b64_tr_b16 v[158:159], v5 offset:29696
ds_read_b64_tr_b16 v[160:161], v6 offset:28672
ds_read_b64_tr_b16 v[162:163], v6 offset:29696
ds_read_b64_tr_b16 v[164:165], v5 offset:30720
ds_read_b64_tr_b16 v[166:167], v5 offset:31744
ds_read_b64_tr_b16 v[168:169], v6 offset:30720
ds_read_b64_tr_b16 v[170:171], v6 offset:31744
s_waitcnt lgkmcnt(0)
s_waitcnt vmcnt(16)
ds_read_b64_tr_b16 v[172:173], v5 offset:32768
ds_read_b64_tr_b16 v[174:175], v5 offset:33792
ds_read_b64_tr_b16 v[176:177], v6 offset:32768
ds_read_b64_tr_b16 v[178:179], v6 offset:33792
ds_read_b64_tr_b16 v[180:181], v5 offset:34816
ds_read_b64_tr_b16 v[182:183], v5 offset:35840
ds_read_b64_tr_b16 v[184:185], v6 offset:34816
ds_read_b64_tr_b16 v[186:187], v6 offset:35840
s_waitcnt lgkmcnt(0)
s_waitcnt vmcnt(12)
ds_read_b64_tr_b16 v[188:189], v5 offset:36864
ds_read_b64_tr_b16 v[190:191], v5 offset:37888
ds_read_b64_tr_b16 v[192:193], v6 offset:36864
ds_read_b64_tr_b16 v[194:195], v6 offset:37888
ds_read_b64_tr_b16 v[196:197], v5 offset:38912
ds_read_b64_tr_b16 v[198:199], v5 offset:39936
ds_read_b64_tr_b16 v[200:201], v6 offset:38912
ds_read_b64_tr_b16 v[202:203], v6 offset:39936
s_waitcnt lgkmcnt(0)
s_waitcnt vmcnt(8)
ds_read_b64_tr_b16 v[204:205], v5 offset:0
ds_read_b64_tr_b16 v[206:207], v5 offset:1024
ds_read_b64_tr_b16 v[208:209], v6 offset:0
ds_read_b64_tr_b16 v[210:211], v6 offset:1024
ds_read_b64_tr_b16 v[212:213], v5 offset:2048
ds_read_b64_tr_b16 v[214:215], v5 offset:3072
ds_read_b64_tr_b16 v[216:217], v6 offset:2048
ds_read_b64_tr_b16 v[218:219], v6 offset:3072
s_waitcnt lgkmcnt(0)
s_waitcnt vmcnt(4)
ds_read_b64_tr_b16 v[220:221], v5 offset:4096
ds_read_b64_tr_b16 v[222:223], v5 offset:5120
ds_read_b64_tr_b16 v[224:225], v6 offset:4096
ds_read_b64_tr_b16 v[226:227], v6 offset:5120
ds_read_b64_tr_b16 v[228:229], v5 offset:6144
ds_read_b64_tr_b16 v[230:231], v5 offset:7168
ds_read_b64_tr_b16 v[232:233], v6 offset:6144
ds_read_b64_tr_b16 v[234:235], v6 offset:7168
s_waitcnt lgkmcnt(0)
s_waitcnt vmcnt(0)
ds_read_b64_tr_b16 v[236:237], v5 offset:8192
ds_read_b64_tr_b16 v[238:239], v5 offset:9216
ds_read_b64_tr_b16 v[240:241], v6 offset:8192
ds_read_b64_tr_b16 v[242:243], v6 offset:9216
ds_read_b64_tr_b16 v[244:245], v5 offset:10240
ds_read_b64_tr_b16 v[246:247], v5 offset:11264
ds_read_b64_tr_b16 v[248:249], v6 offset:10240
ds_read_b64_tr_b16 v[250:251], v6 offset:11264
s_waitcnt lgkmcnt(0)
s_barrier
s_and_b32 s35, s14, 1
s_lshl_b32 s36, s35, 8
s_lshl_b32 s27, s24, 11
s_add_u32 s27, s27, s36
s_add_u32 s27, s27, 100663296
s_lshl_b32 s28, s12, 16
s_add_u32 s28, s28, s36
s_add_u32 s28, s28, 83886080
s_mov_b32 s30, s29
s_mul_i32 s35, s35, 20480
s_add_u32 s29, s29, s35
s_mov_b32 s20, 1579008
s_mov_b32 s22, 0
s_cmp_ge_u32 s14, 2
s_cselect_b32 s16, 29, 0
s_mul_i32 s17, s16, 114688
s_add_u32 s17, s17, s27
v_lshlrev_b32 v2, 2, v0
v_bfe_u32 v136, v0, 4, 2
v_mul_u32_u24 v1, 512, v136
v_bfe_u32 v136, v0, 0, 4
v_mul_u32_u24 v136, 16, v136
v_add_u32 v1, v1, v136
v_bfe_u32 v136, v0, 0, 4
v_mul_u32_u24 v3, 144, v136
v_bfe_u32 v136, v0, 4, 2
v_mul_u32_u24 v136, 16, v136
v_add_u32 v3, v3, v136
s_mul_i32 s36, s12, 2304
v_add_u32 v3, s36, v3
v_bfe_u32 v136, v0, 3, 2
v_mul_u32_u24 v4, 144, v136
v_bfe_u32 v136, v0, 0, 3
v_mul_u32_u24 v136, 16, v136
v_add_u32 v4, v4, v136
s_mul_i32 s36, s12, 576
v_add_u32 v4, s36, v4
v_bfe_u32 v136, v0, 3, 2
v_mul_u32_u24 v5, 1280, v136
v_bfe_u32 v136, v0, 0, 3
v_mul_u32_u24 v136, 8, v136
v_add_u32 v5, v5, v136
s_mul_i32 s36, s12, 5120
v_add_u32 v5, s36, v5
v_bfe_u32 v136, v0, 0, 3
v_mul_u32_u24 v6, 8, v136
buffer_load_dwordx2 v[136:137], v6, s[72:75], s30 offen
s_waitcnt vmcnt(0)
v_lshlrev_b32 v132, 16, v136
v_and_b32 v133, 0xffff0000, v136
v_lshlrev_b32 v134, 16, v137
v_and_b32 v135, 0xffff0000, v137
s_cmp_gt_u32 s22, s16
s_cbranch_scc1 L_wp_f2h0_end
s_cmp_ge_u32 s16, 42
s_cselect_b32 s36, 128, 0
s_cselect_b32 s37, 42, 0
s_add_u32 s36, s36, s20
s_sub_u32 s37, s16, s37
s_mov_b32 s38, 0
s_mov_b32 exec_lo, 0x7ffffff
s_mov_b32 exec_hi, 0
L_wp_f2h0:
buffer_load_dword v7, v2, s[4:7], s36 offen sc1
s_add_u32 s38, s38, 1
s_cmp_ge_u32 s38, 524288
s_cbranch_scc1 L_err
s_waitcnt vmcnt(0)
v_cmp_ge_u32 vcc, s37, v7
s_cbranch_vccnz L_wp_f2h0
s_add_u32 s22, s16, 1
s_add_u32 s35, s37, 2
v_cmp_ge_u32 vcc, s35, v7
s_add_u32 s35, s16, 3
s_cmp_eq_u64 vcc, 0
s_cselect_b32 s22, s35, s22
s_add_u32 s35, s37, 4
v_cmp_ge_u32 vcc, s35, v7
s_add_u32 s35, s16, 5
s_cmp_eq_u64 vcc, 0
s_cselect_b32 s22, s35, s22
s_add_u32 s35, s37, 8
v_cmp_ge_u32 vcc, s35, v7
s_add_u32 s35, s16, 9
s_cmp_eq_u64 vcc, 0
s_cselect_b32 s22, s35, s22
s_mov_b64 exec, -1
L_wp_f2h0_end:
s_add_u32 s35, s17, 0
buffer_load_dwordx4 v[24:27], v1, s[4:7], s35 offen offset:0 sc1
buffer_load_dwordx4 v[28:31], v1, s[4:7], s35 offen offset:2048 sc1
s_add_u32 s35, s17, 4096
buffer_load_dwordx4 v[32:35], v1, s[4:7], s35 offen offset:0 sc1
buffer_load_dwordx4 v[36:39], v1, s[4:7], s35 offen offset:2048 sc1
s_add_u32 s35, s17, 8192
buffer_load_dwordx4 v[40:43], v1, s[4:7], s35 offen offset:0 sc1
buffer_load_dwordx4 v[44:47], v1, s[4:7], s35 offen offset:2048 sc1
s_add_u32 s35, s17, 12288
buffer_load_dwordx4 v[48:51], v1, s[4:7], s35 offen offset:0 sc1
buffer_load_dwordx4 v[52:55], v1, s[4:7], s35 offen offset:2048 sc1
s_add_u32 s35, s17, 16384
buffer_load_dwordx4 v[56:59], v1, s[4:7], s35 offen offset:0 sc1
buffer_load_dwordx4 v[60:63], v1, s[4:7], s35 offen offset:2048 sc1
s_add_u32 s35, s17, 20480
buffer_load_dwordx4 v[64:67], v1, s[4:7], s35 offen offset:0 sc1
buffer_load_dwordx4 v[68:71], v1, s[4:7], s35 offen offset:2048 sc1
s_add_u32 s35, s17, 24576
buffer_load_dwordx4 v[72:75], v1, s[4:7], s35 offen offset:0 sc1
buffer_load_dwordx4 v[76:79], v1, s[4:7], s35 offen offset:2048 sc1
v_mov_b32 v7, 0
s_mov_b32 s35, 1769472
buffer_store_dword v7, off, s[4:7], s35
L_f2_loop:
s_lshl_b32 s18, s16, 18
s_add_u32 s18, s18, s28
s_mul_i32 s19, s16, 40960
s_add_u32 s19, s19, s29
s_add_u32 s32, s16, 2
s_add_u32 s35, s16, 1
s_cmp_lt_u32 s16, 28
s_cselect_b32 s32, s35, s32
s_lshr_b32 s23, s16, 2
s_add_u32 s23, s23, 1
s_and_b32 s35, s16, 3
s_lshl_b32 s21, s35, 7
s_add_u32 s21, s21, 1579264
s_mov_b32 exec_hi, 0
buffer_load_dwordx2 v[138:139], v5, s[88:91], s19 offen
v_cmp_gt_u32 vcc, s23, v7
s_mov_b64 exec, -1
s_cbranch_vccz L_f2_ready
s_waitcnt vmcnt(15)
v_mfma_f32_16x16x32_bf16 v[8:11], a[0:3], v[24:27], 0
v_mfma_f32_16x16x32_bf16 v[12:15], a[4:7], v[24:27], 0
s_waitcnt vmcnt(14)
v_mfma_f32_16x16x32_bf16 v[8:11], a[8:11], v[28:31], v[8:11]
v_mfma_f32_16x16x32_bf16 v[12:15], a[12:15], v[28:31], v[12:15]
s_waitcnt vmcnt(13)
v_mfma_f32_16x16x32_bf16 v[8:11], a[16:19], v[32:35], v[8:11]
v_mfma_f32_16x16x32_bf16 v[12:15], a[20:23], v[32:35], v[12:15]
s_waitcnt vmcnt(12)
v_mfma_f32_16x16x32_bf16 v[8:11], a[24:27], v[36:39], v[8:11]
v_mfma_f32_16x16x32_bf16 v[12:15], a[28:31], v[36:39], v[12:15]
s_waitcnt vmcnt(11)
v_mfma_f32_16x16x32_bf16 v[8:11], a[32:35], v[40:43], v[8:11]
v_mfma_f32_16x16x32_bf16 v[12:15], a[36:39], v[40:43], v[12:15]
s_waitcnt vmcnt(10)
v_mfma_f32_16x16x32_bf16 v[8:11], a[40:43], v[44:47], v[8:11]
v_mfma_f32_16x16x32_bf16 v[12:15], a[44:47], v[44:47], v[12:15]
s_waitcnt vmcnt(9)
v_mfma_f32_16x16x32_bf16 v[8:11], a[48:51], v[48:51], v[8:11]
v_mfma_f32_16x16x32_bf16 v[12:15], a[52:55], v[48:51], v[12:15]
s_waitcnt vmcnt(8)
v_mfma_f32_16x16x32_bf16 v[8:11], a[56:59], v[52:55], v[8:11]
v_mfma_f32_16x16x32_bf16 v[12:15], a[60:63], v[52:55], v[12:15]
s_waitcnt vmcnt(7)
v_mfma_f32_16x16x32_bf16 v[8:11], a[64:67], v[56:59], v[8:11]
v_mfma_f32_16x16x32_bf16 v[12:15], a[68:71], v[56:59], v[12:15]
s_waitcnt vmcnt(6)
v_mfma_f32_16x16x32_bf16 v[8:11], a[72:75], v[60:63], v[8:11]
v_mfma_f32_16x16x32_bf16 v[12:15], a[76:79], v[60:63], v[12:15]
s_waitcnt vmcnt(5)
v_mfma_f32_16x16x32_bf16 v[8:11], a[80:83], v[64:67], v[8:11]
v_mfma_f32_16x16x32_bf16 v[12:15], a[84:87], v[64:67], v[12:15]
s_waitcnt vmcnt(4)
v_mfma_f32_16x16x32_bf16 v[8:11], a[88:91], v[68:71], v[8:11]
v_mfma_f32_16x16x32_bf16 v[12:15], a[92:95], v[68:71], v[12:15]
s_waitcnt vmcnt(3)
v_mfma_f32_16x16x32_bf16 v[8:11], a[96:99], v[72:75], v[8:11]
v_mfma_f32_16x16x32_bf16 v[12:15], a[100:103], v[72:75], v[12:15]
s_waitcnt vmcnt(2)
v_mfma_f32_16x16x32_bf16 v[8:11], a[104:107], v[76:79], v[8:11]
v_mfma_f32_16x16x32_bf16 v[12:15], a[108:111], v[76:79], v[12:15]
s_mov_b32 s38, 0
s_mov_b32 exec_hi, 0
L_f2_wo:
buffer_load_dword v7, v2, s[4:7], s21 offen sc1
s_add_u32 s38, s38, 1
s_cmp_ge_u32 s38, 524288
s_cbranch_scc1 L_err
s_waitcnt vmcnt(0)
v_cmp_gt_u32 vcc, s23, v7
s_cbranch_vccnz L_f2_wo
s_mov_b64 exec, -1
s_add_u32 s36, s25, 0
s_and_b32 s36, s36, 0xffff
s_add_u32 s36, s36, s18
buffer_load_dwordx4 v[80:83], v1, s[4:7], s36 offen offset:0 sc1
buffer_load_dwordx4 v[84:87], v1, s[4:7], s36 offen offset:2048 sc1
s_add_u32 s36, s25, 4096
s_and_b32 s36, s36, 0xffff
s_add_u32 s36, s36, s18
buffer_load_dwordx4 v[88:91], v1, s[4:7], s36 offen offset:0 sc1
buffer_load_dwordx4 v[92:95], v1, s[4:7], s36 offen offset:2048 sc1
s_add_u32 s36, s25, 8192
s_and_b32 s36, s36, 0xffff
s_add_u32 s36, s36, s18
buffer_load_dwordx4 v[96:99], v1, s[4:7], s36 offen offset:0 sc1
buffer_load_dwordx4 v[100:103], v1, s[4:7], s36 offen offset:2048 sc1
s_add_u32 s36, s25, 12288
s_and_b32 s36, s36, 0xffff
s_add_u32 s36, s36, s18
buffer_load_dwordx4 v[104:107], v1, s[4:7], s36 offen offset:0 sc1
buffer_load_dwordx4 v[108:111], v1, s[4:7], s36 offen offset:2048 sc1
s_add_u32 s36, s25, 16384
s_and_b32 s36, s36, 0xffff
s_add_u32 s36, s36, s18
buffer_load_dwordx4 v[112:115], v1, s[4:7], s36 offen offset:0 sc1
buffer_load_dwordx4 v[24:27], v1, s[4:7], s36 offen offset:2048 sc1
s_add_u32 s36, s25, 20480
s_and_b32 s36, s36, 0xffff
s_add_u32 s36, s36, s18
buffer_load_dwordx4 v[28:31], v1, s[4:7], s36 offen offset:0 sc1
buffer_load_dwordx4 v[32:35], v1, s[4:7], s36 offen offset:2048 sc1
s_add_u32 s36, s25, 24576
s_and_b32 s36, s36, 0xffff
s_add_u32 s36, s36, s18
buffer_load_dwordx4 v[36:39], v1, s[4:7], s36 offen offset:0 sc1
buffer_load_dwordx4 v[40:43], v1, s[4:7], s36 offen offset:2048 sc1
s_add_u32 s36, s25, 28672
s_and_b32 s36, s36, 0xffff
s_add_u32 s36, s36, s18
buffer_load_dwordx4 v[44:47], v1, s[4:7], s36 offen offset:0 sc1
buffer_load_dwordx4 v[48:51], v1, s[4:7], s36 offen offset:2048 sc1
s_add_u32 s36, s25, 32768
s_and_b32 s36, s36, 0xffff
s_add_u32 s36, s36, s18
buffer_load_dwordx4 v[52:55], v1, s[4:7], s36 offen offset:0 sc1
buffer_load_dwordx4 v[56:59], v1, s[4:7], s36 offen offset:2048 sc1
s_add_u32 s36, s25, 36864
s_and_b32 s36, s36, 0xffff
s_add_u32 s36, s36, s18
buffer_load_dwordx4 v[60:63], v1, s[4:7], s36 offen offset:0 sc1
buffer_load_dwordx4 v[64:67], v1, s[4:7], s36 offen offset:2048 sc1
s_add_u32 s36, s25, 40960
s_and_b32 s36, s36, 0xffff
s_add_u32 s36, s36, s18
buffer_load_dwordx4 v[68:71], v1, s[4:7], s36 offen offset:0 sc1
buffer_load_dwordx4 v[72:75], v1, s[4:7], s36 offen offset:2048 sc1
s_add_u32 s36, s25, 45056
s_and_b32 s36, s36, 0xffff
s_add_u32 s36, s36, s18
buffer_load_dwordx4 v[76:79], v1, s[4:7], s36 offen offset:0 sc1
s_branch L_f2_o
L_f2_ready:
s_add_u32 s36, s25, 0
s_and_b32 s36, s36, 0xffff
s_add_u32 s36, s36, s18
buffer_load_dwordx4 v[80:83], v1, s[4:7], s36 offen offset:0 sc1
buffer_load_dwordx4 v[84:87], v1, s[4:7], s36 offen offset:2048 sc1
s_add_u32 s36, s25, 4096
s_and_b32 s36, s36, 0xffff
s_add_u32 s36, s36, s18
buffer_load_dwordx4 v[88:91], v1, s[4:7], s36 offen offset:0 sc1
buffer_load_dwordx4 v[92:95], v1, s[4:7], s36 offen offset:2048 sc1
s_add_u32 s36, s25, 8192
s_and_b32 s36, s36, 0xffff
s_add_u32 s36, s36, s18
buffer_load_dwordx4 v[96:99], v1, s[4:7], s36 offen offset:0 sc1
buffer_load_dwordx4 v[100:103], v1, s[4:7], s36 offen offset:2048 sc1
s_add_u32 s36, s25, 12288
s_and_b32 s36, s36, 0xffff
s_add_u32 s36, s36, s18
buffer_load_dwordx4 v[104:107], v1, s[4:7], s36 offen offset:0 sc1
buffer_load_dwordx4 v[108:111], v1, s[4:7], s36 offen offset:2048 sc1
s_add_u32 s36, s25, 16384
s_and_b32 s36, s36, 0xffff
s_add_u32 s36, s36, s18
buffer_load_dwordx4 v[112:115], v1, s[4:7], s36 offen offset:0 sc1
s_waitcnt vmcnt(24)
v_mfma_f32_16x16x32_bf16 v[8:11], a[0:3], v[24:27], 0
v_mfma_f32_16x16x32_bf16 v[12:15], a[4:7], v[24:27], 0
buffer_load_dwordx4 v[24:27], v1, s[4:7], s36 offen offset:2048 sc1
s_waitcnt vmcnt(24)
v_mfma_f32_16x16x32_bf16 v[8:11], a[8:11], v[28:31], v[8:11]
v_mfma_f32_16x16x32_bf16 v[12:15], a[12:15], v[28:31], v[12:15]
s_add_u32 s36, s25, 20480
s_and_b32 s36, s36, 0xffff
s_add_u32 s36, s36, s18
buffer_load_dwordx4 v[28:31], v1, s[4:7], s36 offen offset:0 sc1
s_waitcnt vmcnt(24)
v_mfma_f32_16x16x32_bf16 v[8:11], a[16:19], v[32:35], v[8:11]
v_mfma_f32_16x16x32_bf16 v[12:15], a[20:23], v[32:35], v[12:15]
buffer_load_dwordx4 v[32:35], v1, s[4:7], s36 offen offset:2048 sc1
s_waitcnt vmcnt(24)
v_mfma_f32_16x16x32_bf16 v[8:11], a[24:27], v[36:39], v[8:11]
v_mfma_f32_16x16x32_bf16 v[12:15], a[28:31], v[36:39], v[12:15]
s_add_u32 s36, s25, 24576
s_and_b32 s36, s36, 0xffff
s_add_u32 s36, s36, s18
buffer_load_dwordx4 v[36:39], v1, s[4:7], s36 offen offset:0 sc1
s_waitcnt vmcnt(24)
v_mfma_f32_16x16x32_bf16 v[8:11], a[32:35], v[40:43], v[8:11]
v_mfma_f32_16x16x32_bf16 v[12:15], a[36:39], v[40:43], v[12:15]
buffer_load_dwordx4 v[40:43], v1, s[4:7], s36 offen offset:2048 sc1
s_waitcnt vmcnt(24)
v_mfma_f32_16x16x32_bf16 v[8:11], a[40:43], v[44:47], v[8:11]
v_mfma_f32_16x16x32_bf16 v[12:15], a[44:47], v[44:47], v[12:15]
s_add_u32 s36, s25, 28672
s_and_b32 s36, s36, 0xffff
s_add_u32 s36, s36, s18
buffer_load_dwordx4 v[44:47], v1, s[4:7], s36 offen offset:0 sc1
s_waitcnt vmcnt(24)
v_mfma_f32_16x16x32_bf16 v[8:11], a[48:51], v[48:51], v[8:11]
v_mfma_f32_16x16x32_bf16 v[12:15], a[52:55], v[48:51], v[12:15]
buffer_load_dwordx4 v[48:51], v1, s[4:7], s36 offen offset:2048 sc1
s_waitcnt vmcnt(24)
v_mfma_f32_16x16x32_bf16 v[8:11], a[56:59], v[52:55], v[8:11]
v_mfma_f32_16x16x32_bf16 v[12:15], a[60:63], v[52:55], v[12:15]
s_add_u32 s36, s25, 32768
s_and_b32 s36, s36, 0xffff
s_add_u32 s36, s36, s18
buffer_load_dwordx4 v[52:55], v1, s[4:7], s36 offen offset:0 sc1
s_waitcnt vmcnt(24)
v_mfma_f32_16x16x32_bf16 v[8:11], a[64:67], v[56:59], v[8:11]
v_mfma_f32_16x16x32_bf16 v[12:15], a[68:71], v[56:59], v[12:15]
buffer_load_dwordx4 v[56:59], v1, s[4:7], s36 offen offset:2048 sc1
s_waitcnt vmcnt(24)
v_mfma_f32_16x16x32_bf16 v[8:11], a[72:75], v[60:63], v[8:11]
v_mfma_f32_16x16x32_bf16 v[12:15], a[76:79], v[60:63], v[12:15]
s_add_u32 s36, s25, 36864
s_and_b32 s36, s36, 0xffff
s_add_u32 s36, s36, s18
buffer_load_dwordx4 v[60:63], v1, s[4:7], s36 offen offset:0 sc1
s_waitcnt vmcnt(24)
v_mfma_f32_16x16x32_bf16 v[8:11], a[80:83], v[64:67], v[8:11]
v_mfma_f32_16x16x32_bf16 v[12:15], a[84:87], v[64:67], v[12:15]
buffer_load_dwordx4 v[64:67], v1, s[4:7], s36 offen offset:2048 sc1
s_waitcnt vmcnt(24)
v_mfma_f32_16x16x32_bf16 v[8:11], a[88:91], v[68:71], v[8:11]
v_mfma_f32_16x16x32_bf16 v[12:15], a[92:95], v[68:71], v[12:15]
s_add_u32 s36, s25, 40960
s_and_b32 s36, s36, 0xffff
s_add_u32 s36, s36, s18
buffer_load_dwordx4 v[68:71], v1, s[4:7], s36 offen offset:0 sc1
s_waitcnt vmcnt(24)
v_mfma_f32_16x16x32_bf16 v[8:11], a[96:99], v[72:75], v[8:11]
v_mfma_f32_16x16x32_bf16 v[12:15], a[100:103], v[72:75], v[12:15]
buffer_load_dwordx4 v[72:75], v1, s[4:7], s36 offen offset:2048 sc1
s_waitcnt vmcnt(24)
v_mfma_f32_16x16x32_bf16 v[8:11], a[104:107], v[76:79], v[8:11]
v_mfma_f32_16x16x32_bf16 v[12:15], a[108:111], v[76:79], v[12:15]
s_add_u32 s36, s25, 45056
s_and_b32 s36, s36, 0xffff
s_add_u32 s36, s36, s18
buffer_load_dwordx4 v[76:79], v1, s[4:7], s36 offen offset:0 sc1
L_f2_o:
s_waitcnt vmcnt(22)
v_mfma_f32_16x16x32_bf16 v[8:11], a[112:115], v[80:83], v[8:11]
v_mfma_f32_16x16x32_bf16 v[12:15], a[116:119], v[80:83], v[12:15]
buffer_load_dwordx4 v[80:83], v1, s[4:7], s36 offen offset:2048 sc1
s_waitcnt vmcnt(22)
v_mfma_f32_16x16x32_bf16 v[8:11], a[120:123], v[84:87], v[8:11]
v_mfma_f32_16x16x32_bf16 v[12:15], a[124:127], v[84:87], v[12:15]
s_add_u32 s36, s25, 49152
s_and_b32 s36, s36, 0xffff
s_add_u32 s36, s36, s18
buffer_load_dwordx4 v[84:87], v1, s[4:7], s36 offen offset:0 sc1
s_waitcnt vmcnt(22)
v_mfma_f32_16x16x32_bf16 v[8:11], a[128:131], v[88:91], v[8:11]
v_mfma_f32_16x16x32_bf16 v[12:15], a[132:135], v[88:91], v[12:15]
buffer_load_dwordx4 v[88:91], v1, s[4:7], s36 offen offset:2048 sc1
s_waitcnt vmcnt(22)
v_mfma_f32_16x16x32_bf16 v[8:11], a[136:139], v[92:95], v[8:11]
v_mfma_f32_16x16x32_bf16 v[12:15], a[140:143], v[92:95], v[12:15]
s_add_u32 s36, s25, 53248
s_and_b32 s36, s36, 0xffff
s_add_u32 s36, s36, s18
buffer_load_dwordx4 v[92:95], v1, s[4:7], s36 offen offset:0 sc1
s_waitcnt vmcnt(22)
v_mfma_f32_16x16x32_bf16 v[8:11], a[144:147], v[96:99], v[8:11]
v_mfma_f32_16x16x32_bf16 v[12:15], a[148:151], v[96:99], v[12:15]
buffer_load_dwordx4 v[96:99], v1, s[4:7], s36 offen offset:2048 sc1
s_waitcnt vmcnt(22)
v_mfma_f32_16x16x32_bf16 v[8:11], a[152:155], v[100:103], v[8:11]
v_mfma_f32_16x16x32_bf16 v[12:15], a[156:159], v[100:103], v[12:15]
s_add_u32 s36, s25, 57344
s_and_b32 s36, s36, 0xffff
s_add_u32 s36, s36, s18
buffer_load_dwordx4 v[100:103], v1, s[4:7], s36 offen offset:0 sc1
s_waitcnt vmcnt(22)
v_mfma_f32_16x16x32_bf16 v[8:11], a[160:163], v[104:107], v[8:11]
v_mfma_f32_16x16x32_bf16 v[12:15], a[164:167], v[104:107], v[12:15]
buffer_load_dwordx4 v[104:107], v1, s[4:7], s36 offen offset:2048 sc1
s_waitcnt vmcnt(22)
v_mfma_f32_16x16x32_bf16 v[8:11], a[168:171], v[108:111], v[8:11]
v_mfma_f32_16x16x32_bf16 v[12:15], a[172:175], v[108:111], v[12:15]
s_add_u32 s36, s25, 61440
s_and_b32 s36, s36, 0xffff
s_add_u32 s36, s36, s18
buffer_load_dwordx4 v[108:111], v1, s[4:7], s36 offen offset:0 sc1
s_waitcnt vmcnt(22)
v_mfma_f32_16x16x32_bf16 v[8:11], a[176:179], v[112:115], v[8:11]
v_mfma_f32_16x16x32_bf16 v[12:15], a[180:183], v[112:115], v[12:15]
buffer_load_dwordx4 v[112:115], v1, s[4:7], s36 offen offset:2048 sc1
s_min_u32 s23, s32, 63
s_cmp_gt_u32 s22, s23
s_cbranch_scc1 L_wp_f2h_end
s_cmp_ge_u32 s23, 42
s_cselect_b32 s36, 128, 0
s_cselect_b32 s37, 42, 0
s_add_u32 s36, s36, s20
s_sub_u32 s37, s23, s37
s_mov_b32 s38, 0
s_mov_b32 exec_lo, 0x7ffffff
s_mov_b32 exec_hi, 0
L_wp_f2h:
buffer_load_dword v7, v2, s[4:7], s36 offen sc1
s_add_u32 s38, s38, 1
s_cmp_ge_u32 s38, 524288
s_cbranch_scc1 L_err
s_waitcnt vmcnt(0)
v_cmp_ge_u32 vcc, s37, v7
s_cbranch_vccnz L_wp_f2h
s_add_u32 s22, s23, 1
s_add_u32 s35, s37, 2
v_cmp_ge_u32 vcc, s35, v7
s_add_u32 s35, s23, 3
s_cmp_eq_u64 vcc, 0
s_cselect_b32 s22, s35, s22
s_add_u32 s35, s37, 4
v_cmp_ge_u32 vcc, s35, v7
s_add_u32 s35, s23, 5
s_cmp_eq_u64 vcc, 0
s_cselect_b32 s22, s35, s22
s_add_u32 s35, s37, 8
v_cmp_ge_u32 vcc, s35, v7
s_add_u32 s35, s23, 9
s_cmp_eq_u64 vcc, 0
s_cselect_b32 s22, s35, s22
s_mov_b64 exec, -1
L_wp_f2h_end:
s_mul_i32 s26, s23, 114688
s_add_u32 s26, s26, s27
s_mov_b32 s37, s23
s_lshr_b32 s23, s37, 2
s_add_u32 s23, s23, 1
s_and_b32 s35, s37, 3
s_lshl_b32 s21, s35, 7
s_add_u32 s21, s21, 1579264
s_mov_b32 exec_hi, 0
buffer_load_dword v7, v2, s[4:7], s21 offen sc1
s_mov_b64 exec, -1
s_waitcnt vmcnt(23)
v_mfma_f32_16x16x32_bf16 v[8:11], a[184:187], v[24:27], v[8:11]
v_mfma_f32_16x16x32_bf16 v[12:15], a[188:191], v[24:27], v[12:15]
s_add_u32 s35, s26, 0
buffer_load_dwordx4 v[24:27], v1, s[4:7], s35 offen offset:0 sc1
s_waitcnt vmcnt(23)
v_mfma_f32_16x16x32_bf16 v[8:11], a[192:195], v[28:31], v[8:11]
v_mfma_f32_16x16x32_bf16 v[12:15], a[196:199], v[28:31], v[12:15]
buffer_load_dwordx4 v[28:31], v1, s[4:7], s35 offen offset:2048 sc1
s_waitcnt vmcnt(23)
v_mfma_f32_16x16x32_bf16 v[8:11], a[200:203], v[32:35], v[8:11]
v_mfma_f32_16x16x32_bf16 v[12:15], a[204:207], v[32:35], v[12:15]
s_add_u32 s35, s26, 4096
buffer_load_dwordx4 v[32:35], v1, s[4:7], s35 offen offset:0 sc1
s_waitcnt vmcnt(23)
v_mfma_f32_16x16x32_bf16 v[8:11], a[208:211], v[36:39], v[8:11]
v_mfma_f32_16x16x32_bf16 v[12:15], a[212:215], v[36:39], v[12:15]
buffer_load_dwordx4 v[36:39], v1, s[4:7], s35 offen offset:2048 sc1
s_waitcnt vmcnt(23)
v_mfma_f32_16x16x32_bf16 v[8:11], a[216:219], v[40:43], v[8:11]
v_mfma_f32_16x16x32_bf16 v[12:15], a[220:223], v[40:43], v[12:15]
s_add_u32 s35, s26, 8192
buffer_load_dwordx4 v[40:43], v1, s[4:7], s35 offen offset:0 sc1
s_waitcnt vmcnt(23)
v_mfma_f32_16x16x32_bf16 v[8:11], a[224:227], v[44:47], v[8:11]
v_mfma_f32_16x16x32_bf16 v[12:15], a[228:231], v[44:47], v[12:15]
buffer_load_dwordx4 v[44:47], v1, s[4:7], s35 offen offset:2048 sc1
s_waitcnt vmcnt(23)
v_mfma_f32_16x16x32_bf16 v[8:11], a[232:235], v[48:51], v[8:11]
v_mfma_f32_16x16x32_bf16 v[12:15], a[236:239], v[48:51], v[12:15]
s_add_u32 s35, s26, 12288
buffer_load_dwordx4 v[48:51], v1, s[4:7], s35 offen offset:0 sc1
s_waitcnt vmcnt(23)
v_mfma_f32_16x16x32_bf16 v[8:11], a[240:243], v[52:55], v[8:11]
v_mfma_f32_16x16x32_bf16 v[12:15], a[244:247], v[52:55], v[12:15]
buffer_load_dwordx4 v[52:55], v1, s[4:7], s35 offen offset:2048 sc1
s_waitcnt vmcnt(23)
v_mfma_f32_16x16x32_bf16 v[8:11], a[248:251], v[56:59], v[8:11]
v_mfma_f32_16x16x32_bf16 v[12:15], a[252:255], v[56:59], v[12:15]
s_add_u32 s35, s26, 16384
buffer_load_dwordx4 v[56:59], v1, s[4:7], s35 offen offset:0 sc1
s_waitcnt vmcnt(23)
v_mfma_f32_16x16x32_bf16 v[8:11], v[140:143], v[60:63], v[8:11]
v_mfma_f32_16x16x32_bf16 v[12:15], v[144:147], v[60:63], v[12:15]
buffer_load_dwordx4 v[60:63], v1, s[4:7], s35 offen offset:2048 sc1
s_waitcnt vmcnt(23)
v_mfma_f32_16x16x32_bf16 v[8:11], v[148:151], v[64:67], v[8:11]
v_mfma_f32_16x16x32_bf16 v[12:15], v[152:155], v[64:67], v[12:15]
s_add_u32 s35, s26, 20480
buffer_load_dwordx4 v[64:67], v1, s[4:7], s35 offen offset:0 sc1
s_waitcnt vmcnt(23)
v_mfma_f32_16x16x32_bf16 v[8:11], v[156:159], v[68:71], v[8:11]
v_mfma_f32_16x16x32_bf16 v[12:15], v[160:163], v[68:71], v[12:15]
buffer_load_dwordx4 v[68:71], v1, s[4:7], s35 offen offset:2048 sc1
s_waitcnt vmcnt(23)
v_mfma_f32_16x16x32_bf16 v[8:11], v[164:167], v[72:75], v[8:11]
v_mfma_f32_16x16x32_bf16 v[12:15], v[168:171], v[72:75], v[12:15]
s_add_u32 s35, s26, 24576
buffer_load_dwordx4 v[72:75], v1, s[4:7], s35 offen offset:0 sc1
s_waitcnt vmcnt(23)
v_mfma_f32_16x16x32_bf16 v[8:11], v[172:175], v[76:79], v[8:11]
v_mfma_f32_16x16x32_bf16 v[12:15], v[176:179], v[76:79], v[12:15]
buffer_load_dwordx4 v[76:79], v1, s[4:7], s35 offen offset:2048 sc1
s_waitcnt vmcnt(23)
v_mfma_f32_16x16x32_bf16 v[8:11], v[180:183], v[80:83], v[8:11]
v_mfma_f32_16x16x32_bf16 v[12:15], v[184:187], v[80:83], v[12:15]
s_waitcnt vmcnt(22)
v_mfma_f32_16x16x32_bf16 v[8:11], v[188:191], v[84:87], v[8:11]
v_mfma_f32_16x16x32_bf16 v[12:15], v[192:195], v[84:87], v[12:15]
s_waitcnt vmcnt(21)
v_mfma_f32_16x16x32_bf16 v[8:11], v[196:199], v[88:91], v[8:11]
v_mfma_f32_16x16x32_bf16 v[12:15], v[200:203], v[88:91], v[12:15]
s_waitcnt vmcnt(20)
v_mfma_f32_16x16x32_bf16 v[8:11], v[204:207], v[92:95], v[8:11]
v_mfma_f32_16x16x32_bf16 v[12:15], v[208:211], v[92:95], v[12:15]
s_waitcnt vmcnt(19)
v_mfma_f32_16x16x32_bf16 v[8:11], v[212:215], v[96:99], v[8:11]
v_mfma_f32_16x16x32_bf16 v[12:15], v[216:219], v[96:99], v[12:15]
s_waitcnt vmcnt(18)
v_mfma_f32_16x16x32_bf16 v[8:11], v[220:223], v[100:103], v[8:11]
v_mfma_f32_16x16x32_bf16 v[12:15], v[224:227], v[100:103], v[12:15]
s_waitcnt vmcnt(17)
v_mfma_f32_16x16x32_bf16 v[8:11], v[228:231], v[104:107], v[8:11]
v_mfma_f32_16x16x32_bf16 v[12:15], v[232:235], v[104:107], v[12:15]
s_waitcnt vmcnt(16)
v_mfma_f32_16x16x32_bf16 v[8:11], v[236:239], v[108:111], v[8:11]
v_mfma_f32_16x16x32_bf16 v[12:15], v[240:243], v[108:111], v[12:15]
s_waitcnt vmcnt(15)
v_mfma_f32_16x16x32_bf16 v[8:11], v[244:247], v[112:115], v[8:11]
v_mfma_f32_16x16x32_bf16 v[12:15], v[248:251], v[112:115], v[12:15]
s_mov_b32 s17, s26
s_nop 2
ds_write_b128 v3, v[8:11] offset:0
s_nop 2
ds_write_b128 v3, v[12:15] offset:64
s_waitcnt vmcnt(14) lgkmcnt(0)
s_barrier
s_mov_b32 exec_hi, 0
ds_read_b128 v[12:15], v4 offset:0
ds_read_b128 v[16:19], v4 offset:2304
ds_read_b128 v[20:23], v4 offset:4608
ds_read_b128 v[128:131], v4 offset:6912
v_lshlrev_b32 v8, 16, v138
v_and_b32 v9, 0xffff0000, v138
v_lshlrev_b32 v10, 16, v139
v_and_b32 v11, 0xffff0000, v139
v_add_f32 v8, v8, v132
v_add_f32 v9, v9, v133
v_add_f32 v10, v10, v134
v_add_f32 v11, v11, v135
s_waitcnt lgkmcnt(3)
v_add_f32 v8, v8, v12
v_add_f32 v9, v9, v13
v_add_f32 v10, v10, v14
v_add_f32 v11, v11, v15
s_waitcnt lgkmcnt(2)
v_add_f32 v8, v8, v16
v_add_f32 v9, v9, v17
v_add_f32 v10, v10, v18
v_add_f32 v11, v11, v19
s_waitcnt lgkmcnt(1)
v_add_f32 v8, v8, v20
v_add_f32 v9, v9, v21
v_add_f32 v10, v10, v22
v_add_f32 v11, v11, v23
s_waitcnt lgkmcnt(0)
v_add_f32 v8, v8, v128
v_add_f32 v9, v9, v129
v_add_f32 v10, v10, v130
v_add_f32 v11, v11, v131
v_cvt_pk_bf16_f32 v8, v8, v9
v_cvt_pk_bf16_f32 v9, v10, v11
buffer_store_dwordx2 v[8:9], v5, s[92:95], s19 offen
s_mov_b64 exec, -1
s_barrier
s_mov_b32 s16, s32
s_cmp_lt_u32 s16, 64
s_cbranch_scc1 L_f2_loop
s_waitcnt vmcnt(0)
s_branch L_done
L_role_kv:
s_lshr_b32 s35, s14, 1
s_sub_u32 s35, s35, 2
s_lshl_b32 s35, s35, 4
s_and_b32 s14, s13, 1
s_lshr_b32 s13, s13, 1
s_add_u32 s13, s13, s35
s_cmp_ge_u32 s12, 2
s_cselect_b32 s35, 32, 24
s_load_dwordx2 s[80:81], s[0:1], s35
s_waitcnt lgkmcnt(0)
s_mov_b32 s82, 5242880
s_mov_b32 s83, 0x20000
s_lshl_b32 s35, s13, 8
s_and_b32 s36, s12, 1
s_lshl_b32 s36, s36, 7
s_add_u32 s96, s35, s36
s_mov_b32 s16, s14
s_mov_b32 s21, 32
s_lshl_b32 s35, s13, 2
s_add_u32 s39, s35, s12
s_lshl_b32 s19, s13, 7
s_lshl_b32 s35, s14, 4
s_add_u32 s19, s19, s35
s_lshl_b32 s35, s12, 2
s_add_u32 s19, s19, s35
s_add_u32 s19, s19, 1572864
s_lshl_b32 s18, s39, 12
s_mul_i32 s35, s16, 524288
s_add_u32 s18, s18, s35
s_add_u32 s18, s18, 16777216
s_mul_i32 s22, s12, 10240
v_lshlrev_b32 v1, 4, v0
v_lshlrev_b32 v5, 7, v0
s_barrier
v_bfe_u32 v2, v0, 3, 3
v_mul_u32_u24 v3, 8192, v2
v_bfe_u32 v2, v0, 0, 2
v_mul_u32_u24 v2, 16, v2
v_add_u32 v3, v3, v2
v_bfe_u32 v2, v0, 2, 1
v_bfe_u32 v4, v0, 4, 1
v_xor_b32 v2, v2, v4
v_lshl_add_u32 v3, v2, 6, v3
v_bfe_u32 v2, v0, 5, 1
v_mul_u32_u24 v24, 1024, v2
v_bfe_u32 v2, v0, 2, 2
v_mul_u32_u24 v2, 128, v2
v_add_u32 v24, v24, v2
v_bfe_u32 v2, v0, 3, 1
v_mul_u32_u24 v2, 64, v2
v_add_u32 v24, v24, v2
v_bfe_u32 v2, v0, 4, 1
v_mul_u32_u24 v2, 32, v2
v_add_u32 v24, v24, v2
v_bfe_u32 v2, v0, 0, 2
v_mul_u32_u24 v2, 8, v2
v_add_u32 v24, v24, v2
s_mul_i32 s100, s12, 20480
s_add_u32 s100, s100, 81920
v_add_u32 v24, s100, v24
v_xor_b32 v25, 64, v24
s_add_u32 m0, s100, 0
s_add_u32 s35, s96, 0
buffer_load_dwordx4 v3, s[80:83], s35 offen lds
s_add_u32 m0, s100, 1024
s_add_u32 s35, s96, 65536
buffer_load_dwordx4 v3, s[80:83], s35 offen lds
s_add_u32 m0, s100, 2048
s_add_u32 s35, s96, 131072
buffer_load_dwordx4 v3, s[80:83], s35 offen lds
s_add_u32 m0, s100, 3072
s_add_u32 s35, s96, 196608
buffer_load_dwordx4 v3, s[80:83], s35 offen lds
s_add_u32 m0, s100, 4096
s_add_u32 s35, s96, 262144
buffer_load_dwordx4 v3, s[80:83], s35 offen lds
s_add_u32 m0, s100, 5120
s_add_u32 s35, s96, 327680
buffer_load_dwordx4 v3, s[80:83], s35 offen lds
s_add_u32 m0, s100, 6144
s_add_u32 s35, s96, 393216
buffer_load_dwordx4 v3, s[80:83], s35 offen lds
s_add_u32 m0, s100, 7168
s_add_u32 s35, s96, 458752
buffer_load_dwordx4 v3, s[80:83], s35 offen lds
s_add_u32 m0, s100, 8192
s_add_u32 s35, s96, 524288
buffer_load_dwordx4 v3, s[80:83], s35 offen lds
s_add_u32 m0, s100, 9216
s_add_u32 s35, s96, 589824
buffer_load_dwordx4 v3, s[80:83], s35 offen lds
s_add_u32 m0, s100, 10240
s_add_u32 s35, s96, 655360
buffer_load_dwordx4 v3, s[80:83], s35 offen lds
s_add_u32 m0, s100, 11264
s_add_u32 s35, s96, 720896
buffer_load_dwordx4 v3, s[80:83], s35 offen lds
s_add_u32 m0, s100, 12288
s_add_u32 s35, s96, 786432
buffer_load_dwordx4 v3, s[80:83], s35 offen lds
s_add_u32 m0, s100, 13312
s_add_u32 s35, s96, 851968
buffer_load_dwordx4 v3, s[80:83], s35 offen lds
s_add_u32 m0, s100, 14336
s_add_u32 s35, s96, 917504
buffer_load_dwordx4 v3, s[80:83], s35 offen lds
s_add_u32 m0, s100, 15360
s_add_u32 s35, s96, 983040
buffer_load_dwordx4 v3, s[80:83], s35 offen lds
s_add_u32 m0, s100, 16384
s_add_u32 s35, s96, 1048576
buffer_load_dwordx4 v3, s[80:83], s35 offen lds
s_add_u32 m0, s100, 17408
s_add_u32 s35, s96, 1114112
buffer_load_dwordx4 v3, s[80:83], s35 offen lds
s_add_u32 m0, s100, 18432
s_add_u32 s35, s96, 1179648
buffer_load_dwordx4 v3, s[80:83], s35 offen lds
s_add_u32 m0, s100, 19456
s_add_u32 s35, s96, 1245184
buffer_load_dwordx4 v3, s[80:83], s35 offen lds
s_waitcnt vmcnt(16)
ds_read_b64_tr_b16 a[0:1], v24 offset:0
ds_read_b64_tr_b16 a[2:3], v24 offset:512
ds_read_b64_tr_b16 a[4:5], v25 offset:0
ds_read_b64_tr_b16 a[6:7], v25 offset:512
ds_read_b64_tr_b16 a[8:9], v24 offset:2048
ds_read_b64_tr_b16 a[10:11], v24 offset:2560
ds_read_b64_tr_b16 a[12:13], v25 offset:2048
ds_read_b64_tr_b16 a[14:15], v25 offset:2560
s_waitcnt lgkmcnt(0)
s_add_u32 m0, s100, 0
s_add_u32 s35, s96, 1310720
buffer_load_dwordx4 v3, s[80:83], s35 offen lds
s_add_u32 m0, s100, 1024
s_add_u32 s35, s96, 1376256
buffer_load_dwordx4 v3, s[80:83], s35 offen lds
s_add_u32 m0, s100, 2048
s_add_u32 s35, s96, 1441792
buffer_load_dwordx4 v3, s[80:83], s35 offen lds
s_add_u32 m0, s100, 3072
s_add_u32 s35, s96, 1507328
buffer_load_dwordx4 v3, s[80:83], s35 offen lds
s_waitcnt vmcnt(16)
ds_read_b64_tr_b16 a[16:17], v24 offset:4096
ds_read_b64_tr_b16 a[18:19], v24 offset:4608
ds_read_b64_tr_b16 a[20:21], v25 offset:4096
ds_read_b64_tr_b16 a[22:23], v25 offset:4608
ds_read_b64_tr_b16 a[24:25], v24 offset:6144
ds_read_b64_tr_b16 a[26:27], v24 offset:6656
ds_read_b64_tr_b16 a[28:29], v25 offset:6144
ds_read_b64_tr_b16 a[30:31], v25 offset:6656
s_waitcnt lgkmcnt(0)
s_add_u32 m0, s100, 4096
s_add_u32 s35, s96, 1572864
buffer_load_dwordx4 v3, s[80:83], s35 offen lds
s_add_u32 m0, s100, 5120
s_add_u32 s35, s96, 1638400
buffer_load_dwordx4 v3, s[80:83], s35 offen lds
s_add_u32 m0, s100, 6144
s_add_u32 s35, s96, 1703936
buffer_load_dwordx4 v3, s[80:83], s35 offen lds
s_add_u32 m0, s100, 7168
s_add_u32 s35, s96, 1769472
buffer_load_dwordx4 v3, s[80:83], s35 offen lds
s_waitcnt vmcnt(16)
ds_read_b64_tr_b16 a[32:33], v24 offset:8192
ds_read_b64_tr_b16 a[34:35], v24 offset:8704
ds_read_b64_tr_b16 a[36:37], v25 offset:8192
ds_read_b64_tr_b16 a[38:39], v25 offset:8704
ds_read_b64_tr_b16 a[40:41], v24 offset:10240
ds_read_b64_tr_b16 a[42:43], v24 offset:10752
ds_read_b64_tr_b16 a[44:45], v25 offset:10240
ds_read_b64_tr_b16 a[46:47], v25 offset:10752
s_waitcnt lgkmcnt(0)
s_add_u32 m0, s100, 8192
s_add_u32 s35, s96, 1835008
buffer_load_dwordx4 v3, s[80:83], s35 offen lds
s_add_u32 m0, s100, 9216
s_add_u32 s35, s96, 1900544
buffer_load_dwordx4 v3, s[80:83], s35 offen lds
s_add_u32 m0, s100, 10240
s_add_u32 s35, s96, 1966080
buffer_load_dwordx4 v3, s[80:83], s35 offen lds
s_add_u32 m0, s100, 11264
s_add_u32 s35, s96, 2031616
buffer_load_dwordx4 v3, s[80:83], s35 offen lds
buffer_load_dword v26, off, s[8:11], 0 offset:128 sc1
s_waitcnt vmcnt(16)
ds_read_b64_tr_b16 a[48:49], v24 offset:12288
ds_read_b64_tr_b16 a[50:51], v24 offset:12800
ds_read_b64_tr_b16 a[52:53], v25 offset:12288
ds_read_b64_tr_b16 a[54:55], v25 offset:12800
ds_read_b64_tr_b16 a[56:57], v24 offset:14336
ds_read_b64_tr_b16 a[58:59], v24 offset:14848
ds_read_b64_tr_b16 a[60:61], v25 offset:14336
ds_read_b64_tr_b16 a[62:63], v25 offset:14848
s_waitcnt lgkmcnt(0)
s_add_u32 m0, s100, 12288
s_add_u32 s35, s96, 2097152
buffer_load_dwordx4 v3, s[80:83], s35 offen lds
s_add_u32 m0, s100, 13312
s_add_u32 s35, s96, 2162688
buffer_load_dwordx4 v3, s[80:83], s35 offen lds
s_add_u32 m0, s100, 14336
s_add_u32 s35, s96, 2228224
buffer_load_dwordx4 v3, s[80:83], s35 offen lds
s_add_u32 m0, s100, 15360
s_add_u32 s35, s96, 2293760
buffer_load_dwordx4 v3, s[80:83], s35 offen lds
s_waitcnt vmcnt(16)
ds_read_b64_tr_b16 a[64:65], v24 offset:16384
ds_read_b64_tr_b16 a[66:67], v24 offset:16896
ds_read_b64_tr_b16 a[68:69], v25 offset:16384
ds_read_b64_tr_b16 a[70:71], v25 offset:16896
ds_read_b64_tr_b16 a[72:73], v24 offset:18432
ds_read_b64_tr_b16 a[74:75], v24 offset:18944
ds_read_b64_tr_b16 a[76:77], v25 offset:18432
ds_read_b64_tr_b16 a[78:79], v25 offset:18944
s_waitcnt lgkmcnt(0)
s_add_u32 m0, s100, 16384
s_add_u32 s35, s96, 2359296
buffer_load_dwordx4 v3, s[80:83], s35 offen lds
s_add_u32 m0, s100, 17408
s_add_u32 s35, s96, 2424832
buffer_load_dwordx4 v3, s[80:83], s35 offen lds
s_add_u32 m0, s100, 18432
s_add_u32 s35, s96, 2490368
buffer_load_dwordx4 v3, s[80:83], s35 offen lds
s_add_u32 m0, s100, 19456
s_add_u32 s35, s96, 2555904
buffer_load_dwordx4 v3, s[80:83], s35 offen lds
s_waitcnt vmcnt(16)
ds_read_b64_tr_b16 a[80:81], v24 offset:0
ds_read_b64_tr_b16 a[82:83], v24 offset:512
ds_read_b64_tr_b16 a[84:85], v25 offset:0
ds_read_b64_tr_b16 a[86:87], v25 offset:512
ds_read_b64_tr_b16 a[88:89], v24 offset:2048
ds_read_b64_tr_b16 a[90:91], v24 offset:2560
ds_read_b64_tr_b16 a[92:93], v25 offset:2048
ds_read_b64_tr_b16 a[94:95], v25 offset:2560
s_waitcnt lgkmcnt(0)
s_add_u32 m0, s100, 0
s_add_u32 s35, s96, 2621440
buffer_load_dwordx4 v3, s[80:83], s35 offen lds
s_add_u32 m0, s100, 1024
s_add_u32 s35, s96, 2686976
buffer_load_dwordx4 v3, s[80:83], s35 offen lds
s_add_u32 m0, s100, 2048
s_add_u32 s35, s96, 2752512
buffer_load_dwordx4 v3, s[80:83], s35 offen lds
s_add_u32 m0, s100, 3072
s_add_u32 s35, s96, 2818048
buffer_load_dwordx4 v3, s[80:83], s35 offen lds
s_waitcnt vmcnt(16)
ds_read_b64_tr_b16 a[96:97], v24 offset:4096
ds_read_b64_tr_b16 a[98:99], v24 offset:4608
ds_read_b64_tr_b16 a[100:101], v25 offset:4096
ds_read_b64_tr_b16 a[102:103], v25 offset:4608
ds_read_b64_tr_b16 a[104:105], v24 offset:6144
ds_read_b64_tr_b16 a[106:107], v24 offset:6656
ds_read_b64_tr_b16 a[108:109], v25 offset:6144
ds_read_b64_tr_b16 a[110:111], v25 offset:6656
s_waitcnt lgkmcnt(0)
s_add_u32 m0, s100, 4096
s_add_u32 s35, s96, 2883584
buffer_load_dwordx4 v3, s[80:83], s35 offen lds
s_add_u32 m0, s100, 5120
s_add_u32 s35, s96, 2949120
buffer_load_dwordx4 v3, s[80:83], s35 offen lds
s_add_u32 m0, s100, 6144
s_add_u32 s35, s96, 3014656
buffer_load_dwordx4 v3, s[80:83], s35 offen lds
s_add_u32 m0, s100, 7168
s_add_u32 s35, s96, 3080192
buffer_load_dwordx4 v3, s[80:83], s35 offen lds
s_waitcnt vmcnt(16)
ds_read_b64_tr_b16 a[112:113], v24 offset:8192
ds_read_b64_tr_b16 a[114:115], v24 offset:8704
ds_read_b64_tr_b16 a[116:117], v25 offset:8192
ds_read_b64_tr_b16 a[118:119], v25 offset:8704
ds_read_b64_tr_b16 a[120:121], v24 offset:10240
ds_read_b64_tr_b16 a[122:123], v24 offset:10752
ds_read_b64_tr_b16 a[124:125], v25 offset:10240
ds_read_b64_tr_b16 a[126:127], v25 offset:10752
s_waitcnt lgkmcnt(0)
s_add_u32 m0, s100, 8192
s_add_u32 s35, s96, 3145728
buffer_load_dwordx4 v3, s[80:83], s35 offen lds
s_add_u32 m0, s100, 9216
s_add_u32 s35, s96, 3211264
buffer_load_dwordx4 v3, s[80:83], s35 offen lds
s_add_u32 m0, s100, 10240
s_add_u32 s35, s96, 3276800
buffer_load_dwordx4 v3, s[80:83], s35 offen lds
s_add_u32 m0, s100, 11264
s_add_u32 s35, s96, 3342336
buffer_load_dwordx4 v3, s[80:83], s35 offen lds
s_waitcnt vmcnt(16)
ds_read_b64_tr_b16 a[128:129], v24 offset:12288
ds_read_b64_tr_b16 a[130:131], v24 offset:12800
ds_read_b64_tr_b16 a[132:133], v25 offset:12288
ds_read_b64_tr_b16 a[134:135], v25 offset:12800
ds_read_b64_tr_b16 a[136:137], v24 offset:14336
ds_read_b64_tr_b16 a[138:139], v24 offset:14848
ds_read_b64_tr_b16 a[140:141], v25 offset:14336
ds_read_b64_tr_b16 a[142:143], v25 offset:14848
s_waitcnt lgkmcnt(0)
s_add_u32 m0, s100, 12288
s_add_u32 s35, s96, 3407872
buffer_load_dwordx4 v3, s[80:83], s35 offen lds
s_add_u32 m0, s100, 13312
s_add_u32 s35, s96, 3473408
buffer_load_dwordx4 v3, s[80:83], s35 offen lds
s_add_u32 m0, s100, 14336
s_add_u32 s35, s96, 3538944
buffer_load_dwordx4 v3, s[80:83], s35 offen lds
s_add_u32 m0, s100, 15360
s_add_u32 s35, s96, 3604480
buffer_load_dwordx4 v3, s[80:83], s35 offen lds
v_cmp_gt_u32 vcc, 1, v26
s_cbranch_vccz L_kv_clr
s_mov_b32 s38, 0
L_ww_kvclr:
buffer_load_dword v26, off, s[8:11], 0 offset:128 sc1
s_add_u32 s38, s38, 1
s_cmp_ge_u32 s38, 524288
s_cbranch_scc1 L_err
s_waitcnt vmcnt(0)
v_cmp_gt_u32 vcc, 1, v26
s_cbranch_vccz L_ww_kvclr_ok
s_sleep 4
s_branch L_ww_kvclr
L_ww_kvclr_ok:
L_kv_clr:
s_mov_b32 s35, 1589248
buffer_load_dword v26, v5, s[4:7], s35 offen sc1
s_waitcnt vmcnt(16)
ds_read_b64_tr_b16 a[144:145], v24 offset:16384
ds_read_b64_tr_b16 a[146:147], v24 offset:16896
ds_read_b64_tr_b16 a[148:149], v25 offset:16384
ds_read_b64_tr_b16 a[150:151], v25 offset:16896
ds_read_b64_tr_b16 a[152:153], v24 offset:18432
ds_read_b64_tr_b16 a[154:155], v24 offset:18944
ds_read_b64_tr_b16 a[156:157], v25 offset:18432
ds_read_b64_tr_b16 a[158:159], v25 offset:18944
s_waitcnt lgkmcnt(0)
s_add_u32 m0, s100, 16384
s_add_u32 s35, s96, 3670016
buffer_load_dwordx4 v3, s[80:83], s35 offen lds
s_add_u32 m0, s100, 17408
s_add_u32 s35, s96, 3735552
buffer_load_dwordx4 v3, s[80:83], s35 offen lds
s_add_u32 m0, s100, 18432
s_add_u32 s35, s96, 3801088
buffer_load_dwordx4 v3, s[80:83], s35 offen lds
s_add_u32 m0, s100, 19456
s_add_u32 s35, s96, 3866624
buffer_load_dwordx4 v3, s[80:83], s35 offen lds
s_waitcnt vmcnt(16)
ds_read_b64_tr_b16 a[160:161], v24 offset:0
ds_read_b64_tr_b16 a[162:163], v24 offset:512
ds_read_b64_tr_b16 a[164:165], v25 offset:0
ds_read_b64_tr_b16 a[166:167], v25 offset:512
ds_read_b64_tr_b16 a[168:169], v24 offset:2048
ds_read_b64_tr_b16 a[170:171], v24 offset:2560
ds_read_b64_tr_b16 a[172:173], v25 offset:2048
ds_read_b64_tr_b16 a[174:175], v25 offset:2560
s_waitcnt lgkmcnt(0)
s_add_u32 m0, s100, 0
s_add_u32 s35, s96, 3932160
buffer_load_dwordx4 v3, s[80:83], s35 offen lds
s_add_u32 m0, s100, 1024
s_add_u32 s35, s96, 3997696
buffer_load_dwordx4 v3, s[80:83], s35 offen lds
s_add_u32 m0, s100, 2048
s_add_u32 s35, s96, 4063232
buffer_load_dwordx4 v3, s[80:83], s35 offen lds
s_add_u32 m0, s100, 3072
s_add_u32 s35, s96, 4128768
buffer_load_dwordx4 v3, s[80:83], s35 offen lds
s_waitcnt vmcnt(16)
ds_read_b64_tr_b16 a[176:177], v24 offset:4096
ds_read_b64_tr_b16 a[178:179], v24 offset:4608
ds_read_b64_tr_b16 a[180:181], v25 offset:4096
ds_read_b64_tr_b16 a[182:183], v25 offset:4608
ds_read_b64_tr_b16 a[184:185], v24 offset:6144
ds_read_b64_tr_b16 a[186:187], v24 offset:6656
ds_read_b64_tr_b16 a[188:189], v25 offset:6144
ds_read_b64_tr_b16 a[190:191], v25 offset:6656
s_waitcnt lgkmcnt(0)
s_add_u32 m0, s100, 4096
s_add_u32 s35, s96, 4194304
buffer_load_dwordx4 v3, s[80:83], s35 offen lds
s_add_u32 m0, s100, 5120
s_add_u32 s35, s96, 4259840
buffer_load_dwordx4 v3, s[80:83], s35 offen lds
s_add_u32 m0, s100, 6144
s_add_u32 s35, s96, 4325376
buffer_load_dwordx4 v3, s[80:83], s35 offen lds
s_add_u32 m0, s100, 7168
s_add_u32 s35, s96, 4390912
buffer_load_dwordx4 v3, s[80:83], s35 offen lds
s_waitcnt vmcnt(16)
ds_read_b64_tr_b16 a[192:193], v24 offset:8192
ds_read_b64_tr_b16 a[194:195], v24 offset:8704
ds_read_b64_tr_b16 a[196:197], v25 offset:8192
ds_read_b64_tr_b16 a[198:199], v25 offset:8704
ds_read_b64_tr_b16 a[200:201], v24 offset:10240
ds_read_b64_tr_b16 a[202:203], v24 offset:10752
ds_read_b64_tr_b16 a[204:205], v25 offset:10240
ds_read_b64_tr_b16 a[206:207], v25 offset:10752
s_waitcnt lgkmcnt(0)
s_add_u32 m0, s100, 8192
s_add_u32 s35, s96, 4456448
buffer_load_dwordx4 v3, s[80:83], s35 offen lds
s_add_u32 m0, s100, 9216
s_add_u32 s35, s96, 4521984
buffer_load_dwordx4 v3, s[80:83], s35 offen lds
s_add_u32 m0, s100, 10240
s_add_u32 s35, s96, 4587520
buffer_load_dwordx4 v3, s[80:83], s35 offen lds
s_add_u32 m0, s100, 11264
s_add_u32 s35, s96, 4653056
buffer_load_dwordx4 v3, s[80:83], s35 offen lds
s_waitcnt vmcnt(16)
ds_read_b64_tr_b16 a[208:209], v24 offset:12288
ds_read_b64_tr_b16 a[210:211], v24 offset:12800
ds_read_b64_tr_b16 a[212:213], v25 offset:12288
ds_read_b64_tr_b16 a[214:215], v25 offset:12800
ds_read_b64_tr_b16 a[216:217], v24 offset:14336
ds_read_b64_tr_b16 a[218:219], v24 offset:14848
ds_read_b64_tr_b16 a[220:221], v25 offset:14336
ds_read_b64_tr_b16 a[222:223], v25 offset:14848
s_waitcnt lgkmcnt(0)
s_add_u32 m0, s100, 12288
s_add_u32 s35, s96, 4718592
buffer_load_dwordx4 v3, s[80:83], s35 offen lds
s_add_u32 m0, s100, 13312
s_add_u32 s35, s96, 4784128
buffer_load_dwordx4 v3, s[80:83], s35 offen lds
s_add_u32 m0, s100, 14336
s_add_u32 s35, s96, 4849664
buffer_load_dwordx4 v3, s[80:83], s35 offen lds
s_add_u32 m0, s100, 15360
s_add_u32 s35, s96, 4915200
buffer_load_dwordx4 v3, s[80:83], s35 offen lds
s_waitcnt vmcnt(16)
ds_read_b64_tr_b16 a[224:225], v24 offset:16384
ds_read_b64_tr_b16 a[226:227], v24 offset:16896
ds_read_b64_tr_b16 a[228:229], v25 offset:16384
ds_read_b64_tr_b16 a[230:231], v25 offset:16896
ds_read_b64_tr_b16 a[232:233], v24 offset:18432
ds_read_b64_tr_b16 a[234:235], v24 offset:18944
ds_read_b64_tr_b16 a[236:237], v25 offset:18432
ds_read_b64_tr_b16 a[238:239], v25 offset:18944
s_waitcnt lgkmcnt(0)
s_add_u32 m0, s100, 16384
s_add_u32 s35, s96, 4980736
buffer_load_dwordx4 v3, s[80:83], s35 offen lds
s_add_u32 m0, s100, 17408
s_add_u32 s35, s96, 5046272
buffer_load_dwordx4 v3, s[80:83], s35 offen lds
s_add_u32 m0, s100, 18432
s_add_u32 s35, s96, 5111808
buffer_load_dwordx4 v3, s[80:83], s35 offen lds
s_add_u32 m0, s100, 19456
s_add_u32 s35, s96, 5177344
buffer_load_dwordx4 v3, s[80:83], s35 offen lds
s_waitcnt vmcnt(16)
ds_read_b64_tr_b16 a[240:241], v24 offset:0
ds_read_b64_tr_b16 a[242:243], v24 offset:512
ds_read_b64_tr_b16 a[244:245], v25 offset:0
ds_read_b64_tr_b16 a[246:247], v25 offset:512
ds_read_b64_tr_b16 a[248:249], v24 offset:2048
ds_read_b64_tr_b16 a[250:251], v24 offset:2560
ds_read_b64_tr_b16 a[252:253], v25 offset:2048
ds_read_b64_tr_b16 a[254:255], v25 offset:2560
s_waitcnt lgkmcnt(0)
s_mov_b32 s38, 0
s_mov_b32 s35, 1589248
L_kv_xall:
v_cmp_gt_u32 vcc, 1, v26
s_cbranch_vccz L_kv_xok
buffer_load_dword v26, v5, s[4:7], s35 offen sc1
s_add_u32 s38, s38, 1
s_cmp_ge_u32 s38, 524288
s_cbranch_scc1 L_err
s_waitcnt vmcnt(0)
s_branch L_kv_xall
L_kv_xok:
s_mul_i32 s36, 0, 2
s_add_u32 s36, s36, s16
s_mul_i32 s36, s36, 40960
s_add_u32 s36, s36, s22
s_add_u32 s36, s36, 109051904
s_add_u32 s37, 0, s22
s_add_u32 m0, s37, 0
s_add_u32 s35, s36, 0
buffer_load_dwordx4 v1, s[4:7], s35 offen sc1 lds
s_add_u32 m0, s37, 1024
s_add_u32 s35, s36, 1024
buffer_load_dwordx4 v1, s[4:7], s35 offen sc1 lds
s_add_u32 m0, s37, 2048
s_add_u32 s35, s36, 2048
buffer_load_dwordx4 v1, s[4:7], s35 offen sc1 lds
s_add_u32 m0, s37, 3072
s_add_u32 s35, s36, 3072
buffer_load_dwordx4 v1, s[4:7], s35 offen sc1 lds
s_add_u32 m0, s37, 4096
s_add_u32 s35, s36, 4096
buffer_load_dwordx4 v1, s[4:7], s35 offen sc1 lds
s_add_u32 m0, s37, 5120
s_add_u32 s35, s36, 5120
buffer_load_dwordx4 v1, s[4:7], s35 offen sc1 lds
s_add_u32 m0, s37, 6144
s_add_u32 s35, s36, 6144
buffer_load_dwordx4 v1, s[4:7], s35 offen sc1 lds
s_add_u32 m0, s37, 7168
s_add_u32 s35, s36, 7168
buffer_load_dwordx4 v1, s[4:7], s35 offen sc1 lds
s_add_u32 m0, s37, 8192
s_add_u32 s35, s36, 8192
buffer_load_dwordx4 v1, s[4:7], s35 offen sc1 lds
s_add_u32 m0, s37, 9216
s_add_u32 s35, s36, 9216
buffer_load_dwordx4 v1, s[4:7], s35 offen sc1 lds
s_mul_i32 s36, 1, 2
s_add_u32 s36, s36, s16
s_mul_i32 s36, s36, 40960
s_add_u32 s36, s36, s22
s_add_u32 s36, s36, 109051904
s_add_u32 s37, 40960, s22
s_add_u32 m0, s37, 0
s_add_u32 s35, s36, 0
buffer_load_dwordx4 v1, s[4:7], s35 offen sc1 lds
s_add_u32 m0, s37, 1024
s_add_u32 s35, s36, 1024
buffer_load_dwordx4 v1, s[4:7], s35 offen sc1 lds
s_add_u32 m0, s37, 2048
s_add_u32 s35, s36, 2048
buffer_load_dwordx4 v1, s[4:7], s35 offen sc1 lds
s_add_u32 m0, s37, 3072
s_add_u32 s35, s36, 3072
buffer_load_dwordx4 v1, s[4:7], s35 offen sc1 lds
s_add_u32 m0, s37, 4096
s_add_u32 s35, s36, 4096
buffer_load_dwordx4 v1, s[4:7], s35 offen sc1 lds
s_add_u32 m0, s37, 5120
s_add_u32 s35, s36, 5120
buffer_load_dwordx4 v1, s[4:7], s35 offen sc1 lds
s_add_u32 m0, s37, 6144
s_add_u32 s35, s36, 6144
buffer_load_dwordx4 v1, s[4:7], s35 offen sc1 lds
s_add_u32 m0, s37, 7168
s_add_u32 s35, s36, 7168
buffer_load_dwordx4 v1, s[4:7], s35 offen sc1 lds
s_add_u32 m0, s37, 8192
s_add_u32 s35, s36, 8192
buffer_load_dwordx4 v1, s[4:7], s35 offen sc1 lds
s_add_u32 m0, s37, 9216
s_add_u32 s35, s36, 9216
buffer_load_dwordx4 v1, s[4:7], s35 offen sc1 lds
s_waitcnt vmcnt(32)
ds_read_b64_tr_b16 v[192:193], v24 offset:4096
ds_read_b64_tr_b16 v[194:195], v24 offset:4608
ds_read_b64_tr_b16 v[196:197], v25 offset:4096
ds_read_b64_tr_b16 v[198:199], v25 offset:4608
ds_read_b64_tr_b16 v[200:201], v24 offset:6144
ds_read_b64_tr_b16 v[202:203], v24 offset:6656
ds_read_b64_tr_b16 v[204:205], v25 offset:6144
ds_read_b64_tr_b16 v[206:207], v25 offset:6656
s_waitcnt lgkmcnt(0)
s_waitcnt vmcnt(28)
ds_read_b64_tr_b16 v[208:209], v24 offset:8192
ds_read_b64_tr_b16 v[210:211], v24 offset:8704
ds_read_b64_tr_b16 v[212:213], v25 offset:8192
ds_read_b64_tr_b16 v[214:215], v25 offset:8704
ds_read_b64_tr_b16 v[216:217], v24 offset:10240
ds_read_b64_tr_b16 v[218:219], v24 offset:10752
ds_read_b64_tr_b16 v[220:221], v25 offset:10240
ds_read_b64_tr_b16 v[222:223], v25 offset:10752
s_waitcnt lgkmcnt(0)
s_waitcnt vmcnt(24)
ds_read_b64_tr_b16 v[224:225], v24 offset:12288
ds_read_b64_tr_b16 v[226:227], v24 offset:12800
ds_read_b64_tr_b16 v[228:229], v25 offset:12288
ds_read_b64_tr_b16 v[230:231], v25 offset:12800
ds_read_b64_tr_b16 v[232:233], v24 offset:14336
ds_read_b64_tr_b16 v[234:235], v24 offset:14848
ds_read_b64_tr_b16 v[236:237], v25 offset:14336
ds_read_b64_tr_b16 v[238:239], v25 offset:14848
s_waitcnt lgkmcnt(0)
s_waitcnt vmcnt(20)
ds_read_b64_tr_b16 v[240:241], v24 offset:16384
ds_read_b64_tr_b16 v[242:243], v24 offset:16896
ds_read_b64_tr_b16 v[244:245], v25 offset:16384
ds_read_b64_tr_b16 v[246:247], v25 offset:16896
ds_read_b64_tr_b16 v[248:249], v24 offset:18432
ds_read_b64_tr_b16 v[250:251], v24 offset:18944
ds_read_b64_tr_b16 v[252:253], v25 offset:18432
ds_read_b64_tr_b16 v[254:255], v25 offset:18944
s_waitcnt lgkmcnt(0)
s_mov_b32 s24, 0xc0135761
s_mov_b32 s25, 0xbdd2d3e8
v_mov_b32 v6, s24
s_mov_b32 s17, 0
s_mov_b32 s20, 0
s_sub_u32 s27, s21, 1
s_waitcnt vmcnt(10)
s_barrier
s_cmp_ge_u32 s12, 2
s_cbranch_scc1 L_kv_v
v_add_u32 v7, s20, v1
s_add_u32 s39, s17, 2
s_min_u32 s39, s39, s27
s_add_u32 s26, s20, 81920
s_cmp_ge_u32 s26, 122880
s_cselect_b32 s35, 122880, 0
s_sub_u32 s26, s26, s35
ds_read_b128 v[128:131], v7 offset:0
ds_read_b128 v[132:135], v7 offset:1024
ds_read_b128 v[136:139], v7 offset:2048
s_mul_i32 s36, s39, 2
s_add_u32 s36, s36, s16
s_mul_i32 s36, s36, 40960
s_add_u32 s36, s36, s22
s_add_u32 s36, s36, 109051904
s_add_u32 s37, s26, s22
s_waitcnt lgkmcnt(2)
v_mfma_f32_32x32x16_bf16 v[64:79], a[0:3], v[128:131], 0
v_mfma_f32_32x32x16_bf16 v[80:95], a[4:7], v[128:131], 0
ds_read_b128 v[140:143], v7 offset:3072
s_waitcnt lgkmcnt(2)
v_mfma_f32_32x32x16_bf16 v[64:79], a[8:11], v[132:135], v[64:79]
s_add_u32 m0, s37, 0
s_add_u32 s35, s36, 0
buffer_load_dwordx4 v1, s[4:7], s35 offen sc1 lds
v_mfma_f32_32x32x16_bf16 v[80:95], a[12:15], v[132:135], v[80:95]
ds_read_b128 v[128:131], v7 offset:4096
s_add_u32 m0, s37, 1024
s_add_u32 s35, s36, 1024
buffer_load_dwordx4 v1, s[4:7], s35 offen sc1 lds
s_waitcnt lgkmcnt(2)
v_mfma_f32_32x32x16_bf16 v[64:79], a[16:19], v[136:139], v[64:79]
s_add_u32 m0, s37, 2048
s_add_u32 s35, s36, 2048
buffer_load_dwordx4 v1, s[4:7], s35 offen sc1 lds
v_mfma_f32_32x32x16_bf16 v[80:95], a[20:23], v[136:139], v[80:95]
ds_read_b128 v[132:135], v7 offset:5120
s_add_u32 m0, s37, 3072
s_add_u32 s35, s36, 3072
buffer_load_dwordx4 v1, s[4:7], s35 offen sc1 lds
s_waitcnt lgkmcnt(2)
v_mfma_f32_32x32x16_bf16 v[64:79], a[24:27], v[140:143], v[64:79]
s_add_u32 m0, s37, 4096
s_add_u32 s35, s36, 4096
buffer_load_dwordx4 v1, s[4:7], s35 offen sc1 lds
v_mfma_f32_32x32x16_bf16 v[80:95], a[28:31], v[140:143], v[80:95]
ds_read_b128 v[136:139], v7 offset:6144
s_add_u32 m0, s37, 5120
s_add_u32 s35, s36, 5120
buffer_load_dwordx4 v1, s[4:7], s35 offen sc1 lds
s_waitcnt lgkmcnt(2)
v_mfma_f32_32x32x16_bf16 v[64:79], a[32:35], v[128:131], v[64:79]
s_add_u32 m0, s37, 6144
s_add_u32 s35, s36, 6144
buffer_load_dwordx4 v1, s[4:7], s35 offen sc1 lds
v_mfma_f32_32x32x16_bf16 v[80:95], a[36:39], v[128:131], v[80:95]
ds_read_b128 v[140:143], v7 offset:7168
s_add_u32 m0, s37, 7168
s_add_u32 s35, s36, 7168
buffer_load_dwordx4 v1, s[4:7], s35 offen sc1 lds
s_waitcnt lgkmcnt(2)
v_mfma_f32_32x32x16_bf16 v[64:79], a[40:43], v[132:135], v[64:79]
s_add_u32 m0, s37, 8192
s_add_u32 s35, s36, 8192
buffer_load_dwordx4 v1, s[4:7], s35 offen sc1 lds
v_mfma_f32_32x32x16_bf16 v[80:95], a[44:47], v[132:135], v[80:95]
ds_read_b128 v[128:131], v7 offset:8192
s_add_u32 m0, s37, 9216
s_add_u32 s35, s36, 9216
buffer_load_dwordx4 v1, s[4:7], s35 offen sc1 lds
s_waitcnt lgkmcnt(2)
v_mfma_f32_32x32x16_bf16 v[64:79], a[48:51], v[136:139], v[64:79]
v_mfma_f32_32x32x16_bf16 v[80:95], a[52:55], v[136:139], v[80:95]
ds_read_b128 v[132:135], v7 offset:9216
s_waitcnt lgkmcnt(2)
v_mfma_f32_32x32x16_bf16 v[64:79], a[56:59], v[140:143], v[64:79]
v_mfma_f32_32x32x16_bf16 v[80:95], a[60:63], v[140:143], v[80:95]
ds_read_b128 v[136:139], v7 offset:10240
s_waitcnt lgkmcnt(2)
v_mfma_f32_32x32x16_bf16 v[64:79], a[64:67], v[128:131], v[64:79]
v_mfma_f32_32x32x16_bf16 v[80:95], a[68:71], v[128:131], v[80:95]
ds_read_b128 v[140:143], v7 offset:11264
s_waitcnt lgkmcnt(2)
v_mfma_f32_32x32x16_bf16 v[64:79], a[72:75], v[132:135], v[64:79]
v_mfma_f32_32x32x16_bf16 v[80:95], a[76:79], v[132:135], v[80:95]
ds_read_b128 v[128:131], v7 offset:12288
s_waitcnt lgkmcnt(2)
v_mfma_f32_32x32x16_bf16 v[64:79], a[80:83], v[136:139], v[64:79]
v_mfma_f32_32x32x16_bf16 v[80:95], a[84:87], v[136:139], v[80:95]
ds_read_b128 v[132:135], v7 offset:13312
s_waitcnt lgkmcnt(2)
v_mfma_f32_32x32x16_bf16 v[64:79], a[88:91], v[140:143], v[64:79]
v_mfma_f32_32x32x16_bf16 v[80:95], a[92:95], v[140:143], v[80:95]
ds_read_b128 v[136:139], v7 offset:14336
s_waitcnt lgkmcnt(2)
v_mfma_f32_32x32x16_bf16 v[64:79], a[96:99], v[128:131], v[64:79]
v_mfma_f32_32x32x16_bf16 v[80:95], a[100:103], v[128:131], v[80:95]
ds_read_b128 v[140:143], v7 offset:15360
s_waitcnt lgkmcnt(2)
v_mfma_f32_32x32x16_bf16 v[64:79], a[104:107], v[132:135], v[64:79]
v_mfma_f32_32x32x16_bf16 v[80:95], a[108:111], v[132:135], v[80:95]
ds_read_b128 v[128:131], v7 offset:16384
s_waitcnt lgkmcnt(2)
v_mfma_f32_32x32x16_bf16 v[64:79], a[112:115], v[136:139], v[64:79]
v_mfma_f32_32x32x16_bf16 v[80:95], a[116:119], v[136:139], v[80:95]
ds_read_b128 v[132:135], v7 offset:17408
s_waitcnt lgkmcnt(2)
v_mfma_f32_32x32x16_bf16 v[64:79], a[120:123], v[140:143], v[64:79]
v_mfma_f32_32x32x16_bf16 v[80:95], a[124:127], v[140:143], v[80:95]
ds_read_b128 v[136:139], v7 offset:18432
s_waitcnt lgkmcnt(2)
v_mfma_f32_32x32x16_bf16 v[64:79], a[128:131], v[128:131], v[64:79]
v_mfma_f32_32x32x16_bf16 v[80:95], a[132:135], v[128:131], v[80:95]
ds_read_b128 v[140:143], v7 offset:19456
s_waitcnt lgkmcnt(2)
v_mfma_f32_32x32x16_bf16 v[64:79], a[136:139], v[132:135], v[64:79]
v_mfma_f32_32x32x16_bf16 v[80:95], a[140:143], v[132:135], v[80:95]
ds_read_b128 v[128:131], v7 offset:20480
s_waitcnt lgkmcnt(2)
v_mfma_f32_32x32x16_bf16 v[64:79], a[144:147], v[136:139], v[64:79]
v_mfma_f32_32x32x16_bf16 v[80:95], a[148:151], v[136:139], v[80:95]
ds_read_b128 v[132:135], v7 offset:21504
s_waitcnt lgkmcnt(2)
v_mfma_f32_32x32x16_bf16 v[64:79], a[152:155], v[140:143], v[64:79]
v_mfma_f32_32x32x16_bf16 v[80:95], a[156:159], v[140:143], v[80:95]
ds_read_b128 v[136:139], v7 offset:22528
s_waitcnt lgkmcnt(2)
v_mfma_f32_32x32x16_bf16 v[64:79], a[160:163], v[128:131], v[64:79]
v_mfma_f32_32x32x16_bf16 v[80:95], a[164:167], v[128:131], v[80:95]
ds_read_b128 v[140:143], v7 offset:23552
s_waitcnt lgkmcnt(2)
v_mfma_f32_32x32x16_bf16 v[64:79], a[168:171], v[132:135], v[64:79]
v_mfma_f32_32x32x16_bf16 v[80:95], a[172:175], v[132:135], v[80:95]
ds_read_b128 v[128:131], v7 offset:24576
s_waitcnt lgkmcnt(2)
v_mfma_f32_32x32x16_bf16 v[64:79], a[176:179], v[136:139], v[64:79]
v_mfma_f32_32x32x16_bf16 v[80:95], a[180:183], v[136:139], v[80:95]
ds_read_b128 v[132:135], v7 offset:25600
s_waitcnt lgkmcnt(2)
v_mfma_f32_32x32x16_bf16 v[64:79], a[184:187], v[140:143], v[64:79]
v_mfma_f32_32x32x16_bf16 v[80:95], a[188:191], v[140:143], v[80:95]
ds_read_b128 v[136:139], v7 offset:26624
s_waitcnt lgkmcnt(2)
v_mfma_f32_32x32x16_bf16 v[64:79], a[192:195], v[128:131], v[64:79]
v_mfma_f32_32x32x16_bf16 v[80:95], a[196:199], v[128:131], v[80:95]
ds_read_b128 v[140:143], v7 offset:27648
s_waitcnt lgkmcnt(2)
v_mfma_f32_32x32x16_bf16 v[64:79], a[200:203], v[132:135], v[64:79]
v_mfma_f32_32x32x16_bf16 v[80:95], a[204:207], v[132:135], v[80:95]
ds_read_b128 v[128:131], v7 offset:28672
s_waitcnt lgkmcnt(2)
v_mfma_f32_32x32x16_bf16 v[64:79], a[208:211], v[136:139], v[64:79]
v_mfma_f32_32x32x16_bf16 v[80:95], a[212:215], v[136:139], v[80:95]
ds_read_b128 v[132:135], v7 offset:29696
s_waitcnt lgkmcnt(2)
v_mfma_f32_32x32x16_bf16 v[64:79], a[216:219], v[140:143], v[64:79]
v_mfma_f32_32x32x16_bf16 v[80:95], a[220:223], v[140:143], v[80:95]
ds_read_b128 v[136:139], v7 offset:30720
s_waitcnt lgkmcnt(2)
v_mfma_f32_32x32x16_bf16 v[64:79], a[224:227], v[128:131], v[64:79]
v_mfma_f32_32x32x16_bf16 v[80:95], a[228:231], v[128:131], v[80:95]
ds_read_b128 v[140:143], v7 offset:31744
s_waitcnt lgkmcnt(2)
v_mfma_f32_32x32x16_bf16 v[64:79], a[232:235], v[132:135], v[64:79]
v_mfma_f32_32x32x16_bf16 v[80:95], a[236:239], v[132:135], v[80:95]
ds_read_b128 v[128:131], v7 offset:32768
s_waitcnt lgkmcnt(2)
v_mfma_f32_32x32x16_bf16 v[64:79], a[240:243], v[136:139], v[64:79]
v_mfma_f32_32x32x16_bf16 v[80:95], a[244:247], v[136:139], v[80:95]
ds_read_b128 v[132:135], v7 offset:33792
s_waitcnt lgkmcnt(2)
v_mfma_f32_32x32x16_bf16 v[64:79], a[248:251], v[140:143], v[64:79]
v_mfma_f32_32x32x16_bf16 v[80:95], a[252:255], v[140:143], v[80:95]
ds_read_b128 v[136:139], v7 offset:34816
s_waitcnt lgkmcnt(2)
v_mfma_f32_32x32x16_bf16 v[64:79], v[192:195], v[128:131], v[64:79]
v_mfma_f32_32x32x16_bf16 v[80:95], v[196:199], v[128:131], v[80:95]
ds_read_b128 v[140:143], v7 offset:35840
s_waitcnt lgkmcnt(2)
v_mfma_f32_32x32x16_bf16 v[64:79], v[200:203], v[132:135], v[64:79]
v_mfma_f32_32x32x16_bf16 v[80:95], v[204:207], v[132:135], v[80:95]
ds_read_b128 v[128:131], v7 offset:36864
s_waitcnt lgkmcnt(2)
v_mfma_f32_32x32x16_bf16 v[64:79], v[208:211], v[136:139], v[64:79]
v_mfma_f32_32x32x16_bf16 v[80:95], v[212:215], v[136:139], v[80:95]
ds_read_b128 v[132:135], v7 offset:37888
s_waitcnt lgkmcnt(2)
v_mfma_f32_32x32x16_bf16 v[64:79], v[216:219], v[140:143], v[64:79]
v_mfma_f32_32x32x16_bf16 v[80:95], v[220:223], v[140:143], v[80:95]
ds_read_b128 v[136:139], v7 offset:38912
s_waitcnt lgkmcnt(2)
v_mfma_f32_32x32x16_bf16 v[64:79], v[224:227], v[128:131], v[64:79]
v_mfma_f32_32x32x16_bf16 v[80:95], v[228:231], v[128:131], v[80:95]
ds_read_b128 v[140:143], v7 offset:39936
s_waitcnt lgkmcnt(2)
v_mfma_f32_32x32x16_bf16 v[64:79], v[232:235], v[132:135], v[64:79]
v_mfma_f32_32x32x16_bf16 v[80:95], v[236:239], v[132:135], v[80:95]
s_waitcnt lgkmcnt(1)
v_mfma_f32_32x32x16_bf16 v[64:79], v[240:243], v[136:139], v[64:79]
v_mfma_f32_32x32x16_bf16 v[80:95], v[244:247], v[136:139], v[80:95]
s_waitcnt lgkmcnt(0)
v_mfma_f32_32x32x16_bf16 v[64:79], v[248:251], v[140:143], v[64:79]
v_mfma_f32_32x32x16_bf16 v[80:95], v[252:255], v[140:143], v[80:95]
s_waitcnt vmcnt(10)
s_add_u32 s20, s20, 40960
s_cmp_ge_u32 s20, 122880
s_cselect_b32 s20, 0, s20
s_add_u32 s17, s17, 1
s_barrier
v_cvt_pk_bf16_f32 v144, v64, v65
v_cvt_pk_bf16_f32 v145, v66, v67
v_cvt_pk_bf16_f32 v146, v68, v69
v_cvt_pk_bf16_f32 v147, v70, v71
buffer_store_dwordx4 v[144:147], v1, s[4:7], s18 offen offset:0 sc1
v_cvt_pk_bf16_f32 v148, v72, v73
v_cvt_pk_bf16_f32 v149, v74, v75
v_cvt_pk_bf16_f32 v150, v76, v77
v_cvt_pk_bf16_f32 v151, v78, v79
buffer_store_dwordx4 v[148:151], v1, s[4:7], s18 offen offset:1024 sc1
v_cvt_pk_bf16_f32 v152, v80, v81
v_cvt_pk_bf16_f32 v153, v82, v83
v_cvt_pk_bf16_f32 v154, v84, v85
v_cvt_pk_bf16_f32 v155, v86, v87
buffer_store_dwordx4 v[152:155], v1, s[4:7], s18 offen offset:2048 sc1
v_cvt_pk_bf16_f32 v156, v88, v89
v_cvt_pk_bf16_f32 v157, v90, v91
v_cvt_pk_bf16_f32 v158, v92, v93
v_cvt_pk_bf16_f32 v159, v94, v95
buffer_store_dwordx4 v[156:159], v1, s[4:7], s18 offen offset:3072 sc1
s_add_u32 s18, s18, 1048576
s_waitcnt vmcnt(0)
v_mov_b32 v4, s17
s_mov_b64 exec, 1
buffer_store_dword v4, off, s[4:7], s19 sc1
s_mov_b64 exec, -1
v_add_u32 v7, s20, v1
s_add_u32 s39, s17, 2
s_min_u32 s39, s39, s27
s_add_u32 s26, s20, 81920
s_cmp_ge_u32 s26, 122880
s_cselect_b32 s35, 122880, 0
s_sub_u32 s26, s26, s35
ds_read_b128 v[128:131], v7 offset:0
ds_read_b128 v[132:135], v7 offset:1024
ds_read_b128 v[136:139], v7 offset:2048
s_mul_i32 s36, s39, 2
s_add_u32 s36, s36, s16
s_mul_i32 s36, s36, 40960
s_add_u32 s36, s36, s22
s_add_u32 s36, s36, 109051904
s_add_u32 s37, s26, s22
s_waitcnt lgkmcnt(2)
v_mfma_f32_32x32x16_bf16 v[96:111], a[0:3], v[128:131], 0
v_mfma_f32_32x32x16_bf16 v[112:127], a[4:7], v[128:131], 0
ds_read_b128 v[140:143], v7 offset:3072
s_waitcnt lgkmcnt(2)
v_mfma_f32_32x32x16_bf16 v[96:111], a[8:11], v[132:135], v[96:111]
s_add_u32 m0, s37, 0
s_add_u32 s35, s36, 0
buffer_load_dwordx4 v1, s[4:7], s35 offen sc1 lds
v_mfma_f32_32x32x16_bf16 v[112:127], a[12:15], v[132:135], v[112:127]
ds_read_b128 v[128:131], v7 offset:4096
s_add_u32 m0, s37, 1024
s_add_u32 s35, s36, 1024
buffer_load_dwordx4 v1, s[4:7], s35 offen sc1 lds
s_waitcnt lgkmcnt(2)
v_mfma_f32_32x32x16_bf16 v[96:111], a[16:19], v[136:139], v[96:111]
s_add_u32 m0, s37, 2048
s_add_u32 s35, s36, 2048
buffer_load_dwordx4 v1, s[4:7], s35 offen sc1 lds
v_mfma_f32_32x32x16_bf16 v[112:127], a[20:23], v[136:139], v[112:127]
ds_read_b128 v[132:135], v7 offset:5120
s_add_u32 m0, s37, 3072
s_add_u32 s35, s36, 3072
buffer_load_dwordx4 v1, s[4:7], s35 offen sc1 lds
s_waitcnt lgkmcnt(2)
v_mfma_f32_32x32x16_bf16 v[96:111], a[24:27], v[140:143], v[96:111]
s_add_u32 m0, s37, 4096
s_add_u32 s35, s36, 4096
buffer_load_dwordx4 v1, s[4:7], s35 offen sc1 lds
v_mfma_f32_32x32x16_bf16 v[112:127], a[28:31], v[140:143], v[112:127]
ds_read_b128 v[136:139], v7 offset:6144
s_add_u32 m0, s37, 5120
s_add_u32 s35, s36, 5120
buffer_load_dwordx4 v1, s[4:7], s35 offen sc1 lds
s_waitcnt lgkmcnt(2)
v_mfma_f32_32x32x16_bf16 v[96:111], a[32:35], v[128:131], v[96:111]
s_add_u32 m0, s37, 6144
s_add_u32 s35, s36, 6144
buffer_load_dwordx4 v1, s[4:7], s35 offen sc1 lds
v_mfma_f32_32x32x16_bf16 v[112:127], a[36:39], v[128:131], v[112:127]
ds_read_b128 v[140:143], v7 offset:7168
s_add_u32 m0, s37, 7168
s_add_u32 s35, s36, 7168
buffer_load_dwordx4 v1, s[4:7], s35 offen sc1 lds
s_waitcnt lgkmcnt(2)
v_mfma_f32_32x32x16_bf16 v[96:111], a[40:43], v[132:135], v[96:111]
s_add_u32 m0, s37, 8192
s_add_u32 s35, s36, 8192
buffer_load_dwordx4 v1, s[4:7], s35 offen sc1 lds
v_mfma_f32_32x32x16_bf16 v[112:127], a[44:47], v[132:135], v[112:127]
ds_read_b128 v[128:131], v7 offset:8192
s_add_u32 m0, s37, 9216
s_add_u32 s35, s36, 9216
buffer_load_dwordx4 v1, s[4:7], s35 offen sc1 lds
s_waitcnt lgkmcnt(2)
v_mfma_f32_32x32x16_bf16 v[96:111], a[48:51], v[136:139], v[96:111]
v_mfma_f32_32x32x16_bf16 v[112:127], a[52:55], v[136:139], v[112:127]
ds_read_b128 v[132:135], v7 offset:9216
s_waitcnt lgkmcnt(2)
v_mfma_f32_32x32x16_bf16 v[96:111], a[56:59], v[140:143], v[96:111]
v_mfma_f32_32x32x16_bf16 v[112:127], a[60:63], v[140:143], v[112:127]
ds_read_b128 v[136:139], v7 offset:10240
s_waitcnt lgkmcnt(2)
v_mfma_f32_32x32x16_bf16 v[96:111], a[64:67], v[128:131], v[96:111]
v_mfma_f32_32x32x16_bf16 v[112:127], a[68:71], v[128:131], v[112:127]
ds_read_b128 v[140:143], v7 offset:11264
s_waitcnt lgkmcnt(2)
v_mfma_f32_32x32x16_bf16 v[96:111], a[72:75], v[132:135], v[96:111]
v_mfma_f32_32x32x16_bf16 v[112:127], a[76:79], v[132:135], v[112:127]
ds_read_b128 v[128:131], v7 offset:12288
s_waitcnt lgkmcnt(2)
v_mfma_f32_32x32x16_bf16 v[96:111], a[80:83], v[136:139], v[96:111]
v_mfma_f32_32x32x16_bf16 v[112:127], a[84:87], v[136:139], v[112:127]
ds_read_b128 v[132:135], v7 offset:13312
s_waitcnt lgkmcnt(2)
v_mfma_f32_32x32x16_bf16 v[96:111], a[88:91], v[140:143], v[96:111]
v_mfma_f32_32x32x16_bf16 v[112:127], a[92:95], v[140:143], v[112:127]
ds_read_b128 v[136:139], v7 offset:14336
s_waitcnt lgkmcnt(2)
v_mfma_f32_32x32x16_bf16 v[96:111], a[96:99], v[128:131], v[96:111]
v_mfma_f32_32x32x16_bf16 v[112:127], a[100:103], v[128:131], v[112:127]
ds_read_b128 v[140:143], v7 offset:15360
s_waitcnt lgkmcnt(2)
v_mfma_f32_32x32x16_bf16 v[96:111], a[104:107], v[132:135], v[96:111]
v_mfma_f32_32x32x16_bf16 v[112:127], a[108:111], v[132:135], v[112:127]
ds_read_b128 v[128:131], v7 offset:16384
s_waitcnt lgkmcnt(2)
v_mfma_f32_32x32x16_bf16 v[96:111], a[112:115], v[136:139], v[96:111]
v_mfma_f32_32x32x16_bf16 v[112:127], a[116:119], v[136:139], v[112:127]
ds_read_b128 v[132:135], v7 offset:17408
s_waitcnt lgkmcnt(2)
v_mfma_f32_32x32x16_bf16 v[96:111], a[120:123], v[140:143], v[96:111]
v_mfma_f32_32x32x16_bf16 v[112:127], a[124:127], v[140:143], v[112:127]
ds_read_b128 v[136:139], v7 offset:18432
s_waitcnt lgkmcnt(2)
v_mfma_f32_32x32x16_bf16 v[96:111], a[128:131], v[128:131], v[96:111]
v_mfma_f32_32x32x16_bf16 v[112:127], a[132:135], v[128:131], v[112:127]
ds_read_b128 v[140:143], v7 offset:19456
s_waitcnt lgkmcnt(2)
v_mfma_f32_32x32x16_bf16 v[96:111], a[136:139], v[132:135], v[96:111]
v_mfma_f32_32x32x16_bf16 v[112:127], a[140:143], v[132:135], v[112:127]
ds_read_b128 v[128:131], v7 offset:20480
s_waitcnt lgkmcnt(2)
v_mfma_f32_32x32x16_bf16 v[96:111], a[144:147], v[136:139], v[96:111]
v_mfma_f32_32x32x16_bf16 v[112:127], a[148:151], v[136:139], v[112:127]
ds_read_b128 v[132:135], v7 offset:21504
s_waitcnt lgkmcnt(2)
v_mfma_f32_32x32x16_bf16 v[96:111], a[152:155], v[140:143], v[96:111]
v_mfma_f32_32x32x16_bf16 v[112:127], a[156:159], v[140:143], v[112:127]
ds_read_b128 v[136:139], v7 offset:22528
s_waitcnt lgkmcnt(2)
v_mfma_f32_32x32x16_bf16 v[96:111], a[160:163], v[128:131], v[96:111]
v_mfma_f32_32x32x16_bf16 v[112:127], a[164:167], v[128:131], v[112:127]
ds_read_b128 v[140:143], v7 offset:23552
s_waitcnt lgkmcnt(2)
v_mfma_f32_32x32x16_bf16 v[96:111], a[168:171], v[132:135], v[96:111]
v_mfma_f32_32x32x16_bf16 v[112:127], a[172:175], v[132:135], v[112:127]
ds_read_b128 v[128:131], v7 offset:24576
s_waitcnt lgkmcnt(2)
v_mfma_f32_32x32x16_bf16 v[96:111], a[176:179], v[136:139], v[96:111]
v_mfma_f32_32x32x16_bf16 v[112:127], a[180:183], v[136:139], v[112:127]
ds_read_b128 v[132:135], v7 offset:25600
s_waitcnt lgkmcnt(2)
v_mfma_f32_32x32x16_bf16 v[96:111], a[184:187], v[140:143], v[96:111]
v_mfma_f32_32x32x16_bf16 v[112:127], a[188:191], v[140:143], v[112:127]
ds_read_b128 v[136:139], v7 offset:26624
s_waitcnt lgkmcnt(2)
v_mfma_f32_32x32x16_bf16 v[96:111], a[192:195], v[128:131], v[96:111]
v_mfma_f32_32x32x16_bf16 v[112:127], a[196:199], v[128:131], v[112:127]
ds_read_b128 v[140:143], v7 offset:27648
s_waitcnt lgkmcnt(2)
v_mfma_f32_32x32x16_bf16 v[96:111], a[200:203], v[132:135], v[96:111]
v_mfma_f32_32x32x16_bf16 v[112:127], a[204:207], v[132:135], v[112:127]
ds_read_b128 v[128:131], v7 offset:28672
s_waitcnt lgkmcnt(2)
v_mfma_f32_32x32x16_bf16 v[96:111], a[208:211], v[136:139], v[96:111]
v_mfma_f32_32x32x16_bf16 v[112:127], a[212:215], v[136:139], v[112:127]
ds_read_b128 v[132:135], v7 offset:29696
s_waitcnt lgkmcnt(2)
v_mfma_f32_32x32x16_bf16 v[96:111], a[216:219], v[140:143], v[96:111]
v_mfma_f32_32x32x16_bf16 v[112:127], a[220:223], v[140:143], v[112:127]
ds_read_b128 v[136:139], v7 offset:30720
s_waitcnt lgkmcnt(2)
v_mfma_f32_32x32x16_bf16 v[96:111], a[224:227], v[128:131], v[96:111]
v_mfma_f32_32x32x16_bf16 v[112:127], a[228:231], v[128:131], v[112:127]
ds_read_b128 v[140:143], v7 offset:31744
s_waitcnt lgkmcnt(2)
v_mfma_f32_32x32x16_bf16 v[96:111], a[232:235], v[132:135], v[96:111]
v_mfma_f32_32x32x16_bf16 v[112:127], a[236:239], v[132:135], v[112:127]
ds_read_b128 v[128:131], v7 offset:32768
s_waitcnt lgkmcnt(2)
v_mfma_f32_32x32x16_bf16 v[96:111], a[240:243], v[136:139], v[96:111]
v_mfma_f32_32x32x16_bf16 v[112:127], a[244:247], v[136:139], v[112:127]
ds_read_b128 v[132:135], v7 offset:33792
s_waitcnt lgkmcnt(2)
v_mfma_f32_32x32x16_bf16 v[96:111], a[248:251], v[140:143], v[96:111]
v_mfma_f32_32x32x16_bf16 v[112:127], a[252:255], v[140:143], v[112:127]
ds_read_b128 v[136:139], v7 offset:34816
s_waitcnt lgkmcnt(2)
v_mfma_f32_32x32x16_bf16 v[96:111], v[192:195], v[128:131], v[96:111]
v_mfma_f32_32x32x16_bf16 v[112:127], v[196:199], v[128:131], v[112:127]
ds_read_b128 v[140:143], v7 offset:35840
s_waitcnt lgkmcnt(2)
v_mfma_f32_32x32x16_bf16 v[96:111], v[200:203], v[132:135], v[96:111]
v_mfma_f32_32x32x16_bf16 v[112:127], v[204:207], v[132:135], v[112:127]
ds_read_b128 v[128:131], v7 offset:36864
s_waitcnt lgkmcnt(2)
v_mfma_f32_32x32x16_bf16 v[96:111], v[208:211], v[136:139], v[96:111]
v_mfma_f32_32x32x16_bf16 v[112:127], v[212:215], v[136:139], v[112:127]
ds_read_b128 v[132:135], v7 offset:37888
s_waitcnt lgkmcnt(2)
v_mfma_f32_32x32x16_bf16 v[96:111], v[216:219], v[140:143], v[96:111]
v_mfma_f32_32x32x16_bf16 v[112:127], v[220:223], v[140:143], v[112:127]
ds_read_b128 v[136:139], v7 offset:38912
s_waitcnt lgkmcnt(2)
v_mfma_f32_32x32x16_bf16 v[96:111], v[224:227], v[128:131], v[96:111]
v_mfma_f32_32x32x16_bf16 v[112:127], v[228:231], v[128:131], v[112:127]
ds_read_b128 v[140:143], v7 offset:39936
s_waitcnt lgkmcnt(2)
v_mfma_f32_32x32x16_bf16 v[96:111], v[232:235], v[132:135], v[96:111]
v_mfma_f32_32x32x16_bf16 v[112:127], v[236:239], v[132:135], v[112:127]
s_waitcnt lgkmcnt(1)
v_mfma_f32_32x32x16_bf16 v[96:111], v[240:243], v[136:139], v[96:111]
v_mfma_f32_32x32x16_bf16 v[112:127], v[244:247], v[136:139], v[112:127]
s_waitcnt lgkmcnt(0)
v_mfma_f32_32x32x16_bf16 v[96:111], v[248:251], v[140:143], v[96:111]
v_mfma_f32_32x32x16_bf16 v[112:127], v[252:255], v[140:143], v[112:127]
s_waitcnt vmcnt(10)
s_add_u32 s20, s20, 40960
s_cmp_ge_u32 s20, 122880
s_cselect_b32 s20, 0, s20
s_add_u32 s17, s17, 1
s_barrier
L_kvk_loop:
v_add_u32 v7, s20, v1
s_add_u32 s39, s17, 2
s_min_u32 s39, s39, s27
s_add_u32 s26, s20, 81920
s_cmp_ge_u32 s26, 122880
s_cselect_b32 s35, 122880, 0
s_sub_u32 s26, s26, s35
ds_read_b128 v[128:131], v7 offset:0
ds_read_b128 v[132:135], v7 offset:1024
ds_read_b128 v[136:139], v7 offset:2048
s_mul_i32 s36, s39, 2
s_add_u32 s36, s36, s16
s_mul_i32 s36, s36, 40960
s_add_u32 s36, s36, s22
s_add_u32 s36, s36, 109051904
s_add_u32 s37, s26, s22
s_waitcnt lgkmcnt(2)
v_mfma_f32_32x32x16_bf16 v[64:79], a[0:3], v[128:131], 0
v_mfma_f32_32x32x16_bf16 v[80:95], a[4:7], v[128:131], 0
ds_read_b128 v[140:143], v7 offset:3072
s_waitcnt lgkmcnt(2)
v_mfma_f32_32x32x16_bf16 v[64:79], a[8:11], v[132:135], v[64:79]
v_cvt_pk_bf16_f32 v144, v96, v97
v_mfma_f32_32x32x16_bf16 v[80:95], a[12:15], v[132:135], v[80:95]
ds_read_b128 v[128:131], v7 offset:4096
v_cvt_pk_bf16_f32 v145, v98, v99
s_waitcnt lgkmcnt(2)
v_mfma_f32_32x32x16_bf16 v[64:79], a[16:19], v[136:139], v[64:79]
v_cvt_pk_bf16_f32 v146, v100, v101
v_mfma_f32_32x32x16_bf16 v[80:95], a[20:23], v[136:139], v[80:95]
ds_read_b128 v[132:135], v7 offset:5120
v_cvt_pk_bf16_f32 v147, v102, v103
s_waitcnt lgkmcnt(2)
v_mfma_f32_32x32x16_bf16 v[64:79], a[24:27], v[140:143], v[64:79]
buffer_store_dwordx4 v[144:147], v1, s[4:7], s18 offen offset:0 sc1
v_mfma_f32_32x32x16_bf16 v[80:95], a[28:31], v[140:143], v[80:95]
ds_read_b128 v[136:139], v7 offset:6144
v_cvt_pk_bf16_f32 v148, v104, v105
s_waitcnt lgkmcnt(2)
v_mfma_f32_32x32x16_bf16 v[64:79], a[32:35], v[128:131], v[64:79]
v_cvt_pk_bf16_f32 v149, v106, v107
v_mfma_f32_32x32x16_bf16 v[80:95], a[36:39], v[128:131], v[80:95]
ds_read_b128 v[140:143], v7 offset:7168
v_cvt_pk_bf16_f32 v150, v108, v109
s_waitcnt lgkmcnt(2)
v_mfma_f32_32x32x16_bf16 v[64:79], a[40:43], v[132:135], v[64:79]
v_cvt_pk_bf16_f32 v151, v110, v111
v_mfma_f32_32x32x16_bf16 v[80:95], a[44:47], v[132:135], v[80:95]
ds_read_b128 v[128:131], v7 offset:8192
buffer_store_dwordx4 v[148:151], v1, s[4:7], s18 offen offset:1024 sc1
s_waitcnt lgkmcnt(2)
v_mfma_f32_32x32x16_bf16 v[64:79], a[48:51], v[136:139], v[64:79]
v_cvt_pk_bf16_f32 v152, v112, v113
v_mfma_f32_32x32x16_bf16 v[80:95], a[52:55], v[136:139], v[80:95]
ds_read_b128 v[132:135], v7 offset:9216
v_cvt_pk_bf16_f32 v153, v114, v115
s_waitcnt lgkmcnt(2)
v_mfma_f32_32x32x16_bf16 v[64:79], a[56:59], v[140:143], v[64:79]
v_cvt_pk_bf16_f32 v154, v116, v117
v_mfma_f32_32x32x16_bf16 v[80:95], a[60:63], v[140:143], v[80:95]
ds_read_b128 v[136:139], v7 offset:10240
v_cvt_pk_bf16_f32 v155, v118, v119
s_waitcnt lgkmcnt(2)
v_mfma_f32_32x32x16_bf16 v[64:79], a[64:67], v[128:131], v[64:79]
buffer_store_dwordx4 v[152:155], v1, s[4:7], s18 offen offset:2048 sc1
v_mfma_f32_32x32x16_bf16 v[80:95], a[68:71], v[128:131], v[80:95]
ds_read_b128 v[140:143], v7 offset:11264
v_cvt_pk_bf16_f32 v156, v120, v121
s_waitcnt lgkmcnt(2)
v_mfma_f32_32x32x16_bf16 v[64:79], a[72:75], v[132:135], v[64:79]
v_cvt_pk_bf16_f32 v157, v122, v123
v_mfma_f32_32x32x16_bf16 v[80:95], a[76:79], v[132:135], v[80:95]
ds_read_b128 v[128:131], v7 offset:12288
v_cvt_pk_bf16_f32 v158, v124, v125
s_waitcnt lgkmcnt(2)
v_mfma_f32_32x32x16_bf16 v[64:79], a[80:83], v[136:139], v[64:79]
v_cvt_pk_bf16_f32 v159, v126, v127
v_mfma_f32_32x32x16_bf16 v[80:95], a[84:87], v[136:139], v[80:95]
ds_read_b128 v[132:135], v7 offset:13312
buffer_store_dwordx4 v[156:159], v1, s[4:7], s18 offen offset:3072 sc1
s_waitcnt lgkmcnt(2)
v_mfma_f32_32x32x16_bf16 v[64:79], a[88:91], v[140:143], v[64:79]
s_add_u32 s18, s18, 1048576
v_mfma_f32_32x32x16_bf16 v[80:95], a[92:95], v[140:143], v[80:95]
ds_read_b128 v[136:139], v7 offset:14336
s_add_u32 m0, s37, 0
s_add_u32 s35, s36, 0
buffer_load_dwordx4 v1, s[4:7], s35 offen sc1 lds
s_waitcnt lgkmcnt(2)
v_mfma_f32_32x32x16_bf16 v[64:79], a[96:99], v[128:131], v[64:79]
s_add_u32 m0, s37, 1024
s_add_u32 s35, s36, 1024
buffer_load_dwordx4 v1, s[4:7], s35 offen sc1 lds
v_mfma_f32_32x32x16_bf16 v[80:95], a[100:103], v[128:131], v[80:95]
ds_read_b128 v[140:143], v7 offset:15360
s_add_u32 m0, s37, 2048
s_add_u32 s35, s36, 2048
buffer_load_dwordx4 v1, s[4:7], s35 offen sc1 lds
s_waitcnt lgkmcnt(2)
v_mfma_f32_32x32x16_bf16 v[64:79], a[104:107], v[132:135], v[64:79]
s_add_u32 m0, s37, 3072
s_add_u32 s35, s36, 3072
buffer_load_dwordx4 v1, s[4:7], s35 offen sc1 lds
v_mfma_f32_32x32x16_bf16 v[80:95], a[108:111], v[132:135], v[80:95]
ds_read_b128 v[128:131], v7 offset:16384
s_add_u32 m0, s37, 4096
s_add_u32 s35, s36, 4096
buffer_load_dwordx4 v1, s[4:7], s35 offen sc1 lds
s_waitcnt lgkmcnt(2)
v_mfma_f32_32x32x16_bf16 v[64:79], a[112:115], v[136:139], v[64:79]
s_add_u32 m0, s37, 5120
s_add_u32 s35, s36, 5120
buffer_load_dwordx4 v1, s[4:7], s35 offen sc1 lds
v_mfma_f32_32x32x16_bf16 v[80:95], a[116:119], v[136:139], v[80:95]
ds_read_b128 v[132:135], v7 offset:17408
s_add_u32 m0, s37, 6144
s_add_u32 s35, s36, 6144
buffer_load_dwordx4 v1, s[4:7], s35 offen sc1 lds
s_waitcnt lgkmcnt(2)
v_mfma_f32_32x32x16_bf16 v[64:79], a[120:123], v[140:143], v[64:79]
s_add_u32 m0, s37, 7168
s_add_u32 s35, s36, 7168
buffer_load_dwordx4 v1, s[4:7], s35 offen sc1 lds
v_mfma_f32_32x32x16_bf16 v[80:95], a[124:127], v[140:143], v[80:95]
ds_read_b128 v[136:139], v7 offset:18432
s_add_u32 m0, s37, 8192
s_add_u32 s35, s36, 8192
buffer_load_dwordx4 v1, s[4:7], s35 offen sc1 lds
s_waitcnt lgkmcnt(2)
v_mfma_f32_32x32x16_bf16 v[64:79], a[128:131], v[128:131], v[64:79]
s_add_u32 m0, s37, 9216
s_add_u32 s35, s36, 9216
buffer_load_dwordx4 v1, s[4:7], s35 offen sc1 lds
v_mfma_f32_32x32x16_bf16 v[80:95], a[132:135], v[128:131], v[80:95]
ds_read_b128 v[140:143], v7 offset:19456
s_waitcnt lgkmcnt(2)
v_mfma_f32_32x32x16_bf16 v[64:79], a[136:139], v[132:135], v[64:79]
v_mfma_f32_32x32x16_bf16 v[80:95], a[140:143], v[132:135], v[80:95]
ds_read_b128 v[128:131], v7 offset:20480
s_waitcnt lgkmcnt(2)
v_mfma_f32_32x32x16_bf16 v[64:79], a[144:147], v[136:139], v[64:79]
v_mfma_f32_32x32x16_bf16 v[80:95], a[148:151], v[136:139], v[80:95]
ds_read_b128 v[132:135], v7 offset:21504
s_waitcnt lgkmcnt(2)
v_mfma_f32_32x32x16_bf16 v[64:79], a[152:155], v[140:143], v[64:79]
v_mfma_f32_32x32x16_bf16 v[80:95], a[156:159], v[140:143], v[80:95]
ds_read_b128 v[136:139], v7 offset:22528
s_waitcnt lgkmcnt(2)
v_mfma_f32_32x32x16_bf16 v[64:79], a[160:163], v[128:131], v[64:79]
v_mfma_f32_32x32x16_bf16 v[80:95], a[164:167], v[128:131], v[80:95]
ds_read_b128 v[140:143], v7 offset:23552
s_waitcnt lgkmcnt(2)
v_mfma_f32_32x32x16_bf16 v[64:79], a[168:171], v[132:135], v[64:79]
v_mfma_f32_32x32x16_bf16 v[80:95], a[172:175], v[132:135], v[80:95]
ds_read_b128 v[128:131], v7 offset:24576
s_waitcnt lgkmcnt(2)
v_mfma_f32_32x32x16_bf16 v[64:79], a[176:179], v[136:139], v[64:79]
v_mfma_f32_32x32x16_bf16 v[80:95], a[180:183], v[136:139], v[80:95]
ds_read_b128 v[132:135], v7 offset:25600
s_waitcnt lgkmcnt(2)
v_mfma_f32_32x32x16_bf16 v[64:79], a[184:187], v[140:143], v[64:79]
v_mfma_f32_32x32x16_bf16 v[80:95], a[188:191], v[140:143], v[80:95]
ds_read_b128 v[136:139], v7 offset:26624
s_waitcnt lgkmcnt(2)
v_mfma_f32_32x32x16_bf16 v[64:79], a[192:195], v[128:131], v[64:79]
v_mfma_f32_32x32x16_bf16 v[80:95], a[196:199], v[128:131], v[80:95]
ds_read_b128 v[140:143], v7 offset:27648
s_waitcnt lgkmcnt(2)
v_mfma_f32_32x32x16_bf16 v[64:79], a[200:203], v[132:135], v[64:79]
v_mfma_f32_32x32x16_bf16 v[80:95], a[204:207], v[132:135], v[80:95]
ds_read_b128 v[128:131], v7 offset:28672
s_waitcnt lgkmcnt(2)
v_mfma_f32_32x32x16_bf16 v[64:79], a[208:211], v[136:139], v[64:79]
v_mfma_f32_32x32x16_bf16 v[80:95], a[212:215], v[136:139], v[80:95]
ds_read_b128 v[132:135], v7 offset:29696
s_waitcnt lgkmcnt(2)
v_mfma_f32_32x32x16_bf16 v[64:79], a[216:219], v[140:143], v[64:79]
v_mfma_f32_32x32x16_bf16 v[80:95], a[220:223], v[140:143], v[80:95]
ds_read_b128 v[136:139], v7 offset:30720
s_waitcnt lgkmcnt(2)
v_mfma_f32_32x32x16_bf16 v[64:79], a[224:227], v[128:131], v[64:79]
v_mfma_f32_32x32x16_bf16 v[80:95], a[228:231], v[128:131], v[80:95]
ds_read_b128 v[140:143], v7 offset:31744
s_waitcnt lgkmcnt(2)
v_mfma_f32_32x32x16_bf16 v[64:79], a[232:235], v[132:135], v[64:79]
v_mfma_f32_32x32x16_bf16 v[80:95], a[236:239], v[132:135], v[80:95]
ds_read_b128 v[128:131], v7 offset:32768
s_waitcnt lgkmcnt(2)
v_mfma_f32_32x32x16_bf16 v[64:79], a[240:243], v[136:139], v[64:79]
v_mfma_f32_32x32x16_bf16 v[80:95], a[244:247], v[136:139], v[80:95]
ds_read_b128 v[132:135], v7 offset:33792
s_waitcnt lgkmcnt(2)
v_mfma_f32_32x32x16_bf16 v[64:79], a[248:251], v[140:143], v[64:79]
v_mfma_f32_32x32x16_bf16 v[80:95], a[252:255], v[140:143], v[80:95]
ds_read_b128 v[136:139], v7 offset:34816
s_waitcnt lgkmcnt(2)
v_mfma_f32_32x32x16_bf16 v[64:79], v[192:195], v[128:131], v[64:79]
v_mfma_f32_32x32x16_bf16 v[80:95], v[196:199], v[128:131], v[80:95]
ds_read_b128 v[140:143], v7 offset:35840
s_waitcnt lgkmcnt(2)
v_mfma_f32_32x32x16_bf16 v[64:79], v[200:203], v[132:135], v[64:79]
v_mfma_f32_32x32x16_bf16 v[80:95], v[204:207], v[132:135], v[80:95]
ds_read_b128 v[128:131], v7 offset:36864
s_waitcnt lgkmcnt(2)
v_mfma_f32_32x32x16_bf16 v[64:79], v[208:211], v[136:139], v[64:79]
v_mfma_f32_32x32x16_bf16 v[80:95], v[212:215], v[136:139], v[80:95]
ds_read_b128 v[132:135], v7 offset:37888
s_waitcnt lgkmcnt(2)
v_mfma_f32_32x32x16_bf16 v[64:79], v[216:219], v[140:143], v[64:79]
v_mfma_f32_32x32x16_bf16 v[80:95], v[220:223], v[140:143], v[80:95]
ds_read_b128 v[136:139], v7 offset:38912
s_waitcnt lgkmcnt(2)
v_mfma_f32_32x32x16_bf16 v[64:79], v[224:227], v[128:131], v[64:79]
v_mfma_f32_32x32x16_bf16 v[80:95], v[228:231], v[128:131], v[80:95]
ds_read_b128 v[140:143], v7 offset:39936
s_waitcnt lgkmcnt(2)
v_mfma_f32_32x32x16_bf16 v[64:79], v[232:235], v[132:135], v[64:79]
v_mfma_f32_32x32x16_bf16 v[80:95], v[236:239], v[132:135], v[80:95]
s_waitcnt lgkmcnt(1)
v_mfma_f32_32x32x16_bf16 v[64:79], v[240:243], v[136:139], v[64:79]
v_mfma_f32_32x32x16_bf16 v[80:95], v[244:247], v[136:139], v[80:95]
s_waitcnt lgkmcnt(0)
v_mfma_f32_32x32x16_bf16 v[64:79], v[248:251], v[140:143], v[64:79]
v_mfma_f32_32x32x16_bf16 v[80:95], v[252:255], v[140:143], v[80:95]
s_waitcnt vmcnt(10)
v_mov_b32 v4, s17
s_mov_b64 exec, 1
buffer_store_dword v4, off, s[4:7], s19 sc1
s_mov_b64 exec, -1
s_add_u32 s20, s20, 40960
s_cmp_ge_u32 s20, 122880
s_cselect_b32 s20, 0, s20
s_add_u32 s17, s17, 1
s_barrier
v_add_u32 v7, s20, v1
s_add_u32 s39, s17, 2
s_min_u32 s39, s39, s27
s_add_u32 s26, s20, 81920
s_cmp_ge_u32 s26, 122880
s_cselect_b32 s35, 122880, 0
s_sub_u32 s26, s26, s35
ds_read_b128 v[128:131], v7 offset:0
ds_read_b128 v[132:135], v7 offset:1024
ds_read_b128 v[136:139], v7 offset:2048
s_mul_i32 s36, s39, 2
s_add_u32 s36, s36, s16
s_mul_i32 s36, s36, 40960
s_add_u32 s36, s36, s22
s_add_u32 s36, s36, 109051904
s_add_u32 s37, s26, s22
s_waitcnt lgkmcnt(2)
v_mfma_f32_32x32x16_bf16 v[96:111], a[0:3], v[128:131], 0
v_mfma_f32_32x32x16_bf16 v[112:127], a[4:7], v[128:131], 0
ds_read_b128 v[140:143], v7 offset:3072
s_waitcnt lgkmcnt(2)
v_mfma_f32_32x32x16_bf16 v[96:111], a[8:11], v[132:135], v[96:111]
v_cvt_pk_bf16_f32 v144, v64, v65
v_mfma_f32_32x32x16_bf16 v[112:127], a[12:15], v[132:135], v[112:127]
ds_read_b128 v[128:131], v7 offset:4096
v_cvt_pk_bf16_f32 v145, v66, v67
s_waitcnt lgkmcnt(2)
v_mfma_f32_32x32x16_bf16 v[96:111], a[16:19], v[136:139], v[96:111]
v_cvt_pk_bf16_f32 v146, v68, v69
v_mfma_f32_32x32x16_bf16 v[112:127], a[20:23], v[136:139], v[112:127]
ds_read_b128 v[132:135], v7 offset:5120
v_cvt_pk_bf16_f32 v147, v70, v71
s_waitcnt lgkmcnt(2)
v_mfma_f32_32x32x16_bf16 v[96:111], a[24:27], v[140:143], v[96:111]
buffer_store_dwordx4 v[144:147], v1, s[4:7], s18 offen offset:0 sc1
v_mfma_f32_32x32x16_bf16 v[112:127], a[28:31], v[140:143], v[112:127]
ds_read_b128 v[136:139], v7 offset:6144
v_cvt_pk_bf16_f32 v148, v72, v73
s_waitcnt lgkmcnt(2)
v_mfma_f32_32x32x16_bf16 v[96:111], a[32:35], v[128:131], v[96:111]
v_cvt_pk_bf16_f32 v149, v74, v75
v_mfma_f32_32x32x16_bf16 v[112:127], a[36:39], v[128:131], v[112:127]
ds_read_b128 v[140:143], v7 offset:7168
v_cvt_pk_bf16_f32 v150, v76, v77
s_waitcnt lgkmcnt(2)
v_mfma_f32_32x32x16_bf16 v[96:111], a[40:43], v[132:135], v[96:111]
v_cvt_pk_bf16_f32 v151, v78, v79
v_mfma_f32_32x32x16_bf16 v[112:127], a[44:47], v[132:135], v[112:127]
ds_read_b128 v[128:131], v7 offset:8192
buffer_store_dwordx4 v[148:151], v1, s[4:7], s18 offen offset:1024 sc1
s_waitcnt lgkmcnt(2)
v_mfma_f32_32x32x16_bf16 v[96:111], a[48:51], v[136:139], v[96:111]
v_cvt_pk_bf16_f32 v152, v80, v81
v_mfma_f32_32x32x16_bf16 v[112:127], a[52:55], v[136:139], v[112:127]
ds_read_b128 v[132:135], v7 offset:9216
v_cvt_pk_bf16_f32 v153, v82, v83
s_waitcnt lgkmcnt(2)
v_mfma_f32_32x32x16_bf16 v[96:111], a[56:59], v[140:143], v[96:111]
v_cvt_pk_bf16_f32 v154, v84, v85
v_mfma_f32_32x32x16_bf16 v[112:127], a[60:63], v[140:143], v[112:127]
ds_read_b128 v[136:139], v7 offset:10240
v_cvt_pk_bf16_f32 v155, v86, v87
s_waitcnt lgkmcnt(2)
v_mfma_f32_32x32x16_bf16 v[96:111], a[64:67], v[128:131], v[96:111]
buffer_store_dwordx4 v[152:155], v1, s[4:7], s18 offen offset:2048 sc1
v_mfma_f32_32x32x16_bf16 v[112:127], a[68:71], v[128:131], v[112:127]
ds_read_b128 v[140:143], v7 offset:11264
v_cvt_pk_bf16_f32 v156, v88, v89
s_waitcnt lgkmcnt(2)
v_mfma_f32_32x32x16_bf16 v[96:111], a[72:75], v[132:135], v[96:111]
v_cvt_pk_bf16_f32 v157, v90, v91
v_mfma_f32_32x32x16_bf16 v[112:127], a[76:79], v[132:135], v[112:127]
ds_read_b128 v[128:131], v7 offset:12288
v_cvt_pk_bf16_f32 v158, v92, v93
s_waitcnt lgkmcnt(2)
v_mfma_f32_32x32x16_bf16 v[96:111], a[80:83], v[136:139], v[96:111]
v_cvt_pk_bf16_f32 v159, v94, v95
v_mfma_f32_32x32x16_bf16 v[112:127], a[84:87], v[136:139], v[112:127]
ds_read_b128 v[132:135], v7 offset:13312
buffer_store_dwordx4 v[156:159], v1, s[4:7], s18 offen offset:3072 sc1
s_waitcnt lgkmcnt(2)
v_mfma_f32_32x32x16_bf16 v[96:111], a[88:91], v[140:143], v[96:111]
s_add_u32 s18, s18, 1048576
v_mfma_f32_32x32x16_bf16 v[112:127], a[92:95], v[140:143], v[112:127]
ds_read_b128 v[136:139], v7 offset:14336
s_add_u32 m0, s37, 0
s_add_u32 s35, s36, 0
buffer_load_dwordx4 v1, s[4:7], s35 offen sc1 lds
s_waitcnt lgkmcnt(2)
v_mfma_f32_32x32x16_bf16 v[96:111], a[96:99], v[128:131], v[96:111]
s_add_u32 m0, s37, 1024
s_add_u32 s35, s36, 1024
buffer_load_dwordx4 v1, s[4:7], s35 offen sc1 lds
v_mfma_f32_32x32x16_bf16 v[112:127], a[100:103], v[128:131], v[112:127]
ds_read_b128 v[140:143], v7 offset:15360
s_add_u32 m0, s37, 2048
s_add_u32 s35, s36, 2048
buffer_load_dwordx4 v1, s[4:7], s35 offen sc1 lds
s_waitcnt lgkmcnt(2)
v_mfma_f32_32x32x16_bf16 v[96:111], a[104:107], v[132:135], v[96:111]
s_add_u32 m0, s37, 3072
s_add_u32 s35, s36, 3072
buffer_load_dwordx4 v1, s[4:7], s35 offen sc1 lds
v_mfma_f32_32x32x16_bf16 v[112:127], a[108:111], v[132:135], v[112:127]
ds_read_b128 v[128:131], v7 offset:16384
s_add_u32 m0, s37, 4096
s_add_u32 s35, s36, 4096
buffer_load_dwordx4 v1, s[4:7], s35 offen sc1 lds
s_waitcnt lgkmcnt(2)
v_mfma_f32_32x32x16_bf16 v[96:111], a[112:115], v[136:139], v[96:111]
s_add_u32 m0, s37, 5120
s_add_u32 s35, s36, 5120
buffer_load_dwordx4 v1, s[4:7], s35 offen sc1 lds
v_mfma_f32_32x32x16_bf16 v[112:127], a[116:119], v[136:139], v[112:127]
ds_read_b128 v[132:135], v7 offset:17408
s_add_u32 m0, s37, 6144
s_add_u32 s35, s36, 6144
buffer_load_dwordx4 v1, s[4:7], s35 offen sc1 lds
s_waitcnt lgkmcnt(2)
v_mfma_f32_32x32x16_bf16 v[96:111], a[120:123], v[140:143], v[96:111]
s_add_u32 m0, s37, 7168
s_add_u32 s35, s36, 7168
buffer_load_dwordx4 v1, s[4:7], s35 offen sc1 lds
v_mfma_f32_32x32x16_bf16 v[112:127], a[124:127], v[140:143], v[112:127]
ds_read_b128 v[136:139], v7 offset:18432
s_add_u32 m0, s37, 8192
s_add_u32 s35, s36, 8192
buffer_load_dwordx4 v1, s[4:7], s35 offen sc1 lds
s_waitcnt lgkmcnt(2)
v_mfma_f32_32x32x16_bf16 v[96:111], a[128:131], v[128:131], v[96:111]
s_add_u32 m0, s37, 9216
s_add_u32 s35, s36, 9216
buffer_load_dwordx4 v1, s[4:7], s35 offen sc1 lds
v_mfma_f32_32x32x16_bf16 v[112:127], a[132:135], v[128:131], v[112:127]
ds_read_b128 v[140:143], v7 offset:19456
s_waitcnt lgkmcnt(2)
v_mfma_f32_32x32x16_bf16 v[96:111], a[136:139], v[132:135], v[96:111]
v_mfma_f32_32x32x16_bf16 v[112:127], a[140:143], v[132:135], v[112:127]
ds_read_b128 v[128:131], v7 offset:20480
s_waitcnt lgkmcnt(2)
v_mfma_f32_32x32x16_bf16 v[96:111], a[144:147], v[136:139], v[96:111]
v_mfma_f32_32x32x16_bf16 v[112:127], a[148:151], v[136:139], v[112:127]
ds_read_b128 v[132:135], v7 offset:21504
s_waitcnt lgkmcnt(2)
v_mfma_f32_32x32x16_bf16 v[96:111], a[152:155], v[140:143], v[96:111]
v_mfma_f32_32x32x16_bf16 v[112:127], a[156:159], v[140:143], v[112:127]
ds_read_b128 v[136:139], v7 offset:22528
s_waitcnt lgkmcnt(2)
v_mfma_f32_32x32x16_bf16 v[96:111], a[160:163], v[128:131], v[96:111]
v_mfma_f32_32x32x16_bf16 v[112:127], a[164:167], v[128:131], v[112:127]
ds_read_b128 v[140:143], v7 offset:23552
s_waitcnt lgkmcnt(2)
v_mfma_f32_32x32x16_bf16 v[96:111], a[168:171], v[132:135], v[96:111]
v_mfma_f32_32x32x16_bf16 v[112:127], a[172:175], v[132:135], v[112:127]
ds_read_b128 v[128:131], v7 offset:24576
s_waitcnt lgkmcnt(2)
v_mfma_f32_32x32x16_bf16 v[96:111], a[176:179], v[136:139], v[96:111]
v_mfma_f32_32x32x16_bf16 v[112:127], a[180:183], v[136:139], v[112:127]
ds_read_b128 v[132:135], v7 offset:25600
s_waitcnt lgkmcnt(2)
v_mfma_f32_32x32x16_bf16 v[96:111], a[184:187], v[140:143], v[96:111]
v_mfma_f32_32x32x16_bf16 v[112:127], a[188:191], v[140:143], v[112:127]
ds_read_b128 v[136:139], v7 offset:26624
s_waitcnt lgkmcnt(2)
v_mfma_f32_32x32x16_bf16 v[96:111], a[192:195], v[128:131], v[96:111]
v_mfma_f32_32x32x16_bf16 v[112:127], a[196:199], v[128:131], v[112:127]
ds_read_b128 v[140:143], v7 offset:27648
s_waitcnt lgkmcnt(2)
v_mfma_f32_32x32x16_bf16 v[96:111], a[200:203], v[132:135], v[96:111]
v_mfma_f32_32x32x16_bf16 v[112:127], a[204:207], v[132:135], v[112:127]
ds_read_b128 v[128:131], v7 offset:28672
s_waitcnt lgkmcnt(2)
v_mfma_f32_32x32x16_bf16 v[96:111], a[208:211], v[136:139], v[96:111]
v_mfma_f32_32x32x16_bf16 v[112:127], a[212:215], v[136:139], v[112:127]
ds_read_b128 v[132:135], v7 offset:29696
s_waitcnt lgkmcnt(2)
v_mfma_f32_32x32x16_bf16 v[96:111], a[216:219], v[140:143], v[96:111]
v_mfma_f32_32x32x16_bf16 v[112:127], a[220:223], v[140:143], v[112:127]
ds_read_b128 v[136:139], v7 offset:30720
s_waitcnt lgkmcnt(2)
v_mfma_f32_32x32x16_bf16 v[96:111], a[224:227], v[128:131], v[96:111]
v_mfma_f32_32x32x16_bf16 v[112:127], a[228:231], v[128:131], v[112:127]
ds_read_b128 v[140:143], v7 offset:31744
s_waitcnt lgkmcnt(2)
v_mfma_f32_32x32x16_bf16 v[96:111], a[232:235], v[132:135], v[96:111]
v_mfma_f32_32x32x16_bf16 v[112:127], a[236:239], v[132:135], v[112:127]
ds_read_b128 v[128:131], v7 offset:32768
s_waitcnt lgkmcnt(2)
v_mfma_f32_32x32x16_bf16 v[96:111], a[240:243], v[136:139], v[96:111]
v_mfma_f32_32x32x16_bf16 v[112:127], a[244:247], v[136:139], v[112:127]
ds_read_b128 v[132:135], v7 offset:33792
s_waitcnt lgkmcnt(2)
v_mfma_f32_32x32x16_bf16 v[96:111], a[248:251], v[140:143], v[96:111]
v_mfma_f32_32x32x16_bf16 v[112:127], a[252:255], v[140:143], v[112:127]
ds_read_b128 v[136:139], v7 offset:34816
s_waitcnt lgkmcnt(2)
v_mfma_f32_32x32x16_bf16 v[96:111], v[192:195], v[128:131], v[96:111]
v_mfma_f32_32x32x16_bf16 v[112:127], v[196:199], v[128:131], v[112:127]
ds_read_b128 v[140:143], v7 offset:35840
s_waitcnt lgkmcnt(2)
v_mfma_f32_32x32x16_bf16 v[96:111], v[200:203], v[132:135], v[96:111]
v_mfma_f32_32x32x16_bf16 v[112:127], v[204:207], v[132:135], v[112:127]
ds_read_b128 v[128:131], v7 offset:36864
s_waitcnt lgkmcnt(2)
v_mfma_f32_32x32x16_bf16 v[96:111], v[208:211], v[136:139], v[96:111]
v_mfma_f32_32x32x16_bf16 v[112:127], v[212:215], v[136:139], v[112:127]
ds_read_b128 v[132:135], v7 offset:37888
s_waitcnt lgkmcnt(2)
v_mfma_f32_32x32x16_bf16 v[96:111], v[216:219], v[140:143], v[96:111]
v_mfma_f32_32x32x16_bf16 v[112:127], v[220:223], v[140:143], v[112:127]
ds_read_b128 v[136:139], v7 offset:38912
s_waitcnt lgkmcnt(2)
v_mfma_f32_32x32x16_bf16 v[96:111], v[224:227], v[128:131], v[96:111]
v_mfma_f32_32x32x16_bf16 v[112:127], v[228:231], v[128:131], v[112:127]
ds_read_b128 v[140:143], v7 offset:39936
s_waitcnt lgkmcnt(2)
v_mfma_f32_32x32x16_bf16 v[96:111], v[232:235], v[132:135], v[96:111]
v_mfma_f32_32x32x16_bf16 v[112:127], v[236:239], v[132:135], v[112:127]
s_waitcnt lgkmcnt(1)
v_mfma_f32_32x32x16_bf16 v[96:111], v[240:243], v[136:139], v[96:111]
v_mfma_f32_32x32x16_bf16 v[112:127], v[244:247], v[136:139], v[112:127]
s_waitcnt lgkmcnt(0)
v_mfma_f32_32x32x16_bf16 v[96:111], v[248:251], v[140:143], v[96:111]
v_mfma_f32_32x32x16_bf16 v[112:127], v[252:255], v[140:143], v[112:127]
s_waitcnt vmcnt(10)
v_mov_b32 v4, s17
s_mov_b64 exec, 1
buffer_store_dword v4, off, s[4:7], s19 sc1
s_mov_b64 exec, -1
s_add_u32 s20, s20, 40960
s_cmp_ge_u32 s20, 122880
s_cselect_b32 s20, 0, s20
s_add_u32 s17, s17, 1
s_barrier
s_cmp_lt_u32 s17, s21
s_cbranch_scc1 L_kvk_loop
v_cvt_pk_bf16_f32 v144, v96, v97
v_cvt_pk_bf16_f32 v145, v98, v99
v_cvt_pk_bf16_f32 v146, v100, v101
v_cvt_pk_bf16_f32 v147, v102, v103
buffer_store_dwordx4 v[144:147], v1, s[4:7], s18 offen offset:0 sc1
v_cvt_pk_bf16_f32 v148, v104, v105
v_cvt_pk_bf16_f32 v149, v106, v107
v_cvt_pk_bf16_f32 v150, v108, v109
v_cvt_pk_bf16_f32 v151, v110, v111
buffer_store_dwordx4 v[148:151], v1, s[4:7], s18 offen offset:1024 sc1
v_cvt_pk_bf16_f32 v152, v112, v113
v_cvt_pk_bf16_f32 v153, v114, v115
v_cvt_pk_bf16_f32 v154, v116, v117
v_cvt_pk_bf16_f32 v155, v118, v119
buffer_store_dwordx4 v[152:155], v1, s[4:7], s18 offen offset:2048 sc1
v_cvt_pk_bf16_f32 v156, v120, v121
v_cvt_pk_bf16_f32 v157, v122, v123
v_cvt_pk_bf16_f32 v158, v124, v125
v_cvt_pk_bf16_f32 v159, v126, v127
buffer_store_dwordx4 v[156:159], v1, s[4:7], s18 offen offset:3072 sc1
s_add_u32 s18, s18, 1048576
s_waitcnt vmcnt(0)
v_mov_b32 v4, s17
s_mov_b64 exec, 1
buffer_store_dword v4, off, s[4:7], s19 sc1
s_mov_b64 exec, -1
s_waitcnt vmcnt(0)
s_branch L_kv_fin
L_kv_v:
v_add_u32 v7, s20, v1
s_add_u32 s39, s17, 2
s_min_u32 s39, s39, s27
s_add_u32 s26, s20, 81920
s_cmp_ge_u32 s26, 122880
s_cselect_b32 s35, 122880, 0
s_sub_u32 s26, s26, s35
ds_read_b128 v[128:131], v7 offset:0
ds_read_b128 v[132:135], v7 offset:1024
ds_read_b128 v[136:139], v7 offset:2048
s_mul_i32 s36, s39, 2
s_add_u32 s36, s36, s16
s_mul_i32 s36, s36, 40960
s_add_u32 s36, s36, s22
s_add_u32 s36, s36, 109051904
s_add_u32 s37, s26, s22
s_waitcnt lgkmcnt(2)
v_mfma_f32_32x32x16_bf16 v[64:79], v[128:131], a[0:3], 0
v_mfma_f32_32x32x16_bf16 v[80:95], v[128:131], a[4:7], 0
ds_read_b128 v[140:143], v7 offset:3072
s_waitcnt lgkmcnt(2)
v_mfma_f32_32x32x16_bf16 v[64:79], v[132:135], a[8:11], v[64:79]
s_add_u32 m0, s37, 0
s_add_u32 s35, s36, 0
buffer_load_dwordx4 v1, s[4:7], s35 offen sc1 lds
v_mfma_f32_32x32x16_bf16 v[80:95], v[132:135], a[12:15], v[80:95]
ds_read_b128 v[128:131], v7 offset:4096
s_add_u32 m0, s37, 1024
s_add_u32 s35, s36, 1024
buffer_load_dwordx4 v1, s[4:7], s35 offen sc1 lds
s_waitcnt lgkmcnt(2)
v_mfma_f32_32x32x16_bf16 v[64:79], v[136:139], a[16:19], v[64:79]
s_add_u32 m0, s37, 2048
s_add_u32 s35, s36, 2048
buffer_load_dwordx4 v1, s[4:7], s35 offen sc1 lds
v_mfma_f32_32x32x16_bf16 v[80:95], v[136:139], a[20:23], v[80:95]
ds_read_b128 v[132:135], v7 offset:5120
s_add_u32 m0, s37, 3072
s_add_u32 s35, s36, 3072
buffer_load_dwordx4 v1, s[4:7], s35 offen sc1 lds
s_waitcnt lgkmcnt(2)
v_mfma_f32_32x32x16_bf16 v[64:79], v[140:143], a[24:27], v[64:79]
s_add_u32 m0, s37, 4096
s_add_u32 s35, s36, 4096
buffer_load_dwordx4 v1, s[4:7], s35 offen sc1 lds
v_mfma_f32_32x32x16_bf16 v[80:95], v[140:143], a[28:31], v[80:95]
ds_read_b128 v[136:139], v7 offset:6144
s_add_u32 m0, s37, 5120
s_add_u32 s35, s36, 5120
buffer_load_dwordx4 v1, s[4:7], s35 offen sc1 lds
s_waitcnt lgkmcnt(2)
v_mfma_f32_32x32x16_bf16 v[64:79], v[128:131], a[32:35], v[64:79]
s_add_u32 m0, s37, 6144
s_add_u32 s35, s36, 6144
buffer_load_dwordx4 v1, s[4:7], s35 offen sc1 lds
v_mfma_f32_32x32x16_bf16 v[80:95], v[128:131], a[36:39], v[80:95]
ds_read_b128 v[140:143], v7 offset:7168
s_add_u32 m0, s37, 7168
s_add_u32 s35, s36, 7168
buffer_load_dwordx4 v1, s[4:7], s35 offen sc1 lds
s_waitcnt lgkmcnt(2)
v_mfma_f32_32x32x16_bf16 v[64:79], v[132:135], a[40:43], v[64:79]
s_add_u32 m0, s37, 8192
s_add_u32 s35, s36, 8192
buffer_load_dwordx4 v1, s[4:7], s35 offen sc1 lds
v_mfma_f32_32x32x16_bf16 v[80:95], v[132:135], a[44:47], v[80:95]
ds_read_b128 v[128:131], v7 offset:8192
s_add_u32 m0, s37, 9216
s_add_u32 s35, s36, 9216
buffer_load_dwordx4 v1, s[4:7], s35 offen sc1 lds
s_waitcnt lgkmcnt(2)
v_mfma_f32_32x32x16_bf16 v[64:79], v[136:139], a[48:51], v[64:79]
v_mfma_f32_32x32x16_bf16 v[80:95], v[136:139], a[52:55], v[80:95]
ds_read_b128 v[132:135], v7 offset:9216
s_waitcnt lgkmcnt(2)
v_mfma_f32_32x32x16_bf16 v[64:79], v[140:143], a[56:59], v[64:79]
v_mfma_f32_32x32x16_bf16 v[80:95], v[140:143], a[60:63], v[80:95]
ds_read_b128 v[136:139], v7 offset:10240
s_waitcnt lgkmcnt(2)
v_mfma_f32_32x32x16_bf16 v[64:79], v[128:131], a[64:67], v[64:79]
v_mfma_f32_32x32x16_bf16 v[80:95], v[128:131], a[68:71], v[80:95]
ds_read_b128 v[140:143], v7 offset:11264
s_waitcnt lgkmcnt(2)
v_mfma_f32_32x32x16_bf16 v[64:79], v[132:135], a[72:75], v[64:79]
v_mfma_f32_32x32x16_bf16 v[80:95], v[132:135], a[76:79], v[80:95]
ds_read_b128 v[128:131], v7 offset:12288
s_waitcnt lgkmcnt(2)
v_mfma_f32_32x32x16_bf16 v[64:79], v[136:139], a[80:83], v[64:79]
v_mfma_f32_32x32x16_bf16 v[80:95], v[136:139], a[84:87], v[80:95]
ds_read_b128 v[132:135], v7 offset:13312
s_waitcnt lgkmcnt(2)
v_mfma_f32_32x32x16_bf16 v[64:79], v[140:143], a[88:91], v[64:79]
v_mfma_f32_32x32x16_bf16 v[80:95], v[140:143], a[92:95], v[80:95]
ds_read_b128 v[136:139], v7 offset:14336
s_waitcnt lgkmcnt(2)
v_mfma_f32_32x32x16_bf16 v[64:79], v[128:131], a[96:99], v[64:79]
v_mfma_f32_32x32x16_bf16 v[80:95], v[128:131], a[100:103], v[80:95]
ds_read_b128 v[140:143], v7 offset:15360
s_waitcnt lgkmcnt(2)
v_mfma_f32_32x32x16_bf16 v[64:79], v[132:135], a[104:107], v[64:79]
v_mfma_f32_32x32x16_bf16 v[80:95], v[132:135], a[108:111], v[80:95]
ds_read_b128 v[128:131], v7 offset:16384
s_waitcnt lgkmcnt(2)
v_mfma_f32_32x32x16_bf16 v[64:79], v[136:139], a[112:115], v[64:79]
v_mfma_f32_32x32x16_bf16 v[80:95], v[136:139], a[116:119], v[80:95]
ds_read_b128 v[132:135], v7 offset:17408
s_waitcnt lgkmcnt(2)
v_mfma_f32_32x32x16_bf16 v[64:79], v[140:143], a[120:123], v[64:79]
v_mfma_f32_32x32x16_bf16 v[80:95], v[140:143], a[124:127], v[80:95]
ds_read_b128 v[136:139], v7 offset:18432
s_waitcnt lgkmcnt(2)
v_mfma_f32_32x32x16_bf16 v[64:79], v[128:131], a[128:131], v[64:79]
v_mfma_f32_32x32x16_bf16 v[80:95], v[128:131], a[132:135], v[80:95]
ds_read_b128 v[140:143], v7 offset:19456
s_waitcnt lgkmcnt(2)
v_mfma_f32_32x32x16_bf16 v[64:79], v[132:135], a[136:139], v[64:79]
v_mfma_f32_32x32x16_bf16 v[80:95], v[132:135], a[140:143], v[80:95]
ds_read_b128 v[128:131], v7 offset:20480
s_waitcnt lgkmcnt(2)
v_mfma_f32_32x32x16_bf16 v[64:79], v[136:139], a[144:147], v[64:79]
v_mfma_f32_32x32x16_bf16 v[80:95], v[136:139], a[148:151], v[80:95]
ds_read_b128 v[132:135], v7 offset:21504
s_waitcnt lgkmcnt(2)
v_mfma_f32_32x32x16_bf16 v[64:79], v[140:143], a[152:155], v[64:79]
v_mfma_f32_32x32x16_bf16 v[80:95], v[140:143], a[156:159], v[80:95]
ds_read_b128 v[136:139], v7 offset:22528
s_waitcnt lgkmcnt(2)
v_mfma_f32_32x32x16_bf16 v[64:79], v[128:131], a[160:163], v[64:79]
v_mfma_f32_32x32x16_bf16 v[80:95], v[128:131], a[164:167], v[80:95]
ds_read_b128 v[140:143], v7 offset:23552
s_waitcnt lgkmcnt(2)
v_mfma_f32_32x32x16_bf16 v[64:79], v[132:135], a[168:171], v[64:79]
v_mfma_f32_32x32x16_bf16 v[80:95], v[132:135], a[172:175], v[80:95]
ds_read_b128 v[128:131], v7 offset:24576
s_waitcnt lgkmcnt(2)
v_mfma_f32_32x32x16_bf16 v[64:79], v[136:139], a[176:179], v[64:79]
v_mfma_f32_32x32x16_bf16 v[80:95], v[136:139], a[180:183], v[80:95]
ds_read_b128 v[132:135], v7 offset:25600
s_waitcnt lgkmcnt(2)
v_mfma_f32_32x32x16_bf16 v[64:79], v[140:143], a[184:187], v[64:79]
v_mfma_f32_32x32x16_bf16 v[80:95], v[140:143], a[188:191], v[80:95]
ds_read_b128 v[136:139], v7 offset:26624
s_waitcnt lgkmcnt(2)
v_mfma_f32_32x32x16_bf16 v[64:79], v[128:131], a[192:195], v[64:79]
v_mfma_f32_32x32x16_bf16 v[80:95], v[128:131], a[196:199], v[80:95]
ds_read_b128 v[140:143], v7 offset:27648
s_waitcnt lgkmcnt(2)
v_mfma_f32_32x32x16_bf16 v[64:79], v[132:135], a[200:203], v[64:79]
v_mfma_f32_32x32x16_bf16 v[80:95], v[132:135], a[204:207], v[80:95]
ds_read_b128 v[128:131], v7 offset:28672
s_waitcnt lgkmcnt(2)
v_mfma_f32_32x32x16_bf16 v[64:79], v[136:139], a[208:211], v[64:79]
v_mfma_f32_32x32x16_bf16 v[80:95], v[136:139], a[212:215], v[80:95]
ds_read_b128 v[132:135], v7 offset:29696
s_waitcnt lgkmcnt(2)
v_mfma_f32_32x32x16_bf16 v[64:79], v[140:143], a[216:219], v[64:79]
v_mfma_f32_32x32x16_bf16 v[80:95], v[140:143], a[220:223], v[80:95]
ds_read_b128 v[136:139], v7 offset:30720
s_waitcnt lgkmcnt(2)
v_mfma_f32_32x32x16_bf16 v[64:79], v[128:131], a[224:227], v[64:79]
v_mfma_f32_32x32x16_bf16 v[80:95], v[128:131], a[228:231], v[80:95]
ds_read_b128 v[140:143], v7 offset:31744
s_waitcnt lgkmcnt(2)
v_mfma_f32_32x32x16_bf16 v[64:79], v[132:135], a[232:235], v[64:79]
v_mfma_f32_32x32x16_bf16 v[80:95], v[132:135], a[236:239], v[80:95]
ds_read_b128 v[128:131], v7 offset:32768
s_waitcnt lgkmcnt(2)
v_mfma_f32_32x32x16_bf16 v[64:79], v[136:139], a[240:243], v[64:79]
v_mfma_f32_32x32x16_bf16 v[80:95], v[136:139], a[244:247], v[80:95]
ds_read_b128 v[132:135], v7 offset:33792
s_waitcnt lgkmcnt(2)
v_mfma_f32_32x32x16_bf16 v[64:79], v[140:143], a[248:251], v[64:79]
v_mfma_f32_32x32x16_bf16 v[80:95], v[140:143], a[252:255], v[80:95]
ds_read_b128 v[136:139], v7 offset:34816
s_waitcnt lgkmcnt(2)
v_mfma_f32_32x32x16_bf16 v[64:79], v[128:131], v[192:195], v[64:79]
v_mfma_f32_32x32x16_bf16 v[80:95], v[128:131], v[196:199], v[80:95]
ds_read_b128 v[140:143], v7 offset:35840
s_waitcnt lgkmcnt(2)
v_mfma_f32_32x32x16_bf16 v[64:79], v[132:135], v[200:203], v[64:79]
v_mfma_f32_32x32x16_bf16 v[80:95], v[132:135], v[204:207], v[80:95]
ds_read_b128 v[128:131], v7 offset:36864
s_waitcnt lgkmcnt(2)
v_mfma_f32_32x32x16_bf16 v[64:79], v[136:139], v[208:211], v[64:79]
v_mfma_f32_32x32x16_bf16 v[80:95], v[136:139], v[212:215], v[80:95]
ds_read_b128 v[132:135], v7 offset:37888
s_waitcnt lgkmcnt(2)
v_mfma_f32_32x32x16_bf16 v[64:79], v[140:143], v[216:219], v[64:79]
v_mfma_f32_32x32x16_bf16 v[80:95], v[140:143], v[220:223], v[80:95]
ds_read_b128 v[136:139], v7 offset:38912
s_waitcnt lgkmcnt(2)
v_mfma_f32_32x32x16_bf16 v[64:79], v[128:131], v[224:227], v[64:79]
v_mfma_f32_32x32x16_bf16 v[80:95], v[128:131], v[228:231], v[80:95]
ds_read_b128 v[140:143], v7 offset:39936
s_waitcnt lgkmcnt(2)
v_mfma_f32_32x32x16_bf16 v[64:79], v[132:135], v[232:235], v[64:79]
v_mfma_f32_32x32x16_bf16 v[80:95], v[132:135], v[236:239], v[80:95]
s_waitcnt lgkmcnt(1)
v_mfma_f32_32x32x16_bf16 v[64:79], v[136:139], v[240:243], v[64:79]
v_mfma_f32_32x32x16_bf16 v[80:95], v[136:139], v[244:247], v[80:95]
s_waitcnt lgkmcnt(0)
v_mfma_f32_32x32x16_bf16 v[64:79], v[140:143], v[248:251], v[64:79]
v_mfma_f32_32x32x16_bf16 v[80:95], v[140:143], v[252:255], v[80:95]
s_waitcnt vmcnt(10)
s_add_u32 s20, s20, 40960
s_cmp_ge_u32 s20, 122880
s_cselect_b32 s20, 0, s20
s_add_u32 s17, s17, 1
s_barrier
v_cvt_pk_bf16_f32 v144, v64, v65
v_cvt_pk_bf16_f32 v145, v66, v67
v_cvt_pk_bf16_f32 v146, v68, v69
v_cvt_pk_bf16_f32 v147, v70, v71
buffer_store_dwordx4 v[144:147], v1, s[4:7], s18 offen offset:0 sc1
v_cvt_pk_bf16_f32 v148, v72, v73
v_cvt_pk_bf16_f32 v149, v74, v75
v_cvt_pk_bf16_f32 v150, v76, v77
v_cvt_pk_bf16_f32 v151, v78, v79
buffer_store_dwordx4 v[148:151], v1, s[4:7], s18 offen offset:1024 sc1
v_cvt_pk_bf16_f32 v152, v80, v81
v_cvt_pk_bf16_f32 v153, v82, v83
v_cvt_pk_bf16_f32 v154, v84, v85
v_cvt_pk_bf16_f32 v155, v86, v87
buffer_store_dwordx4 v[152:155], v1, s[4:7], s18 offen offset:2048 sc1
v_cvt_pk_bf16_f32 v156, v88, v89
v_cvt_pk_bf16_f32 v157, v90, v91
v_cvt_pk_bf16_f32 v158, v92, v93
v_cvt_pk_bf16_f32 v159, v94, v95
buffer_store_dwordx4 v[156:159], v1, s[4:7], s18 offen offset:3072 sc1
s_add_u32 s18, s18, 1048576
s_waitcnt vmcnt(0)
v_mov_b32 v4, s17
s_mov_b64 exec, 1
buffer_store_dword v4, off, s[4:7], s19 sc1
s_mov_b64 exec, -1
v_add_u32 v7, s20, v1
s_add_u32 s39, s17, 2
s_min_u32 s39, s39, s27
s_add_u32 s26, s20, 81920
s_cmp_ge_u32 s26, 122880
s_cselect_b32 s35, 122880, 0
s_sub_u32 s26, s26, s35
ds_read_b128 v[128:131], v7 offset:0
ds_read_b128 v[132:135], v7 offset:1024
ds_read_b128 v[136:139], v7 offset:2048
s_mul_i32 s36, s39, 2
s_add_u32 s36, s36, s16
s_mul_i32 s36, s36, 40960
s_add_u32 s36, s36, s22
s_add_u32 s36, s36, 109051904
s_add_u32 s37, s26, s22
s_waitcnt lgkmcnt(2)
v_mfma_f32_32x32x16_bf16 v[96:111], v[128:131], a[0:3], 0
v_mfma_f32_32x32x16_bf16 v[112:127], v[128:131], a[4:7], 0
ds_read_b128 v[140:143], v7 offset:3072
s_waitcnt lgkmcnt(2)
v_mfma_f32_32x32x16_bf16 v[96:111], v[132:135], a[8:11], v[96:111]
s_add_u32 m0, s37, 0
s_add_u32 s35, s36, 0
buffer_load_dwordx4 v1, s[4:7], s35 offen sc1 lds
v_mfma_f32_32x32x16_bf16 v[112:127], v[132:135], a[12:15], v[112:127]
ds_read_b128 v[128:131], v7 offset:4096
s_add_u32 m0, s37, 1024
s_add_u32 s35, s36, 1024
buffer_load_dwordx4 v1, s[4:7], s35 offen sc1 lds
s_waitcnt lgkmcnt(2)
v_mfma_f32_32x32x16_bf16 v[96:111], v[136:139], a[16:19], v[96:111]
s_add_u32 m0, s37, 2048
s_add_u32 s35, s36, 2048
buffer_load_dwordx4 v1, s[4:7], s35 offen sc1 lds
v_mfma_f32_32x32x16_bf16 v[112:127], v[136:139], a[20:23], v[112:127]
ds_read_b128 v[132:135], v7 offset:5120
s_add_u32 m0, s37, 3072
s_add_u32 s35, s36, 3072
buffer_load_dwordx4 v1, s[4:7], s35 offen sc1 lds
s_waitcnt lgkmcnt(2)
v_mfma_f32_32x32x16_bf16 v[96:111], v[140:143], a[24:27], v[96:111]
s_add_u32 m0, s37, 4096
s_add_u32 s35, s36, 4096
buffer_load_dwordx4 v1, s[4:7], s35 offen sc1 lds
v_mfma_f32_32x32x16_bf16 v[112:127], v[140:143], a[28:31], v[112:127]
ds_read_b128 v[136:139], v7 offset:6144
s_add_u32 m0, s37, 5120
s_add_u32 s35, s36, 5120
buffer_load_dwordx4 v1, s[4:7], s35 offen sc1 lds
s_waitcnt lgkmcnt(2)
v_mfma_f32_32x32x16_bf16 v[96:111], v[128:131], a[32:35], v[96:111]
s_add_u32 m0, s37, 6144
s_add_u32 s35, s36, 6144
buffer_load_dwordx4 v1, s[4:7], s35 offen sc1 lds
v_mfma_f32_32x32x16_bf16 v[112:127], v[128:131], a[36:39], v[112:127]
ds_read_b128 v[140:143], v7 offset:7168
s_add_u32 m0, s37, 7168
s_add_u32 s35, s36, 7168
buffer_load_dwordx4 v1, s[4:7], s35 offen sc1 lds
s_waitcnt lgkmcnt(2)
v_mfma_f32_32x32x16_bf16 v[96:111], v[132:135], a[40:43], v[96:111]
s_add_u32 m0, s37, 8192
s_add_u32 s35, s36, 8192
buffer_load_dwordx4 v1, s[4:7], s35 offen sc1 lds
v_mfma_f32_32x32x16_bf16 v[112:127], v[132:135], a[44:47], v[112:127]
ds_read_b128 v[128:131], v7 offset:8192
s_add_u32 m0, s37, 9216
s_add_u32 s35, s36, 9216
buffer_load_dwordx4 v1, s[4:7], s35 offen sc1 lds
s_waitcnt lgkmcnt(2)
v_mfma_f32_32x32x16_bf16 v[96:111], v[136:139], a[48:51], v[96:111]
v_mfma_f32_32x32x16_bf16 v[112:127], v[136:139], a[52:55], v[112:127]
ds_read_b128 v[132:135], v7 offset:9216
s_waitcnt lgkmcnt(2)
v_mfma_f32_32x32x16_bf16 v[96:111], v[140:143], a[56:59], v[96:111]
v_mfma_f32_32x32x16_bf16 v[112:127], v[140:143], a[60:63], v[112:127]
ds_read_b128 v[136:139], v7 offset:10240
s_waitcnt lgkmcnt(2)
v_mfma_f32_32x32x16_bf16 v[96:111], v[128:131], a[64:67], v[96:111]
v_mfma_f32_32x32x16_bf16 v[112:127], v[128:131], a[68:71], v[112:127]
ds_read_b128 v[140:143], v7 offset:11264
s_waitcnt lgkmcnt(2)
v_mfma_f32_32x32x16_bf16 v[96:111], v[132:135], a[72:75], v[96:111]
v_mfma_f32_32x32x16_bf16 v[112:127], v[132:135], a[76:79], v[112:127]
ds_read_b128 v[128:131], v7 offset:12288
s_waitcnt lgkmcnt(2)
v_mfma_f32_32x32x16_bf16 v[96:111], v[136:139], a[80:83], v[96:111]
v_mfma_f32_32x32x16_bf16 v[112:127], v[136:139], a[84:87], v[112:127]
ds_read_b128 v[132:135], v7 offset:13312
s_waitcnt lgkmcnt(2)
v_mfma_f32_32x32x16_bf16 v[96:111], v[140:143], a[88:91], v[96:111]
v_mfma_f32_32x32x16_bf16 v[112:127], v[140:143], a[92:95], v[112:127]
ds_read_b128 v[136:139], v7 offset:14336
s_waitcnt lgkmcnt(2)
v_mfma_f32_32x32x16_bf16 v[96:111], v[128:131], a[96:99], v[96:111]
v_mfma_f32_32x32x16_bf16 v[112:127], v[128:131], a[100:103], v[112:127]
ds_read_b128 v[140:143], v7 offset:15360
s_waitcnt lgkmcnt(2)
v_mfma_f32_32x32x16_bf16 v[96:111], v[132:135], a[104:107], v[96:111]
v_mfma_f32_32x32x16_bf16 v[112:127], v[132:135], a[108:111], v[112:127]
ds_read_b128 v[128:131], v7 offset:16384
s_waitcnt lgkmcnt(2)
v_mfma_f32_32x32x16_bf16 v[96:111], v[136:139], a[112:115], v[96:111]
v_mfma_f32_32x32x16_bf16 v[112:127], v[136:139], a[116:119], v[112:127]
ds_read_b128 v[132:135], v7 offset:17408
s_waitcnt lgkmcnt(2)
v_mfma_f32_32x32x16_bf16 v[96:111], v[140:143], a[120:123], v[96:111]
v_mfma_f32_32x32x16_bf16 v[112:127], v[140:143], a[124:127], v[112:127]
ds_read_b128 v[136:139], v7 offset:18432
s_waitcnt lgkmcnt(2)
v_mfma_f32_32x32x16_bf16 v[96:111], v[128:131], a[128:131], v[96:111]
v_mfma_f32_32x32x16_bf16 v[112:127], v[128:131], a[132:135], v[112:127]
ds_read_b128 v[140:143], v7 offset:19456
s_waitcnt lgkmcnt(2)
v_mfma_f32_32x32x16_bf16 v[96:111], v[132:135], a[136:139], v[96:111]
v_mfma_f32_32x32x16_bf16 v[112:127], v[132:135], a[140:143], v[112:127]
ds_read_b128 v[128:131], v7 offset:20480
s_waitcnt lgkmcnt(2)
v_mfma_f32_32x32x16_bf16 v[96:111], v[136:139], a[144:147], v[96:111]
v_mfma_f32_32x32x16_bf16 v[112:127], v[136:139], a[148:151], v[112:127]
ds_read_b128 v[132:135], v7 offset:21504
s_waitcnt lgkmcnt(2)
v_mfma_f32_32x32x16_bf16 v[96:111], v[140:143], a[152:155], v[96:111]
v_mfma_f32_32x32x16_bf16 v[112:127], v[140:143], a[156:159], v[112:127]
ds_read_b128 v[136:139], v7 offset:22528
s_waitcnt lgkmcnt(2)
v_mfma_f32_32x32x16_bf16 v[96:111], v[128:131], a[160:163], v[96:111]
v_mfma_f32_32x32x16_bf16 v[112:127], v[128:131], a[164:167], v[112:127]
ds_read_b128 v[140:143], v7 offset:23552
s_waitcnt lgkmcnt(2)
v_mfma_f32_32x32x16_bf16 v[96:111], v[132:135], a[168:171], v[96:111]
v_mfma_f32_32x32x16_bf16 v[112:127], v[132:135], a[172:175], v[112:127]
ds_read_b128 v[128:131], v7 offset:24576
s_waitcnt lgkmcnt(2)
v_mfma_f32_32x32x16_bf16 v[96:111], v[136:139], a[176:179], v[96:111]
v_mfma_f32_32x32x16_bf16 v[112:127], v[136:139], a[180:183], v[112:127]
ds_read_b128 v[132:135], v7 offset:25600
s_waitcnt lgkmcnt(2)
v_mfma_f32_32x32x16_bf16 v[96:111], v[140:143], a[184:187], v[96:111]
v_mfma_f32_32x32x16_bf16 v[112:127], v[140:143], a[188:191], v[112:127]
ds_read_b128 v[136:139], v7 offset:26624
s_waitcnt lgkmcnt(2)
v_mfma_f32_32x32x16_bf16 v[96:111], v[128:131], a[192:195], v[96:111]
v_mfma_f32_32x32x16_bf16 v[112:127], v[128:131], a[196:199], v[112:127]
ds_read_b128 v[140:143], v7 offset:27648
s_waitcnt lgkmcnt(2)
v_mfma_f32_32x32x16_bf16 v[96:111], v[132:135], a[200:203], v[96:111]
v_mfma_f32_32x32x16_bf16 v[112:127], v[132:135], a[204:207], v[112:127]
ds_read_b128 v[128:131], v7 offset:28672
s_waitcnt lgkmcnt(2)
v_mfma_f32_32x32x16_bf16 v[96:111], v[136:139], a[208:211], v[96:111]
v_mfma_f32_32x32x16_bf16 v[112:127], v[136:139], a[212:215], v[112:127]
ds_read_b128 v[132:135], v7 offset:29696
s_waitcnt lgkmcnt(2)
v_mfma_f32_32x32x16_bf16 v[96:111], v[140:143], a[216:219], v[96:111]
v_mfma_f32_32x32x16_bf16 v[112:127], v[140:143], a[220:223], v[112:127]
ds_read_b128 v[136:139], v7 offset:30720
s_waitcnt lgkmcnt(2)
v_mfma_f32_32x32x16_bf16 v[96:111], v[128:131], a[224:227], v[96:111]
v_mfma_f32_32x32x16_bf16 v[112:127], v[128:131], a[228:231], v[112:127]
ds_read_b128 v[140:143], v7 offset:31744
s_waitcnt lgkmcnt(2)
v_mfma_f32_32x32x16_bf16 v[96:111], v[132:135], a[232:235], v[96:111]
v_mfma_f32_32x32x16_bf16 v[112:127], v[132:135], a[236:239], v[112:127]
ds_read_b128 v[128:131], v7 offset:32768
s_waitcnt lgkmcnt(2)
v_mfma_f32_32x32x16_bf16 v[96:111], v[136:139], a[240:243], v[96:111]
v_mfma_f32_32x32x16_bf16 v[112:127], v[136:139], a[244:247], v[112:127]
ds_read_b128 v[132:135], v7 offset:33792
s_waitcnt lgkmcnt(2)
v_mfma_f32_32x32x16_bf16 v[96:111], v[140:143], a[248:251], v[96:111]
v_mfma_f32_32x32x16_bf16 v[112:127], v[140:143], a[252:255], v[112:127]
ds_read_b128 v[136:139], v7 offset:34816
s_waitcnt lgkmcnt(2)
v_mfma_f32_32x32x16_bf16 v[96:111], v[128:131], v[192:195], v[96:111]
v_mfma_f32_32x32x16_bf16 v[112:127], v[128:131], v[196:199], v[112:127]
ds_read_b128 v[140:143], v7 offset:35840
s_waitcnt lgkmcnt(2)
v_mfma_f32_32x32x16_bf16 v[96:111], v[132:135], v[200:203], v[96:111]
v_mfma_f32_32x32x16_bf16 v[112:127], v[132:135], v[204:207], v[112:127]
ds_read_b128 v[128:131], v7 offset:36864
s_waitcnt lgkmcnt(2)
v_mfma_f32_32x32x16_bf16 v[96:111], v[136:139], v[208:211], v[96:111]
v_mfma_f32_32x32x16_bf16 v[112:127], v[136:139], v[212:215], v[112:127]
ds_read_b128 v[132:135], v7 offset:37888
s_waitcnt lgkmcnt(2)
v_mfma_f32_32x32x16_bf16 v[96:111], v[140:143], v[216:219], v[96:111]
v_mfma_f32_32x32x16_bf16 v[112:127], v[140:143], v[220:223], v[112:127]
ds_read_b128 v[136:139], v7 offset:38912
s_waitcnt lgkmcnt(2)
v_mfma_f32_32x32x16_bf16 v[96:111], v[128:131], v[224:227], v[96:111]
v_mfma_f32_32x32x16_bf16 v[112:127], v[128:131], v[228:231], v[112:127]
ds_read_b128 v[140:143], v7 offset:39936
s_waitcnt lgkmcnt(2)
v_mfma_f32_32x32x16_bf16 v[96:111], v[132:135], v[232:235], v[96:111]
v_mfma_f32_32x32x16_bf16 v[112:127], v[132:135], v[236:239], v[112:127]
s_waitcnt lgkmcnt(1)
v_mfma_f32_32x32x16_bf16 v[96:111], v[136:139], v[240:243], v[96:111]
v_mfma_f32_32x32x16_bf16 v[112:127], v[136:139], v[244:247], v[112:127]
s_waitcnt lgkmcnt(0)
v_mfma_f32_32x32x16_bf16 v[96:111], v[140:143], v[248:251], v[96:111]
v_mfma_f32_32x32x16_bf16 v[112:127], v[140:143], v[252:255], v[112:127]
s_waitcnt vmcnt(10)
s_add_u32 s20, s20, 40960
s_cmp_ge_u32 s20, 122880
s_cselect_b32 s20, 0, s20
s_add_u32 s17, s17, 1
s_barrier
L_kvv_loop:
v_add_u32 v7, s20, v1
s_add_u32 s39, s17, 2
s_min_u32 s39, s39, s27
s_add_u32 s26, s20, 81920
s_cmp_ge_u32 s26, 122880
s_cselect_b32 s35, 122880, 0
s_sub_u32 s26, s26, s35
ds_read_b128 v[128:131], v7 offset:0
ds_read_b128 v[132:135], v7 offset:1024
ds_read_b128 v[136:139], v7 offset:2048
s_mul_i32 s36, s39, 2
s_add_u32 s36, s36, s16
s_mul_i32 s36, s36, 40960
s_add_u32 s36, s36, s22
s_add_u32 s36, s36, 109051904
s_add_u32 s37, s26, s22
s_waitcnt lgkmcnt(2)
v_mfma_f32_32x32x16_bf16 v[64:79], v[128:131], a[0:3], 0
v_mfma_f32_32x32x16_bf16 v[80:95], v[128:131], a[4:7], 0
ds_read_b128 v[140:143], v7 offset:3072
s_waitcnt lgkmcnt(2)
v_mfma_f32_32x32x16_bf16 v[64:79], v[132:135], a[8:11], v[64:79]
v_cvt_pk_bf16_f32 v144, v96, v97
v_mfma_f32_32x32x16_bf16 v[80:95], v[132:135], a[12:15], v[80:95]
ds_read_b128 v[128:131], v7 offset:4096
v_cvt_pk_bf16_f32 v145, v98, v99
s_waitcnt lgkmcnt(2)
v_mfma_f32_32x32x16_bf16 v[64:79], v[136:139], a[16:19], v[64:79]
v_cvt_pk_bf16_f32 v146, v100, v101
v_mfma_f32_32x32x16_bf16 v[80:95], v[136:139], a[20:23], v[80:95]
ds_read_b128 v[132:135], v7 offset:5120
v_cvt_pk_bf16_f32 v147, v102, v103
s_waitcnt lgkmcnt(2)
v_mfma_f32_32x32x16_bf16 v[64:79], v[140:143], a[24:27], v[64:79]
buffer_store_dwordx4 v[144:147], v1, s[4:7], s18 offen offset:0 sc1
v_mfma_f32_32x32x16_bf16 v[80:95], v[140:143], a[28:31], v[80:95]
ds_read_b128 v[136:139], v7 offset:6144
v_cvt_pk_bf16_f32 v148, v104, v105
s_waitcnt lgkmcnt(2)
v_mfma_f32_32x32x16_bf16 v[64:79], v[128:131], a[32:35], v[64:79]
v_cvt_pk_bf16_f32 v149, v106, v107
v_mfma_f32_32x32x16_bf16 v[80:95], v[128:131], a[36:39], v[80:95]
ds_read_b128 v[140:143], v7 offset:7168
v_cvt_pk_bf16_f32 v150, v108, v109
s_waitcnt lgkmcnt(2)
v_mfma_f32_32x32x16_bf16 v[64:79], v[132:135], a[40:43], v[64:79]
v_cvt_pk_bf16_f32 v151, v110, v111
v_mfma_f32_32x32x16_bf16 v[80:95], v[132:135], a[44:47], v[80:95]
ds_read_b128 v[128:131], v7 offset:8192
buffer_store_dwordx4 v[148:151], v1, s[4:7], s18 offen offset:1024 sc1
s_waitcnt lgkmcnt(2)
v_mfma_f32_32x32x16_bf16 v[64:79], v[136:139], a[48:51], v[64:79]
v_cvt_pk_bf16_f32 v152, v112, v113
v_mfma_f32_32x32x16_bf16 v[80:95], v[136:139], a[52:55], v[80:95]
ds_read_b128 v[132:135], v7 offset:9216
v_cvt_pk_bf16_f32 v153, v114, v115
s_waitcnt lgkmcnt(2)
v_mfma_f32_32x32x16_bf16 v[64:79], v[140:143], a[56:59], v[64:79]
v_cvt_pk_bf16_f32 v154, v116, v117
v_mfma_f32_32x32x16_bf16 v[80:95], v[140:143], a[60:63], v[80:95]
ds_read_b128 v[136:139], v7 offset:10240
v_cvt_pk_bf16_f32 v155, v118, v119
s_waitcnt lgkmcnt(2)
v_mfma_f32_32x32x16_bf16 v[64:79], v[128:131], a[64:67], v[64:79]
buffer_store_dwordx4 v[152:155], v1, s[4:7], s18 offen offset:2048 sc1
v_mfma_f32_32x32x16_bf16 v[80:95], v[128:131], a[68:71], v[80:95]
ds_read_b128 v[140:143], v7 offset:11264
v_cvt_pk_bf16_f32 v156, v120, v121
s_waitcnt lgkmcnt(2)
v_mfma_f32_32x32x16_bf16 v[64:79], v[132:135], a[72:75], v[64:79]
v_cvt_pk_bf16_f32 v157, v122, v123
v_mfma_f32_32x32x16_bf16 v[80:95], v[132:135], a[76:79], v[80:95]
ds_read_b128 v[128:131], v7 offset:12288
v_cvt_pk_bf16_f32 v158, v124, v125
s_waitcnt lgkmcnt(2)
v_mfma_f32_32x32x16_bf16 v[64:79], v[136:139], a[80:83], v[64:79]
v_cvt_pk_bf16_f32 v159, v126, v127
v_mfma_f32_32x32x16_bf16 v[80:95], v[136:139], a[84:87], v[80:95]
ds_read_b128 v[132:135], v7 offset:13312
buffer_store_dwordx4 v[156:159], v1, s[4:7], s18 offen offset:3072 sc1
s_waitcnt lgkmcnt(2)
v_mfma_f32_32x32x16_bf16 v[64:79], v[140:143], a[88:91], v[64:79]
s_add_u32 s18, s18, 1048576
v_mfma_f32_32x32x16_bf16 v[80:95], v[140:143], a[92:95], v[80:95]
ds_read_b128 v[136:139], v7 offset:14336
s_add_u32 m0, s37, 0
s_add_u32 s35, s36, 0
buffer_load_dwordx4 v1, s[4:7], s35 offen sc1 lds
s_waitcnt lgkmcnt(2)
v_mfma_f32_32x32x16_bf16 v[64:79], v[128:131], a[96:99], v[64:79]
s_add_u32 m0, s37, 1024
s_add_u32 s35, s36, 1024
buffer_load_dwordx4 v1, s[4:7], s35 offen sc1 lds
v_mfma_f32_32x32x16_bf16 v[80:95], v[128:131], a[100:103], v[80:95]
ds_read_b128 v[140:143], v7 offset:15360
s_add_u32 m0, s37, 2048
s_add_u32 s35, s36, 2048
buffer_load_dwordx4 v1, s[4:7], s35 offen sc1 lds
s_waitcnt lgkmcnt(2)
v_mfma_f32_32x32x16_bf16 v[64:79], v[132:135], a[104:107], v[64:79]
s_add_u32 m0, s37, 3072
s_add_u32 s35, s36, 3072
buffer_load_dwordx4 v1, s[4:7], s35 offen sc1 lds
v_mfma_f32_32x32x16_bf16 v[80:95], v[132:135], a[108:111], v[80:95]
ds_read_b128 v[128:131], v7 offset:16384
s_add_u32 m0, s37, 4096
s_add_u32 s35, s36, 4096
buffer_load_dwordx4 v1, s[4:7], s35 offen sc1 lds
s_waitcnt lgkmcnt(2)
v_mfma_f32_32x32x16_bf16 v[64:79], v[136:139], a[112:115], v[64:79]
s_add_u32 m0, s37, 5120
s_add_u32 s35, s36, 5120
buffer_load_dwordx4 v1, s[4:7], s35 offen sc1 lds
v_mfma_f32_32x32x16_bf16 v[80:95], v[136:139], a[116:119], v[80:95]
ds_read_b128 v[132:135], v7 offset:17408
s_add_u32 m0, s37, 6144
s_add_u32 s35, s36, 6144
buffer_load_dwordx4 v1, s[4:7], s35 offen sc1 lds
s_waitcnt lgkmcnt(2)
v_mfma_f32_32x32x16_bf16 v[64:79], v[140:143], a[120:123], v[64:79]
s_add_u32 m0, s37, 7168
s_add_u32 s35, s36, 7168
buffer_load_dwordx4 v1, s[4:7], s35 offen sc1 lds
v_mfma_f32_32x32x16_bf16 v[80:95], v[140:143], a[124:127], v[80:95]
ds_read_b128 v[136:139], v7 offset:18432
s_add_u32 m0, s37, 8192
s_add_u32 s35, s36, 8192
buffer_load_dwordx4 v1, s[4:7], s35 offen sc1 lds
s_waitcnt lgkmcnt(2)
v_mfma_f32_32x32x16_bf16 v[64:79], v[128:131], a[128:131], v[64:79]
s_add_u32 m0, s37, 9216
s_add_u32 s35, s36, 9216
buffer_load_dwordx4 v1, s[4:7], s35 offen sc1 lds
v_mfma_f32_32x32x16_bf16 v[80:95], v[128:131], a[132:135], v[80:95]
ds_read_b128 v[140:143], v7 offset:19456
s_waitcnt lgkmcnt(2)
v_mfma_f32_32x32x16_bf16 v[64:79], v[132:135], a[136:139], v[64:79]
v_mfma_f32_32x32x16_bf16 v[80:95], v[132:135], a[140:143], v[80:95]
ds_read_b128 v[128:131], v7 offset:20480
s_waitcnt lgkmcnt(2)
v_mfma_f32_32x32x16_bf16 v[64:79], v[136:139], a[144:147], v[64:79]
v_mfma_f32_32x32x16_bf16 v[80:95], v[136:139], a[148:151], v[80:95]
ds_read_b128 v[132:135], v7 offset:21504
s_waitcnt lgkmcnt(2)
v_mfma_f32_32x32x16_bf16 v[64:79], v[140:143], a[152:155], v[64:79]
v_mfma_f32_32x32x16_bf16 v[80:95], v[140:143], a[156:159], v[80:95]
ds_read_b128 v[136:139], v7 offset:22528
s_waitcnt lgkmcnt(2)
v_mfma_f32_32x32x16_bf16 v[64:79], v[128:131], a[160:163], v[64:79]
v_mfma_f32_32x32x16_bf16 v[80:95], v[128:131], a[164:167], v[80:95]
ds_read_b128 v[140:143], v7 offset:23552
s_waitcnt lgkmcnt(2)
v_mfma_f32_32x32x16_bf16 v[64:79], v[132:135], a[168:171], v[64:79]
v_mfma_f32_32x32x16_bf16 v[80:95], v[132:135], a[172:175], v[80:95]
ds_read_b128 v[128:131], v7 offset:24576
s_waitcnt lgkmcnt(2)
v_mfma_f32_32x32x16_bf16 v[64:79], v[136:139], a[176:179], v[64:79]
v_mfma_f32_32x32x16_bf16 v[80:95], v[136:139], a[180:183], v[80:95]
ds_read_b128 v[132:135], v7 offset:25600
s_waitcnt lgkmcnt(2)
v_mfma_f32_32x32x16_bf16 v[64:79], v[140:143], a[184:187], v[64:79]
v_mfma_f32_32x32x16_bf16 v[80:95], v[140:143], a[188:191], v[80:95]
ds_read_b128 v[136:139], v7 offset:26624
s_waitcnt lgkmcnt(2)
v_mfma_f32_32x32x16_bf16 v[64:79], v[128:131], a[192:195], v[64:79]
v_mfma_f32_32x32x16_bf16 v[80:95], v[128:131], a[196:199], v[80:95]
ds_read_b128 v[140:143], v7 offset:27648
s_waitcnt lgkmcnt(2)
v_mfma_f32_32x32x16_bf16 v[64:79], v[132:135], a[200:203], v[64:79]
v_mfma_f32_32x32x16_bf16 v[80:95], v[132:135], a[204:207], v[80:95]
ds_read_b128 v[128:131], v7 offset:28672
s_waitcnt lgkmcnt(2)
v_mfma_f32_32x32x16_bf16 v[64:79], v[136:139], a[208:211], v[64:79]
v_mfma_f32_32x32x16_bf16 v[80:95], v[136:139], a[212:215], v[80:95]
ds_read_b128 v[132:135], v7 offset:29696
s_waitcnt lgkmcnt(2)
v_mfma_f32_32x32x16_bf16 v[64:79], v[140:143], a[216:219], v[64:79]
v_mfma_f32_32x32x16_bf16 v[80:95], v[140:143], a[220:223], v[80:95]
ds_read_b128 v[136:139], v7 offset:30720
s_waitcnt lgkmcnt(2)
v_mfma_f32_32x32x16_bf16 v[64:79], v[128:131], a[224:227], v[64:79]
v_mfma_f32_32x32x16_bf16 v[80:95], v[128:131], a[228:231], v[80:95]
ds_read_b128 v[140:143], v7 offset:31744
s_waitcnt lgkmcnt(2)
v_mfma_f32_32x32x16_bf16 v[64:79], v[132:135], a[232:235], v[64:79]
v_mfma_f32_32x32x16_bf16 v[80:95], v[132:135], a[236:239], v[80:95]
ds_read_b128 v[128:131], v7 offset:32768
s_waitcnt lgkmcnt(2)
v_mfma_f32_32x32x16_bf16 v[64:79], v[136:139], a[240:243], v[64:79]
v_mfma_f32_32x32x16_bf16 v[80:95], v[136:139], a[244:247], v[80:95]
ds_read_b128 v[132:135], v7 offset:33792
s_waitcnt lgkmcnt(2)
v_mfma_f32_32x32x16_bf16 v[64:79], v[140:143], a[248:251], v[64:79]
v_mfma_f32_32x32x16_bf16 v[80:95], v[140:143], a[252:255], v[80:95]
ds_read_b128 v[136:139], v7 offset:34816
s_waitcnt lgkmcnt(2)
v_mfma_f32_32x32x16_bf16 v[64:79], v[128:131], v[192:195], v[64:79]
v_mfma_f32_32x32x16_bf16 v[80:95], v[128:131], v[196:199], v[80:95]
ds_read_b128 v[140:143], v7 offset:35840
s_waitcnt lgkmcnt(2)
v_mfma_f32_32x32x16_bf16 v[64:79], v[132:135], v[200:203], v[64:79]
v_mfma_f32_32x32x16_bf16 v[80:95], v[132:135], v[204:207], v[80:95]
ds_read_b128 v[128:131], v7 offset:36864
s_waitcnt lgkmcnt(2)
v_mfma_f32_32x32x16_bf16 v[64:79], v[136:139], v[208:211], v[64:79]
v_mfma_f32_32x32x16_bf16 v[80:95], v[136:139], v[212:215], v[80:95]
ds_read_b128 v[132:135], v7 offset:37888
s_waitcnt lgkmcnt(2)
v_mfma_f32_32x32x16_bf16 v[64:79], v[140:143], v[216:219], v[64:79]
v_mfma_f32_32x32x16_bf16 v[80:95], v[140:143], v[220:223], v[80:95]
ds_read_b128 v[136:139], v7 offset:38912
s_waitcnt lgkmcnt(2)
v_mfma_f32_32x32x16_bf16 v[64:79], v[128:131], v[224:227], v[64:79]
v_mfma_f32_32x32x16_bf16 v[80:95], v[128:131], v[228:231], v[80:95]
ds_read_b128 v[140:143], v7 offset:39936
s_waitcnt lgkmcnt(2)
v_mfma_f32_32x32x16_bf16 v[64:79], v[132:135], v[232:235], v[64:79]
v_mfma_f32_32x32x16_bf16 v[80:95], v[132:135], v[236:239], v[80:95]
s_waitcnt lgkmcnt(1)
v_mfma_f32_32x32x16_bf16 v[64:79], v[136:139], v[240:243], v[64:79]
v_mfma_f32_32x32x16_bf16 v[80:95], v[136:139], v[244:247], v[80:95]
s_waitcnt lgkmcnt(0)
v_mfma_f32_32x32x16_bf16 v[64:79], v[140:143], v[248:251], v[64:79]
v_mfma_f32_32x32x16_bf16 v[80:95], v[140:143], v[252:255], v[80:95]
s_waitcnt vmcnt(10)
v_mov_b32 v4, s17
s_mov_b64 exec, 1
buffer_store_dword v4, off, s[4:7], s19 sc1
s_mov_b64 exec, -1
s_add_u32 s20, s20, 40960
s_cmp_ge_u32 s20, 122880
s_cselect_b32 s20, 0, s20
s_add_u32 s17, s17, 1
s_barrier
v_add_u32 v7, s20, v1
s_add_u32 s39, s17, 2
s_min_u32 s39, s39, s27
s_add_u32 s26, s20, 81920
s_cmp_ge_u32 s26, 122880
s_cselect_b32 s35, 122880, 0
s_sub_u32 s26, s26, s35
ds_read_b128 v[128:131], v7 offset:0
ds_read_b128 v[132:135], v7 offset:1024
ds_read_b128 v[136:139], v7 offset:2048
s_mul_i32 s36, s39, 2
s_add_u32 s36, s36, s16
s_mul_i32 s36, s36, 40960
s_add_u32 s36, s36, s22
s_add_u32 s36, s36, 109051904
s_add_u32 s37, s26, s22
s_waitcnt lgkmcnt(2)
v_mfma_f32_32x32x16_bf16 v[96:111], v[128:131], a[0:3], 0
v_mfma_f32_32x32x16_bf16 v[112:127], v[128:131], a[4:7], 0
ds_read_b128 v[140:143], v7 offset:3072
s_waitcnt lgkmcnt(2)
v_mfma_f32_32x32x16_bf16 v[96:111], v[132:135], a[8:11], v[96:111]
v_cvt_pk_bf16_f32 v144, v64, v65
v_mfma_f32_32x32x16_bf16 v[112:127], v[132:135], a[12:15], v[112:127]
ds_read_b128 v[128:131], v7 offset:4096
v_cvt_pk_bf16_f32 v145, v66, v67
s_waitcnt lgkmcnt(2)
v_mfma_f32_32x32x16_bf16 v[96:111], v[136:139], a[16:19], v[96:111]
v_cvt_pk_bf16_f32 v146, v68, v69
v_mfma_f32_32x32x16_bf16 v[112:127], v[136:139], a[20:23], v[112:127]
ds_read_b128 v[132:135], v7 offset:5120
v_cvt_pk_bf16_f32 v147, v70, v71
s_waitcnt lgkmcnt(2)
v_mfma_f32_32x32x16_bf16 v[96:111], v[140:143], a[24:27], v[96:111]
buffer_store_dwordx4 v[144:147], v1, s[4:7], s18 offen offset:0 sc1
v_mfma_f32_32x32x16_bf16 v[112:127], v[140:143], a[28:31], v[112:127]
ds_read_b128 v[136:139], v7 offset:6144
v_cvt_pk_bf16_f32 v148, v72, v73
s_waitcnt lgkmcnt(2)
v_mfma_f32_32x32x16_bf16 v[96:111], v[128:131], a[32:35], v[96:111]
v_cvt_pk_bf16_f32 v149, v74, v75
v_mfma_f32_32x32x16_bf16 v[112:127], v[128:131], a[36:39], v[112:127]
ds_read_b128 v[140:143], v7 offset:7168
v_cvt_pk_bf16_f32 v150, v76, v77
s_waitcnt lgkmcnt(2)
v_mfma_f32_32x32x16_bf16 v[96:111], v[132:135], a[40:43], v[96:111]
v_cvt_pk_bf16_f32 v151, v78, v79
v_mfma_f32_32x32x16_bf16 v[112:127], v[132:135], a[44:47], v[112:127]
ds_read_b128 v[128:131], v7 offset:8192
buffer_store_dwordx4 v[148:151], v1, s[4:7], s18 offen offset:1024 sc1
s_waitcnt lgkmcnt(2)
v_mfma_f32_32x32x16_bf16 v[96:111], v[136:139], a[48:51], v[96:111]
v_cvt_pk_bf16_f32 v152, v80, v81
v_mfma_f32_32x32x16_bf16 v[112:127], v[136:139], a[52:55], v[112:127]
ds_read_b128 v[132:135], v7 offset:9216
v_cvt_pk_bf16_f32 v153, v82, v83
s_waitcnt lgkmcnt(2)
v_mfma_f32_32x32x16_bf16 v[96:111], v[140:143], a[56:59], v[96:111]
v_cvt_pk_bf16_f32 v154, v84, v85
v_mfma_f32_32x32x16_bf16 v[112:127], v[140:143], a[60:63], v[112:127]
ds_read_b128 v[136:139], v7 offset:10240
v_cvt_pk_bf16_f32 v155, v86, v87
s_waitcnt lgkmcnt(2)
v_mfma_f32_32x32x16_bf16 v[96:111], v[128:131], a[64:67], v[96:111]
buffer_store_dwordx4 v[152:155], v1, s[4:7], s18 offen offset:2048 sc1
v_mfma_f32_32x32x16_bf16 v[112:127], v[128:131], a[68:71], v[112:127]
ds_read_b128 v[140:143], v7 offset:11264
v_cvt_pk_bf16_f32 v156, v88, v89
s_waitcnt lgkmcnt(2)
v_mfma_f32_32x32x16_bf16 v[96:111], v[132:135], a[72:75], v[96:111]
v_cvt_pk_bf16_f32 v157, v90, v91
v_mfma_f32_32x32x16_bf16 v[112:127], v[132:135], a[76:79], v[112:127]
ds_read_b128 v[128:131], v7 offset:12288
v_cvt_pk_bf16_f32 v158, v92, v93
s_waitcnt lgkmcnt(2)
v_mfma_f32_32x32x16_bf16 v[96:111], v[136:139], a[80:83], v[96:111]
v_cvt_pk_bf16_f32 v159, v94, v95
v_mfma_f32_32x32x16_bf16 v[112:127], v[136:139], a[84:87], v[112:127]
ds_read_b128 v[132:135], v7 offset:13312
buffer_store_dwordx4 v[156:159], v1, s[4:7], s18 offen offset:3072 sc1
s_waitcnt lgkmcnt(2)
v_mfma_f32_32x32x16_bf16 v[96:111], v[140:143], a[88:91], v[96:111]
s_add_u32 s18, s18, 1048576
v_mfma_f32_32x32x16_bf16 v[112:127], v[140:143], a[92:95], v[112:127]
ds_read_b128 v[136:139], v7 offset:14336
s_add_u32 m0, s37, 0
s_add_u32 s35, s36, 0
buffer_load_dwordx4 v1, s[4:7], s35 offen sc1 lds
s_waitcnt lgkmcnt(2)
v_mfma_f32_32x32x16_bf16 v[96:111], v[128:131], a[96:99], v[96:111]
s_add_u32 m0, s37, 1024
s_add_u32 s35, s36, 1024
buffer_load_dwordx4 v1, s[4:7], s35 offen sc1 lds
v_mfma_f32_32x32x16_bf16 v[112:127], v[128:131], a[100:103], v[112:127]
ds_read_b128 v[140:143], v7 offset:15360
s_add_u32 m0, s37, 2048
s_add_u32 s35, s36, 2048
buffer_load_dwordx4 v1, s[4:7], s35 offen sc1 lds
s_waitcnt lgkmcnt(2)
v_mfma_f32_32x32x16_bf16 v[96:111], v[132:135], a[104:107], v[96:111]
s_add_u32 m0, s37, 3072
s_add_u32 s35, s36, 3072
buffer_load_dwordx4 v1, s[4:7], s35 offen sc1 lds
v_mfma_f32_32x32x16_bf16 v[112:127], v[132:135], a[108:111], v[112:127]
ds_read_b128 v[128:131], v7 offset:16384
s_add_u32 m0, s37, 4096
s_add_u32 s35, s36, 4096
buffer_load_dwordx4 v1, s[4:7], s35 offen sc1 lds
s_waitcnt lgkmcnt(2)
v_mfma_f32_32x32x16_bf16 v[96:111], v[136:139], a[112:115], v[96:111]
s_add_u32 m0, s37, 5120
s_add_u32 s35, s36, 5120
buffer_load_dwordx4 v1, s[4:7], s35 offen sc1 lds
v_mfma_f32_32x32x16_bf16 v[112:127], v[136:139], a[116:119], v[112:127]
ds_read_b128 v[132:135], v7 offset:17408
s_add_u32 m0, s37, 6144
s_add_u32 s35, s36, 6144
buffer_load_dwordx4 v1, s[4:7], s35 offen sc1 lds
s_waitcnt lgkmcnt(2)
v_mfma_f32_32x32x16_bf16 v[96:111], v[140:143], a[120:123], v[96:111]
s_add_u32 m0, s37, 7168
s_add_u32 s35, s36, 7168
buffer_load_dwordx4 v1, s[4:7], s35 offen sc1 lds
v_mfma_f32_32x32x16_bf16 v[112:127], v[140:143], a[124:127], v[112:127]
ds_read_b128 v[136:139], v7 offset:18432
s_add_u32 m0, s37, 8192
s_add_u32 s35, s36, 8192
buffer_load_dwordx4 v1, s[4:7], s35 offen sc1 lds
s_waitcnt lgkmcnt(2)
v_mfma_f32_32x32x16_bf16 v[96:111], v[128:131], a[128:131], v[96:111]
s_add_u32 m0, s37, 9216
s_add_u32 s35, s36, 9216
buffer_load_dwordx4 v1, s[4:7], s35 offen sc1 lds
v_mfma_f32_32x32x16_bf16 v[112:127], v[128:131], a[132:135], v[112:127]
ds_read_b128 v[140:143], v7 offset:19456
s_waitcnt lgkmcnt(2)
v_mfma_f32_32x32x16_bf16 v[96:111], v[132:135], a[136:139], v[96:111]
v_mfma_f32_32x32x16_bf16 v[112:127], v[132:135], a[140:143], v[112:127]
ds_read_b128 v[128:131], v7 offset:20480
s_waitcnt lgkmcnt(2)
v_mfma_f32_32x32x16_bf16 v[96:111], v[136:139], a[144:147], v[96:111]
v_mfma_f32_32x32x16_bf16 v[112:127], v[136:139], a[148:151], v[112:127]
ds_read_b128 v[132:135], v7 offset:21504
s_waitcnt lgkmcnt(2)
v_mfma_f32_32x32x16_bf16 v[96:111], v[140:143], a[152:155], v[96:111]
v_mfma_f32_32x32x16_bf16 v[112:127], v[140:143], a[156:159], v[112:127]
ds_read_b128 v[136:139], v7 offset:22528
s_waitcnt lgkmcnt(2)
v_mfma_f32_32x32x16_bf16 v[96:111], v[128:131], a[160:163], v[96:111]
v_mfma_f32_32x32x16_bf16 v[112:127], v[128:131], a[164:167], v[112:127]
ds_read_b128 v[140:143], v7 offset:23552
s_waitcnt lgkmcnt(2)
v_mfma_f32_32x32x16_bf16 v[96:111], v[132:135], a[168:171], v[96:111]
v_mfma_f32_32x32x16_bf16 v[112:127], v[132:135], a[172:175], v[112:127]
ds_read_b128 v[128:131], v7 offset:24576
s_waitcnt lgkmcnt(2)
v_mfma_f32_32x32x16_bf16 v[96:111], v[136:139], a[176:179], v[96:111]
v_mfma_f32_32x32x16_bf16 v[112:127], v[136:139], a[180:183], v[112:127]
ds_read_b128 v[132:135], v7 offset:25600
s_waitcnt lgkmcnt(2)
v_mfma_f32_32x32x16_bf16 v[96:111], v[140:143], a[184:187], v[96:111]
v_mfma_f32_32x32x16_bf16 v[112:127], v[140:143], a[188:191], v[112:127]
ds_read_b128 v[136:139], v7 offset:26624
s_waitcnt lgkmcnt(2)
v_mfma_f32_32x32x16_bf16 v[96:111], v[128:131], a[192:195], v[96:111]
v_mfma_f32_32x32x16_bf16 v[112:127], v[128:131], a[196:199], v[112:127]
ds_read_b128 v[140:143], v7 offset:27648
s_waitcnt lgkmcnt(2)
v_mfma_f32_32x32x16_bf16 v[96:111], v[132:135], a[200:203], v[96:111]
v_mfma_f32_32x32x16_bf16 v[112:127], v[132:135], a[204:207], v[112:127]
ds_read_b128 v[128:131], v7 offset:28672
s_waitcnt lgkmcnt(2)
v_mfma_f32_32x32x16_bf16 v[96:111], v[136:139], a[208:211], v[96:111]
v_mfma_f32_32x32x16_bf16 v[112:127], v[136:139], a[212:215], v[112:127]
ds_read_b128 v[132:135], v7 offset:29696
s_waitcnt lgkmcnt(2)
v_mfma_f32_32x32x16_bf16 v[96:111], v[140:143], a[216:219], v[96:111]
v_mfma_f32_32x32x16_bf16 v[112:127], v[140:143], a[220:223], v[112:127]
ds_read_b128 v[136:139], v7 offset:30720
s_waitcnt lgkmcnt(2)
v_mfma_f32_32x32x16_bf16 v[96:111], v[128:131], a[224:227], v[96:111]
v_mfma_f32_32x32x16_bf16 v[112:127], v[128:131], a[228:231], v[112:127]
ds_read_b128 v[140:143], v7 offset:31744
s_waitcnt lgkmcnt(2)
v_mfma_f32_32x32x16_bf16 v[96:111], v[132:135], a[232:235], v[96:111]
v_mfma_f32_32x32x16_bf16 v[112:127], v[132:135], a[236:239], v[112:127]
ds_read_b128 v[128:131], v7 offset:32768
s_waitcnt lgkmcnt(2)
v_mfma_f32_32x32x16_bf16 v[96:111], v[136:139], a[240:243], v[96:111]
v_mfma_f32_32x32x16_bf16 v[112:127], v[136:139], a[244:247], v[112:127]
ds_read_b128 v[132:135], v7 offset:33792
s_waitcnt lgkmcnt(2)
v_mfma_f32_32x32x16_bf16 v[96:111], v[140:143], a[248:251], v[96:111]
v_mfma_f32_32x32x16_bf16 v[112:127], v[140:143], a[252:255], v[112:127]
ds_read_b128 v[136:139], v7 offset:34816
s_waitcnt lgkmcnt(2)
v_mfma_f32_32x32x16_bf16 v[96:111], v[128:131], v[192:195], v[96:111]
v_mfma_f32_32x32x16_bf16 v[112:127], v[128:131], v[196:199], v[112:127]
ds_read_b128 v[140:143], v7 offset:35840
s_waitcnt lgkmcnt(2)
v_mfma_f32_32x32x16_bf16 v[96:111], v[132:135], v[200:203], v[96:111]
v_mfma_f32_32x32x16_bf16 v[112:127], v[132:135], v[204:207], v[112:127]
ds_read_b128 v[128:131], v7 offset:36864
s_waitcnt lgkmcnt(2)
v_mfma_f32_32x32x16_bf16 v[96:111], v[136:139], v[208:211], v[96:111]
v_mfma_f32_32x32x16_bf16 v[112:127], v[136:139], v[212:215], v[112:127]
ds_read_b128 v[132:135], v7 offset:37888
s_waitcnt lgkmcnt(2)
v_mfma_f32_32x32x16_bf16 v[96:111], v[140:143], v[216:219], v[96:111]
v_mfma_f32_32x32x16_bf16 v[112:127], v[140:143], v[220:223], v[112:127]
ds_read_b128 v[136:139], v7 offset:38912
s_waitcnt lgkmcnt(2)
v_mfma_f32_32x32x16_bf16 v[96:111], v[128:131], v[224:227], v[96:111]
v_mfma_f32_32x32x16_bf16 v[112:127], v[128:131], v[228:231], v[112:127]
ds_read_b128 v[140:143], v7 offset:39936
s_waitcnt lgkmcnt(2)
v_mfma_f32_32x32x16_bf16 v[96:111], v[132:135], v[232:235], v[96:111]
v_mfma_f32_32x32x16_bf16 v[112:127], v[132:135], v[236:239], v[112:127]
s_waitcnt lgkmcnt(1)
v_mfma_f32_32x32x16_bf16 v[96:111], v[136:139], v[240:243], v[96:111]
v_mfma_f32_32x32x16_bf16 v[112:127], v[136:139], v[244:247], v[112:127]
s_waitcnt lgkmcnt(0)
v_mfma_f32_32x32x16_bf16 v[96:111], v[140:143], v[248:251], v[96:111]
v_mfma_f32_32x32x16_bf16 v[112:127], v[140:143], v[252:255], v[112:127]
s_waitcnt vmcnt(10)
v_mov_b32 v4, s17
s_mov_b64 exec, 1
buffer_store_dword v4, off, s[4:7], s19 sc1
s_mov_b64 exec, -1
s_add_u32 s20, s20, 40960
s_cmp_ge_u32 s20, 122880
s_cselect_b32 s20, 0, s20
s_add_u32 s17, s17, 1
s_barrier
s_cmp_lt_u32 s17, s21
s_cbranch_scc1 L_kvv_loop
v_cvt_pk_bf16_f32 v144, v96, v97
v_cvt_pk_bf16_f32 v145, v98, v99
v_cvt_pk_bf16_f32 v146, v100, v101
v_cvt_pk_bf16_f32 v147, v102, v103
buffer_store_dwordx4 v[144:147], v1, s[4:7], s18 offen offset:0 sc1
v_cvt_pk_bf16_f32 v148, v104, v105
v_cvt_pk_bf16_f32 v149, v106, v107
v_cvt_pk_bf16_f32 v150, v108, v109
v_cvt_pk_bf16_f32 v151, v110, v111
buffer_store_dwordx4 v[148:151], v1, s[4:7], s18 offen offset:1024 sc1
v_cvt_pk_bf16_f32 v152, v112, v113
v_cvt_pk_bf16_f32 v153, v114, v115
v_cvt_pk_bf16_f32 v154, v116, v117
v_cvt_pk_bf16_f32 v155, v118, v119
buffer_store_dwordx4 v[152:155], v1, s[4:7], s18 offen offset:2048 sc1
v_cvt_pk_bf16_f32 v156, v120, v121
v_cvt_pk_bf16_f32 v157, v122, v123
v_cvt_pk_bf16_f32 v158, v124, v125
v_cvt_pk_bf16_f32 v159, v126, v127
buffer_store_dwordx4 v[156:159], v1, s[4:7], s18 offen offset:3072 sc1
s_add_u32 s18, s18, 1048576
s_waitcnt vmcnt(0)
v_mov_b32 v4, s17
s_mov_b64 exec, 1
buffer_store_dword v4, off, s[4:7], s19 sc1
s_mov_b64 exec, -1
s_waitcnt vmcnt(0)
L_kv_fin:
s_and_b32 s13, s3, 31
s_cmp_lt_u32 s3, 160
s_cbranch_scc1 L_after_kv0
s_mov_b32 s14, 2
s_cmp_lt_u32 s13, 20
s_cbranch_scc1 L_role_f2
s_mov_b32 s14, 3
s_sub_u32 s13, s13, 20
s_branch L_role_f2
L_after_kv0:
s_mov_b32 s14, 1
s_cmp_lt_u32 s13, 16
s_cbranch_scc1 L_role_q
s_sub_u32 s13, s13, 16
s_cmp_lt_u32 s13, 7
s_cbranch_scc1 L_role_h
s_mov_b32 s14, 3
s_add_u32 s13, s13, 5
s_cmp_lt_u32 s13, 20
s_cbranch_scc1 L_role_f2
s_branch L_done
L_role_q:
s_mul_i32 s16, s14, 48
s_cmp_eq_u32 s14, 0
s_cselect_b32 s21, 48, 16
s_lshl_b32 s35, s13, 2
s_add_u32 s39, s35, s12
s_load_dwordx2 s[80:81], s[0:1], 16
s_waitcnt lgkmcnt(0)
s_mov_b32 s82, 5242880
s_mov_b32 s83, 0x20000
s_lshl_b32 s96, s39, 7
s_lshl_b32 s19, s13, 7
s_lshl_b32 s35, s14, 4
s_add_u32 s19, s19, s35
s_lshl_b32 s35, s12, 2
s_add_u32 s19, s19, s35
s_add_u32 s19, s19, 1576960
s_lshl_b32 s18, s39, 12
s_mul_i32 s35, s16, 262144
s_add_u32 s18, s18, s35
s_add_u32 s18, s18, 67108864
s_mul_i32 s22, s12, 10240
v_lshlrev_b32 v1, 4, v0
v_lshlrev_b32 v5, 7, v0
s_mov_b32 s38, 0
L_ww_qclr0:
buffer_load_dword v4, off, s[8:11], 0 offset:128 sc1
s_add_u32 s38, s38, 1
s_cmp_ge_u32 s38, 524288
s_cbranch_scc1 L_err
s_waitcnt vmcnt(0)
v_cmp_gt_u32 vcc, 1, v4
s_cbranch_vccz L_ww_qclr0_ok
s_sleep 4
s_branch L_ww_qclr0
L_ww_qclr0_ok:
s_mov_b32 s35, 1597312
s_mov_b32 s38, 0
L_ww_qhold:
buffer_load_dword v4, off, s[4:7], s35 offset:0 sc1
s_add_u32 s38, s38, 1
s_cmp_ge_u32 s38, 524288
s_cbranch_scc1 L_err
s_waitcnt vmcnt(0)
v_cmp_gt_u32 vcc, 1, v4
s_cbranch_vccz L_ww_qhold_ok
s_sleep 4
s_branch L_ww_qhold
L_ww_qhold_ok:
s_barrier
v_bfe_u32 v2, v0, 3, 3
v_mul_u32_u24 v3, 8192, v2
v_bfe_u32 v2, v0, 0, 2
v_mul_u32_u24 v2, 16, v2
v_add_u32 v3, v3, v2
v_bfe_u32 v2, v0, 2, 1
v_bfe_u32 v4, v0, 4, 1
v_xor_b32 v2, v2, v4
v_lshl_add_u32 v3, v2, 6, v3
v_bfe_u32 v2, v0, 5, 1
v_mul_u32_u24 v24, 1024, v2
v_bfe_u32 v2, v0, 2, 2
v_mul_u32_u24 v2, 128, v2
v_add_u32 v24, v24, v2
v_bfe_u32 v2, v0, 3, 1
v_mul_u32_u24 v2, 64, v2
v_add_u32 v24, v24, v2
v_bfe_u32 v2, v0, 4, 1
v_mul_u32_u24 v2, 32, v2
v_add_u32 v24, v24, v2
v_bfe_u32 v2, v0, 0, 2
v_mul_u32_u24 v2, 8, v2
v_add_u32 v24, v24, v2
s_mul_i32 s100, s12, 20480
s_add_u32 s100, s100, 81920
v_add_u32 v24, s100, v24
v_xor_b32 v25, 64, v24
s_add_u32 m0, s100, 0
s_add_u32 s35, s96, 0
buffer_load_dwordx4 v3, s[80:83], s35 offen lds
s_add_u32 m0, s100, 1024
s_add_u32 s35, s96, 65536
buffer_load_dwordx4 v3, s[80:83], s35 offen lds
s_add_u32 m0, s100, 2048
s_add_u32 s35, s96, 131072
buffer_load_dwordx4 v3, s[80:83], s35 offen lds
s_add_u32 m0, s100, 3072
s_add_u32 s35, s96, 196608
buffer_load_dwordx4 v3, s[80:83], s35 offen lds
s_add_u32 m0, s100, 4096
s_add_u32 s35, s96, 262144
buffer_load_dwordx4 v3, s[80:83], s35 offen lds
s_add_u32 m0, s100, 5120
s_add_u32 s35, s96, 327680
buffer_load_dwordx4 v3, s[80:83], s35 offen lds
s_add_u32 m0, s100, 6144
s_add_u32 s35, s96, 393216
buffer_load_dwordx4 v3, s[80:83], s35 offen lds
s_add_u32 m0, s100, 7168
s_add_u32 s35, s96, 458752
buffer_load_dwordx4 v3, s[80:83], s35 offen lds
s_add_u32 m0, s100, 8192
s_add_u32 s35, s96, 524288
buffer_load_dwordx4 v3, s[80:83], s35 offen lds
s_add_u32 m0, s100, 9216
s_add_u32 s35, s96, 589824
buffer_load_dwordx4 v3, s[80:83], s35 offen lds
s_add_u32 m0, s100, 10240
s_add_u32 s35, s96, 655360
buffer_load_dwordx4 v3, s[80:83], s35 offen lds
s_add_u32 m0, s100, 11264
s_add_u32 s35, s96, 720896
buffer_load_dwordx4 v3, s[80:83], s35 offen lds
s_add_u32 m0, s100, 12288
s_add_u32 s35, s96, 786432
buffer_load_dwordx4 v3, s[80:83], s35 offen lds
s_add_u32 m0, s100, 13312
s_add_u32 s35, s96, 851968
buffer_load_dwordx4 v3, s[80:83], s35 offen lds
s_add_u32 m0, s100, 14336
s_add_u32 s35, s96, 917504
buffer_load_dwordx4 v3, s[80:83], s35 offen lds
s_add_u32 m0, s100, 15360
s_add_u32 s35, s96, 983040
buffer_load_dwordx4 v3, s[80:83], s35 offen lds
s_add_u32 m0, s100, 16384
s_add_u32 s35, s96, 1048576
buffer_load_dwordx4 v3, s[80:83], s35 offen lds
s_add_u32 m0, s100, 17408
s_add_u32 s35, s96, 1114112
buffer_load_dwordx4 v3, s[80:83], s35 offen lds
s_add_u32 m0, s100, 18432
s_add_u32 s35, s96, 1179648
buffer_load_dwordx4 v3, s[80:83], s35 offen lds
s_add_u32 m0, s100, 19456
s_add_u32 s35, s96, 1245184
buffer_load_dwordx4 v3, s[80:83], s35 offen lds
s_waitcnt vmcnt(16)
ds_read_b64_tr_b16 a[0:1], v24 offset:0
ds_read_b64_tr_b16 a[2:3], v24 offset:512
ds_read_b64_tr_b16 a[4:5], v25 offset:0
ds_read_b64_tr_b16 a[6:7], v25 offset:512
ds_read_b64_tr_b16 a[8:9], v24 offset:2048
ds_read_b64_tr_b16 a[10:11], v24 offset:2560
ds_read_b64_tr_b16 a[12:13], v25 offset:2048
ds_read_b64_tr_b16 a[14:15], v25 offset:2560
s_waitcnt lgkmcnt(0)
s_add_u32 m0, s100, 0
s_add_u32 s35, s96, 1310720
buffer_load_dwordx4 v3, s[80:83], s35 offen lds
s_add_u32 m0, s100, 1024
s_add_u32 s35, s96, 1376256
buffer_load_dwordx4 v3, s[80:83], s35 offen lds
s_add_u32 m0, s100, 2048
s_add_u32 s35, s96, 1441792
buffer_load_dwordx4 v3, s[80:83], s35 offen lds
s_add_u32 m0, s100, 3072
s_add_u32 s35, s96, 1507328
buffer_load_dwordx4 v3, s[80:83], s35 offen lds
s_waitcnt vmcnt(16)
ds_read_b64_tr_b16 a[16:17], v24 offset:4096
ds_read_b64_tr_b16 a[18:19], v24 offset:4608
ds_read_b64_tr_b16 a[20:21], v25 offset:4096
ds_read_b64_tr_b16 a[22:23], v25 offset:4608
ds_read_b64_tr_b16 a[24:25], v24 offset:6144
ds_read_b64_tr_b16 a[26:27], v24 offset:6656
ds_read_b64_tr_b16 a[28:29], v25 offset:6144
ds_read_b64_tr_b16 a[30:31], v25 offset:6656
s_waitcnt lgkmcnt(0)
s_add_u32 m0, s100, 4096
s_add_u32 s35, s96, 1572864
buffer_load_dwordx4 v3, s[80:83], s35 offen lds
s_add_u32 m0, s100, 5120
s_add_u32 s35, s96, 1638400
buffer_load_dwordx4 v3, s[80:83], s35 offen lds
s_add_u32 m0, s100, 6144
s_add_u32 s35, s96, 1703936
buffer_load_dwordx4 v3, s[80:83], s35 offen lds
s_add_u32 m0, s100, 7168
s_add_u32 s35, s96, 1769472
buffer_load_dwordx4 v3, s[80:83], s35 offen lds
s_waitcnt vmcnt(16)
ds_read_b64_tr_b16 a[32:33], v24 offset:8192
ds_read_b64_tr_b16 a[34:35], v24 offset:8704
ds_read_b64_tr_b16 a[36:37], v25 offset:8192
ds_read_b64_tr_b16 a[38:39], v25 offset:8704
ds_read_b64_tr_b16 a[40:41], v24 offset:10240
ds_read_b64_tr_b16 a[42:43], v24 offset:10752
ds_read_b64_tr_b16 a[44:45], v25 offset:10240
ds_read_b64_tr_b16 a[46:47], v25 offset:10752
s_waitcnt lgkmcnt(0)
s_add_u32 m0, s100, 8192
s_add_u32 s35, s96, 1835008
buffer_load_dwordx4 v3, s[80:83], s35 offen lds
s_add_u32 m0, s100, 9216
s_add_u32 s35, s96, 1900544
buffer_load_dwordx4 v3, s[80:83], s35 offen lds
s_add_u32 m0, s100, 10240
s_add_u32 s35, s96, 1966080
buffer_load_dwordx4 v3, s[80:83], s35 offen lds
s_add_u32 m0, s100, 11264
s_add_u32 s35, s96, 2031616
buffer_load_dwordx4 v3, s[80:83], s35 offen lds
buffer_load_dword v26, off, s[8:11], 0 offset:128 sc1
s_waitcnt vmcnt(16)
ds_read_b64_tr_b16 a[48:49], v24 offset:12288
ds_read_b64_tr_b16 a[50:51], v24 offset:12800
ds_read_b64_tr_b16 a[52:53], v25 offset:12288
ds_read_b64_tr_b16 a[54:55], v25 offset:12800
ds_read_b64_tr_b16 a[56:57], v24 offset:14336
ds_read_b64_tr_b16 a[58:59], v24 offset:14848
ds_read_b64_tr_b16 a[60:61], v25 offset:14336
ds_read_b64_tr_b16 a[62:63], v25 offset:14848
s_waitcnt lgkmcnt(0)
s_add_u32 m0, s100, 12288
s_add_u32 s35, s96, 2097152
buffer_load_dwordx4 v3, s[80:83], s35 offen lds
s_add_u32 m0, s100, 13312
s_add_u32 s35, s96, 2162688
buffer_load_dwordx4 v3, s[80:83], s35 offen lds
s_add_u32 m0, s100, 14336
s_add_u32 s35, s96, 2228224
buffer_load_dwordx4 v3, s[80:83], s35 offen lds
s_add_u32 m0, s100, 15360
s_add_u32 s35, s96, 2293760
buffer_load_dwordx4 v3, s[80:83], s35 offen lds
s_waitcnt vmcnt(16)
ds_read_b64_tr_b16 a[64:65], v24 offset:16384
ds_read_b64_tr_b16 a[66:67], v24 offset:16896
ds_read_b64_tr_b16 a[68:69], v25 offset:16384
ds_read_b64_tr_b16 a[70:71], v25 offset:16896
ds_read_b64_tr_b16 a[72:73], v24 offset:18432
ds_read_b64_tr_b16 a[74:75], v24 offset:18944
ds_read_b64_tr_b16 a[76:77], v25 offset:18432
ds_read_b64_tr_b16 a[78:79], v25 offset:18944
s_waitcnt lgkmcnt(0)
s_add_u32 m0, s100, 16384
s_add_u32 s35, s96, 2359296
buffer_load_dwordx4 v3, s[80:83], s35 offen lds
s_add_u32 m0, s100, 17408
s_add_u32 s35, s96, 2424832
buffer_load_dwordx4 v3, s[80:83], s35 offen lds
s_add_u32 m0, s100, 18432
s_add_u32 s35, s96, 2490368
buffer_load_dwordx4 v3, s[80:83], s35 offen lds
s_add_u32 m0, s100, 19456
s_add_u32 s35, s96, 2555904
buffer_load_dwordx4 v3, s[80:83], s35 offen lds
s_waitcnt vmcnt(16)
ds_read_b64_tr_b16 a[80:81], v24 offset:0
ds_read_b64_tr_b16 a[82:83], v24 offset:512
ds_read_b64_tr_b16 a[84:85], v25 offset:0
ds_read_b64_tr_b16 a[86:87], v25 offset:512
ds_read_b64_tr_b16 a[88:89], v24 offset:2048
ds_read_b64_tr_b16 a[90:91], v24 offset:2560
ds_read_b64_tr_b16 a[92:93], v25 offset:2048
ds_read_b64_tr_b16 a[94:95], v25 offset:2560
s_waitcnt lgkmcnt(0)
s_add_u32 m0, s100, 0
s_add_u32 s35, s96, 2621440
buffer_load_dwordx4 v3, s[80:83], s35 offen lds
s_add_u32 m0, s100, 1024
s_add_u32 s35, s96, 2686976
buffer_load_dwordx4 v3, s[80:83], s35 offen lds
s_add_u32 m0, s100, 2048
s_add_u32 s35, s96, 2752512
buffer_load_dwordx4 v3, s[80:83], s35 offen lds
s_add_u32 m0, s100, 3072
s_add_u32 s35, s96, 2818048
buffer_load_dwordx4 v3, s[80:83], s35 offen lds
s_waitcnt vmcnt(16)
ds_read_b64_tr_b16 a[96:97], v24 offset:4096
ds_read_b64_tr_b16 a[98:99], v24 offset:4608
ds_read_b64_tr_b16 a[100:101], v25 offset:4096
ds_read_b64_tr_b16 a[102:103], v25 offset:4608
ds_read_b64_tr_b16 a[104:105], v24 offset:6144
ds_read_b64_tr_b16 a[106:107], v24 offset:6656
ds_read_b64_tr_b16 a[108:109], v25 offset:6144
ds_read_b64_tr_b16 a[110:111], v25 offset:6656
s_waitcnt lgkmcnt(0)
s_add_u32 m0, s100, 4096
s_add_u32 s35, s96, 2883584
buffer_load_dwordx4 v3, s[80:83], s35 offen lds
s_add_u32 m0, s100, 5120
s_add_u32 s35, s96, 2949120
buffer_load_dwordx4 v3, s[80:83], s35 offen lds
s_add_u32 m0, s100, 6144
s_add_u32 s35, s96, 3014656
buffer_load_dwordx4 v3, s[80:83], s35 offen lds
s_add_u32 m0, s100, 7168
s_add_u32 s35, s96, 3080192
buffer_load_dwordx4 v3, s[80:83], s35 offen lds
s_waitcnt vmcnt(16)
ds_read_b64_tr_b16 a[112:113], v24 offset:8192
ds_read_b64_tr_b16 a[114:115], v24 offset:8704
ds_read_b64_tr_b16 a[116:117], v25 offset:8192
ds_read_b64_tr_b16 a[118:119], v25 offset:8704
ds_read_b64_tr_b16 a[120:121], v24 offset:10240
ds_read_b64_tr_b16 a[122:123], v24 offset:10752
ds_read_b64_tr_b16 a[124:125], v25 offset:10240
ds_read_b64_tr_b16 a[126:127], v25 offset:10752
s_waitcnt lgkmcnt(0)
s_add_u32 m0, s100, 8192
s_add_u32 s35, s96, 3145728
buffer_load_dwordx4 v3, s[80:83], s35 offen lds
s_add_u32 m0, s100, 9216
s_add_u32 s35, s96, 3211264
buffer_load_dwordx4 v3, s[80:83], s35 offen lds
s_add_u32 m0, s100, 10240
s_add_u32 s35, s96, 3276800
buffer_load_dwordx4 v3, s[80:83], s35 offen lds
s_add_u32 m0, s100, 11264
s_add_u32 s35, s96, 3342336
buffer_load_dwordx4 v3, s[80:83], s35 offen lds
s_waitcnt vmcnt(16)
ds_read_b64_tr_b16 a[128:129], v24 offset:12288
ds_read_b64_tr_b16 a[130:131], v24 offset:12800
ds_read_b64_tr_b16 a[132:133], v25 offset:12288
ds_read_b64_tr_b16 a[134:135], v25 offset:12800
ds_read_b64_tr_b16 a[136:137], v24 offset:14336
ds_read_b64_tr_b16 a[138:139], v24 offset:14848
ds_read_b64_tr_b16 a[140:141], v25 offset:14336
ds_read_b64_tr_b16 a[142:143], v25 offset:14848
s_waitcnt lgkmcnt(0)
s_add_u32 m0, s100, 12288
s_add_u32 s35, s96, 3407872
buffer_load_dwordx4 v3, s[80:83], s35 offen lds
s_add_u32 m0, s100, 13312
s_add_u32 s35, s96, 3473408
buffer_load_dwordx4 v3, s[80:83], s35 offen lds
s_add_u32 m0, s100, 14336
s_add_u32 s35, s96, 3538944
buffer_load_dwordx4 v3, s[80:83], s35 offen lds
s_add_u32 m0, s100, 15360
s_add_u32 s35, s96, 3604480
buffer_load_dwordx4 v3, s[80:83], s35 offen lds
v_cmp_gt_u32 vcc, 1, v26
s_cbranch_vccz L_q_clr
s_mov_b32 s38, 0
L_ww_qclr:
buffer_load_dword v26, off, s[8:11], 0 offset:128 sc1
s_add_u32 s38, s38, 1
s_cmp_ge_u32 s38, 524288
s_cbranch_scc1 L_err
s_waitcnt vmcnt(0)
v_cmp_gt_u32 vcc, 1, v26
s_cbranch_vccz L_ww_qclr_ok
s_sleep 4
s_branch L_ww_qclr
L_ww_qclr_ok:
L_q_clr:
s_mov_b32 s35, 1589248
buffer_load_dword v26, v5, s[4:7], s35 offen sc1
s_waitcnt vmcnt(16)
ds_read_b64_tr_b16 a[144:145], v24 offset:16384
ds_read_b64_tr_b16 a[146:147], v24 offset:16896
ds_read_b64_tr_b16 a[148:149], v25 offset:16384
ds_read_b64_tr_b16 a[150:151], v25 offset:16896
ds_read_b64_tr_b16 a[152:153], v24 offset:18432
ds_read_b64_tr_b16 a[154:155], v24 offset:18944
ds_read_b64_tr_b16 a[156:157], v25 offset:18432
ds_read_b64_tr_b16 a[158:159], v25 offset:18944
s_waitcnt lgkmcnt(0)
s_add_u32 m0, s100, 16384
s_add_u32 s35, s96, 3670016
buffer_load_dwordx4 v3, s[80:83], s35 offen lds
s_add_u32 m0, s100, 17408
s_add_u32 s35, s96, 3735552
buffer_load_dwordx4 v3, s[80:83], s35 offen lds
s_add_u32 m0, s100, 18432
s_add_u32 s35, s96, 3801088
buffer_load_dwordx4 v3, s[80:83], s35 offen lds
s_add_u32 m0, s100, 19456
s_add_u32 s35, s96, 3866624
buffer_load_dwordx4 v3, s[80:83], s35 offen lds
s_waitcnt vmcnt(16)
ds_read_b64_tr_b16 a[160:161], v24 offset:0
ds_read_b64_tr_b16 a[162:163], v24 offset:512
ds_read_b64_tr_b16 a[164:165], v25 offset:0
ds_read_b64_tr_b16 a[166:167], v25 offset:512
ds_read_b64_tr_b16 a[168:169], v24 offset:2048
ds_read_b64_tr_b16 a[170:171], v24 offset:2560
ds_read_b64_tr_b16 a[172:173], v25 offset:2048
ds_read_b64_tr_b16 a[174:175], v25 offset:2560
s_waitcnt lgkmcnt(0)
s_add_u32 m0, s100, 0
s_add_u32 s35, s96, 3932160
buffer_load_dwordx4 v3, s[80:83], s35 offen lds
s_add_u32 m0, s100, 1024
s_add_u32 s35, s96, 3997696
buffer_load_dwordx4 v3, s[80:83], s35 offen lds
s_add_u32 m0, s100, 2048
s_add_u32 s35, s96, 4063232
buffer_load_dwordx4 v3, s[80:83], s35 offen lds
s_add_u32 m0, s100, 3072
s_add_u32 s35, s96, 4128768
buffer_load_dwordx4 v3, s[80:83], s35 offen lds
s_waitcnt vmcnt(16)
ds_read_b64_tr_b16 a[176:177], v24 offset:4096
ds_read_b64_tr_b16 a[178:179], v24 offset:4608
ds_read_b64_tr_b16 a[180:181], v25 offset:4096
ds_read_b64_tr_b16 a[182:183], v25 offset:4608
ds_read_b64_tr_b16 a[184:185], v24 offset:6144
ds_read_b64_tr_b16 a[186:187], v24 offset:6656
ds_read_b64_tr_b16 a[188:189], v25 offset:6144
ds_read_b64_tr_b16 a[190:191], v25 offset:6656
s_waitcnt lgkmcnt(0)
s_add_u32 m0, s100, 4096
s_add_u32 s35, s96, 4194304
buffer_load_dwordx4 v3, s[80:83], s35 offen lds
s_add_u32 m0, s100, 5120
s_add_u32 s35, s96, 4259840
buffer_load_dwordx4 v3, s[80:83], s35 offen lds
s_add_u32 m0, s100, 6144
s_add_u32 s35, s96, 4325376
buffer_load_dwordx4 v3, s[80:83], s35 offen lds
s_add_u32 m0, s100, 7168
s_add_u32 s35, s96, 4390912
buffer_load_dwordx4 v3, s[80:83], s35 offen lds
s_waitcnt vmcnt(16)
ds_read_b64_tr_b16 a[192:193], v24 offset:8192
ds_read_b64_tr_b16 a[194:195], v24 offset:8704
ds_read_b64_tr_b16 a[196:197], v25 offset:8192
ds_read_b64_tr_b16 a[198:199], v25 offset:8704
ds_read_b64_tr_b16 a[200:201], v24 offset:10240
ds_read_b64_tr_b16 a[202:203], v24 offset:10752
ds_read_b64_tr_b16 a[204:205], v25 offset:10240
ds_read_b64_tr_b16 a[206:207], v25 offset:10752
s_waitcnt lgkmcnt(0)
s_add_u32 m0, s100, 8192
s_add_u32 s35, s96, 4456448
buffer_load_dwordx4 v3, s[80:83], s35 offen lds
s_add_u32 m0, s100, 9216
s_add_u32 s35, s96, 4521984
buffer_load_dwordx4 v3, s[80:83], s35 offen lds
s_add_u32 m0, s100, 10240
s_add_u32 s35, s96, 4587520
buffer_load_dwordx4 v3, s[80:83], s35 offen lds
s_add_u32 m0, s100, 11264
s_add_u32 s35, s96, 4653056
buffer_load_dwordx4 v3, s[80:83], s35 offen lds
s_waitcnt vmcnt(16)
ds_read_b64_tr_b16 a[208:209], v24 offset:12288
ds_read_b64_tr_b16 a[210:211], v24 offset:12800
ds_read_b64_tr_b16 a[212:213], v25 offset:12288
ds_read_b64_tr_b16 a[214:215], v25 offset:12800
ds_read_b64_tr_b16 a[216:217], v24 offset:14336
ds_read_b64_tr_b16 a[218:219], v24 offset:14848
ds_read_b64_tr_b16 a[220:221], v25 offset:14336
ds_read_b64_tr_b16 a[222:223], v25 offset:14848
s_waitcnt lgkmcnt(0)
s_add_u32 m0, s100, 12288
s_add_u32 s35, s96, 4718592
buffer_load_dwordx4 v3, s[80:83], s35 offen lds
s_add_u32 m0, s100, 13312
s_add_u32 s35, s96, 4784128
buffer_load_dwordx4 v3, s[80:83], s35 offen lds
s_add_u32 m0, s100, 14336
s_add_u32 s35, s96, 4849664
buffer_load_dwordx4 v3, s[80:83], s35 offen lds
s_add_u32 m0, s100, 15360
s_add_u32 s35, s96, 4915200
buffer_load_dwordx4 v3, s[80:83], s35 offen lds
s_waitcnt vmcnt(16)
ds_read_b64_tr_b16 a[224:225], v24 offset:16384
ds_read_b64_tr_b16 a[226:227], v24 offset:16896
ds_read_b64_tr_b16 a[228:229], v25 offset:16384
ds_read_b64_tr_b16 a[230:231], v25 offset:16896
ds_read_b64_tr_b16 a[232:233], v24 offset:18432
ds_read_b64_tr_b16 a[234:235], v24 offset:18944
ds_read_b64_tr_b16 a[236:237], v25 offset:18432
ds_read_b64_tr_b16 a[238:239], v25 offset:18944
s_waitcnt lgkmcnt(0)
s_add_u32 m0, s100, 16384
s_add_u32 s35, s96, 4980736
buffer_load_dwordx4 v3, s[80:83], s35 offen lds
s_add_u32 m0, s100, 17408
s_add_u32 s35, s96, 5046272
buffer_load_dwordx4 v3, s[80:83], s35 offen lds
s_add_u32 m0, s100, 18432
s_add_u32 s35, s96, 5111808
buffer_load_dwordx4 v3, s[80:83], s35 offen lds
s_add_u32 m0, s100, 19456
s_add_u32 s35, s96, 5177344
buffer_load_dwordx4 v3, s[80:83], s35 offen lds
s_waitcnt vmcnt(16)
ds_read_b64_tr_b16 a[240:241], v24 offset:0
ds_read_b64_tr_b16 a[242:243], v24 offset:512
ds_read_b64_tr_b16 a[244:245], v25 offset:0
ds_read_b64_tr_b16 a[246:247], v25 offset:512
ds_read_b64_tr_b16 a[248:249], v24 offset:2048
ds_read_b64_tr_b16 a[250:251], v24 offset:2560
ds_read_b64_tr_b16 a[252:253], v25 offset:2048
ds_read_b64_tr_b16 a[254:255], v25 offset:2560
s_waitcnt lgkmcnt(0)
s_mov_b32 s38, 0
s_mov_b32 s35, 1589248
L_q_xall:
v_cmp_gt_u32 vcc, 1, v26
s_cbranch_vccz L_q_xok
buffer_load_dword v26, v5, s[4:7], s35 offen sc1
s_add_u32 s38, s38, 1
s_cmp_ge_u32 s38, 524288
s_cbranch_scc1 L_err
s_waitcnt vmcnt(0)
s_branch L_q_xall
L_q_xok:
s_mul_i32 s36, 0, 1
s_add_u32 s36, s36, s16
s_mul_i32 s36, s36, 40960
s_add_u32 s36, s36, s22
s_add_u32 s36, s36, 109051904
s_add_u32 s37, 0, s22
s_add_u32 m0, s37, 0
s_add_u32 s35, s36, 0
buffer_load_dwordx4 v1, s[4:7], s35 offen sc1 lds
s_add_u32 m0, s37, 1024
s_add_u32 s35, s36, 1024
buffer_load_dwordx4 v1, s[4:7], s35 offen sc1 lds
s_add_u32 m0, s37, 2048
s_add_u32 s35, s36, 2048
buffer_load_dwordx4 v1, s[4:7], s35 offen sc1 lds
s_add_u32 m0, s37, 3072
s_add_u32 s35, s36, 3072
buffer_load_dwordx4 v1, s[4:7], s35 offen sc1 lds
s_add_u32 m0, s37, 4096
s_add_u32 s35, s36, 4096
buffer_load_dwordx4 v1, s[4:7], s35 offen sc1 lds
s_add_u32 m0, s37, 5120
s_add_u32 s35, s36, 5120
buffer_load_dwordx4 v1, s[4:7], s35 offen sc1 lds
s_add_u32 m0, s37, 6144
s_add_u32 s35, s36, 6144
buffer_load_dwordx4 v1, s[4:7], s35 offen sc1 lds
s_add_u32 m0, s37, 7168
s_add_u32 s35, s36, 7168
buffer_load_dwordx4 v1, s[4:7], s35 offen sc1 lds
s_add_u32 m0, s37, 8192
s_add_u32 s35, s36, 8192
buffer_load_dwordx4 v1, s[4:7], s35 offen sc1 lds
s_add_u32 m0, s37, 9216
s_add_u32 s35, s36, 9216
buffer_load_dwordx4 v1, s[4:7], s35 offen sc1 lds
s_mul_i32 s36, 1, 1
s_add_u32 s36, s36, s16
s_mul_i32 s36, s36, 40960
s_add_u32 s36, s36, s22
s_add_u32 s36, s36, 109051904
s_add_u32 s37, 40960, s22
s_add_u32 m0, s37, 0
s_add_u32 s35, s36, 0
buffer_load_dwordx4 v1, s[4:7], s35 offen sc1 lds
s_add_u32 m0, s37, 1024
s_add_u32 s35, s36, 1024
buffer_load_dwordx4 v1, s[4:7], s35 offen sc1 lds
s_add_u32 m0, s37, 2048
s_add_u32 s35, s36, 2048
buffer_load_dwordx4 v1, s[4:7], s35 offen sc1 lds
s_add_u32 m0, s37, 3072
s_add_u32 s35, s36, 3072
buffer_load_dwordx4 v1, s[4:7], s35 offen sc1 lds
s_add_u32 m0, s37, 4096
s_add_u32 s35, s36, 4096
buffer_load_dwordx4 v1, s[4:7], s35 offen sc1 lds
s_add_u32 m0, s37, 5120
s_add_u32 s35, s36, 5120
buffer_load_dwordx4 v1, s[4:7], s35 offen sc1 lds
s_add_u32 m0, s37, 6144
s_add_u32 s35, s36, 6144
buffer_load_dwordx4 v1, s[4:7], s35 offen sc1 lds
s_add_u32 m0, s37, 7168
s_add_u32 s35, s36, 7168
buffer_load_dwordx4 v1, s[4:7], s35 offen sc1 lds
s_add_u32 m0, s37, 8192
s_add_u32 s35, s36, 8192
buffer_load_dwordx4 v1, s[4:7], s35 offen sc1 lds
s_add_u32 m0, s37, 9216
s_add_u32 s35, s36, 9216
buffer_load_dwordx4 v1, s[4:7], s35 offen sc1 lds
s_waitcnt vmcnt(32)
ds_read_b64_tr_b16 v[192:193], v24 offset:4096
ds_read_b64_tr_b16 v[194:195], v24 offset:4608
ds_read_b64_tr_b16 v[196:197], v25 offset:4096
ds_read_b64_tr_b16 v[198:199], v25 offset:4608
ds_read_b64_tr_b16 v[200:201], v24 offset:6144
ds_read_b64_tr_b16 v[202:203], v24 offset:6656
ds_read_b64_tr_b16 v[204:205], v25 offset:6144
ds_read_b64_tr_b16 v[206:207], v25 offset:6656
s_waitcnt lgkmcnt(0)
s_waitcnt vmcnt(28)
ds_read_b64_tr_b16 v[208:209], v24 offset:8192
ds_read_b64_tr_b16 v[210:211], v24 offset:8704
ds_read_b64_tr_b16 v[212:213], v25 offset:8192
ds_read_b64_tr_b16 v[214:215], v25 offset:8704
ds_read_b64_tr_b16 v[216:217], v24 offset:10240
ds_read_b64_tr_b16 v[218:219], v24 offset:10752
ds_read_b64_tr_b16 v[220:221], v25 offset:10240
ds_read_b64_tr_b16 v[222:223], v25 offset:10752
s_waitcnt lgkmcnt(0)
s_waitcnt vmcnt(24)
ds_read_b64_tr_b16 v[224:225], v24 offset:12288
ds_read_b64_tr_b16 v[226:227], v24 offset:12800
ds_read_b64_tr_b16 v[228:229], v25 offset:12288
ds_read_b64_tr_b16 v[230:231], v25 offset:12800
ds_read_b64_tr_b16 v[232:233], v24 offset:14336
ds_read_b64_tr_b16 v[234:235], v24 offset:14848
ds_read_b64_tr_b16 v[236:237], v25 offset:14336
ds_read_b64_tr_b16 v[238:239], v25 offset:14848
s_waitcnt lgkmcnt(0)
s_waitcnt vmcnt(20)
ds_read_b64_tr_b16 v[240:241], v24 offset:16384
ds_read_b64_tr_b16 v[242:243], v24 offset:16896
ds_read_b64_tr_b16 v[244:245], v25 offset:16384
ds_read_b64_tr_b16 v[246:247], v25 offset:16896
ds_read_b64_tr_b16 v[248:249], v24 offset:18432
ds_read_b64_tr_b16 v[250:251], v24 offset:18944
ds_read_b64_tr_b16 v[252:253], v25 offset:18432
ds_read_b64_tr_b16 v[254:255], v25 offset:18944
s_waitcnt lgkmcnt(0)
s_mov_b32 s24, 0xc0135761
s_mov_b32 s25, 0xbdd2d3e8
v_mov_b32 v6, s24
s_mov_b32 s17, 0
s_mov_b32 s20, 0
s_sub_u32 s27, s21, 1
s_waitcnt vmcnt(10)
s_barrier
v_add_u32 v7, s20, v1
s_add_u32 s39, s17, 2
s_min_u32 s39, s39, s27
s_add_u32 s26, s20, 81920
s_cmp_ge_u32 s26, 122880
s_cselect_b32 s35, 122880, 0
s_sub_u32 s26, s26, s35
ds_read_b128 v[128:131], v7 offset:0
ds_read_b128 v[132:135], v7 offset:1024
ds_read_b128 v[136:139], v7 offset:2048
s_mul_i32 s36, s39, 1
s_add_u32 s36, s36, s16
s_mul_i32 s36, s36, 40960
s_add_u32 s36, s36, s22
s_add_u32 s36, s36, 109051904
s_add_u32 s37, s26, s22
s_waitcnt lgkmcnt(2)
v_mfma_f32_32x32x16_bf16 v[64:79], a[0:3], v[128:131], 0
v_mfma_f32_32x32x16_bf16 v[80:95], a[4:7], v[128:131], 0
ds_read_b128 v[140:143], v7 offset:3072
s_waitcnt lgkmcnt(2)
v_mfma_f32_32x32x16_bf16 v[64:79], a[8:11], v[132:135], v[64:79]
s_add_u32 m0, s37, 0
s_add_u32 s35, s36, 0
buffer_load_dwordx4 v1, s[4:7], s35 offen sc1 lds
v_mfma_f32_32x32x16_bf16 v[80:95], a[12:15], v[132:135], v[80:95]
ds_read_b128 v[128:131], v7 offset:4096
s_add_u32 m0, s37, 1024
s_add_u32 s35, s36, 1024
buffer_load_dwordx4 v1, s[4:7], s35 offen sc1 lds
s_waitcnt lgkmcnt(2)
v_mfma_f32_32x32x16_bf16 v[64:79], a[16:19], v[136:139], v[64:79]
s_add_u32 m0, s37, 2048
s_add_u32 s35, s36, 2048
buffer_load_dwordx4 v1, s[4:7], s35 offen sc1 lds
v_mfma_f32_32x32x16_bf16 v[80:95], a[20:23], v[136:139], v[80:95]
ds_read_b128 v[132:135], v7 offset:5120
s_add_u32 m0, s37, 3072
s_add_u32 s35, s36, 3072
buffer_load_dwordx4 v1, s[4:7], s35 offen sc1 lds
s_waitcnt lgkmcnt(2)
v_mfma_f32_32x32x16_bf16 v[64:79], a[24:27], v[140:143], v[64:79]
s_add_u32 m0, s37, 4096
s_add_u32 s35, s36, 4096
buffer_load_dwordx4 v1, s[4:7], s35 offen sc1 lds
v_mfma_f32_32x32x16_bf16 v[80:95], a[28:31], v[140:143], v[80:95]
ds_read_b128 v[136:139], v7 offset:6144
s_add_u32 m0, s37, 5120
s_add_u32 s35, s36, 5120
buffer_load_dwordx4 v1, s[4:7], s35 offen sc1 lds
s_waitcnt lgkmcnt(2)
v_mfma_f32_32x32x16_bf16 v[64:79], a[32:35], v[128:131], v[64:79]
s_add_u32 m0, s37, 6144
s_add_u32 s35, s36, 6144
buffer_load_dwordx4 v1, s[4:7], s35 offen sc1 lds
v_mfma_f32_32x32x16_bf16 v[80:95], a[36:39], v[128:131], v[80:95]
ds_read_b128 v[140:143], v7 offset:7168
s_add_u32 m0, s37, 7168
s_add_u32 s35, s36, 7168
buffer_load_dwordx4 v1, s[4:7], s35 offen sc1 lds
s_waitcnt lgkmcnt(2)
v_mfma_f32_32x32x16_bf16 v[64:79], a[40:43], v[132:135], v[64:79]
s_add_u32 m0, s37, 8192
s_add_u32 s35, s36, 8192
buffer_load_dwordx4 v1, s[4:7], s35 offen sc1 lds
v_mfma_f32_32x32x16_bf16 v[80:95], a[44:47], v[132:135], v[80:95]
ds_read_b128 v[128:131], v7 offset:8192
s_add_u32 m0, s37, 9216
s_add_u32 s35, s36, 9216
buffer_load_dwordx4 v1, s[4:7], s35 offen sc1 lds
s_waitcnt lgkmcnt(2)
v_mfma_f32_32x32x16_bf16 v[64:79], a[48:51], v[136:139], v[64:79]
v_mfma_f32_32x32x16_bf16 v[80:95], a[52:55], v[136:139], v[80:95]
ds_read_b128 v[132:135], v7 offset:9216
s_waitcnt lgkmcnt(2)
v_mfma_f32_32x32x16_bf16 v[64:79], a[56:59], v[140:143], v[64:79]
v_mfma_f32_32x32x16_bf16 v[80:95], a[60:63], v[140:143], v[80:95]
ds_read_b128 v[136:139], v7 offset:10240
s_waitcnt lgkmcnt(2)
v_mfma_f32_32x32x16_bf16 v[64:79], a[64:67], v[128:131], v[64:79]
v_mfma_f32_32x32x16_bf16 v[80:95], a[68:71], v[128:131], v[80:95]
ds_read_b128 v[140:143], v7 offset:11264
s_waitcnt lgkmcnt(2)
v_mfma_f32_32x32x16_bf16 v[64:79], a[72:75], v[132:135], v[64:79]
v_mfma_f32_32x32x16_bf16 v[80:95], a[76:79], v[132:135], v[80:95]
ds_read_b128 v[128:131], v7 offset:12288
s_waitcnt lgkmcnt(2)
v_mfma_f32_32x32x16_bf16 v[64:79], a[80:83], v[136:139], v[64:79]
v_mfma_f32_32x32x16_bf16 v[80:95], a[84:87], v[136:139], v[80:95]
ds_read_b128 v[132:135], v7 offset:13312
s_waitcnt lgkmcnt(2)
v_mfma_f32_32x32x16_bf16 v[64:79], a[88:91], v[140:143], v[64:79]
v_mfma_f32_32x32x16_bf16 v[80:95], a[92:95], v[140:143], v[80:95]
ds_read_b128 v[136:139], v7 offset:14336
s_waitcnt lgkmcnt(2)
v_mfma_f32_32x32x16_bf16 v[64:79], a[96:99], v[128:131], v[64:79]
v_mfma_f32_32x32x16_bf16 v[80:95], a[100:103], v[128:131], v[80:95]
ds_read_b128 v[140:143], v7 offset:15360
s_waitcnt lgkmcnt(2)
v_mfma_f32_32x32x16_bf16 v[64:79], a[104:107], v[132:135], v[64:79]
v_mfma_f32_32x32x16_bf16 v[80:95], a[108:111], v[132:135], v[80:95]
ds_read_b128 v[128:131], v7 offset:16384
s_waitcnt lgkmcnt(2)
v_mfma_f32_32x32x16_bf16 v[64:79], a[112:115], v[136:139], v[64:79]
v_mfma_f32_32x32x16_bf16 v[80:95], a[116:119], v[136:139], v[80:95]
ds_read_b128 v[132:135], v7 offset:17408
s_waitcnt lgkmcnt(2)
v_mfma_f32_32x32x16_bf16 v[64:79], a[120:123], v[140:143], v[64:79]
v_mfma_f32_32x32x16_bf16 v[80:95], a[124:127], v[140:143], v[80:95]
ds_read_b128 v[136:139], v7 offset:18432
s_waitcnt lgkmcnt(2)
v_mfma_f32_32x32x16_bf16 v[64:79], a[128:131], v[128:131], v[64:79]
v_mfma_f32_32x32x16_bf16 v[80:95], a[132:135], v[128:131], v[80:95]
ds_read_b128 v[140:143], v7 offset:19456
s_waitcnt lgkmcnt(2)
v_mfma_f32_32x32x16_bf16 v[64:79], a[136:139], v[132:135], v[64:79]
v_mfma_f32_32x32x16_bf16 v[80:95], a[140:143], v[132:135], v[80:95]
ds_read_b128 v[128:131], v7 offset:20480
s_waitcnt lgkmcnt(2)
v_mfma_f32_32x32x16_bf16 v[64:79], a[144:147], v[136:139], v[64:79]
v_mfma_f32_32x32x16_bf16 v[80:95], a[148:151], v[136:139], v[80:95]
ds_read_b128 v[132:135], v7 offset:21504
s_waitcnt lgkmcnt(2)
v_mfma_f32_32x32x16_bf16 v[64:79], a[152:155], v[140:143], v[64:79]
v_mfma_f32_32x32x16_bf16 v[80:95], a[156:159], v[140:143], v[80:95]
ds_read_b128 v[136:139], v7 offset:22528
s_waitcnt lgkmcnt(2)
v_mfma_f32_32x32x16_bf16 v[64:79], a[160:163], v[128:131], v[64:79]
v_mfma_f32_32x32x16_bf16 v[80:95], a[164:167], v[128:131], v[80:95]
ds_read_b128 v[140:143], v7 offset:23552
s_waitcnt lgkmcnt(2)
v_mfma_f32_32x32x16_bf16 v[64:79], a[168:171], v[132:135], v[64:79]
v_mfma_f32_32x32x16_bf16 v[80:95], a[172:175], v[132:135], v[80:95]
ds_read_b128 v[128:131], v7 offset:24576
s_waitcnt lgkmcnt(2)
v_mfma_f32_32x32x16_bf16 v[64:79], a[176:179], v[136:139], v[64:79]
v_mfma_f32_32x32x16_bf16 v[80:95], a[180:183], v[136:139], v[80:95]
ds_read_b128 v[132:135], v7 offset:25600
s_waitcnt lgkmcnt(2)
v_mfma_f32_32x32x16_bf16 v[64:79], a[184:187], v[140:143], v[64:79]
v_mfma_f32_32x32x16_bf16 v[80:95], a[188:191], v[140:143], v[80:95]
ds_read_b128 v[136:139], v7 offset:26624
s_waitcnt lgkmcnt(2)
v_mfma_f32_32x32x16_bf16 v[64:79], a[192:195], v[128:131], v[64:79]
v_mfma_f32_32x32x16_bf16 v[80:95], a[196:199], v[128:131], v[80:95]
ds_read_b128 v[140:143], v7 offset:27648
s_waitcnt lgkmcnt(2)
v_mfma_f32_32x32x16_bf16 v[64:79], a[200:203], v[132:135], v[64:79]
v_mfma_f32_32x32x16_bf16 v[80:95], a[204:207], v[132:135], v[80:95]
ds_read_b128 v[128:131], v7 offset:28672
s_waitcnt lgkmcnt(2)
v_mfma_f32_32x32x16_bf16 v[64:79], a[208:211], v[136:139], v[64:79]
v_mfma_f32_32x32x16_bf16 v[80:95], a[212:215], v[136:139], v[80:95]
ds_read_b128 v[132:135], v7 offset:29696
s_waitcnt lgkmcnt(2)
v_mfma_f32_32x32x16_bf16 v[64:79], a[216:219], v[140:143], v[64:79]
v_mfma_f32_32x32x16_bf16 v[80:95], a[220:223], v[140:143], v[80:95]
ds_read_b128 v[136:139], v7 offset:30720
s_waitcnt lgkmcnt(2)
v_mfma_f32_32x32x16_bf16 v[64:79], a[224:227], v[128:131], v[64:79]
v_mfma_f32_32x32x16_bf16 v[80:95], a[228:231], v[128:131], v[80:95]
ds_read_b128 v[140:143], v7 offset:31744
s_waitcnt lgkmcnt(2)
v_mfma_f32_32x32x16_bf16 v[64:79], a[232:235], v[132:135], v[64:79]
v_mfma_f32_32x32x16_bf16 v[80:95], a[236:239], v[132:135], v[80:95]
ds_read_b128 v[128:131], v7 offset:32768
s_waitcnt lgkmcnt(2)
v_mfma_f32_32x32x16_bf16 v[64:79], a[240:243], v[136:139], v[64:79]
v_mfma_f32_32x32x16_bf16 v[80:95], a[244:247], v[136:139], v[80:95]
ds_read_b128 v[132:135], v7 offset:33792
s_waitcnt lgkmcnt(2)
v_mfma_f32_32x32x16_bf16 v[64:79], a[248:251], v[140:143], v[64:79]
v_mfma_f32_32x32x16_bf16 v[80:95], a[252:255], v[140:143], v[80:95]
ds_read_b128 v[136:139], v7 offset:34816
s_waitcnt lgkmcnt(2)
v_mfma_f32_32x32x16_bf16 v[64:79], v[192:195], v[128:131], v[64:79]
v_mfma_f32_32x32x16_bf16 v[80:95], v[196:199], v[128:131], v[80:95]
ds_read_b128 v[140:143], v7 offset:35840
s_waitcnt lgkmcnt(2)
v_mfma_f32_32x32x16_bf16 v[64:79], v[200:203], v[132:135], v[64:79]
v_mfma_f32_32x32x16_bf16 v[80:95], v[204:207], v[132:135], v[80:95]
ds_read_b128 v[128:131], v7 offset:36864
s_waitcnt lgkmcnt(2)
v_mfma_f32_32x32x16_bf16 v[64:79], v[208:211], v[136:139], v[64:79]
v_mfma_f32_32x32x16_bf16 v[80:95], v[212:215], v[136:139], v[80:95]
ds_read_b128 v[132:135], v7 offset:37888
s_waitcnt lgkmcnt(2)
v_mfma_f32_32x32x16_bf16 v[64:79], v[216:219], v[140:143], v[64:79]
v_mfma_f32_32x32x16_bf16 v[80:95], v[220:223], v[140:143], v[80:95]
ds_read_b128 v[136:139], v7 offset:38912
s_waitcnt lgkmcnt(2)
v_mfma_f32_32x32x16_bf16 v[64:79], v[224:227], v[128:131], v[64:79]
v_mfma_f32_32x32x16_bf16 v[80:95], v[228:231], v[128:131], v[80:95]
ds_read_b128 v[140:143], v7 offset:39936
s_waitcnt lgkmcnt(2)
v_mfma_f32_32x32x16_bf16 v[64:79], v[232:235], v[132:135], v[64:79]
v_mfma_f32_32x32x16_bf16 v[80:95], v[236:239], v[132:135], v[80:95]
s_waitcnt lgkmcnt(1)
v_mfma_f32_32x32x16_bf16 v[64:79], v[240:243], v[136:139], v[64:79]
v_mfma_f32_32x32x16_bf16 v[80:95], v[244:247], v[136:139], v[80:95]
s_waitcnt lgkmcnt(0)
v_mfma_f32_32x32x16_bf16 v[64:79], v[248:251], v[140:143], v[64:79]
v_mfma_f32_32x32x16_bf16 v[80:95], v[252:255], v[140:143], v[80:95]
s_waitcnt vmcnt(10)
s_add_u32 s20, s20, 40960
s_cmp_ge_u32 s20, 122880
s_cselect_b32 s20, 0, s20
s_add_u32 s17, s17, 1
s_barrier
v_cvt_pk_bf16_f32 v144, v64, v65
v_cvt_pk_bf16_f32 v145, v66, v67
v_cvt_pk_bf16_f32 v146, v68, v69
v_cvt_pk_bf16_f32 v147, v70, v71
buffer_store_dwordx4 v[144:147], v1, s[4:7], s18 offen offset:0 sc1
v_cvt_pk_bf16_f32 v148, v72, v73
v_cvt_pk_bf16_f32 v149, v74, v75
v_cvt_pk_bf16_f32 v150, v76, v77
v_cvt_pk_bf16_f32 v151, v78, v79
buffer_store_dwordx4 v[148:151], v1, s[4:7], s18 offen offset:1024 sc1
v_cvt_pk_bf16_f32 v152, v80, v81
v_cvt_pk_bf16_f32 v153, v82, v83
v_cvt_pk_bf16_f32 v154, v84, v85
v_cvt_pk_bf16_f32 v155, v86, v87
buffer_store_dwordx4 v[152:155], v1, s[4:7], s18 offen offset:2048 sc1
v_cvt_pk_bf16_f32 v156, v88, v89
v_cvt_pk_bf16_f32 v157, v90, v91
v_cvt_pk_bf16_f32 v158, v92, v93
v_cvt_pk_bf16_f32 v159, v94, v95
buffer_store_dwordx4 v[156:159], v1, s[4:7], s18 offen offset:3072 sc1
s_add_u32 s18, s18, 262144
s_waitcnt vmcnt(0)
v_mov_b32 v4, s17
s_mov_b64 exec, 1
buffer_store_dword v4, off, s[4:7], s19 sc1
s_mov_b64 exec, -1
v_add_u32 v7, s20, v1
s_add_u32 s39, s17, 2
s_min_u32 s39, s39, s27
s_add_u32 s26, s20, 81920
s_cmp_ge_u32 s26, 122880
s_cselect_b32 s35, 122880, 0
s_sub_u32 s26, s26, s35
ds_read_b128 v[128:131], v7 offset:0
ds_read_b128 v[132:135], v7 offset:1024
ds_read_b128 v[136:139], v7 offset:2048
s_mul_i32 s36, s39, 1
s_add_u32 s36, s36, s16
s_mul_i32 s36, s36, 40960
s_add_u32 s36, s36, s22
s_add_u32 s36, s36, 109051904
s_add_u32 s37, s26, s22
s_waitcnt lgkmcnt(2)
v_mfma_f32_32x32x16_bf16 v[96:111], a[0:3], v[128:131], 0
v_mfma_f32_32x32x16_bf16 v[112:127], a[4:7], v[128:131], 0
ds_read_b128 v[140:143], v7 offset:3072
s_waitcnt lgkmcnt(2)
v_mfma_f32_32x32x16_bf16 v[96:111], a[8:11], v[132:135], v[96:111]
s_add_u32 m0, s37, 0
s_add_u32 s35, s36, 0
buffer_load_dwordx4 v1, s[4:7], s35 offen sc1 lds
v_mfma_f32_32x32x16_bf16 v[112:127], a[12:15], v[132:135], v[112:127]
ds_read_b128 v[128:131], v7 offset:4096
s_add_u32 m0, s37, 1024
s_add_u32 s35, s36, 1024
buffer_load_dwordx4 v1, s[4:7], s35 offen sc1 lds
s_waitcnt lgkmcnt(2)
v_mfma_f32_32x32x16_bf16 v[96:111], a[16:19], v[136:139], v[96:111]
s_add_u32 m0, s37, 2048
s_add_u32 s35, s36, 2048
buffer_load_dwordx4 v1, s[4:7], s35 offen sc1 lds
v_mfma_f32_32x32x16_bf16 v[112:127], a[20:23], v[136:139], v[112:127]
ds_read_b128 v[132:135], v7 offset:5120
s_add_u32 m0, s37, 3072
s_add_u32 s35, s36, 3072
buffer_load_dwordx4 v1, s[4:7], s35 offen sc1 lds
s_waitcnt lgkmcnt(2)
v_mfma_f32_32x32x16_bf16 v[96:111], a[24:27], v[140:143], v[96:111]
s_add_u32 m0, s37, 4096
s_add_u32 s35, s36, 4096
buffer_load_dwordx4 v1, s[4:7], s35 offen sc1 lds
v_mfma_f32_32x32x16_bf16 v[112:127], a[28:31], v[140:143], v[112:127]
ds_read_b128 v[136:139], v7 offset:6144
s_add_u32 m0, s37, 5120
s_add_u32 s35, s36, 5120
buffer_load_dwordx4 v1, s[4:7], s35 offen sc1 lds
s_waitcnt lgkmcnt(2)
v_mfma_f32_32x32x16_bf16 v[96:111], a[32:35], v[128:131], v[96:111]
s_add_u32 m0, s37, 6144
s_add_u32 s35, s36, 6144
buffer_load_dwordx4 v1, s[4:7], s35 offen sc1 lds
v_mfma_f32_32x32x16_bf16 v[112:127], a[36:39], v[128:131], v[112:127]
ds_read_b128 v[140:143], v7 offset:7168
s_add_u32 m0, s37, 7168
s_add_u32 s35, s36, 7168
buffer_load_dwordx4 v1, s[4:7], s35 offen sc1 lds
s_waitcnt lgkmcnt(2)
v_mfma_f32_32x32x16_bf16 v[96:111], a[40:43], v[132:135], v[96:111]
s_add_u32 m0, s37, 8192
s_add_u32 s35, s36, 8192
buffer_load_dwordx4 v1, s[4:7], s35 offen sc1 lds
v_mfma_f32_32x32x16_bf16 v[112:127], a[44:47], v[132:135], v[112:127]
ds_read_b128 v[128:131], v7 offset:8192
s_add_u32 m0, s37, 9216
s_add_u32 s35, s36, 9216
buffer_load_dwordx4 v1, s[4:7], s35 offen sc1 lds
s_waitcnt lgkmcnt(2)
v_mfma_f32_32x32x16_bf16 v[96:111], a[48:51], v[136:139], v[96:111]
v_mfma_f32_32x32x16_bf16 v[112:127], a[52:55], v[136:139], v[112:127]
ds_read_b128 v[132:135], v7 offset:9216
s_waitcnt lgkmcnt(2)
v_mfma_f32_32x32x16_bf16 v[96:111], a[56:59], v[140:143], v[96:111]
v_mfma_f32_32x32x16_bf16 v[112:127], a[60:63], v[140:143], v[112:127]
ds_read_b128 v[136:139], v7 offset:10240
s_waitcnt lgkmcnt(2)
v_mfma_f32_32x32x16_bf16 v[96:111], a[64:67], v[128:131], v[96:111]
v_mfma_f32_32x32x16_bf16 v[112:127], a[68:71], v[128:131], v[112:127]
ds_read_b128 v[140:143], v7 offset:11264
s_waitcnt lgkmcnt(2)
v_mfma_f32_32x32x16_bf16 v[96:111], a[72:75], v[132:135], v[96:111]
v_mfma_f32_32x32x16_bf16 v[112:127], a[76:79], v[132:135], v[112:127]
ds_read_b128 v[128:131], v7 offset:12288
s_waitcnt lgkmcnt(2)
v_mfma_f32_32x32x16_bf16 v[96:111], a[80:83], v[136:139], v[96:111]
v_mfma_f32_32x32x16_bf16 v[112:127], a[84:87], v[136:139], v[112:127]
ds_read_b128 v[132:135], v7 offset:13312
s_waitcnt lgkmcnt(2)
v_mfma_f32_32x32x16_bf16 v[96:111], a[88:91], v[140:143], v[96:111]
v_mfma_f32_32x32x16_bf16 v[112:127], a[92:95], v[140:143], v[112:127]
ds_read_b128 v[136:139], v7 offset:14336
s_waitcnt lgkmcnt(2)
v_mfma_f32_32x32x16_bf16 v[96:111], a[96:99], v[128:131], v[96:111]
v_mfma_f32_32x32x16_bf16 v[112:127], a[100:103], v[128:131], v[112:127]
ds_read_b128 v[140:143], v7 offset:15360
s_waitcnt lgkmcnt(2)
v_mfma_f32_32x32x16_bf16 v[96:111], a[104:107], v[132:135], v[96:111]
v_mfma_f32_32x32x16_bf16 v[112:127], a[108:111], v[132:135], v[112:127]
ds_read_b128 v[128:131], v7 offset:16384
s_waitcnt lgkmcnt(2)
v_mfma_f32_32x32x16_bf16 v[96:111], a[112:115], v[136:139], v[96:111]
v_mfma_f32_32x32x16_bf16 v[112:127], a[116:119], v[136:139], v[112:127]
ds_read_b128 v[132:135], v7 offset:17408
s_waitcnt lgkmcnt(2)
v_mfma_f32_32x32x16_bf16 v[96:111], a[120:123], v[140:143], v[96:111]
v_mfma_f32_32x32x16_bf16 v[112:127], a[124:127], v[140:143], v[112:127]
ds_read_b128 v[136:139], v7 offset:18432
s_waitcnt lgkmcnt(2)
v_mfma_f32_32x32x16_bf16 v[96:111], a[128:131], v[128:131], v[96:111]
v_mfma_f32_32x32x16_bf16 v[112:127], a[132:135], v[128:131], v[112:127]
ds_read_b128 v[140:143], v7 offset:19456
s_waitcnt lgkmcnt(2)
v_mfma_f32_32x32x16_bf16 v[96:111], a[136:139], v[132:135], v[96:111]
v_mfma_f32_32x32x16_bf16 v[112:127], a[140:143], v[132:135], v[112:127]
ds_read_b128 v[128:131], v7 offset:20480
s_waitcnt lgkmcnt(2)
v_mfma_f32_32x32x16_bf16 v[96:111], a[144:147], v[136:139], v[96:111]
v_mfma_f32_32x32x16_bf16 v[112:127], a[148:151], v[136:139], v[112:127]
ds_read_b128 v[132:135], v7 offset:21504
s_waitcnt lgkmcnt(2)
v_mfma_f32_32x32x16_bf16 v[96:111], a[152:155], v[140:143], v[96:111]
v_mfma_f32_32x32x16_bf16 v[112:127], a[156:159], v[140:143], v[112:127]
ds_read_b128 v[136:139], v7 offset:22528
s_waitcnt lgkmcnt(2)
v_mfma_f32_32x32x16_bf16 v[96:111], a[160:163], v[128:131], v[96:111]
v_mfma_f32_32x32x16_bf16 v[112:127], a[164:167], v[128:131], v[112:127]
ds_read_b128 v[140:143], v7 offset:23552
s_waitcnt lgkmcnt(2)
v_mfma_f32_32x32x16_bf16 v[96:111], a[168:171], v[132:135], v[96:111]
v_mfma_f32_32x32x16_bf16 v[112:127], a[172:175], v[132:135], v[112:127]
ds_read_b128 v[128:131], v7 offset:24576
s_waitcnt lgkmcnt(2)
v_mfma_f32_32x32x16_bf16 v[96:111], a[176:179], v[136:139], v[96:111]
v_mfma_f32_32x32x16_bf16 v[112:127], a[180:183], v[136:139], v[112:127]
ds_read_b128 v[132:135], v7 offset:25600
s_waitcnt lgkmcnt(2)
v_mfma_f32_32x32x16_bf16 v[96:111], a[184:187], v[140:143], v[96:111]
v_mfma_f32_32x32x16_bf16 v[112:127], a[188:191], v[140:143], v[112:127]
ds_read_b128 v[136:139], v7 offset:26624
s_waitcnt lgkmcnt(2)
v_mfma_f32_32x32x16_bf16 v[96:111], a[192:195], v[128:131], v[96:111]
v_mfma_f32_32x32x16_bf16 v[112:127], a[196:199], v[128:131], v[112:127]
ds_read_b128 v[140:143], v7 offset:27648
s_waitcnt lgkmcnt(2)
v_mfma_f32_32x32x16_bf16 v[96:111], a[200:203], v[132:135], v[96:111]
v_mfma_f32_32x32x16_bf16 v[112:127], a[204:207], v[132:135], v[112:127]
ds_read_b128 v[128:131], v7 offset:28672
s_waitcnt lgkmcnt(2)
v_mfma_f32_32x32x16_bf16 v[96:111], a[208:211], v[136:139], v[96:111]
v_mfma_f32_32x32x16_bf16 v[112:127], a[212:215], v[136:139], v[112:127]
ds_read_b128 v[132:135], v7 offset:29696
s_waitcnt lgkmcnt(2)
v_mfma_f32_32x32x16_bf16 v[96:111], a[216:219], v[140:143], v[96:111]
v_mfma_f32_32x32x16_bf16 v[112:127], a[220:223], v[140:143], v[112:127]
ds_read_b128 v[136:139], v7 offset:30720
s_waitcnt lgkmcnt(2)
v_mfma_f32_32x32x16_bf16 v[96:111], a[224:227], v[128:131], v[96:111]
v_mfma_f32_32x32x16_bf16 v[112:127], a[228:231], v[128:131], v[112:127]
ds_read_b128 v[140:143], v7 offset:31744
s_waitcnt lgkmcnt(2)
v_mfma_f32_32x32x16_bf16 v[96:111], a[232:235], v[132:135], v[96:111]
v_mfma_f32_32x32x16_bf16 v[112:127], a[236:239], v[132:135], v[112:127]
ds_read_b128 v[128:131], v7 offset:32768
s_waitcnt lgkmcnt(2)
v_mfma_f32_32x32x16_bf16 v[96:111], a[240:243], v[136:139], v[96:111]
v_mfma_f32_32x32x16_bf16 v[112:127], a[244:247], v[136:139], v[112:127]
ds_read_b128 v[132:135], v7 offset:33792
s_waitcnt lgkmcnt(2)
v_mfma_f32_32x32x16_bf16 v[96:111], a[248:251], v[140:143], v[96:111]
v_mfma_f32_32x32x16_bf16 v[112:127], a[252:255], v[140:143], v[112:127]
ds_read_b128 v[136:139], v7 offset:34816
s_waitcnt lgkmcnt(2)
v_mfma_f32_32x32x16_bf16 v[96:111], v[192:195], v[128:131], v[96:111]
v_mfma_f32_32x32x16_bf16 v[112:127], v[196:199], v[128:131], v[112:127]
ds_read_b128 v[140:143], v7 offset:35840
s_waitcnt lgkmcnt(2)
v_mfma_f32_32x32x16_bf16 v[96:111], v[200:203], v[132:135], v[96:111]
v_mfma_f32_32x32x16_bf16 v[112:127], v[204:207], v[132:135], v[112:127]
ds_read_b128 v[128:131], v7 offset:36864
s_waitcnt lgkmcnt(2)
v_mfma_f32_32x32x16_bf16 v[96:111], v[208:211], v[136:139], v[96:111]
v_mfma_f32_32x32x16_bf16 v[112:127], v[212:215], v[136:139], v[112:127]
ds_read_b128 v[132:135], v7 offset:37888
s_waitcnt lgkmcnt(2)
v_mfma_f32_32x32x16_bf16 v[96:111], v[216:219], v[140:143], v[96:111]
v_mfma_f32_32x32x16_bf16 v[112:127], v[220:223], v[140:143], v[112:127]
ds_read_b128 v[136:139], v7 offset:38912
s_waitcnt lgkmcnt(2)
v_mfma_f32_32x32x16_bf16 v[96:111], v[224:227], v[128:131], v[96:111]
v_mfma_f32_32x32x16_bf16 v[112:127], v[228:231], v[128:131], v[112:127]
ds_read_b128 v[140:143], v7 offset:39936
s_waitcnt lgkmcnt(2)
v_mfma_f32_32x32x16_bf16 v[96:111], v[232:235], v[132:135], v[96:111]
v_mfma_f32_32x32x16_bf16 v[112:127], v[236:239], v[132:135], v[112:127]
s_waitcnt lgkmcnt(1)
v_mfma_f32_32x32x16_bf16 v[96:111], v[240:243], v[136:139], v[96:111]
v_mfma_f32_32x32x16_bf16 v[112:127], v[244:247], v[136:139], v[112:127]
s_waitcnt lgkmcnt(0)
v_mfma_f32_32x32x16_bf16 v[96:111], v[248:251], v[140:143], v[96:111]
v_mfma_f32_32x32x16_bf16 v[112:127], v[252:255], v[140:143], v[112:127]
s_waitcnt vmcnt(10)
s_add_u32 s20, s20, 40960
s_cmp_ge_u32 s20, 122880
s_cselect_b32 s20, 0, s20
s_add_u32 s17, s17, 1
s_barrier
L_q_loop:
v_add_u32 v7, s20, v1
s_add_u32 s39, s17, 2
s_min_u32 s39, s39, s27
s_add_u32 s26, s20, 81920
s_cmp_ge_u32 s26, 122880
s_cselect_b32 s35, 122880, 0
s_sub_u32 s26, s26, s35
ds_read_b128 v[128:131], v7 offset:0
ds_read_b128 v[132:135], v7 offset:1024
ds_read_b128 v[136:139], v7 offset:2048
s_mul_i32 s36, s39, 1
s_add_u32 s36, s36, s16
s_mul_i32 s36, s36, 40960
s_add_u32 s36, s36, s22
s_add_u32 s36, s36, 109051904
s_add_u32 s37, s26, s22
s_waitcnt lgkmcnt(2)
v_mfma_f32_32x32x16_bf16 v[64:79], a[0:3], v[128:131], 0
v_mfma_f32_32x32x16_bf16 v[80:95], a[4:7], v[128:131], 0
ds_read_b128 v[140:143], v7 offset:3072
s_waitcnt lgkmcnt(2)
v_mfma_f32_32x32x16_bf16 v[64:79], a[8:11], v[132:135], v[64:79]
v_cvt_pk_bf16_f32 v144, v96, v97
v_mfma_f32_32x32x16_bf16 v[80:95], a[12:15], v[132:135], v[80:95]
ds_read_b128 v[128:131], v7 offset:4096
v_cvt_pk_bf16_f32 v145, v98, v99
s_waitcnt lgkmcnt(2)
v_mfma_f32_32x32x16_bf16 v[64:79], a[16:19], v[136:139], v[64:79]
v_cvt_pk_bf16_f32 v146, v100, v101
v_mfma_f32_32x32x16_bf16 v[80:95], a[20:23], v[136:139], v[80:95]
ds_read_b128 v[132:135], v7 offset:5120
v_cvt_pk_bf16_f32 v147, v102, v103
s_waitcnt lgkmcnt(2)
v_mfma_f32_32x32x16_bf16 v[64:79], a[24:27], v[140:143], v[64:79]
buffer_store_dwordx4 v[144:147], v1, s[4:7], s18 offen offset:0 sc1
v_mfma_f32_32x32x16_bf16 v[80:95], a[28:31], v[140:143], v[80:95]
ds_read_b128 v[136:139], v7 offset:6144
v_cvt_pk_bf16_f32 v148, v104, v105
s_waitcnt lgkmcnt(2)
v_mfma_f32_32x32x16_bf16 v[64:79], a[32:35], v[128:131], v[64:79]
v_cvt_pk_bf16_f32 v149, v106, v107
v_mfma_f32_32x32x16_bf16 v[80:95], a[36:39], v[128:131], v[80:95]
ds_read_b128 v[140:143], v7 offset:7168
v_cvt_pk_bf16_f32 v150, v108, v109
s_waitcnt lgkmcnt(2)
v_mfma_f32_32x32x16_bf16 v[64:79], a[40:43], v[132:135], v[64:79]
v_cvt_pk_bf16_f32 v151, v110, v111
v_mfma_f32_32x32x16_bf16 v[80:95], a[44:47], v[132:135], v[80:95]
ds_read_b128 v[128:131], v7 offset:8192
buffer_store_dwordx4 v[148:151], v1, s[4:7], s18 offen offset:1024 sc1
s_waitcnt lgkmcnt(2)
v_mfma_f32_32x32x16_bf16 v[64:79], a[48:51], v[136:139], v[64:79]
v_cvt_pk_bf16_f32 v152, v112, v113
v_mfma_f32_32x32x16_bf16 v[80:95], a[52:55], v[136:139], v[80:95]
ds_read_b128 v[132:135], v7 offset:9216
v_cvt_pk_bf16_f32 v153, v114, v115
s_waitcnt lgkmcnt(2)
v_mfma_f32_32x32x16_bf16 v[64:79], a[56:59], v[140:143], v[64:79]
v_cvt_pk_bf16_f32 v154, v116, v117
v_mfma_f32_32x32x16_bf16 v[80:95], a[60:63], v[140:143], v[80:95]
ds_read_b128 v[136:139], v7 offset:10240
v_cvt_pk_bf16_f32 v155, v118, v119
s_waitcnt lgkmcnt(2)
v_mfma_f32_32x32x16_bf16 v[64:79], a[64:67], v[128:131], v[64:79]
buffer_store_dwordx4 v[152:155], v1, s[4:7], s18 offen offset:2048 sc1
v_mfma_f32_32x32x16_bf16 v[80:95], a[68:71], v[128:131], v[80:95]
ds_read_b128 v[140:143], v7 offset:11264
v_cvt_pk_bf16_f32 v156, v120, v121
s_waitcnt lgkmcnt(2)
v_mfma_f32_32x32x16_bf16 v[64:79], a[72:75], v[132:135], v[64:79]
v_cvt_pk_bf16_f32 v157, v122, v123
v_mfma_f32_32x32x16_bf16 v[80:95], a[76:79], v[132:135], v[80:95]
ds_read_b128 v[128:131], v7 offset:12288
v_cvt_pk_bf16_f32 v158, v124, v125
s_waitcnt lgkmcnt(2)
v_mfma_f32_32x32x16_bf16 v[64:79], a[80:83], v[136:139], v[64:79]
v_cvt_pk_bf16_f32 v159, v126, v127
v_mfma_f32_32x32x16_bf16 v[80:95], a[84:87], v[136:139], v[80:95]
ds_read_b128 v[132:135], v7 offset:13312
buffer_store_dwordx4 v[156:159], v1, s[4:7], s18 offen offset:3072 sc1
s_waitcnt lgkmcnt(2)
v_mfma_f32_32x32x16_bf16 v[64:79], a[88:91], v[140:143], v[64:79]
s_add_u32 s18, s18, 262144
v_mfma_f32_32x32x16_bf16 v[80:95], a[92:95], v[140:143], v[80:95]
ds_read_b128 v[136:139], v7 offset:14336
s_add_u32 m0, s37, 0
s_add_u32 s35, s36, 0
buffer_load_dwordx4 v1, s[4:7], s35 offen sc1 lds
s_waitcnt lgkmcnt(2)
v_mfma_f32_32x32x16_bf16 v[64:79], a[96:99], v[128:131], v[64:79]
s_add_u32 m0, s37, 1024
s_add_u32 s35, s36, 1024
buffer_load_dwordx4 v1, s[4:7], s35 offen sc1 lds
v_mfma_f32_32x32x16_bf16 v[80:95], a[100:103], v[128:131], v[80:95]
ds_read_b128 v[140:143], v7 offset:15360
s_add_u32 m0, s37, 2048
s_add_u32 s35, s36, 2048
buffer_load_dwordx4 v1, s[4:7], s35 offen sc1 lds
s_waitcnt lgkmcnt(2)
v_mfma_f32_32x32x16_bf16 v[64:79], a[104:107], v[132:135], v[64:79]
s_add_u32 m0, s37, 3072
s_add_u32 s35, s36, 3072
buffer_load_dwordx4 v1, s[4:7], s35 offen sc1 lds
v_mfma_f32_32x32x16_bf16 v[80:95], a[108:111], v[132:135], v[80:95]
ds_read_b128 v[128:131], v7 offset:16384
s_add_u32 m0, s37, 4096
s_add_u32 s35, s36, 4096
buffer_load_dwordx4 v1, s[4:7], s35 offen sc1 lds
s_waitcnt lgkmcnt(2)
v_mfma_f32_32x32x16_bf16 v[64:79], a[112:115], v[136:139], v[64:79]
s_add_u32 m0, s37, 5120
s_add_u32 s35, s36, 5120
buffer_load_dwordx4 v1, s[4:7], s35 offen sc1 lds
v_mfma_f32_32x32x16_bf16 v[80:95], a[116:119], v[136:139], v[80:95]
ds_read_b128 v[132:135], v7 offset:17408
s_add_u32 m0, s37, 6144
s_add_u32 s35, s36, 6144
buffer_load_dwordx4 v1, s[4:7], s35 offen sc1 lds
s_waitcnt lgkmcnt(2)
v_mfma_f32_32x32x16_bf16 v[64:79], a[120:123], v[140:143], v[64:79]
s_add_u32 m0, s37, 7168
s_add_u32 s35, s36, 7168
buffer_load_dwordx4 v1, s[4:7], s35 offen sc1 lds
v_mfma_f32_32x32x16_bf16 v[80:95], a[124:127], v[140:143], v[80:95]
ds_read_b128 v[136:139], v7 offset:18432
s_add_u32 m0, s37, 8192
s_add_u32 s35, s36, 8192
buffer_load_dwordx4 v1, s[4:7], s35 offen sc1 lds
s_waitcnt lgkmcnt(2)
v_mfma_f32_32x32x16_bf16 v[64:79], a[128:131], v[128:131], v[64:79]
s_add_u32 m0, s37, 9216
s_add_u32 s35, s36, 9216
buffer_load_dwordx4 v1, s[4:7], s35 offen sc1 lds
v_mfma_f32_32x32x16_bf16 v[80:95], a[132:135], v[128:131], v[80:95]
ds_read_b128 v[140:143], v7 offset:19456
s_waitcnt lgkmcnt(2)
v_mfma_f32_32x32x16_bf16 v[64:79], a[136:139], v[132:135], v[64:79]
v_mfma_f32_32x32x16_bf16 v[80:95], a[140:143], v[132:135], v[80:95]
ds_read_b128 v[128:131], v7 offset:20480
s_waitcnt lgkmcnt(2)
v_mfma_f32_32x32x16_bf16 v[64:79], a[144:147], v[136:139], v[64:79]
v_mfma_f32_32x32x16_bf16 v[80:95], a[148:151], v[136:139], v[80:95]
ds_read_b128 v[132:135], v7 offset:21504
s_waitcnt lgkmcnt(2)
v_mfma_f32_32x32x16_bf16 v[64:79], a[152:155], v[140:143], v[64:79]
v_mfma_f32_32x32x16_bf16 v[80:95], a[156:159], v[140:143], v[80:95]
ds_read_b128 v[136:139], v7 offset:22528
s_waitcnt lgkmcnt(2)
v_mfma_f32_32x32x16_bf16 v[64:79], a[160:163], v[128:131], v[64:79]
v_mfma_f32_32x32x16_bf16 v[80:95], a[164:167], v[128:131], v[80:95]
ds_read_b128 v[140:143], v7 offset:23552
s_waitcnt lgkmcnt(2)
v_mfma_f32_32x32x16_bf16 v[64:79], a[168:171], v[132:135], v[64:79]
v_mfma_f32_32x32x16_bf16 v[80:95], a[172:175], v[132:135], v[80:95]
ds_read_b128 v[128:131], v7 offset:24576
s_waitcnt lgkmcnt(2)
v_mfma_f32_32x32x16_bf16 v[64:79], a[176:179], v[136:139], v[64:79]
v_mfma_f32_32x32x16_bf16 v[80:95], a[180:183], v[136:139], v[80:95]
ds_read_b128 v[132:135], v7 offset:25600
s_waitcnt lgkmcnt(2)
v_mfma_f32_32x32x16_bf16 v[64:79], a[184:187], v[140:143], v[64:79]
v_mfma_f32_32x32x16_bf16 v[80:95], a[188:191], v[140:143], v[80:95]
ds_read_b128 v[136:139], v7 offset:26624
s_waitcnt lgkmcnt(2)
v_mfma_f32_32x32x16_bf16 v[64:79], a[192:195], v[128:131], v[64:79]
v_mfma_f32_32x32x16_bf16 v[80:95], a[196:199], v[128:131], v[80:95]
ds_read_b128 v[140:143], v7 offset:27648
s_waitcnt lgkmcnt(2)
v_mfma_f32_32x32x16_bf16 v[64:79], a[200:203], v[132:135], v[64:79]
v_mfma_f32_32x32x16_bf16 v[80:95], a[204:207], v[132:135], v[80:95]
ds_read_b128 v[128:131], v7 offset:28672
s_waitcnt lgkmcnt(2)
v_mfma_f32_32x32x16_bf16 v[64:79], a[208:211], v[136:139], v[64:79]
v_mfma_f32_32x32x16_bf16 v[80:95], a[212:215], v[136:139], v[80:95]
ds_read_b128 v[132:135], v7 offset:29696
s_waitcnt lgkmcnt(2)
v_mfma_f32_32x32x16_bf16 v[64:79], a[216:219], v[140:143], v[64:79]
v_mfma_f32_32x32x16_bf16 v[80:95], a[220:223], v[140:143], v[80:95]
ds_read_b128 v[136:139], v7 offset:30720
s_waitcnt lgkmcnt(2)
v_mfma_f32_32x32x16_bf16 v[64:79], a[224:227], v[128:131], v[64:79]
v_mfma_f32_32x32x16_bf16 v[80:95], a[228:231], v[128:131], v[80:95]
ds_read_b128 v[140:143], v7 offset:31744
s_waitcnt lgkmcnt(2)
v_mfma_f32_32x32x16_bf16 v[64:79], a[232:235], v[132:135], v[64:79]
v_mfma_f32_32x32x16_bf16 v[80:95], a[236:239], v[132:135], v[80:95]
ds_read_b128 v[128:131], v7 offset:32768
s_waitcnt lgkmcnt(2)
v_mfma_f32_32x32x16_bf16 v[64:79], a[240:243], v[136:139], v[64:79]
v_mfma_f32_32x32x16_bf16 v[80:95], a[244:247], v[136:139], v[80:95]
ds_read_b128 v[132:135], v7 offset:33792
s_waitcnt lgkmcnt(2)
v_mfma_f32_32x32x16_bf16 v[64:79], a[248:251], v[140:143], v[64:79]
v_mfma_f32_32x32x16_bf16 v[80:95], a[252:255], v[140:143], v[80:95]
ds_read_b128 v[136:139], v7 offset:34816
s_waitcnt lgkmcnt(2)
v_mfma_f32_32x32x16_bf16 v[64:79], v[192:195], v[128:131], v[64:79]
v_mfma_f32_32x32x16_bf16 v[80:95], v[196:199], v[128:131], v[80:95]
ds_read_b128 v[140:143], v7 offset:35840
s_waitcnt lgkmcnt(2)
v_mfma_f32_32x32x16_bf16 v[64:79], v[200:203], v[132:135], v[64:79]
v_mfma_f32_32x32x16_bf16 v[80:95], v[204:207], v[132:135], v[80:95]
ds_read_b128 v[128:131], v7 offset:36864
s_waitcnt lgkmcnt(2)
v_mfma_f32_32x32x16_bf16 v[64:79], v[208:211], v[136:139], v[64:79]
v_mfma_f32_32x32x16_bf16 v[80:95], v[212:215], v[136:139], v[80:95]
ds_read_b128 v[132:135], v7 offset:37888
s_waitcnt lgkmcnt(2)
v_mfma_f32_32x32x16_bf16 v[64:79], v[216:219], v[140:143], v[64:79]
v_mfma_f32_32x32x16_bf16 v[80:95], v[220:223], v[140:143], v[80:95]
ds_read_b128 v[136:139], v7 offset:38912
s_waitcnt lgkmcnt(2)
v_mfma_f32_32x32x16_bf16 v[64:79], v[224:227], v[128:131], v[64:79]
v_mfma_f32_32x32x16_bf16 v[80:95], v[228:231], v[128:131], v[80:95]
ds_read_b128 v[140:143], v7 offset:39936
s_waitcnt lgkmcnt(2)
v_mfma_f32_32x32x16_bf16 v[64:79], v[232:235], v[132:135], v[64:79]
v_mfma_f32_32x32x16_bf16 v[80:95], v[236:239], v[132:135], v[80:95]
s_waitcnt lgkmcnt(1)
v_mfma_f32_32x32x16_bf16 v[64:79], v[240:243], v[136:139], v[64:79]
v_mfma_f32_32x32x16_bf16 v[80:95], v[244:247], v[136:139], v[80:95]
s_waitcnt lgkmcnt(0)
v_mfma_f32_32x32x16_bf16 v[64:79], v[248:251], v[140:143], v[64:79]
v_mfma_f32_32x32x16_bf16 v[80:95], v[252:255], v[140:143], v[80:95]
s_waitcnt vmcnt(10)
v_mov_b32 v4, s17
s_mov_b64 exec, 1
buffer_store_dword v4, off, s[4:7], s19 sc1
s_mov_b64 exec, -1
s_add_u32 s20, s20, 40960
s_cmp_ge_u32 s20, 122880
s_cselect_b32 s20, 0, s20
s_add_u32 s17, s17, 1
s_barrier
v_add_u32 v7, s20, v1
s_add_u32 s39, s17, 2
s_min_u32 s39, s39, s27
s_add_u32 s26, s20, 81920
s_cmp_ge_u32 s26, 122880
s_cselect_b32 s35, 122880, 0
s_sub_u32 s26, s26, s35
ds_read_b128 v[128:131], v7 offset:0
ds_read_b128 v[132:135], v7 offset:1024
ds_read_b128 v[136:139], v7 offset:2048
s_mul_i32 s36, s39, 1
s_add_u32 s36, s36, s16
s_mul_i32 s36, s36, 40960
s_add_u32 s36, s36, s22
s_add_u32 s36, s36, 109051904
s_add_u32 s37, s26, s22
s_waitcnt lgkmcnt(2)
v_mfma_f32_32x32x16_bf16 v[96:111], a[0:3], v[128:131], 0
v_mfma_f32_32x32x16_bf16 v[112:127], a[4:7], v[128:131], 0
ds_read_b128 v[140:143], v7 offset:3072
s_waitcnt lgkmcnt(2)
v_mfma_f32_32x32x16_bf16 v[96:111], a[8:11], v[132:135], v[96:111]
v_cvt_pk_bf16_f32 v144, v64, v65
v_mfma_f32_32x32x16_bf16 v[112:127], a[12:15], v[132:135], v[112:127]
ds_read_b128 v[128:131], v7 offset:4096
v_cvt_pk_bf16_f32 v145, v66, v67
s_waitcnt lgkmcnt(2)
v_mfma_f32_32x32x16_bf16 v[96:111], a[16:19], v[136:139], v[96:111]
v_cvt_pk_bf16_f32 v146, v68, v69
v_mfma_f32_32x32x16_bf16 v[112:127], a[20:23], v[136:139], v[112:127]
ds_read_b128 v[132:135], v7 offset:5120
v_cvt_pk_bf16_f32 v147, v70, v71
s_waitcnt lgkmcnt(2)
v_mfma_f32_32x32x16_bf16 v[96:111], a[24:27], v[140:143], v[96:111]
buffer_store_dwordx4 v[144:147], v1, s[4:7], s18 offen offset:0 sc1
v_mfma_f32_32x32x16_bf16 v[112:127], a[28:31], v[140:143], v[112:127]
ds_read_b128 v[136:139], v7 offset:6144
v_cvt_pk_bf16_f32 v148, v72, v73
s_waitcnt lgkmcnt(2)
v_mfma_f32_32x32x16_bf16 v[96:111], a[32:35], v[128:131], v[96:111]
v_cvt_pk_bf16_f32 v149, v74, v75
v_mfma_f32_32x32x16_bf16 v[112:127], a[36:39], v[128:131], v[112:127]
ds_read_b128 v[140:143], v7 offset:7168
v_cvt_pk_bf16_f32 v150, v76, v77
s_waitcnt lgkmcnt(2)
v_mfma_f32_32x32x16_bf16 v[96:111], a[40:43], v[132:135], v[96:111]
v_cvt_pk_bf16_f32 v151, v78, v79
v_mfma_f32_32x32x16_bf16 v[112:127], a[44:47], v[132:135], v[112:127]
ds_read_b128 v[128:131], v7 offset:8192
buffer_store_dwordx4 v[148:151], v1, s[4:7], s18 offen offset:1024 sc1
s_waitcnt lgkmcnt(2)
v_mfma_f32_32x32x16_bf16 v[96:111], a[48:51], v[136:139], v[96:111]
v_cvt_pk_bf16_f32 v152, v80, v81
v_mfma_f32_32x32x16_bf16 v[112:127], a[52:55], v[136:139], v[112:127]
ds_read_b128 v[132:135], v7 offset:9216
v_cvt_pk_bf16_f32 v153, v82, v83
s_waitcnt lgkmcnt(2)
v_mfma_f32_32x32x16_bf16 v[96:111], a[56:59], v[140:143], v[96:111]
v_cvt_pk_bf16_f32 v154, v84, v85
v_mfma_f32_32x32x16_bf16 v[112:127], a[60:63], v[140:143], v[112:127]
ds_read_b128 v[136:139], v7 offset:10240
v_cvt_pk_bf16_f32 v155, v86, v87
s_waitcnt lgkmcnt(2)
v_mfma_f32_32x32x16_bf16 v[96:111], a[64:67], v[128:131], v[96:111]
buffer_store_dwordx4 v[152:155], v1, s[4:7], s18 offen offset:2048 sc1
v_mfma_f32_32x32x16_bf16 v[112:127], a[68:71], v[128:131], v[112:127]
ds_read_b128 v[140:143], v7 offset:11264
v_cvt_pk_bf16_f32 v156, v88, v89
s_waitcnt lgkmcnt(2)
v_mfma_f32_32x32x16_bf16 v[96:111], a[72:75], v[132:135], v[96:111]
v_cvt_pk_bf16_f32 v157, v90, v91
v_mfma_f32_32x32x16_bf16 v[112:127], a[76:79], v[132:135], v[112:127]
ds_read_b128 v[128:131], v7 offset:12288
v_cvt_pk_bf16_f32 v158, v92, v93
s_waitcnt lgkmcnt(2)
v_mfma_f32_32x32x16_bf16 v[96:111], a[80:83], v[136:139], v[96:111]
v_cvt_pk_bf16_f32 v159, v94, v95
v_mfma_f32_32x32x16_bf16 v[112:127], a[84:87], v[136:139], v[112:127]
ds_read_b128 v[132:135], v7 offset:13312
buffer_store_dwordx4 v[156:159], v1, s[4:7], s18 offen offset:3072 sc1
s_waitcnt lgkmcnt(2)
v_mfma_f32_32x32x16_bf16 v[96:111], a[88:91], v[140:143], v[96:111]
s_add_u32 s18, s18, 262144
v_mfma_f32_32x32x16_bf16 v[112:127], a[92:95], v[140:143], v[112:127]
ds_read_b128 v[136:139], v7 offset:14336
s_add_u32 m0, s37, 0
s_add_u32 s35, s36, 0
buffer_load_dwordx4 v1, s[4:7], s35 offen sc1 lds
s_waitcnt lgkmcnt(2)
v_mfma_f32_32x32x16_bf16 v[96:111], a[96:99], v[128:131], v[96:111]
s_add_u32 m0, s37, 1024
s_add_u32 s35, s36, 1024
buffer_load_dwordx4 v1, s[4:7], s35 offen sc1 lds
v_mfma_f32_32x32x16_bf16 v[112:127], a[100:103], v[128:131], v[112:127]
ds_read_b128 v[140:143], v7 offset:15360
s_add_u32 m0, s37, 2048
s_add_u32 s35, s36, 2048
buffer_load_dwordx4 v1, s[4:7], s35 offen sc1 lds
s_waitcnt lgkmcnt(2)
v_mfma_f32_32x32x16_bf16 v[96:111], a[104:107], v[132:135], v[96:111]
s_add_u32 m0, s37, 3072
s_add_u32 s35, s36, 3072
buffer_load_dwordx4 v1, s[4:7], s35 offen sc1 lds
v_mfma_f32_32x32x16_bf16 v[112:127], a[108:111], v[132:135], v[112:127]
ds_read_b128 v[128:131], v7 offset:16384
s_add_u32 m0, s37, 4096
s_add_u32 s35, s36, 4096
buffer_load_dwordx4 v1, s[4:7], s35 offen sc1 lds
s_waitcnt lgkmcnt(2)
v_mfma_f32_32x32x16_bf16 v[96:111], a[112:115], v[136:139], v[96:111]
s_add_u32 m0, s37, 5120
s_add_u32 s35, s36, 5120
buffer_load_dwordx4 v1, s[4:7], s35 offen sc1 lds
v_mfma_f32_32x32x16_bf16 v[112:127], a[116:119], v[136:139], v[112:127]
ds_read_b128 v[132:135], v7 offset:17408
s_add_u32 m0, s37, 6144
s_add_u32 s35, s36, 6144
buffer_load_dwordx4 v1, s[4:7], s35 offen sc1 lds
s_waitcnt lgkmcnt(2)
v_mfma_f32_32x32x16_bf16 v[96:111], a[120:123], v[140:143], v[96:111]
s_add_u32 m0, s37, 7168
s_add_u32 s35, s36, 7168
buffer_load_dwordx4 v1, s[4:7], s35 offen sc1 lds
v_mfma_f32_32x32x16_bf16 v[112:127], a[124:127], v[140:143], v[112:127]
ds_read_b128 v[136:139], v7 offset:18432
s_add_u32 m0, s37, 8192
s_add_u32 s35, s36, 8192
buffer_load_dwordx4 v1, s[4:7], s35 offen sc1 lds
s_waitcnt lgkmcnt(2)
v_mfma_f32_32x32x16_bf16 v[96:111], a[128:131], v[128:131], v[96:111]
s_add_u32 m0, s37, 9216
s_add_u32 s35, s36, 9216
buffer_load_dwordx4 v1, s[4:7], s35 offen sc1 lds
v_mfma_f32_32x32x16_bf16 v[112:127], a[132:135], v[128:131], v[112:127]
ds_read_b128 v[140:143], v7 offset:19456
s_waitcnt lgkmcnt(2)
v_mfma_f32_32x32x16_bf16 v[96:111], a[136:139], v[132:135], v[96:111]
v_mfma_f32_32x32x16_bf16 v[112:127], a[140:143], v[132:135], v[112:127]
ds_read_b128 v[128:131], v7 offset:20480
s_waitcnt lgkmcnt(2)
v_mfma_f32_32x32x16_bf16 v[96:111], a[144:147], v[136:139], v[96:111]
v_mfma_f32_32x32x16_bf16 v[112:127], a[148:151], v[136:139], v[112:127]
ds_read_b128 v[132:135], v7 offset:21504
s_waitcnt lgkmcnt(2)
v_mfma_f32_32x32x16_bf16 v[96:111], a[152:155], v[140:143], v[96:111]
v_mfma_f32_32x32x16_bf16 v[112:127], a[156:159], v[140:143], v[112:127]
ds_read_b128 v[136:139], v7 offset:22528
s_waitcnt lgkmcnt(2)
v_mfma_f32_32x32x16_bf16 v[96:111], a[160:163], v[128:131], v[96:111]
v_mfma_f32_32x32x16_bf16 v[112:127], a[164:167], v[128:131], v[112:127]
ds_read_b128 v[140:143], v7 offset:23552
s_waitcnt lgkmcnt(2)
v_mfma_f32_32x32x16_bf16 v[96:111], a[168:171], v[132:135], v[96:111]
v_mfma_f32_32x32x16_bf16 v[112:127], a[172:175], v[132:135], v[112:127]
ds_read_b128 v[128:131], v7 offset:24576
s_waitcnt lgkmcnt(2)
v_mfma_f32_32x32x16_bf16 v[96:111], a[176:179], v[136:139], v[96:111]
v_mfma_f32_32x32x16_bf16 v[112:127], a[180:183], v[136:139], v[112:127]
ds_read_b128 v[132:135], v7 offset:25600
s_waitcnt lgkmcnt(2)
v_mfma_f32_32x32x16_bf16 v[96:111], a[184:187], v[140:143], v[96:111]
v_mfma_f32_32x32x16_bf16 v[112:127], a[188:191], v[140:143], v[112:127]
ds_read_b128 v[136:139], v7 offset:26624
s_waitcnt lgkmcnt(2)
v_mfma_f32_32x32x16_bf16 v[96:111], a[192:195], v[128:131], v[96:111]
v_mfma_f32_32x32x16_bf16 v[112:127], a[196:199], v[128:131], v[112:127]
ds_read_b128 v[140:143], v7 offset:27648
s_waitcnt lgkmcnt(2)
v_mfma_f32_32x32x16_bf16 v[96:111], a[200:203], v[132:135], v[96:111]
v_mfma_f32_32x32x16_bf16 v[112:127], a[204:207], v[132:135], v[112:127]
ds_read_b128 v[128:131], v7 offset:28672
s_waitcnt lgkmcnt(2)
v_mfma_f32_32x32x16_bf16 v[96:111], a[208:211], v[136:139], v[96:111]
v_mfma_f32_32x32x16_bf16 v[112:127], a[212:215], v[136:139], v[112:127]
ds_read_b128 v[132:135], v7 offset:29696
s_waitcnt lgkmcnt(2)
v_mfma_f32_32x32x16_bf16 v[96:111], a[216:219], v[140:143], v[96:111]
v_mfma_f32_32x32x16_bf16 v[112:127], a[220:223], v[140:143], v[112:127]
ds_read_b128 v[136:139], v7 offset:30720
s_waitcnt lgkmcnt(2)
v_mfma_f32_32x32x16_bf16 v[96:111], a[224:227], v[128:131], v[96:111]
v_mfma_f32_32x32x16_bf16 v[112:127], a[228:231], v[128:131], v[112:127]
ds_read_b128 v[140:143], v7 offset:31744
s_waitcnt lgkmcnt(2)
v_mfma_f32_32x32x16_bf16 v[96:111], a[232:235], v[132:135], v[96:111]
v_mfma_f32_32x32x16_bf16 v[112:127], a[236:239], v[132:135], v[112:127]
ds_read_b128 v[128:131], v7 offset:32768
s_waitcnt lgkmcnt(2)
v_mfma_f32_32x32x16_bf16 v[96:111], a[240:243], v[136:139], v[96:111]
v_mfma_f32_32x32x16_bf16 v[112:127], a[244:247], v[136:139], v[112:127]
ds_read_b128 v[132:135], v7 offset:33792
s_waitcnt lgkmcnt(2)
v_mfma_f32_32x32x16_bf16 v[96:111], a[248:251], v[140:143], v[96:111]
v_mfma_f32_32x32x16_bf16 v[112:127], a[252:255], v[140:143], v[112:127]
ds_read_b128 v[136:139], v7 offset:34816
s_waitcnt lgkmcnt(2)
v_mfma_f32_32x32x16_bf16 v[96:111], v[192:195], v[128:131], v[96:111]
v_mfma_f32_32x32x16_bf16 v[112:127], v[196:199], v[128:131], v[112:127]
ds_read_b128 v[140:143], v7 offset:35840
s_waitcnt lgkmcnt(2)
v_mfma_f32_32x32x16_bf16 v[96:111], v[200:203], v[132:135], v[96:111]
v_mfma_f32_32x32x16_bf16 v[112:127], v[204:207], v[132:135], v[112:127]
ds_read_b128 v[128:131], v7 offset:36864
s_waitcnt lgkmcnt(2)
v_mfma_f32_32x32x16_bf16 v[96:111], v[208:211], v[136:139], v[96:111]
v_mfma_f32_32x32x16_bf16 v[112:127], v[212:215], v[136:139], v[112:127]
ds_read_b128 v[132:135], v7 offset:37888
s_waitcnt lgkmcnt(2)
v_mfma_f32_32x32x16_bf16 v[96:111], v[216:219], v[140:143], v[96:111]
v_mfma_f32_32x32x16_bf16 v[112:127], v[220:223], v[140:143], v[112:127]
ds_read_b128 v[136:139], v7 offset:38912
s_waitcnt lgkmcnt(2)
v_mfma_f32_32x32x16_bf16 v[96:111], v[224:227], v[128:131], v[96:111]
v_mfma_f32_32x32x16_bf16 v[112:127], v[228:231], v[128:131], v[112:127]
ds_read_b128 v[140:143], v7 offset:39936
s_waitcnt lgkmcnt(2)
v_mfma_f32_32x32x16_bf16 v[96:111], v[232:235], v[132:135], v[96:111]
v_mfma_f32_32x32x16_bf16 v[112:127], v[236:239], v[132:135], v[112:127]
s_waitcnt lgkmcnt(1)
v_mfma_f32_32x32x16_bf16 v[96:111], v[240:243], v[136:139], v[96:111]
v_mfma_f32_32x32x16_bf16 v[112:127], v[244:247], v[136:139], v[112:127]
s_waitcnt lgkmcnt(0)
v_mfma_f32_32x32x16_bf16 v[96:111], v[248:251], v[140:143], v[96:111]
v_mfma_f32_32x32x16_bf16 v[112:127], v[252:255], v[140:143], v[112:127]
s_waitcnt vmcnt(10)
v_mov_b32 v4, s17
s_mov_b64 exec, 1
buffer_store_dword v4, off, s[4:7], s19 sc1
s_mov_b64 exec, -1
s_add_u32 s20, s20, 40960
s_cmp_ge_u32 s20, 122880
s_cselect_b32 s20, 0, s20
s_add_u32 s17, s17, 1
s_barrier
s_cmp_lt_u32 s17, s21
s_cbranch_scc1 L_q_loop
v_cvt_pk_bf16_f32 v144, v96, v97
v_cvt_pk_bf16_f32 v145, v98, v99
v_cvt_pk_bf16_f32 v146, v100, v101
v_cvt_pk_bf16_f32 v147, v102, v103
buffer_store_dwordx4 v[144:147], v1, s[4:7], s18 offen offset:0 sc1
v_cvt_pk_bf16_f32 v148, v104, v105
v_cvt_pk_bf16_f32 v149, v106, v107
v_cvt_pk_bf16_f32 v150, v108, v109
v_cvt_pk_bf16_f32 v151, v110, v111
buffer_store_dwordx4 v[148:151], v1, s[4:7], s18 offen offset:1024 sc1
v_cvt_pk_bf16_f32 v152, v112, v113
v_cvt_pk_bf16_f32 v153, v114, v115
v_cvt_pk_bf16_f32 v154, v116, v117
v_cvt_pk_bf16_f32 v155, v118, v119
buffer_store_dwordx4 v[152:155], v1, s[4:7], s18 offen offset:2048 sc1
v_cvt_pk_bf16_f32 v156, v120, v121
v_cvt_pk_bf16_f32 v157, v122, v123
v_cvt_pk_bf16_f32 v158, v124, v125
v_cvt_pk_bf16_f32 v159, v126, v127
buffer_store_dwordx4 v[156:159], v1, s[4:7], s18 offen offset:3072 sc1
s_add_u32 s18, s18, 262144
s_waitcnt vmcnt(0)
v_mov_b32 v4, s17
s_mov_b64 exec, 1
buffer_store_dword v4, off, s[4:7], s19 sc1
s_mov_b64 exec, -1
s_waitcnt vmcnt(0)
s_branch L_done
L_role_h:
s_mul_i32 s16, s14, 42
s_cmp_eq_u32 s14, 0
s_cselect_b32 s21, 42, 22
s_lshl_b32 s35, s13, 2
s_add_u32 s39, s35, s12
s_load_dwordx2 s[80:81], s[0:1], 64
s_waitcnt lgkmcnt(0)
s_mov_b32 s82, 2211840
s_mov_b32 s83, 0x20000
s_load_dwordx2 s[84:85], s[0:1], 72
s_waitcnt lgkmcnt(0)
s_mov_b32 s86, 3456
s_mov_b32 s87, 0x20000
s_cmp_eq_u32 s39, 27
s_cselect_b32 s35, 0, s39
s_lshl_b32 s96, s35, 7
v_bfe_u32 v2, v0, 5, 1
v_mul_u32_u24 v4, 8, v2
buffer_load_dwordx2 v[8:9], v4, s[84:87], s96 offen offset:0
buffer_load_dwordx2 v[10:11], v4, s[84:87], s96 offen offset:16
buffer_load_dwordx2 v[12:13], v4, s[84:87], s96 offen offset:32
buffer_load_dwordx2 v[14:15], v4, s[84:87], s96 offen offset:48
buffer_load_dwordx2 v[16:17], v4, s[84:87], s96 offen offset:64
buffer_load_dwordx2 v[18:19], v4, s[84:87], s96 offen offset:80
buffer_load_dwordx2 v[20:21], v4, s[84:87], s96 offen offset:96
buffer_load_dwordx2 v[22:23], v4, s[84:87], s96 offen offset:112
s_waitcnt vmcnt(0)
v_lshlrev_b32 v160, 16, v8
v_and_b32 v161, 0xffff0000, v8
v_lshlrev_b32 v162, 16, v9
v_and_b32 v163, 0xffff0000, v9
v_lshlrev_b32 v164, 16, v10
v_and_b32 v165, 0xffff0000, v10
v_lshlrev_b32 v166, 16, v11
v_and_b32 v167, 0xffff0000, v11
v_lshlrev_b32 v168, 16, v12
v_and_b32 v169, 0xffff0000, v12
v_lshlrev_b32 v170, 16, v13
v_and_b32 v171, 0xffff0000, v13
v_lshlrev_b32 v172, 16, v14
v_and_b32 v173, 0xffff0000, v14
v_lshlrev_b32 v174, 16, v15
v_and_b32 v175, 0xffff0000, v15
v_lshlrev_b32 v176, 16, v16
v_and_b32 v177, 0xffff0000, v16
v_lshlrev_b32 v178, 16, v17
v_and_b32 v179, 0xffff0000, v17
v_lshlrev_b32 v180, 16, v18
v_and_b32 v181, 0xffff0000, v18
v_lshlrev_b32 v182, 16, v19
v_and_b32 v183, 0xffff0000, v19
v_lshlrev_b32 v184, 16, v20
v_and_b32 v185, 0xffff0000, v20
v_lshlrev_b32 v186, 16, v21
v_and_b32 v187, 0xffff0000, v21
v_lshlrev_b32 v188, 16, v22
v_and_b32 v189, 0xffff0000, v22
v_lshlrev_b32 v190, 16, v23
v_and_b32 v191, 0xffff0000, v23
s_lshl_b32 s19, s14, 7
s_lshl_b32 s35, s39, 2
s_add_u32 s19, s19, s35
s_add_u32 s19, s19, 1579008
s_lshl_b32 s18, s39, 12
s_mul_i32 s35, s16, 114688
s_add_u32 s18, s18, s35
s_add_u32 s18, s18, 100663296
s_mul_i32 s22, s12, 10240
v_lshlrev_b32 v1, 4, v0
v_lshlrev_b32 v5, 7, v0
s_mov_b32 s38, 0
L_ww_hclr0:
buffer_load_dword v4, off, s[8:11], 0 offset:128 sc1
s_add_u32 s38, s38, 1
s_cmp_ge_u32 s38, 524288
s_cbranch_scc1 L_err
s_waitcnt vmcnt(0)
v_cmp_gt_u32 vcc, 1, v4
s_cbranch_vccz L_ww_hclr0_ok
s_sleep 4
s_branch L_ww_hclr0
L_ww_hclr0_ok:
s_mov_b32 s35, 1597312
s_mov_b32 s38, 0
L_ww_hhold:
buffer_load_dword v4, off, s[4:7], s35 offset:0 sc1
s_add_u32 s38, s38, 1
s_cmp_ge_u32 s38, 524288
s_cbranch_scc1 L_err
s_waitcnt vmcnt(0)
v_cmp_gt_u32 vcc, 1, v4
s_cbranch_vccz L_ww_hhold_ok
s_sleep 4
s_branch L_ww_hhold
L_ww_hhold_ok:
s_barrier
v_bfe_u32 v2, v0, 3, 3
v_mul_u32_u24 v3, 3456, v2
v_bfe_u32 v2, v0, 0, 2
v_mul_u32_u24 v2, 16, v2
v_add_u32 v3, v3, v2
v_bfe_u32 v2, v0, 2, 1
v_bfe_u32 v4, v0, 4, 1
v_xor_b32 v2, v2, v4
v_lshl_add_u32 v3, v2, 6, v3
v_bfe_u32 v2, v0, 5, 1
v_mul_u32_u24 v24, 1024, v2
v_bfe_u32 v2, v0, 2, 2
v_mul_u32_u24 v2, 128, v2
v_add_u32 v24, v24, v2
v_bfe_u32 v2, v0, 3, 1
v_mul_u32_u24 v2, 64, v2
v_add_u32 v24, v24, v2
v_bfe_u32 v2, v0, 4, 1
v_mul_u32_u24 v2, 32, v2
v_add_u32 v24, v24, v2
v_bfe_u32 v2, v0, 0, 2
v_mul_u32_u24 v2, 8, v2
v_add_u32 v24, v24, v2
s_mul_i32 s100, s12, 20480
s_add_u32 s100, s100, 81920
v_add_u32 v24, s100, v24
v_xor_b32 v25, 64, v24
s_add_u32 m0, s100, 0
s_add_u32 s35, s96, 0
buffer_load_dwordx4 v3, s[80:83], s35 offen lds
s_add_u32 m0, s100, 1024
s_add_u32 s35, s96, 27648
buffer_load_dwordx4 v3, s[80:83], s35 offen lds
s_add_u32 m0, s100, 2048
s_add_u32 s35, s96, 55296
buffer_load_dwordx4 v3, s[80:83], s35 offen lds
s_add_u32 m0, s100, 3072
s_add_u32 s35, s96, 82944
buffer_load_dwordx4 v3, s[80:83], s35 offen lds
s_add_u32 m0, s100, 4096
s_add_u32 s35, s96, 110592
buffer_load_dwordx4 v3, s[80:83], s35 offen lds
s_add_u32 m0, s100, 5120
s_add_u32 s35, s96, 138240
buffer_load_dwordx4 v3, s[80:83], s35 offen lds
s_add_u32 m0, s100, 6144
s_add_u32 s35, s96, 165888
buffer_load_dwordx4 v3, s[80:83], s35 offen lds
s_add_u32 m0, s100, 7168
s_add_u32 s35, s96, 193536
buffer_load_dwordx4 v3, s[80:83], s35 offen lds
s_add_u32 m0, s100, 8192
s_add_u32 s35, s96, 221184
buffer_load_dwordx4 v3, s[80:83], s35 offen lds
s_add_u32 m0, s100, 9216
s_add_u32 s35, s96, 248832
buffer_load_dwordx4 v3, s[80:83], s35 offen lds
s_add_u32 m0, s100, 10240
s_add_u32 s35, s96, 276480
buffer_load_dwordx4 v3, s[80:83], s35 offen lds
s_add_u32 m0, s100, 11264
s_add_u32 s35, s96, 304128
buffer_load_dwordx4 v3, s[80:83], s35 offen lds
s_add_u32 m0, s100, 12288
s_add_u32 s35, s96, 331776
buffer_load_dwordx4 v3, s[80:83], s35 offen lds
s_add_u32 m0, s100, 13312
s_add_u32 s35, s96, 359424
buffer_load_dwordx4 v3, s[80:83], s35 offen lds
s_add_u32 m0, s100, 14336
s_add_u32 s35, s96, 387072
buffer_load_dwordx4 v3, s[80:83], s35 offen lds
s_add_u32 m0, s100, 15360
s_add_u32 s35, s96, 414720
buffer_load_dwordx4 v3, s[80:83], s35 offen lds
s_add_u32 m0, s100, 16384
s_add_u32 s35, s96, 442368
buffer_load_dwordx4 v3, s[80:83], s35 offen lds
s_add_u32 m0, s100, 17408
s_add_u32 s35, s96, 470016
buffer_load_dwordx4 v3, s[80:83], s35 offen lds
s_add_u32 m0, s100, 18432
s_add_u32 s35, s96, 497664
buffer_load_dwordx4 v3, s[80:83], s35 offen lds
s_add_u32 m0, s100, 19456
s_add_u32 s35, s96, 525312
buffer_load_dwordx4 v3, s[80:83], s35 offen lds
s_waitcnt vmcnt(16)
ds_read_b64_tr_b16 a[0:1], v24 offset:0
ds_read_b64_tr_b16 a[2:3], v24 offset:512
ds_read_b64_tr_b16 a[4:5], v25 offset:0
ds_read_b64_tr_b16 a[6:7], v25 offset:512
ds_read_b64_tr_b16 a[8:9], v24 offset:2048
ds_read_b64_tr_b16 a[10:11], v24 offset:2560
ds_read_b64_tr_b16 a[12:13], v25 offset:2048
ds_read_b64_tr_b16 a[14:15], v25 offset:2560
s_waitcnt lgkmcnt(0)
s_add_u32 m0, s100, 0
s_add_u32 s35, s96, 552960
buffer_load_dwordx4 v3, s[80:83], s35 offen lds
s_add_u32 m0, s100, 1024
s_add_u32 s35, s96, 580608
buffer_load_dwordx4 v3, s[80:83], s35 offen lds
s_add_u32 m0, s100, 2048
s_add_u32 s35, s96, 608256
buffer_load_dwordx4 v3, s[80:83], s35 offen lds
s_add_u32 m0, s100, 3072
s_add_u32 s35, s96, 635904
buffer_load_dwordx4 v3, s[80:83], s35 offen lds
s_waitcnt vmcnt(16)
ds_read_b64_tr_b16 a[16:17], v24 offset:4096
ds_read_b64_tr_b16 a[18:19], v24 offset:4608
ds_read_b64_tr_b16 a[20:21], v25 offset:4096
ds_read_b64_tr_b16 a[22:23], v25 offset:4608
ds_read_b64_tr_b16 a[24:25], v24 offset:6144
ds_read_b64_tr_b16 a[26:27], v24 offset:6656
ds_read_b64_tr_b16 a[28:29], v25 offset:6144
ds_read_b64_tr_b16 a[30:31], v25 offset:6656
s_waitcnt lgkmcnt(0)
s_add_u32 m0, s100, 4096
s_add_u32 s35, s96, 663552
buffer_load_dwordx4 v3, s[80:83], s35 offen lds
s_add_u32 m0, s100, 5120
s_add_u32 s35, s96, 691200
buffer_load_dwordx4 v3, s[80:83], s35 offen lds
s_add_u32 m0, s100, 6144
s_add_u32 s35, s96, 718848
buffer_load_dwordx4 v3, s[80:83], s35 offen lds
s_add_u32 m0, s100, 7168
s_add_u32 s35, s96, 746496
buffer_load_dwordx4 v3, s[80:83], s35 offen lds
s_waitcnt vmcnt(16)
ds_read_b64_tr_b16 a[32:33], v24 offset:8192
ds_read_b64_tr_b16 a[34:35], v24 offset:8704
ds_read_b64_tr_b16 a[36:37], v25 offset:8192
ds_read_b64_tr_b16 a[38:39], v25 offset:8704
ds_read_b64_tr_b16 a[40:41], v24 offset:10240
ds_read_b64_tr_b16 a[42:43], v24 offset:10752
ds_read_b64_tr_b16 a[44:45], v25 offset:10240
ds_read_b64_tr_b16 a[46:47], v25 offset:10752
s_waitcnt lgkmcnt(0)
s_add_u32 m0, s100, 8192
s_add_u32 s35, s96, 774144
buffer_load_dwordx4 v3, s[80:83], s35 offen lds
s_add_u32 m0, s100, 9216
s_add_u32 s35, s96, 801792
buffer_load_dwordx4 v3, s[80:83], s35 offen lds
s_add_u32 m0, s100, 10240
s_add_u32 s35, s96, 829440
buffer_load_dwordx4 v3, s[80:83], s35 offen lds
s_add_u32 m0, s100, 11264
s_add_u32 s35, s96, 857088
buffer_load_dwordx4 v3, s[80:83], s35 offen lds
buffer_load_dword v26, off, s[8:11], 0 offset:128 sc1
s_waitcnt vmcnt(16)
ds_read_b64_tr_b16 a[48:49], v24 offset:12288
ds_read_b64_tr_b16 a[50:51], v24 offset:12800
ds_read_b64_tr_b16 a[52:53], v25 offset:12288
ds_read_b64_tr_b16 a[54:55], v25 offset:12800
ds_read_b64_tr_b16 a[56:57], v24 offset:14336
ds_read_b64_tr_b16 a[58:59], v24 offset:14848
ds_read_b64_tr_b16 a[60:61], v25 offset:14336
ds_read_b64_tr_b16 a[62:63], v25 offset:14848
s_waitcnt lgkmcnt(0)
s_add_u32 m0, s100, 12288
s_add_u32 s35, s96, 884736
buffer_load_dwordx4 v3, s[80:83], s35 offen lds
s_add_u32 m0, s100, 13312
s_add_u32 s35, s96, 912384
buffer_load_dwordx4 v3, s[80:83], s35 offen lds
s_add_u32 m0, s100, 14336
s_add_u32 s35, s96, 940032
buffer_load_dwordx4 v3, s[80:83], s35 offen lds
s_add_u32 m0, s100, 15360
s_add_u32 s35, s96, 967680
buffer_load_dwordx4 v3, s[80:83], s35 offen lds
s_waitcnt vmcnt(16)
ds_read_b64_tr_b16 a[64:65], v24 offset:16384
ds_read_b64_tr_b16 a[66:67], v24 offset:16896
ds_read_b64_tr_b16 a[68:69], v25 offset:16384
ds_read_b64_tr_b16 a[70:71], v25 offset:16896
ds_read_b64_tr_b16 a[72:73], v24 offset:18432
ds_read_b64_tr_b16 a[74:75], v24 offset:18944
ds_read_b64_tr_b16 a[76:77], v25 offset:18432
ds_read_b64_tr_b16 a[78:79], v25 offset:18944
s_waitcnt lgkmcnt(0)
s_add_u32 m0, s100, 16384
s_add_u32 s35, s96, 995328
buffer_load_dwordx4 v3, s[80:83], s35 offen lds
s_add_u32 m0, s100, 17408
s_add_u32 s35, s96, 1022976
buffer_load_dwordx4 v3, s[80:83], s35 offen lds
s_add_u32 m0, s100, 18432
s_add_u32 s35, s96, 1050624
buffer_load_dwordx4 v3, s[80:83], s35 offen lds
s_add_u32 m0, s100, 19456
s_add_u32 s35, s96, 1078272
buffer_load_dwordx4 v3, s[80:83], s35 offen lds
s_waitcnt vmcnt(16)
ds_read_b64_tr_b16 a[80:81], v24 offset:0
ds_read_b64_tr_b16 a[82:83], v24 offset:512
ds_read_b64_tr_b16 a[84:85], v25 offset:0
ds_read_b64_tr_b16 a[86:87], v25 offset:512
ds_read_b64_tr_b16 a[88:89], v24 offset:2048
ds_read_b64_tr_b16 a[90:91], v24 offset:2560
ds_read_b64_tr_b16 a[92:93], v25 offset:2048
ds_read_b64_tr_b16 a[94:95], v25 offset:2560
s_waitcnt lgkmcnt(0)
s_add_u32 m0, s100, 0
s_add_u32 s35, s96, 1105920
buffer_load_dwordx4 v3, s[80:83], s35 offen lds
s_add_u32 m0, s100, 1024
s_add_u32 s35, s96, 1133568
buffer_load_dwordx4 v3, s[80:83], s35 offen lds
s_add_u32 m0, s100, 2048
s_add_u32 s35, s96, 1161216
buffer_load_dwordx4 v3, s[80:83], s35 offen lds
s_add_u32 m0, s100, 3072
s_add_u32 s35, s96, 1188864
buffer_load_dwordx4 v3, s[80:83], s35 offen lds
s_waitcnt vmcnt(16)
ds_read_b64_tr_b16 a[96:97], v24 offset:4096
ds_read_b64_tr_b16 a[98:99], v24 offset:4608
ds_read_b64_tr_b16 a[100:101], v25 offset:4096
ds_read_b64_tr_b16 a[102:103], v25 offset:4608
ds_read_b64_tr_b16 a[104:105], v24 offset:6144
ds_read_b64_tr_b16 a[106:107], v24 offset:6656
ds_read_b64_tr_b16 a[108:109], v25 offset:6144
ds_read_b64_tr_b16 a[110:111], v25 offset:6656
s_waitcnt lgkmcnt(0)
s_add_u32 m0, s100, 4096
s_add_u32 s35, s96, 1216512
buffer_load_dwordx4 v3, s[80:83], s35 offen lds
s_add_u32 m0, s100, 5120
s_add_u32 s35, s96, 1244160
buffer_load_dwordx4 v3, s[80:83], s35 offen lds
s_add_u32 m0, s100, 6144
s_add_u32 s35, s96, 1271808
buffer_load_dwordx4 v3, s[80:83], s35 offen lds
s_add_u32 m0, s100, 7168
s_add_u32 s35, s96, 1299456
buffer_load_dwordx4 v3, s[80:83], s35 offen lds
s_waitcnt vmcnt(16)
ds_read_b64_tr_b16 a[112:113], v24 offset:8192
ds_read_b64_tr_b16 a[114:115], v24 offset:8704
ds_read_b64_tr_b16 a[116:117], v25 offset:8192
ds_read_b64_tr_b16 a[118:119], v25 offset:8704
ds_read_b64_tr_b16 a[120:121], v24 offset:10240
ds_read_b64_tr_b16 a[122:123], v24 offset:10752
ds_read_b64_tr_b16 a[124:125], v25 offset:10240
ds_read_b64_tr_b16 a[126:127], v25 offset:10752
s_waitcnt lgkmcnt(0)
s_add_u32 m0, s100, 8192
s_add_u32 s35, s96, 1327104
buffer_load_dwordx4 v3, s[80:83], s35 offen lds
s_add_u32 m0, s100, 9216
s_add_u32 s35, s96, 1354752
buffer_load_dwordx4 v3, s[80:83], s35 offen lds
s_add_u32 m0, s100, 10240
s_add_u32 s35, s96, 1382400
buffer_load_dwordx4 v3, s[80:83], s35 offen lds
s_add_u32 m0, s100, 11264
s_add_u32 s35, s96, 1410048
buffer_load_dwordx4 v3, s[80:83], s35 offen lds
s_waitcnt vmcnt(16)
ds_read_b64_tr_b16 a[128:129], v24 offset:12288
ds_read_b64_tr_b16 a[130:131], v24 offset:12800
ds_read_b64_tr_b16 a[132:133], v25 offset:12288
ds_read_b64_tr_b16 a[134:135], v25 offset:12800
ds_read_b64_tr_b16 a[136:137], v24 offset:14336
ds_read_b64_tr_b16 a[138:139], v24 offset:14848
ds_read_b64_tr_b16 a[140:141], v25 offset:14336
ds_read_b64_tr_b16 a[142:143], v25 offset:14848
s_waitcnt lgkmcnt(0)
s_add_u32 m0, s100, 12288
s_add_u32 s35, s96, 1437696
buffer_load_dwordx4 v3, s[80:83], s35 offen lds
s_add_u32 m0, s100, 13312
s_add_u32 s35, s96, 1465344
buffer_load_dwordx4 v3, s[80:83], s35 offen lds
s_add_u32 m0, s100, 14336
s_add_u32 s35, s96, 1492992
buffer_load_dwordx4 v3, s[80:83], s35 offen lds
s_add_u32 m0, s100, 15360
s_add_u32 s35, s96, 1520640
buffer_load_dwordx4 v3, s[80:83], s35 offen lds
v_cmp_gt_u32 vcc, 1, v26
s_cbranch_vccz L_h_clr
s_mov_b32 s38, 0
L_ww_hclr:
buffer_load_dword v26, off, s[8:11], 0 offset:128 sc1
s_add_u32 s38, s38, 1
s_cmp_ge_u32 s38, 524288
s_cbranch_scc1 L_err
s_waitcnt vmcnt(0)
v_cmp_gt_u32 vcc, 1, v26
s_cbranch_vccz L_ww_hclr_ok
s_sleep 4
s_branch L_ww_hclr
L_ww_hclr_ok:
L_h_clr:
s_mov_b32 s35, 1589248
buffer_load_dword v26, v5, s[4:7], s35 offen sc1
s_waitcnt vmcnt(16)
ds_read_b64_tr_b16 a[144:145], v24 offset:16384
ds_read_b64_tr_b16 a[146:147], v24 offset:16896
ds_read_b64_tr_b16 a[148:149], v25 offset:16384
ds_read_b64_tr_b16 a[150:151], v25 offset:16896
ds_read_b64_tr_b16 a[152:153], v24 offset:18432
ds_read_b64_tr_b16 a[154:155], v24 offset:18944
ds_read_b64_tr_b16 a[156:157], v25 offset:18432
ds_read_b64_tr_b16 a[158:159], v25 offset:18944
s_waitcnt lgkmcnt(0)
s_add_u32 m0, s100, 16384
s_add_u32 s35, s96, 1548288
buffer_load_dwordx4 v3, s[80:83], s35 offen lds
s_add_u32 m0, s100, 17408
s_add_u32 s35, s96, 1575936
buffer_load_dwordx4 v3, s[80:83], s35 offen lds
s_add_u32 m0, s100, 18432
s_add_u32 s35, s96, 1603584
buffer_load_dwordx4 v3, s[80:83], s35 offen lds
s_add_u32 m0, s100, 19456
s_add_u32 s35, s96, 1631232
buffer_load_dwordx4 v3, s[80:83], s35 offen lds
s_waitcnt vmcnt(16)
ds_read_b64_tr_b16 a[160:161], v24 offset:0
ds_read_b64_tr_b16 a[162:163], v24 offset:512
ds_read_b64_tr_b16 a[164:165], v25 offset:0
ds_read_b64_tr_b16 a[166:167], v25 offset:512
ds_read_b64_tr_b16 a[168:169], v24 offset:2048
ds_read_b64_tr_b16 a[170:171], v24 offset:2560
ds_read_b64_tr_b16 a[172:173], v25 offset:2048
ds_read_b64_tr_b16 a[174:175], v25 offset:2560
s_waitcnt lgkmcnt(0)
s_add_u32 m0, s100, 0
s_add_u32 s35, s96, 1658880
buffer_load_dwordx4 v3, s[80:83], s35 offen lds
s_add_u32 m0, s100, 1024
s_add_u32 s35, s96, 1686528
buffer_load_dwordx4 v3, s[80:83], s35 offen lds
s_add_u32 m0, s100, 2048
s_add_u32 s35, s96, 1714176
buffer_load_dwordx4 v3, s[80:83], s35 offen lds
s_add_u32 m0, s100, 3072
s_add_u32 s35, s96, 1741824
buffer_load_dwordx4 v3, s[80:83], s35 offen lds
s_waitcnt vmcnt(16)
ds_read_b64_tr_b16 a[176:177], v24 offset:4096
ds_read_b64_tr_b16 a[178:179], v24 offset:4608
ds_read_b64_tr_b16 a[180:181], v25 offset:4096
ds_read_b64_tr_b16 a[182:183], v25 offset:4608
ds_read_b64_tr_b16 a[184:185], v24 offset:6144
ds_read_b64_tr_b16 a[186:187], v24 offset:6656
ds_read_b64_tr_b16 a[188:189], v25 offset:6144
ds_read_b64_tr_b16 a[190:191], v25 offset:6656
s_waitcnt lgkmcnt(0)
s_add_u32 m0, s100, 4096
s_add_u32 s35, s96, 1769472
buffer_load_dwordx4 v3, s[80:83], s35 offen lds
s_add_u32 m0, s100, 5120
s_add_u32 s35, s96, 1797120
buffer_load_dwordx4 v3, s[80:83], s35 offen lds
s_add_u32 m0, s100, 6144
s_add_u32 s35, s96, 1824768
buffer_load_dwordx4 v3, s[80:83], s35 offen lds
s_add_u32 m0, s100, 7168
s_add_u32 s35, s96, 1852416
buffer_load_dwordx4 v3, s[80:83], s35 offen lds
s_waitcnt vmcnt(16)
ds_read_b64_tr_b16 a[192:193], v24 offset:8192
ds_read_b64_tr_b16 a[194:195], v24 offset:8704
ds_read_b64_tr_b16 a[196:197], v25 offset:8192
ds_read_b64_tr_b16 a[198:199], v25 offset:8704
ds_read_b64_tr_b16 a[200:201], v24 offset:10240
ds_read_b64_tr_b16 a[202:203], v24 offset:10752
ds_read_b64_tr_b16 a[204:205], v25 offset:10240
ds_read_b64_tr_b16 a[206:207], v25 offset:10752
s_waitcnt lgkmcnt(0)
s_add_u32 m0, s100, 8192
s_add_u32 s35, s96, 1880064
buffer_load_dwordx4 v3, s[80:83], s35 offen lds
s_add_u32 m0, s100, 9216
s_add_u32 s35, s96, 1907712
buffer_load_dwordx4 v3, s[80:83], s35 offen lds
s_add_u32 m0, s100, 10240
s_add_u32 s35, s96, 1935360
buffer_load_dwordx4 v3, s[80:83], s35 offen lds
s_add_u32 m0, s100, 11264
s_add_u32 s35, s96, 1963008
buffer_load_dwordx4 v3, s[80:83], s35 offen lds
s_waitcnt vmcnt(16)
ds_read_b64_tr_b16 a[208:209], v24 offset:12288
ds_read_b64_tr_b16 a[210:211], v24 offset:12800
ds_read_b64_tr_b16 a[212:213], v25 offset:12288
ds_read_b64_tr_b16 a[214:215], v25 offset:12800
ds_read_b64_tr_b16 a[216:217], v24 offset:14336
ds_read_b64_tr_b16 a[218:219], v24 offset:14848
ds_read_b64_tr_b16 a[220:221], v25 offset:14336
ds_read_b64_tr_b16 a[222:223], v25 offset:14848
s_waitcnt lgkmcnt(0)
s_add_u32 m0, s100, 12288
s_add_u32 s35, s96, 1990656
buffer_load_dwordx4 v3, s[80:83], s35 offen lds
s_add_u32 m0, s100, 13312
s_add_u32 s35, s96, 2018304
buffer_load_dwordx4 v3, s[80:83], s35 offen lds
s_add_u32 m0, s100, 14336
s_add_u32 s35, s96, 2045952
buffer_load_dwordx4 v3, s[80:83], s35 offen lds
s_add_u32 m0, s100, 15360
s_add_u32 s35, s96, 2073600
buffer_load_dwordx4 v3, s[80:83], s35 offen lds
s_waitcnt vmcnt(16)
ds_read_b64_tr_b16 a[224:225], v24 offset:16384
ds_read_b64_tr_b16 a[226:227], v24 offset:16896
ds_read_b64_tr_b16 a[228:229], v25 offset:16384
ds_read_b64_tr_b16 a[230:231], v25 offset:16896
ds_read_b64_tr_b16 a[232:233], v24 offset:18432
ds_read_b64_tr_b16 a[234:235], v24 offset:18944
ds_read_b64_tr_b16 a[236:237], v25 offset:18432
ds_read_b64_tr_b16 a[238:239], v25 offset:18944
s_waitcnt lgkmcnt(0)
s_add_u32 m0, s100, 16384
s_add_u32 s35, s96, 2101248
buffer_load_dwordx4 v3, s[80:83], s35 offen lds
s_add_u32 m0, s100, 17408
s_add_u32 s35, s96, 2128896
buffer_load_dwordx4 v3, s[80:83], s35 offen lds
s_add_u32 m0, s100, 18432
s_add_u32 s35, s96, 2156544
buffer_load_dwordx4 v3, s[80:83], s35 offen lds
s_add_u32 m0, s100, 19456
s_add_u32 s35, s96, 2184192
buffer_load_dwordx4 v3, s[80:83], s35 offen lds
s_waitcnt vmcnt(16)
ds_read_b64_tr_b16 a[240:241], v24 offset:0
ds_read_b64_tr_b16 a[242:243], v24 offset:512
ds_read_b64_tr_b16 a[244:245], v25 offset:0
ds_read_b64_tr_b16 a[246:247], v25 offset:512
ds_read_b64_tr_b16 a[248:249], v24 offset:2048
ds_read_b64_tr_b16 a[250:251], v24 offset:2560
ds_read_b64_tr_b16 a[252:253], v25 offset:2048
ds_read_b64_tr_b16 a[254:255], v25 offset:2560
s_waitcnt lgkmcnt(0)
s_mov_b32 s38, 0
s_mov_b32 s35, 1589248
L_h_xall:
v_cmp_gt_u32 vcc, 1, v26
s_cbranch_vccz L_h_xok
buffer_load_dword v26, v5, s[4:7], s35 offen sc1
s_add_u32 s38, s38, 1
s_cmp_ge_u32 s38, 524288
s_cbranch_scc1 L_err
s_waitcnt vmcnt(0)
s_branch L_h_xall
L_h_xok:
s_mul_i32 s36, 0, 1
s_add_u32 s36, s36, s16
s_mul_i32 s36, s36, 40960
s_add_u32 s36, s36, s22
s_add_u32 s36, s36, 109051904
s_add_u32 s37, 0, s22
s_add_u32 m0, s37, 0
s_add_u32 s35, s36, 0
buffer_load_dwordx4 v1, s[4:7], s35 offen sc1 lds
s_add_u32 m0, s37, 1024
s_add_u32 s35, s36, 1024
buffer_load_dwordx4 v1, s[4:7], s35 offen sc1 lds
s_add_u32 m0, s37, 2048
s_add_u32 s35, s36, 2048
buffer_load_dwordx4 v1, s[4:7], s35 offen sc1 lds
s_add_u32 m0, s37, 3072
s_add_u32 s35, s36, 3072
buffer_load_dwordx4 v1, s[4:7], s35 offen sc1 lds
s_add_u32 m0, s37, 4096
s_add_u32 s35, s36, 4096
buffer_load_dwordx4 v1, s[4:7], s35 offen sc1 lds
s_add_u32 m0, s37, 5120
s_add_u32 s35, s36, 5120
buffer_load_dwordx4 v1, s[4:7], s35 offen sc1 lds
s_add_u32 m0, s37, 6144
s_add_u32 s35, s36, 6144
buffer_load_dwordx4 v1, s[4:7], s35 offen sc1 lds
s_add_u32 m0, s37, 7168
s_add_u32 s35, s36, 7168
buffer_load_dwordx4 v1, s[4:7], s35 offen sc1 lds
s_add_u32 m0, s37, 8192
s_add_u32 s35, s36, 8192
buffer_load_dwordx4 v1, s[4:7], s35 offen sc1 lds
s_add_u32 m0, s37, 9216
s_add_u32 s35, s36, 9216
buffer_load_dwordx4 v1, s[4:7], s35 offen sc1 lds
s_mul_i32 s36, 1, 1
s_add_u32 s36, s36, s16
s_mul_i32 s36, s36, 40960
s_add_u32 s36, s36, s22
s_add_u32 s36, s36, 109051904
s_add_u32 s37, 40960, s22
s_add_u32 m0, s37, 0
s_add_u32 s35, s36, 0
buffer_load_dwordx4 v1, s[4:7], s35 offen sc1 lds
s_add_u32 m0, s37, 1024
s_add_u32 s35, s36, 1024
buffer_load_dwordx4 v1, s[4:7], s35 offen sc1 lds
s_add_u32 m0, s37, 2048
s_add_u32 s35, s36, 2048
buffer_load_dwordx4 v1, s[4:7], s35 offen sc1 lds
s_add_u32 m0, s37, 3072
s_add_u32 s35, s36, 3072
buffer_load_dwordx4 v1, s[4:7], s35 offen sc1 lds
s_add_u32 m0, s37, 4096
s_add_u32 s35, s36, 4096
buffer_load_dwordx4 v1, s[4:7], s35 offen sc1 lds
s_add_u32 m0, s37, 5120
s_add_u32 s35, s36, 5120
buffer_load_dwordx4 v1, s[4:7], s35 offen sc1 lds
s_add_u32 m0, s37, 6144
s_add_u32 s35, s36, 6144
buffer_load_dwordx4 v1, s[4:7], s35 offen sc1 lds
s_add_u32 m0, s37, 7168
s_add_u32 s35, s36, 7168
buffer_load_dwordx4 v1, s[4:7], s35 offen sc1 lds
s_add_u32 m0, s37, 8192
s_add_u32 s35, s36, 8192
buffer_load_dwordx4 v1, s[4:7], s35 offen sc1 lds
s_add_u32 m0, s37, 9216
s_add_u32 s35, s36, 9216
buffer_load_dwordx4 v1, s[4:7], s35 offen sc1 lds
s_waitcnt vmcnt(32)
ds_read_b64_tr_b16 v[192:193], v24 offset:4096
ds_read_b64_tr_b16 v[194:195], v24 offset:4608
ds_read_b64_tr_b16 v[196:197], v25 offset:4096
ds_read_b64_tr_b16 v[198:199], v25 offset:4608
ds_read_b64_tr_b16 v[200:201], v24 offset:6144
ds_read_b64_tr_b16 v[202:203], v24 offset:6656
ds_read_b64_tr_b16 v[204:205], v25 offset:6144
ds_read_b64_tr_b16 v[206:207], v25 offset:6656
s_waitcnt lgkmcnt(0)
s_waitcnt vmcnt(28)
ds_read_b64_tr_b16 v[208:209], v24 offset:8192
ds_read_b64_tr_b16 v[210:211], v24 offset:8704
ds_read_b64_tr_b16 v[212:213], v25 offset:8192
ds_read_b64_tr_b16 v[214:215], v25 offset:8704
ds_read_b64_tr_b16 v[216:217], v24 offset:10240
ds_read_b64_tr_b16 v[218:219], v24 offset:10752
ds_read_b64_tr_b16 v[220:221], v25 offset:10240
ds_read_b64_tr_b16 v[222:223], v25 offset:10752
s_waitcnt lgkmcnt(0)
s_waitcnt vmcnt(24)
ds_read_b64_tr_b16 v[224:225], v24 offset:12288
ds_read_b64_tr_b16 v[226:227], v24 offset:12800
ds_read_b64_tr_b16 v[228:229], v25 offset:12288
ds_read_b64_tr_b16 v[230:231], v25 offset:12800
ds_read_b64_tr_b16 v[232:233], v24 offset:14336
ds_read_b64_tr_b16 v[234:235], v24 offset:14848
ds_read_b64_tr_b16 v[236:237], v25 offset:14336
ds_read_b64_tr_b16 v[238:239], v25 offset:14848
s_waitcnt lgkmcnt(0)
s_waitcnt vmcnt(20)
ds_read_b64_tr_b16 v[240:241], v24 offset:16384
ds_read_b64_tr_b16 v[242:243], v24 offset:16896
ds_read_b64_tr_b16 v[244:245], v25 offset:16384
ds_read_b64_tr_b16 v[246:247], v25 offset:16896
ds_read_b64_tr_b16 v[248:249], v24 offset:18432
ds_read_b64_tr_b16 v[250:251], v24 offset:18944
ds_read_b64_tr_b16 v[252:253], v25 offset:18432
ds_read_b64_tr_b16 v[254:255], v25 offset:18944
s_waitcnt lgkmcnt(0)
s_mov_b32 s24, 0xc0135761
s_mov_b32 s25, 0xbdd2d3e8
v_mov_b32 v6, s24
s_mov_b32 s17, 0
s_mov_b32 s20, 0
s_sub_u32 s27, s21, 1
s_waitcnt vmcnt(10)
s_barrier
v_add_u32 v7, s20, v1
s_add_u32 s39, s17, 2
s_min_u32 s39, s39, s27
s_add_u32 s26, s20, 81920
s_cmp_ge_u32 s26, 122880
s_cselect_b32 s35, 122880, 0
s_sub_u32 s26, s26, s35
ds_read_b128 v[128:131], v7 offset:0
ds_read_b128 v[132:135], v7 offset:1024
ds_read_b128 v[136:139], v7 offset:2048
s_mul_i32 s36, s39, 1
s_add_u32 s36, s36, s16
s_mul_i32 s36, s36, 40960
s_add_u32 s36, s36, s22
s_add_u32 s36, s36, 109051904
s_add_u32 s37, s26, s22
s_waitcnt lgkmcnt(2)
v_mfma_f32_32x32x16_bf16 v[64:79], a[0:3], v[128:131], v[160:175]
v_mfma_f32_32x32x16_bf16 v[80:95], a[4:7], v[128:131], v[176:191]
ds_read_b128 v[140:143], v7 offset:3072
s_waitcnt lgkmcnt(2)
v_mfma_f32_32x32x16_bf16 v[64:79], a[8:11], v[132:135], v[64:79]
s_add_u32 m0, s37, 0
s_add_u32 s35, s36, 0
buffer_load_dwordx4 v1, s[4:7], s35 offen sc1 lds
v_mfma_f32_32x32x16_bf16 v[80:95], a[12:15], v[132:135], v[80:95]
ds_read_b128 v[128:131], v7 offset:4096
s_add_u32 m0, s37, 1024
s_add_u32 s35, s36, 1024
buffer_load_dwordx4 v1, s[4:7], s35 offen sc1 lds
s_waitcnt lgkmcnt(2)
v_mfma_f32_32x32x16_bf16 v[64:79], a[16:19], v[136:139], v[64:79]
s_add_u32 m0, s37, 2048
s_add_u32 s35, s36, 2048
buffer_load_dwordx4 v1, s[4:7], s35 offen sc1 lds
v_mfma_f32_32x32x16_bf16 v[80:95], a[20:23], v[136:139], v[80:95]
ds_read_b128 v[132:135], v7 offset:5120
s_add_u32 m0, s37, 3072
s_add_u32 s35, s36, 3072
buffer_load_dwordx4 v1, s[4:7], s35 offen sc1 lds
s_waitcnt lgkmcnt(2)
v_mfma_f32_32x32x16_bf16 v[64:79], a[24:27], v[140:143], v[64:79]
s_add_u32 m0, s37, 4096
s_add_u32 s35, s36, 4096
buffer_load_dwordx4 v1, s[4:7], s35 offen sc1 lds
v_mfma_f32_32x32x16_bf16 v[80:95], a[28:31], v[140:143], v[80:95]
ds_read_b128 v[136:139], v7 offset:6144
s_add_u32 m0, s37, 5120
s_add_u32 s35, s36, 5120
buffer_load_dwordx4 v1, s[4:7], s35 offen sc1 lds
s_waitcnt lgkmcnt(2)
v_mfma_f32_32x32x16_bf16 v[64:79], a[32:35], v[128:131], v[64:79]
s_add_u32 m0, s37, 6144
s_add_u32 s35, s36, 6144
buffer_load_dwordx4 v1, s[4:7], s35 offen sc1 lds
v_mfma_f32_32x32x16_bf16 v[80:95], a[36:39], v[128:131], v[80:95]
ds_read_b128 v[140:143], v7 offset:7168
s_add_u32 m0, s37, 7168
s_add_u32 s35, s36, 7168
buffer_load_dwordx4 v1, s[4:7], s35 offen sc1 lds
s_waitcnt lgkmcnt(2)
v_mfma_f32_32x32x16_bf16 v[64:79], a[40:43], v[132:135], v[64:79]
s_add_u32 m0, s37, 8192
s_add_u32 s35, s36, 8192
buffer_load_dwordx4 v1, s[4:7], s35 offen sc1 lds
v_mfma_f32_32x32x16_bf16 v[80:95], a[44:47], v[132:135], v[80:95]
ds_read_b128 v[128:131], v7 offset:8192
s_add_u32 m0, s37, 9216
s_add_u32 s35, s36, 9216
buffer_load_dwordx4 v1, s[4:7], s35 offen sc1 lds
s_waitcnt lgkmcnt(2)
v_mfma_f32_32x32x16_bf16 v[64:79], a[48:51], v[136:139], v[64:79]
v_mfma_f32_32x32x16_bf16 v[80:95], a[52:55], v[136:139], v[80:95]
ds_read_b128 v[132:135], v7 offset:9216
s_waitcnt lgkmcnt(2)
v_mfma_f32_32x32x16_bf16 v[64:79], a[56:59], v[140:143], v[64:79]
v_mfma_f32_32x32x16_bf16 v[80:95], a[60:63], v[140:143], v[80:95]
ds_read_b128 v[136:139], v7 offset:10240
s_waitcnt lgkmcnt(2)
v_mfma_f32_32x32x16_bf16 v[64:79], a[64:67], v[128:131], v[64:79]
v_mfma_f32_32x32x16_bf16 v[80:95], a[68:71], v[128:131], v[80:95]
ds_read_b128 v[140:143], v7 offset:11264
s_waitcnt lgkmcnt(2)
v_mfma_f32_32x32x16_bf16 v[64:79], a[72:75], v[132:135], v[64:79]
v_mfma_f32_32x32x16_bf16 v[80:95], a[76:79], v[132:135], v[80:95]
ds_read_b128 v[128:131], v7 offset:12288
s_waitcnt lgkmcnt(2)
v_mfma_f32_32x32x16_bf16 v[64:79], a[80:83], v[136:139], v[64:79]
v_mfma_f32_32x32x16_bf16 v[80:95], a[84:87], v[136:139], v[80:95]
ds_read_b128 v[132:135], v7 offset:13312
s_waitcnt lgkmcnt(2)
v_mfma_f32_32x32x16_bf16 v[64:79], a[88:91], v[140:143], v[64:79]
v_mfma_f32_32x32x16_bf16 v[80:95], a[92:95], v[140:143], v[80:95]
ds_read_b128 v[136:139], v7 offset:14336
s_waitcnt lgkmcnt(2)
v_mfma_f32_32x32x16_bf16 v[64:79], a[96:99], v[128:131], v[64:79]
v_mfma_f32_32x32x16_bf16 v[80:95], a[100:103], v[128:131], v[80:95]
ds_read_b128 v[140:143], v7 offset:15360
s_waitcnt lgkmcnt(2)
v_mfma_f32_32x32x16_bf16 v[64:79], a[104:107], v[132:135], v[64:79]
v_mfma_f32_32x32x16_bf16 v[80:95], a[108:111], v[132:135], v[80:95]
ds_read_b128 v[128:131], v7 offset:16384
s_waitcnt lgkmcnt(2)
v_mfma_f32_32x32x16_bf16 v[64:79], a[112:115], v[136:139], v[64:79]
v_mfma_f32_32x32x16_bf16 v[80:95], a[116:119], v[136:139], v[80:95]
ds_read_b128 v[132:135], v7 offset:17408
s_waitcnt lgkmcnt(2)
v_mfma_f32_32x32x16_bf16 v[64:79], a[120:123], v[140:143], v[64:79]
v_mfma_f32_32x32x16_bf16 v[80:95], a[124:127], v[140:143], v[80:95]
ds_read_b128 v[136:139], v7 offset:18432
s_waitcnt lgkmcnt(2)
v_mfma_f32_32x32x16_bf16 v[64:79], a[128:131], v[128:131], v[64:79]
v_mfma_f32_32x32x16_bf16 v[80:95], a[132:135], v[128:131], v[80:95]
ds_read_b128 v[140:143], v7 offset:19456
s_waitcnt lgkmcnt(2)
v_mfma_f32_32x32x16_bf16 v[64:79], a[136:139], v[132:135], v[64:79]
v_mfma_f32_32x32x16_bf16 v[80:95], a[140:143], v[132:135], v[80:95]
ds_read_b128 v[128:131], v7 offset:20480
s_waitcnt lgkmcnt(2)
v_mfma_f32_32x32x16_bf16 v[64:79], a[144:147], v[136:139], v[64:79]
v_mfma_f32_32x32x16_bf16 v[80:95], a[148:151], v[136:139], v[80:95]
ds_read_b128 v[132:135], v7 offset:21504
s_waitcnt lgkmcnt(2)
v_mfma_f32_32x32x16_bf16 v[64:79], a[152:155], v[140:143], v[64:79]
v_mfma_f32_32x32x16_bf16 v[80:95], a[156:159], v[140:143], v[80:95]
ds_read_b128 v[136:139], v7 offset:22528
s_waitcnt lgkmcnt(2)
v_mfma_f32_32x32x16_bf16 v[64:79], a[160:163], v[128:131], v[64:79]
v_mfma_f32_32x32x16_bf16 v[80:95], a[164:167], v[128:131], v[80:95]
ds_read_b128 v[140:143], v7 offset:23552
s_waitcnt lgkmcnt(2)
v_mfma_f32_32x32x16_bf16 v[64:79], a[168:171], v[132:135], v[64:79]
v_mfma_f32_32x32x16_bf16 v[80:95], a[172:175], v[132:135], v[80:95]
ds_read_b128 v[128:131], v7 offset:24576
s_waitcnt lgkmcnt(2)
v_mfma_f32_32x32x16_bf16 v[64:79], a[176:179], v[136:139], v[64:79]
v_mfma_f32_32x32x16_bf16 v[80:95], a[180:183], v[136:139], v[80:95]
ds_read_b128 v[132:135], v7 offset:25600
s_waitcnt lgkmcnt(2)
v_mfma_f32_32x32x16_bf16 v[64:79], a[184:187], v[140:143], v[64:79]
v_mfma_f32_32x32x16_bf16 v[80:95], a[188:191], v[140:143], v[80:95]
ds_read_b128 v[136:139], v7 offset:26624
s_waitcnt lgkmcnt(2)
v_mfma_f32_32x32x16_bf16 v[64:79], a[192:195], v[128:131], v[64:79]
v_mfma_f32_32x32x16_bf16 v[80:95], a[196:199], v[128:131], v[80:95]
ds_read_b128 v[140:143], v7 offset:27648
s_waitcnt lgkmcnt(2)
v_mfma_f32_32x32x16_bf16 v[64:79], a[200:203], v[132:135], v[64:79]
v_mfma_f32_32x32x16_bf16 v[80:95], a[204:207], v[132:135], v[80:95]
ds_read_b128 v[128:131], v7 offset:28672
s_waitcnt lgkmcnt(2)
v_mfma_f32_32x32x16_bf16 v[64:79], a[208:211], v[136:139], v[64:79]
v_mfma_f32_32x32x16_bf16 v[80:95], a[212:215], v[136:139], v[80:95]
ds_read_b128 v[132:135], v7 offset:29696
s_waitcnt lgkmcnt(2)
v_mfma_f32_32x32x16_bf16 v[64:79], a[216:219], v[140:143], v[64:79]
v_mfma_f32_32x32x16_bf16 v[80:95], a[220:223], v[140:143], v[80:95]
ds_read_b128 v[136:139], v7 offset:30720
s_waitcnt lgkmcnt(2)
v_mfma_f32_32x32x16_bf16 v[64:79], a[224:227], v[128:131], v[64:79]
v_mfma_f32_32x32x16_bf16 v[80:95], a[228:231], v[128:131], v[80:95]
ds_read_b128 v[140:143], v7 offset:31744
s_waitcnt lgkmcnt(2)
v_mfma_f32_32x32x16_bf16 v[64:79], a[232:235], v[132:135], v[64:79]
v_mfma_f32_32x32x16_bf16 v[80:95], a[236:239], v[132:135], v[80:95]
ds_read_b128 v[128:131], v7 offset:32768
s_waitcnt lgkmcnt(2)
v_mfma_f32_32x32x16_bf16 v[64:79], a[240:243], v[136:139], v[64:79]
v_mfma_f32_32x32x16_bf16 v[80:95], a[244:247], v[136:139], v[80:95]
ds_read_b128 v[132:135], v7 offset:33792
s_waitcnt lgkmcnt(2)
v_mfma_f32_32x32x16_bf16 v[64:79], a[248:251], v[140:143], v[64:79]
v_mfma_f32_32x32x16_bf16 v[80:95], a[252:255], v[140:143], v[80:95]
ds_read_b128 v[136:139], v7 offset:34816
s_waitcnt lgkmcnt(2)
v_mfma_f32_32x32x16_bf16 v[64:79], v[192:195], v[128:131], v[64:79]
v_mfma_f32_32x32x16_bf16 v[80:95], v[196:199], v[128:131], v[80:95]
ds_read_b128 v[140:143], v7 offset:35840
s_waitcnt lgkmcnt(2)
v_mfma_f32_32x32x16_bf16 v[64:79], v[200:203], v[132:135], v[64:79]
v_mfma_f32_32x32x16_bf16 v[80:95], v[204:207], v[132:135], v[80:95]
ds_read_b128 v[128:131], v7 offset:36864
s_waitcnt lgkmcnt(2)
v_mfma_f32_32x32x16_bf16 v[64:79], v[208:211], v[136:139], v[64:79]
v_mfma_f32_32x32x16_bf16 v[80:95], v[212:215], v[136:139], v[80:95]
ds_read_b128 v[132:135], v7 offset:37888
s_waitcnt lgkmcnt(2)
v_mfma_f32_32x32x16_bf16 v[64:79], v[216:219], v[140:143], v[64:79]
v_mfma_f32_32x32x16_bf16 v[80:95], v[220:223], v[140:143], v[80:95]
ds_read_b128 v[136:139], v7 offset:38912
s_waitcnt lgkmcnt(2)
v_mfma_f32_32x32x16_bf16 v[64:79], v[224:227], v[128:131], v[64:79]
v_mfma_f32_32x32x16_bf16 v[80:95], v[228:231], v[128:131], v[80:95]
ds_read_b128 v[140:143], v7 offset:39936
s_waitcnt lgkmcnt(2)
v_mfma_f32_32x32x16_bf16 v[64:79], v[232:235], v[132:135], v[64:79]
v_mfma_f32_32x32x16_bf16 v[80:95], v[236:239], v[132:135], v[80:95]
s_waitcnt lgkmcnt(1)
v_mfma_f32_32x32x16_bf16 v[64:79], v[240:243], v[136:139], v[64:79]
v_mfma_f32_32x32x16_bf16 v[80:95], v[244:247], v[136:139], v[80:95]
s_waitcnt lgkmcnt(0)
v_mfma_f32_32x32x16_bf16 v[64:79], v[248:251], v[140:143], v[64:79]
v_mfma_f32_32x32x16_bf16 v[80:95], v[252:255], v[140:143], v[80:95]
s_waitcnt vmcnt(10)
s_add_u32 s20, s20, 40960
s_cmp_ge_u32 s20, 122880
s_cselect_b32 s20, 0, s20
s_add_u32 s17, s17, 1
s_barrier
v_mul_f32 v8, v64, v64
v_mul_f32 v9, v65, v65
v_fma_f32 v8, v8, s25, v6
v_fma_f32 v9, v9, s25, v6
v_mul_f32 v8, v8, v64
v_mul_f32 v9, v9, v65
v_exp_f32 v8, v8
v_exp_f32 v9, v9
v_add_f32 v8, 1.0, v8
v_add_f32 v9, 1.0, v9
v_rcp_f32 v8, v8
v_rcp_f32 v9, v9
v_mul_f32 v64, v64, v8
v_mul_f32 v65, v65, v9
v_mul_f32 v10, v66, v66
v_mul_f32 v11, v67, v67
v_fma_f32 v10, v10, s25, v6
v_fma_f32 v11, v11, s25, v6
v_mul_f32 v10, v10, v66
v_mul_f32 v11, v11, v67
v_exp_f32 v10, v10
v_exp_f32 v11, v11
v_add_f32 v10, 1.0, v10
v_add_f32 v11, 1.0, v11
v_rcp_f32 v10, v10
v_rcp_f32 v11, v11
v_mul_f32 v66, v66, v10
v_mul_f32 v67, v67, v11
v_mul_f32 v8, v68, v68
v_mul_f32 v9, v69, v69
v_fma_f32 v8, v8, s25, v6
v_fma_f32 v9, v9, s25, v6
v_mul_f32 v8, v8, v68
v_mul_f32 v9, v9, v69
v_exp_f32 v8, v8
v_exp_f32 v9, v9
v_add_f32 v8, 1.0, v8
v_add_f32 v9, 1.0, v9
v_rcp_f32 v8, v8
v_rcp_f32 v9, v9
v_mul_f32 v68, v68, v8
v_mul_f32 v69, v69, v9
v_mul_f32 v10, v70, v70
v_mul_f32 v11, v71, v71
v_fma_f32 v10, v10, s25, v6
v_fma_f32 v11, v11, s25, v6
v_mul_f32 v10, v10, v70
v_mul_f32 v11, v11, v71
v_exp_f32 v10, v10
v_exp_f32 v11, v11
v_add_f32 v10, 1.0, v10
v_add_f32 v11, 1.0, v11
v_rcp_f32 v10, v10
v_rcp_f32 v11, v11
v_mul_f32 v70, v70, v10
v_mul_f32 v71, v71, v11
v_mul_f32 v8, v72, v72
v_mul_f32 v9, v73, v73
v_fma_f32 v8, v8, s25, v6
v_fma_f32 v9, v9, s25, v6
v_mul_f32 v8, v8, v72
v_mul_f32 v9, v9, v73
v_exp_f32 v8, v8
v_exp_f32 v9, v9
v_add_f32 v8, 1.0, v8
v_add_f32 v9, 1.0, v9
v_rcp_f32 v8, v8
v_rcp_f32 v9, v9
v_mul_f32 v72, v72, v8
v_mul_f32 v73, v73, v9
v_mul_f32 v10, v74, v74
v_mul_f32 v11, v75, v75
v_fma_f32 v10, v10, s25, v6
v_fma_f32 v11, v11, s25, v6
v_mul_f32 v10, v10, v74
v_mul_f32 v11, v11, v75
v_exp_f32 v10, v10
v_exp_f32 v11, v11
v_add_f32 v10, 1.0, v10
v_add_f32 v11, 1.0, v11
v_rcp_f32 v10, v10
v_rcp_f32 v11, v11
v_mul_f32 v74, v74, v10
v_mul_f32 v75, v75, v11
v_mul_f32 v8, v76, v76
v_mul_f32 v9, v77, v77
v_fma_f32 v8, v8, s25, v6
v_fma_f32 v9, v9, s25, v6
v_mul_f32 v8, v8, v76
v_mul_f32 v9, v9, v77
v_exp_f32 v8, v8
v_exp_f32 v9, v9
v_add_f32 v8, 1.0, v8
v_add_f32 v9, 1.0, v9
v_rcp_f32 v8, v8
v_rcp_f32 v9, v9
v_mul_f32 v76, v76, v8
v_mul_f32 v77, v77, v9
v_mul_f32 v10, v78, v78
v_mul_f32 v11, v79, v79
v_fma_f32 v10, v10, s25, v6
v_fma_f32 v11, v11, s25, v6
v_mul_f32 v10, v10, v78
v_mul_f32 v11, v11, v79
v_exp_f32 v10, v10
v_exp_f32 v11, v11
v_add_f32 v10, 1.0, v10
v_add_f32 v11, 1.0, v11
v_rcp_f32 v10, v10
v_rcp_f32 v11, v11
v_mul_f32 v78, v78, v10
v_mul_f32 v79, v79, v11
v_cvt_pk_bf16_f32 v144, v64, v65
v_cvt_pk_bf16_f32 v145, v66, v67
v_cvt_pk_bf16_f32 v146, v68, v69
v_cvt_pk_bf16_f32 v147, v70, v71
buffer_store_dwordx4 v[144:147], v1, s[4:7], s18 offen offset:0 sc1
v_cvt_pk_bf16_f32 v148, v72, v73
v_cvt_pk_bf16_f32 v149, v74, v75
v_cvt_pk_bf16_f32 v150, v76, v77
v_cvt_pk_bf16_f32 v151, v78, v79
buffer_store_dwordx4 v[148:151], v1, s[4:7], s18 offen offset:1024 sc1
v_mul_f32 v8, v80, v80
v_mul_f32 v9, v81, v81
v_fma_f32 v8, v8, s25, v6
v_fma_f32 v9, v9, s25, v6
v_mul_f32 v8, v8, v80
v_mul_f32 v9, v9, v81
v_exp_f32 v8, v8
v_exp_f32 v9, v9
v_add_f32 v8, 1.0, v8
v_add_f32 v9, 1.0, v9
v_rcp_f32 v8, v8
v_rcp_f32 v9, v9
v_mul_f32 v80, v80, v8
v_mul_f32 v81, v81, v9
v_mul_f32 v10, v82, v82
v_mul_f32 v11, v83, v83
v_fma_f32 v10, v10, s25, v6
v_fma_f32 v11, v11, s25, v6
v_mul_f32 v10, v10, v82
v_mul_f32 v11, v11, v83
v_exp_f32 v10, v10
v_exp_f32 v11, v11
v_add_f32 v10, 1.0, v10
v_add_f32 v11, 1.0, v11
v_rcp_f32 v10, v10
v_rcp_f32 v11, v11
v_mul_f32 v82, v82, v10
v_mul_f32 v83, v83, v11
v_mul_f32 v8, v84, v84
v_mul_f32 v9, v85, v85
v_fma_f32 v8, v8, s25, v6
v_fma_f32 v9, v9, s25, v6
v_mul_f32 v8, v8, v84
v_mul_f32 v9, v9, v85
v_exp_f32 v8, v8
v_exp_f32 v9, v9
v_add_f32 v8, 1.0, v8
v_add_f32 v9, 1.0, v9
v_rcp_f32 v8, v8
v_rcp_f32 v9, v9
v_mul_f32 v84, v84, v8
v_mul_f32 v85, v85, v9
v_mul_f32 v10, v86, v86
v_mul_f32 v11, v87, v87
v_fma_f32 v10, v10, s25, v6
v_fma_f32 v11, v11, s25, v6
v_mul_f32 v10, v10, v86
v_mul_f32 v11, v11, v87
v_exp_f32 v10, v10
v_exp_f32 v11, v11
v_add_f32 v10, 1.0, v10
v_add_f32 v11, 1.0, v11
v_rcp_f32 v10, v10
v_rcp_f32 v11, v11
v_mul_f32 v86, v86, v10
v_mul_f32 v87, v87, v11
v_mul_f32 v8, v88, v88
v_mul_f32 v9, v89, v89
v_fma_f32 v8, v8, s25, v6
v_fma_f32 v9, v9, s25, v6
v_mul_f32 v8, v8, v88
v_mul_f32 v9, v9, v89
v_exp_f32 v8, v8
v_exp_f32 v9, v9
v_add_f32 v8, 1.0, v8
v_add_f32 v9, 1.0, v9
v_rcp_f32 v8, v8
v_rcp_f32 v9, v9
v_mul_f32 v88, v88, v8
v_mul_f32 v89, v89, v9
v_mul_f32 v10, v90, v90
v_mul_f32 v11, v91, v91
v_fma_f32 v10, v10, s25, v6
v_fma_f32 v11, v11, s25, v6
v_mul_f32 v10, v10, v90
v_mul_f32 v11, v11, v91
v_exp_f32 v10, v10
v_exp_f32 v11, v11
v_add_f32 v10, 1.0, v10
v_add_f32 v11, 1.0, v11
v_rcp_f32 v10, v10
v_rcp_f32 v11, v11
v_mul_f32 v90, v90, v10
v_mul_f32 v91, v91, v11
v_mul_f32 v8, v92, v92
v_mul_f32 v9, v93, v93
v_fma_f32 v8, v8, s25, v6
v_fma_f32 v9, v9, s25, v6
v_mul_f32 v8, v8, v92
v_mul_f32 v9, v9, v93
v_exp_f32 v8, v8
v_exp_f32 v9, v9
v_add_f32 v8, 1.0, v8
v_add_f32 v9, 1.0, v9
v_rcp_f32 v8, v8
v_rcp_f32 v9, v9
v_mul_f32 v92, v92, v8
v_mul_f32 v93, v93, v9
v_mul_f32 v10, v94, v94
v_mul_f32 v11, v95, v95
v_fma_f32 v10, v10, s25, v6
v_fma_f32 v11, v11, s25, v6
v_mul_f32 v10, v10, v94
v_mul_f32 v11, v11, v95
v_exp_f32 v10, v10
v_exp_f32 v11, v11
v_add_f32 v10, 1.0, v10
v_add_f32 v11, 1.0, v11
v_rcp_f32 v10, v10
v_rcp_f32 v11, v11
v_mul_f32 v94, v94, v10
v_mul_f32 v95, v95, v11
v_cvt_pk_bf16_f32 v152, v80, v81
v_cvt_pk_bf16_f32 v153, v82, v83
v_cvt_pk_bf16_f32 v154, v84, v85
v_cvt_pk_bf16_f32 v155, v86, v87
buffer_store_dwordx4 v[152:155], v1, s[4:7], s18 offen offset:2048 sc1
v_cvt_pk_bf16_f32 v156, v88, v89
v_cvt_pk_bf16_f32 v157, v90, v91
v_cvt_pk_bf16_f32 v158, v92, v93
v_cvt_pk_bf16_f32 v159, v94, v95
buffer_store_dwordx4 v[156:159], v1, s[4:7], s18 offen offset:3072 sc1
s_add_u32 s18, s18, 114688
s_waitcnt vmcnt(0)
v_mov_b32 v4, s17
s_mov_b64 exec, 1
buffer_store_dword v4, off, s[4:7], s19 sc1
s_mov_b64 exec, -1
v_add_u32 v7, s20, v1
s_add_u32 s39, s17, 2
s_min_u32 s39, s39, s27
s_add_u32 s26, s20, 81920
s_cmp_ge_u32 s26, 122880
s_cselect_b32 s35, 122880, 0
s_sub_u32 s26, s26, s35
ds_read_b128 v[128:131], v7 offset:0
ds_read_b128 v[132:135], v7 offset:1024
ds_read_b128 v[136:139], v7 offset:2048
s_mul_i32 s36, s39, 1
s_add_u32 s36, s36, s16
s_mul_i32 s36, s36, 40960
s_add_u32 s36, s36, s22
s_add_u32 s36, s36, 109051904
s_add_u32 s37, s26, s22
s_waitcnt lgkmcnt(2)
v_mfma_f32_32x32x16_bf16 v[96:111], a[0:3], v[128:131], v[160:175]
v_mfma_f32_32x32x16_bf16 v[112:127], a[4:7], v[128:131], v[176:191]
ds_read_b128 v[140:143], v7 offset:3072
s_waitcnt lgkmcnt(2)
v_mfma_f32_32x32x16_bf16 v[96:111], a[8:11], v[132:135], v[96:111]
s_add_u32 m0, s37, 0
s_add_u32 s35, s36, 0
buffer_load_dwordx4 v1, s[4:7], s35 offen sc1 lds
v_mfma_f32_32x32x16_bf16 v[112:127], a[12:15], v[132:135], v[112:127]
ds_read_b128 v[128:131], v7 offset:4096
s_add_u32 m0, s37, 1024
s_add_u32 s35, s36, 1024
buffer_load_dwordx4 v1, s[4:7], s35 offen sc1 lds
s_waitcnt lgkmcnt(2)
v_mfma_f32_32x32x16_bf16 v[96:111], a[16:19], v[136:139], v[96:111]
s_add_u32 m0, s37, 2048
s_add_u32 s35, s36, 2048
buffer_load_dwordx4 v1, s[4:7], s35 offen sc1 lds
v_mfma_f32_32x32x16_bf16 v[112:127], a[20:23], v[136:139], v[112:127]
ds_read_b128 v[132:135], v7 offset:5120
s_add_u32 m0, s37, 3072
s_add_u32 s35, s36, 3072
buffer_load_dwordx4 v1, s[4:7], s35 offen sc1 lds
s_waitcnt lgkmcnt(2)
v_mfma_f32_32x32x16_bf16 v[96:111], a[24:27], v[140:143], v[96:111]
s_add_u32 m0, s37, 4096
s_add_u32 s35, s36, 4096
buffer_load_dwordx4 v1, s[4:7], s35 offen sc1 lds
v_mfma_f32_32x32x16_bf16 v[112:127], a[28:31], v[140:143], v[112:127]
ds_read_b128 v[136:139], v7 offset:6144
s_add_u32 m0, s37, 5120
s_add_u32 s35, s36, 5120
buffer_load_dwordx4 v1, s[4:7], s35 offen sc1 lds
s_waitcnt lgkmcnt(2)
v_mfma_f32_32x32x16_bf16 v[96:111], a[32:35], v[128:131], v[96:111]
s_add_u32 m0, s37, 6144
s_add_u32 s35, s36, 6144
buffer_load_dwordx4 v1, s[4:7], s35 offen sc1 lds
v_mfma_f32_32x32x16_bf16 v[112:127], a[36:39], v[128:131], v[112:127]
ds_read_b128 v[140:143], v7 offset:7168
s_add_u32 m0, s37, 7168
s_add_u32 s35, s36, 7168
buffer_load_dwordx4 v1, s[4:7], s35 offen sc1 lds
s_waitcnt lgkmcnt(2)
v_mfma_f32_32x32x16_bf16 v[96:111], a[40:43], v[132:135], v[96:111]
s_add_u32 m0, s37, 8192
s_add_u32 s35, s36, 8192
buffer_load_dwordx4 v1, s[4:7], s35 offen sc1 lds
v_mfma_f32_32x32x16_bf16 v[112:127], a[44:47], v[132:135], v[112:127]
ds_read_b128 v[128:131], v7 offset:8192
s_add_u32 m0, s37, 9216
s_add_u32 s35, s36, 9216
buffer_load_dwordx4 v1, s[4:7], s35 offen sc1 lds
s_waitcnt lgkmcnt(2)
v_mfma_f32_32x32x16_bf16 v[96:111], a[48:51], v[136:139], v[96:111]
v_mfma_f32_32x32x16_bf16 v[112:127], a[52:55], v[136:139], v[112:127]
ds_read_b128 v[132:135], v7 offset:9216
s_waitcnt lgkmcnt(2)
v_mfma_f32_32x32x16_bf16 v[96:111], a[56:59], v[140:143], v[96:111]
v_mfma_f32_32x32x16_bf16 v[112:127], a[60:63], v[140:143], v[112:127]
ds_read_b128 v[136:139], v7 offset:10240
s_waitcnt lgkmcnt(2)
v_mfma_f32_32x32x16_bf16 v[96:111], a[64:67], v[128:131], v[96:111]
v_mfma_f32_32x32x16_bf16 v[112:127], a[68:71], v[128:131], v[112:127]
ds_read_b128 v[140:143], v7 offset:11264
s_waitcnt lgkmcnt(2)
v_mfma_f32_32x32x16_bf16 v[96:111], a[72:75], v[132:135], v[96:111]
v_mfma_f32_32x32x16_bf16 v[112:127], a[76:79], v[132:135], v[112:127]
ds_read_b128 v[128:131], v7 offset:12288
s_waitcnt lgkmcnt(2)
v_mfma_f32_32x32x16_bf16 v[96:111], a[80:83], v[136:139], v[96:111]
v_mfma_f32_32x32x16_bf16 v[112:127], a[84:87], v[136:139], v[112:127]
ds_read_b128 v[132:135], v7 offset:13312
s_waitcnt lgkmcnt(2)
v_mfma_f32_32x32x16_bf16 v[96:111], a[88:91], v[140:143], v[96:111]
v_mfma_f32_32x32x16_bf16 v[112:127], a[92:95], v[140:143], v[112:127]
ds_read_b128 v[136:139], v7 offset:14336
s_waitcnt lgkmcnt(2)
v_mfma_f32_32x32x16_bf16 v[96:111], a[96:99], v[128:131], v[96:111]
v_mfma_f32_32x32x16_bf16 v[112:127], a[100:103], v[128:131], v[112:127]
ds_read_b128 v[140:143], v7 offset:15360
s_waitcnt lgkmcnt(2)
v_mfma_f32_32x32x16_bf16 v[96:111], a[104:107], v[132:135], v[96:111]
v_mfma_f32_32x32x16_bf16 v[112:127], a[108:111], v[132:135], v[112:127]
ds_read_b128 v[128:131], v7 offset:16384
s_waitcnt lgkmcnt(2)
v_mfma_f32_32x32x16_bf16 v[96:111], a[112:115], v[136:139], v[96:111]
v_mfma_f32_32x32x16_bf16 v[112:127], a[116:119], v[136:139], v[112:127]
ds_read_b128 v[132:135], v7 offset:17408
s_waitcnt lgkmcnt(2)
v_mfma_f32_32x32x16_bf16 v[96:111], a[120:123], v[140:143], v[96:111]
v_mfma_f32_32x32x16_bf16 v[112:127], a[124:127], v[140:143], v[112:127]
ds_read_b128 v[136:139], v7 offset:18432
s_waitcnt lgkmcnt(2)
v_mfma_f32_32x32x16_bf16 v[96:111], a[128:131], v[128:131], v[96:111]
v_mfma_f32_32x32x16_bf16 v[112:127], a[132:135], v[128:131], v[112:127]
ds_read_b128 v[140:143], v7 offset:19456
s_waitcnt lgkmcnt(2)
v_mfma_f32_32x32x16_bf16 v[96:111], a[136:139], v[132:135], v[96:111]
v_mfma_f32_32x32x16_bf16 v[112:127], a[140:143], v[132:135], v[112:127]
ds_read_b128 v[128:131], v7 offset:20480
s_waitcnt lgkmcnt(2)
v_mfma_f32_32x32x16_bf16 v[96:111], a[144:147], v[136:139], v[96:111]
v_mfma_f32_32x32x16_bf16 v[112:127], a[148:151], v[136:139], v[112:127]
ds_read_b128 v[132:135], v7 offset:21504
s_waitcnt lgkmcnt(2)
v_mfma_f32_32x32x16_bf16 v[96:111], a[152:155], v[140:143], v[96:111]
v_mfma_f32_32x32x16_bf16 v[112:127], a[156:159], v[140:143], v[112:127]
ds_read_b128 v[136:139], v7 offset:22528
s_waitcnt lgkmcnt(2)
v_mfma_f32_32x32x16_bf16 v[96:111], a[160:163], v[128:131], v[96:111]
v_mfma_f32_32x32x16_bf16 v[112:127], a[164:167], v[128:131], v[112:127]
ds_read_b128 v[140:143], v7 offset:23552
s_waitcnt lgkmcnt(2)
v_mfma_f32_32x32x16_bf16 v[96:111], a[168:171], v[132:135], v[96:111]
v_mfma_f32_32x32x16_bf16 v[112:127], a[172:175], v[132:135], v[112:127]
ds_read_b128 v[128:131], v7 offset:24576
s_waitcnt lgkmcnt(2)
v_mfma_f32_32x32x16_bf16 v[96:111], a[176:179], v[136:139], v[96:111]
v_mfma_f32_32x32x16_bf16 v[112:127], a[180:183], v[136:139], v[112:127]
ds_read_b128 v[132:135], v7 offset:25600
s_waitcnt lgkmcnt(2)
v_mfma_f32_32x32x16_bf16 v[96:111], a[184:187], v[140:143], v[96:111]
v_mfma_f32_32x32x16_bf16 v[112:127], a[188:191], v[140:143], v[112:127]
ds_read_b128 v[136:139], v7 offset:26624
s_waitcnt lgkmcnt(2)
v_mfma_f32_32x32x16_bf16 v[96:111], a[192:195], v[128:131], v[96:111]
v_mfma_f32_32x32x16_bf16 v[112:127], a[196:199], v[128:131], v[112:127]
ds_read_b128 v[140:143], v7 offset:27648
s_waitcnt lgkmcnt(2)
v_mfma_f32_32x32x16_bf16 v[96:111], a[200:203], v[132:135], v[96:111]
v_mfma_f32_32x32x16_bf16 v[112:127], a[204:207], v[132:135], v[112:127]
ds_read_b128 v[128:131], v7 offset:28672
s_waitcnt lgkmcnt(2)
v_mfma_f32_32x32x16_bf16 v[96:111], a[208:211], v[136:139], v[96:111]
v_mfma_f32_32x32x16_bf16 v[112:127], a[212:215], v[136:139], v[112:127]
ds_read_b128 v[132:135], v7 offset:29696
s_waitcnt lgkmcnt(2)
v_mfma_f32_32x32x16_bf16 v[96:111], a[216:219], v[140:143], v[96:111]
v_mfma_f32_32x32x16_bf16 v[112:127], a[220:223], v[140:143], v[112:127]
ds_read_b128 v[136:139], v7 offset:30720
s_waitcnt lgkmcnt(2)
v_mfma_f32_32x32x16_bf16 v[96:111], a[224:227], v[128:131], v[96:111]
v_mfma_f32_32x32x16_bf16 v[112:127], a[228:231], v[128:131], v[112:127]
ds_read_b128 v[140:143], v7 offset:31744
s_waitcnt lgkmcnt(2)
v_mfma_f32_32x32x16_bf16 v[96:111], a[232:235], v[132:135], v[96:111]
v_mfma_f32_32x32x16_bf16 v[112:127], a[236:239], v[132:135], v[112:127]
ds_read_b128 v[128:131], v7 offset:32768
s_waitcnt lgkmcnt(2)
v_mfma_f32_32x32x16_bf16 v[96:111], a[240:243], v[136:139], v[96:111]
v_mfma_f32_32x32x16_bf16 v[112:127], a[244:247], v[136:139], v[112:127]
ds_read_b128 v[132:135], v7 offset:33792
s_waitcnt lgkmcnt(2)
v_mfma_f32_32x32x16_bf16 v[96:111], a[248:251], v[140:143], v[96:111]
v_mfma_f32_32x32x16_bf16 v[112:127], a[252:255], v[140:143], v[112:127]
ds_read_b128 v[136:139], v7 offset:34816
s_waitcnt lgkmcnt(2)
v_mfma_f32_32x32x16_bf16 v[96:111], v[192:195], v[128:131], v[96:111]
v_mfma_f32_32x32x16_bf16 v[112:127], v[196:199], v[128:131], v[112:127]
ds_read_b128 v[140:143], v7 offset:35840
s_waitcnt lgkmcnt(2)
v_mfma_f32_32x32x16_bf16 v[96:111], v[200:203], v[132:135], v[96:111]
v_mfma_f32_32x32x16_bf16 v[112:127], v[204:207], v[132:135], v[112:127]
ds_read_b128 v[128:131], v7 offset:36864
s_waitcnt lgkmcnt(2)
v_mfma_f32_32x32x16_bf16 v[96:111], v[208:211], v[136:139], v[96:111]
v_mfma_f32_32x32x16_bf16 v[112:127], v[212:215], v[136:139], v[112:127]
ds_read_b128 v[132:135], v7 offset:37888
s_waitcnt lgkmcnt(2)
v_mfma_f32_32x32x16_bf16 v[96:111], v[216:219], v[140:143], v[96:111]
v_mfma_f32_32x32x16_bf16 v[112:127], v[220:223], v[140:143], v[112:127]
ds_read_b128 v[136:139], v7 offset:38912
s_waitcnt lgkmcnt(2)
v_mfma_f32_32x32x16_bf16 v[96:111], v[224:227], v[128:131], v[96:111]
v_mfma_f32_32x32x16_bf16 v[112:127], v[228:231], v[128:131], v[112:127]
ds_read_b128 v[140:143], v7 offset:39936
s_waitcnt lgkmcnt(2)
v_mfma_f32_32x32x16_bf16 v[96:111], v[232:235], v[132:135], v[96:111]
v_mfma_f32_32x32x16_bf16 v[112:127], v[236:239], v[132:135], v[112:127]
s_waitcnt lgkmcnt(1)
v_mfma_f32_32x32x16_bf16 v[96:111], v[240:243], v[136:139], v[96:111]
v_mfma_f32_32x32x16_bf16 v[112:127], v[244:247], v[136:139], v[112:127]
s_waitcnt lgkmcnt(0)
v_mfma_f32_32x32x16_bf16 v[96:111], v[248:251], v[140:143], v[96:111]
v_mfma_f32_32x32x16_bf16 v[112:127], v[252:255], v[140:143], v[112:127]
s_waitcnt vmcnt(10)
s_add_u32 s20, s20, 40960
s_cmp_ge_u32 s20, 122880
s_cselect_b32 s20, 0, s20
s_add_u32 s17, s17, 1
s_barrier
L_h_loop:
v_add_u32 v7, s20, v1
s_add_u32 s39, s17, 2
s_min_u32 s39, s39, s27
s_add_u32 s26, s20, 81920
s_cmp_ge_u32 s26, 122880
s_cselect_b32 s35, 122880, 0
s_sub_u32 s26, s26, s35
ds_read_b128 v[128:131], v7 offset:0
ds_read_b128 v[132:135], v7 offset:1024
ds_read_b128 v[136:139], v7 offset:2048
s_mul_i32 s36, s39, 1
s_add_u32 s36, s36, s16
s_mul_i32 s36, s36, 40960
s_add_u32 s36, s36, s22
s_add_u32 s36, s36, 109051904
s_add_u32 s37, s26, s22
s_waitcnt lgkmcnt(2)
v_mfma_f32_32x32x16_bf16 v[64:79], a[0:3], v[128:131], v[160:175]
v_mfma_f32_32x32x16_bf16 v[80:95], a[4:7], v[128:131], v[176:191]
ds_read_b128 v[140:143], v7 offset:3072
s_waitcnt lgkmcnt(2)
v_mfma_f32_32x32x16_bf16 v[64:79], a[8:11], v[132:135], v[64:79]
v_mul_f32 v8, v96, v96
v_mul_f32 v9, v97, v97
v_fma_f32 v8, v8, s25, v6
v_fma_f32 v9, v9, s25, v6
v_mfma_f32_32x32x16_bf16 v[80:95], a[12:15], v[132:135], v[80:95]
ds_read_b128 v[128:131], v7 offset:4096
v_mul_f32 v8, v8, v96
v_mul_f32 v9, v9, v97
v_exp_f32 v8, v8
v_exp_f32 v9, v9
s_waitcnt lgkmcnt(2)
v_mfma_f32_32x32x16_bf16 v[64:79], a[16:19], v[136:139], v[64:79]
v_add_f32 v8, 1.0, v8
v_add_f32 v9, 1.0, v9
v_rcp_f32 v8, v8
v_rcp_f32 v9, v9
v_mfma_f32_32x32x16_bf16 v[80:95], a[20:23], v[136:139], v[80:95]
ds_read_b128 v[132:135], v7 offset:5120
v_mul_f32 v96, v96, v8
v_mul_f32 v97, v97, v9
v_mul_f32 v10, v98, v98
v_mul_f32 v11, v99, v99
s_waitcnt lgkmcnt(2)
v_mfma_f32_32x32x16_bf16 v[64:79], a[24:27], v[140:143], v[64:79]
v_fma_f32 v10, v10, s25, v6
v_fma_f32 v11, v11, s25, v6
v_mul_f32 v10, v10, v98
v_mul_f32 v11, v11, v99
v_mfma_f32_32x32x16_bf16 v[80:95], a[28:31], v[140:143], v[80:95]
ds_read_b128 v[136:139], v7 offset:6144
v_exp_f32 v10, v10
v_exp_f32 v11, v11
v_add_f32 v10, 1.0, v10
v_add_f32 v11, 1.0, v11
s_waitcnt lgkmcnt(2)
v_mfma_f32_32x32x16_bf16 v[64:79], a[32:35], v[128:131], v[64:79]
v_rcp_f32 v10, v10
v_rcp_f32 v11, v11
v_mul_f32 v98, v98, v10
v_mul_f32 v99, v99, v11
v_mfma_f32_32x32x16_bf16 v[80:95], a[36:39], v[128:131], v[80:95]
ds_read_b128 v[140:143], v7 offset:7168
v_mul_f32 v8, v100, v100
v_mul_f32 v9, v101, v101
v_fma_f32 v8, v8, s25, v6
v_fma_f32 v9, v9, s25, v6
s_waitcnt lgkmcnt(2)
v_mfma_f32_32x32x16_bf16 v[64:79], a[40:43], v[132:135], v[64:79]
v_mul_f32 v8, v8, v100
v_mul_f32 v9, v9, v101
v_exp_f32 v8, v8
v_exp_f32 v9, v9
v_mfma_f32_32x32x16_bf16 v[80:95], a[44:47], v[132:135], v[80:95]
ds_read_b128 v[128:131], v7 offset:8192
v_add_f32 v8, 1.0, v8
v_add_f32 v9, 1.0, v9
v_rcp_f32 v8, v8
v_rcp_f32 v9, v9
s_waitcnt lgkmcnt(2)
v_mfma_f32_32x32x16_bf16 v[64:79], a[48:51], v[136:139], v[64:79]
v_mul_f32 v100, v100, v8
v_mul_f32 v101, v101, v9
v_mul_f32 v10, v102, v102
v_mul_f32 v11, v103, v103
v_mfma_f32_32x32x16_bf16 v[80:95], a[52:55], v[136:139], v[80:95]
ds_read_b128 v[132:135], v7 offset:9216
v_fma_f32 v10, v10, s25, v6
v_fma_f32 v11, v11, s25, v6
v_mul_f32 v10, v10, v102
v_mul_f32 v11, v11, v103
s_waitcnt lgkmcnt(2)
v_mfma_f32_32x32x16_bf16 v[64:79], a[56:59], v[140:143], v[64:79]
v_exp_f32 v10, v10
v_exp_f32 v11, v11
v_add_f32 v10, 1.0, v10
v_add_f32 v11, 1.0, v11
v_mfma_f32_32x32x16_bf16 v[80:95], a[60:63], v[140:143], v[80:95]
ds_read_b128 v[136:139], v7 offset:10240
v_rcp_f32 v10, v10
v_rcp_f32 v11, v11
v_mul_f32 v102, v102, v10
v_mul_f32 v103, v103, v11
s_waitcnt lgkmcnt(2)
v_mfma_f32_32x32x16_bf16 v[64:79], a[64:67], v[128:131], v[64:79]
v_mul_f32 v8, v104, v104
v_mul_f32 v9, v105, v105
v_fma_f32 v8, v8, s25, v6
v_fma_f32 v9, v9, s25, v6
v_mfma_f32_32x32x16_bf16 v[80:95], a[68:71], v[128:131], v[80:95]
ds_read_b128 v[140:143], v7 offset:11264
v_mul_f32 v8, v8, v104
v_mul_f32 v9, v9, v105
v_exp_f32 v8, v8
v_exp_f32 v9, v9
s_waitcnt lgkmcnt(2)
v_mfma_f32_32x32x16_bf16 v[64:79], a[72:75], v[132:135], v[64:79]
v_add_f32 v8, 1.0, v8
v_add_f32 v9, 1.0, v9
v_rcp_f32 v8, v8
v_rcp_f32 v9, v9
v_mfma_f32_32x32x16_bf16 v[80:95], a[76:79], v[132:135], v[80:95]
ds_read_b128 v[128:131], v7 offset:12288
v_mul_f32 v104, v104, v8
v_mul_f32 v105, v105, v9
v_mul_f32 v10, v106, v106
v_mul_f32 v11, v107, v107
s_waitcnt lgkmcnt(2)
v_mfma_f32_32x32x16_bf16 v[64:79], a[80:83], v[136:139], v[64:79]
v_fma_f32 v10, v10, s25, v6
v_fma_f32 v11, v11, s25, v6
v_mul_f32 v10, v10, v106
v_mul_f32 v11, v11, v107
v_mfma_f32_32x32x16_bf16 v[80:95], a[84:87], v[136:139], v[80:95]
ds_read_b128 v[132:135], v7 offset:13312
v_exp_f32 v10, v10
v_exp_f32 v11, v11
v_add_f32 v10, 1.0, v10
v_add_f32 v11, 1.0, v11
s_waitcnt lgkmcnt(2)
v_mfma_f32_32x32x16_bf16 v[64:79], a[88:91], v[140:143], v[64:79]
v_rcp_f32 v10, v10
v_rcp_f32 v11, v11
v_mul_f32 v106, v106, v10
v_mul_f32 v107, v107, v11
v_mfma_f32_32x32x16_bf16 v[80:95], a[92:95], v[140:143], v[80:95]
ds_read_b128 v[136:139], v7 offset:14336
v_mul_f32 v8, v108, v108
v_mul_f32 v9, v109, v109
v_fma_f32 v8, v8, s25, v6
v_fma_f32 v9, v9, s25, v6
s_waitcnt lgkmcnt(2)
v_mfma_f32_32x32x16_bf16 v[64:79], a[96:99], v[128:131], v[64:79]
v_mul_f32 v8, v8, v108
v_mul_f32 v9, v9, v109
v_exp_f32 v8, v8
v_exp_f32 v9, v9
v_mfma_f32_32x32x16_bf16 v[80:95], a[100:103], v[128:131], v[80:95]
ds_read_b128 v[140:143], v7 offset:15360
v_add_f32 v8, 1.0, v8
v_add_f32 v9, 1.0, v9
v_rcp_f32 v8, v8
v_rcp_f32 v9, v9
s_waitcnt lgkmcnt(2)
v_mfma_f32_32x32x16_bf16 v[64:79], a[104:107], v[132:135], v[64:79]
v_mul_f32 v108, v108, v8
v_mul_f32 v109, v109, v9
v_mul_f32 v10, v110, v110
v_mul_f32 v11, v111, v111
v_mfma_f32_32x32x16_bf16 v[80:95], a[108:111], v[132:135], v[80:95]
ds_read_b128 v[128:131], v7 offset:16384
v_fma_f32 v10, v10, s25, v6
v_fma_f32 v11, v11, s25, v6
v_mul_f32 v10, v10, v110
v_mul_f32 v11, v11, v111
s_waitcnt lgkmcnt(2)
v_mfma_f32_32x32x16_bf16 v[64:79], a[112:115], v[136:139], v[64:79]
v_exp_f32 v10, v10
v_exp_f32 v11, v11
v_add_f32 v10, 1.0, v10
v_add_f32 v11, 1.0, v11
v_mfma_f32_32x32x16_bf16 v[80:95], a[116:119], v[136:139], v[80:95]
ds_read_b128 v[132:135], v7 offset:17408
v_rcp_f32 v10, v10
v_rcp_f32 v11, v11
v_mul_f32 v110, v110, v10
v_mul_f32 v111, v111, v11
s_waitcnt lgkmcnt(2)
v_mfma_f32_32x32x16_bf16 v[64:79], a[120:123], v[140:143], v[64:79]
v_cvt_pk_bf16_f32 v144, v96, v97
v_cvt_pk_bf16_f32 v145, v98, v99
v_cvt_pk_bf16_f32 v146, v100, v101
v_cvt_pk_bf16_f32 v147, v102, v103
v_mfma_f32_32x32x16_bf16 v[80:95], a[124:127], v[140:143], v[80:95]
ds_read_b128 v[136:139], v7 offset:18432
buffer_store_dwordx4 v[144:147], v1, s[4:7], s18 offen offset:0 sc1
v_cvt_pk_bf16_f32 v148, v104, v105
v_cvt_pk_bf16_f32 v149, v106, v107
v_cvt_pk_bf16_f32 v150, v108, v109
s_waitcnt lgkmcnt(2)
v_mfma_f32_32x32x16_bf16 v[64:79], a[128:131], v[128:131], v[64:79]
v_cvt_pk_bf16_f32 v151, v110, v111
buffer_store_dwordx4 v[148:151], v1, s[4:7], s18 offen offset:1024 sc1
v_mul_f32 v8, v112, v112
v_mul_f32 v9, v113, v113
v_mfma_f32_32x32x16_bf16 v[80:95], a[132:135], v[128:131], v[80:95]
ds_read_b128 v[140:143], v7 offset:19456
v_fma_f32 v8, v8, s25, v6
v_fma_f32 v9, v9, s25, v6
v_mul_f32 v8, v8, v112
v_mul_f32 v9, v9, v113
s_waitcnt lgkmcnt(2)
v_mfma_f32_32x32x16_bf16 v[64:79], a[136:139], v[132:135], v[64:79]
v_exp_f32 v8, v8
v_exp_f32 v9, v9
v_add_f32 v8, 1.0, v8
v_add_f32 v9, 1.0, v9
v_mfma_f32_32x32x16_bf16 v[80:95], a[140:143], v[132:135], v[80:95]
ds_read_b128 v[128:131], v7 offset:20480
v_rcp_f32 v8, v8
v_rcp_f32 v9, v9
v_mul_f32 v112, v112, v8
v_mul_f32 v113, v113, v9
s_waitcnt lgkmcnt(2)
v_mfma_f32_32x32x16_bf16 v[64:79], a[144:147], v[136:139], v[64:79]
v_mul_f32 v10, v114, v114
v_mul_f32 v11, v115, v115
v_fma_f32 v10, v10, s25, v6
v_fma_f32 v11, v11, s25, v6
v_mfma_f32_32x32x16_bf16 v[80:95], a[148:151], v[136:139], v[80:95]
ds_read_b128 v[132:135], v7 offset:21504
v_mul_f32 v10, v10, v114
v_mul_f32 v11, v11, v115
v_exp_f32 v10, v10
v_exp_f32 v11, v11
s_waitcnt lgkmcnt(2)
v_mfma_f32_32x32x16_bf16 v[64:79], a[152:155], v[140:143], v[64:79]
v_add_f32 v10, 1.0, v10
v_add_f32 v11, 1.0, v11
v_rcp_f32 v10, v10
v_rcp_f32 v11, v11
v_mfma_f32_32x32x16_bf16 v[80:95], a[156:159], v[140:143], v[80:95]
ds_read_b128 v[136:139], v7 offset:22528
v_mul_f32 v114, v114, v10
v_mul_f32 v115, v115, v11
v_mul_f32 v8, v116, v116
v_mul_f32 v9, v117, v117
s_waitcnt lgkmcnt(2)
v_mfma_f32_32x32x16_bf16 v[64:79], a[160:163], v[128:131], v[64:79]
v_fma_f32 v8, v8, s25, v6
v_fma_f32 v9, v9, s25, v6
v_mul_f32 v8, v8, v116
v_mul_f32 v9, v9, v117
v_mfma_f32_32x32x16_bf16 v[80:95], a[164:167], v[128:131], v[80:95]
ds_read_b128 v[140:143], v7 offset:23552
v_exp_f32 v8, v8
v_exp_f32 v9, v9
v_add_f32 v8, 1.0, v8
v_add_f32 v9, 1.0, v9
s_waitcnt lgkmcnt(2)
v_mfma_f32_32x32x16_bf16 v[64:79], a[168:171], v[132:135], v[64:79]
v_rcp_f32 v8, v8
v_rcp_f32 v9, v9
v_mul_f32 v116, v116, v8
v_mul_f32 v117, v117, v9
v_mfma_f32_32x32x16_bf16 v[80:95], a[172:175], v[132:135], v[80:95]
ds_read_b128 v[128:131], v7 offset:24576
v_mul_f32 v10, v118, v118
v_mul_f32 v11, v119, v119
v_fma_f32 v10, v10, s25, v6
v_fma_f32 v11, v11, s25, v6
s_waitcnt lgkmcnt(2)
v_mfma_f32_32x32x16_bf16 v[64:79], a[176:179], v[136:139], v[64:79]
v_mul_f32 v10, v10, v118
v_mul_f32 v11, v11, v119
v_exp_f32 v10, v10
v_exp_f32 v11, v11
v_mfma_f32_32x32x16_bf16 v[80:95], a[180:183], v[136:139], v[80:95]
ds_read_b128 v[132:135], v7 offset:25600
v_add_f32 v10, 1.0, v10
v_add_f32 v11, 1.0, v11
v_rcp_f32 v10, v10
v_rcp_f32 v11, v11
s_waitcnt lgkmcnt(2)
v_mfma_f32_32x32x16_bf16 v[64:79], a[184:187], v[140:143], v[64:79]
v_mul_f32 v118, v118, v10
v_mul_f32 v119, v119, v11
v_mul_f32 v8, v120, v120
v_mul_f32 v9, v121, v121
v_mfma_f32_32x32x16_bf16 v[80:95], a[188:191], v[140:143], v[80:95]
ds_read_b128 v[136:139], v7 offset:26624
v_fma_f32 v8, v8, s25, v6
v_fma_f32 v9, v9, s25, v6
v_mul_f32 v8, v8, v120
v_mul_f32 v9, v9, v121
s_waitcnt lgkmcnt(2)
v_mfma_f32_32x32x16_bf16 v[64:79], a[192:195], v[128:131], v[64:79]
v_exp_f32 v8, v8
v_exp_f32 v9, v9
v_add_f32 v8, 1.0, v8
v_add_f32 v9, 1.0, v9
v_mfma_f32_32x32x16_bf16 v[80:95], a[196:199], v[128:131], v[80:95]
ds_read_b128 v[140:143], v7 offset:27648
v_rcp_f32 v8, v8
v_rcp_f32 v9, v9
v_mul_f32 v120, v120, v8
v_mul_f32 v121, v121, v9
s_waitcnt lgkmcnt(2)
v_mfma_f32_32x32x16_bf16 v[64:79], a[200:203], v[132:135], v[64:79]
v_mul_f32 v10, v122, v122
v_mul_f32 v11, v123, v123
v_fma_f32 v10, v10, s25, v6
v_fma_f32 v11, v11, s25, v6
v_mfma_f32_32x32x16_bf16 v[80:95], a[204:207], v[132:135], v[80:95]
ds_read_b128 v[128:131], v7 offset:28672
v_mul_f32 v10, v10, v122
v_mul_f32 v11, v11, v123
v_exp_f32 v10, v10
v_exp_f32 v11, v11
s_waitcnt lgkmcnt(2)
v_mfma_f32_32x32x16_bf16 v[64:79], a[208:211], v[136:139], v[64:79]
v_add_f32 v10, 1.0, v10
v_add_f32 v11, 1.0, v11
v_rcp_f32 v10, v10
v_rcp_f32 v11, v11
v_mfma_f32_32x32x16_bf16 v[80:95], a[212:215], v[136:139], v[80:95]
ds_read_b128 v[132:135], v7 offset:29696
v_mul_f32 v122, v122, v10
v_mul_f32 v123, v123, v11
v_mul_f32 v8, v124, v124
v_mul_f32 v9, v125, v125
s_waitcnt lgkmcnt(2)
v_mfma_f32_32x32x16_bf16 v[64:79], a[216:219], v[140:143], v[64:79]
v_fma_f32 v8, v8, s25, v6
v_fma_f32 v9, v9, s25, v6
v_mul_f32 v8, v8, v124
v_mul_f32 v9, v9, v125
v_mfma_f32_32x32x16_bf16 v[80:95], a[220:223], v[140:143], v[80:95]
ds_read_b128 v[136:139], v7 offset:30720
v_exp_f32 v8, v8
v_exp_f32 v9, v9
v_add_f32 v8, 1.0, v8
v_add_f32 v9, 1.0, v9
s_waitcnt lgkmcnt(2)
v_mfma_f32_32x32x16_bf16 v[64:79], a[224:227], v[128:131], v[64:79]
v_rcp_f32 v8, v8
v_rcp_f32 v9, v9
v_mul_f32 v124, v124, v8
v_mul_f32 v125, v125, v9
v_mfma_f32_32x32x16_bf16 v[80:95], a[228:231], v[128:131], v[80:95]
ds_read_b128 v[140:143], v7 offset:31744
v_mul_f32 v10, v126, v126
v_mul_f32 v11, v127, v127
v_fma_f32 v10, v10, s25, v6
v_fma_f32 v11, v11, s25, v6
s_waitcnt lgkmcnt(2)
v_mfma_f32_32x32x16_bf16 v[64:79], a[232:235], v[132:135], v[64:79]
v_mul_f32 v10, v10, v126
v_mul_f32 v11, v11, v127
v_exp_f32 v10, v10
v_exp_f32 v11, v11
v_mfma_f32_32x32x16_bf16 v[80:95], a[236:239], v[132:135], v[80:95]
ds_read_b128 v[128:131], v7 offset:32768
v_add_f32 v10, 1.0, v10
v_add_f32 v11, 1.0, v11
v_rcp_f32 v10, v10
v_rcp_f32 v11, v11
s_waitcnt lgkmcnt(2)
v_mfma_f32_32x32x16_bf16 v[64:79], a[240:243], v[136:139], v[64:79]
v_mul_f32 v126, v126, v10
v_mul_f32 v127, v127, v11
v_cvt_pk_bf16_f32 v152, v112, v113
v_cvt_pk_bf16_f32 v153, v114, v115
v_mfma_f32_32x32x16_bf16 v[80:95], a[244:247], v[136:139], v[80:95]
ds_read_b128 v[132:135], v7 offset:33792
v_cvt_pk_bf16_f32 v154, v116, v117
v_cvt_pk_bf16_f32 v155, v118, v119
buffer_store_dwordx4 v[152:155], v1, s[4:7], s18 offen offset:2048 sc1
v_cvt_pk_bf16_f32 v156, v120, v121
s_waitcnt lgkmcnt(2)
v_mfma_f32_32x32x16_bf16 v[64:79], a[248:251], v[140:143], v[64:79]
v_cvt_pk_bf16_f32 v157, v122, v123
v_cvt_pk_bf16_f32 v158, v124, v125
v_cvt_pk_bf16_f32 v159, v126, v127
buffer_store_dwordx4 v[156:159], v1, s[4:7], s18 offen offset:3072 sc1
v_mfma_f32_32x32x16_bf16 v[80:95], a[252:255], v[140:143], v[80:95]
ds_read_b128 v[136:139], v7 offset:34816
s_add_u32 s18, s18, 114688
s_add_u32 m0, s37, 0
s_add_u32 s35, s36, 0
buffer_load_dwordx4 v1, s[4:7], s35 offen sc1 lds
s_add_u32 m0, s37, 1024
s_add_u32 s35, s36, 1024
buffer_load_dwordx4 v1, s[4:7], s35 offen sc1 lds
s_add_u32 m0, s37, 2048
s_add_u32 s35, s36, 2048
buffer_load_dwordx4 v1, s[4:7], s35 offen sc1 lds
s_waitcnt lgkmcnt(2)
v_mfma_f32_32x32x16_bf16 v[64:79], v[192:195], v[128:131], v[64:79]
s_add_u32 m0, s37, 3072
s_add_u32 s35, s36, 3072
buffer_load_dwordx4 v1, s[4:7], s35 offen sc1 lds
s_add_u32 m0, s37, 4096
s_add_u32 s35, s36, 4096
buffer_load_dwordx4 v1, s[4:7], s35 offen sc1 lds
s_add_u32 m0, s37, 5120
s_add_u32 s35, s36, 5120
buffer_load_dwordx4 v1, s[4:7], s35 offen sc1 lds
s_add_u32 m0, s37, 6144
s_add_u32 s35, s36, 6144
buffer_load_dwordx4 v1, s[4:7], s35 offen sc1 lds
v_mfma_f32_32x32x16_bf16 v[80:95], v[196:199], v[128:131], v[80:95]
ds_read_b128 v[140:143], v7 offset:35840
s_add_u32 m0, s37, 7168
s_add_u32 s35, s36, 7168
buffer_load_dwordx4 v1, s[4:7], s35 offen sc1 lds
s_add_u32 m0, s37, 8192
s_add_u32 s35, s36, 8192
buffer_load_dwordx4 v1, s[4:7], s35 offen sc1 lds
s_add_u32 m0, s37, 9216
s_add_u32 s35, s36, 9216
buffer_load_dwordx4 v1, s[4:7], s35 offen sc1 lds
s_waitcnt lgkmcnt(2)
v_mfma_f32_32x32x16_bf16 v[64:79], v[200:203], v[132:135], v[64:79]
v_mfma_f32_32x32x16_bf16 v[80:95], v[204:207], v[132:135], v[80:95]
ds_read_b128 v[128:131], v7 offset:36864
s_waitcnt lgkmcnt(2)
v_mfma_f32_32x32x16_bf16 v[64:79], v[208:211], v[136:139], v[64:79]
v_mfma_f32_32x32x16_bf16 v[80:95], v[212:215], v[136:139], v[80:95]
ds_read_b128 v[132:135], v7 offset:37888
s_waitcnt lgkmcnt(2)
v_mfma_f32_32x32x16_bf16 v[64:79], v[216:219], v[140:143], v[64:79]
v_mfma_f32_32x32x16_bf16 v[80:95], v[220:223], v[140:143], v[80:95]
ds_read_b128 v[136:139], v7 offset:38912
s_waitcnt lgkmcnt(2)
v_mfma_f32_32x32x16_bf16 v[64:79], v[224:227], v[128:131], v[64:79]
v_mfma_f32_32x32x16_bf16 v[80:95], v[228:231], v[128:131], v[80:95]
ds_read_b128 v[140:143], v7 offset:39936
s_waitcnt lgkmcnt(2)
v_mfma_f32_32x32x16_bf16 v[64:79], v[232:235], v[132:135], v[64:79]
v_mfma_f32_32x32x16_bf16 v[80:95], v[236:239], v[132:135], v[80:95]
s_waitcnt lgkmcnt(1)
v_mfma_f32_32x32x16_bf16 v[64:79], v[240:243], v[136:139], v[64:79]
v_mfma_f32_32x32x16_bf16 v[80:95], v[244:247], v[136:139], v[80:95]
s_waitcnt lgkmcnt(0)
v_mfma_f32_32x32x16_bf16 v[64:79], v[248:251], v[140:143], v[64:79]
v_mfma_f32_32x32x16_bf16 v[80:95], v[252:255], v[140:143], v[80:95]
s_waitcnt vmcnt(10)
v_mov_b32 v4, s17
s_mov_b64 exec, 1
buffer_store_dword v4, off, s[4:7], s19 sc1
s_mov_b64 exec, -1
s_add_u32 s20, s20, 40960
s_cmp_ge_u32 s20, 122880
s_cselect_b32 s20, 0, s20
s_add_u32 s17, s17, 1
s_barrier
v_add_u32 v7, s20, v1
s_add_u32 s39, s17, 2
s_min_u32 s39, s39, s27
s_add_u32 s26, s20, 81920
s_cmp_ge_u32 s26, 122880
s_cselect_b32 s35, 122880, 0
s_sub_u32 s26, s26, s35
ds_read_b128 v[128:131], v7 offset:0
ds_read_b128 v[132:135], v7 offset:1024
ds_read_b128 v[136:139], v7 offset:2048
s_mul_i32 s36, s39, 1
s_add_u32 s36, s36, s16
s_mul_i32 s36, s36, 40960
s_add_u32 s36, s36, s22
s_add_u32 s36, s36, 109051904
s_add_u32 s37, s26, s22
s_waitcnt lgkmcnt(2)
v_mfma_f32_32x32x16_bf16 v[96:111], a[0:3], v[128:131], v[160:175]
v_mfma_f32_32x32x16_bf16 v[112:127], a[4:7], v[128:131], v[176:191]
ds_read_b128 v[140:143], v7 offset:3072
s_waitcnt lgkmcnt(2)
v_mfma_f32_32x32x16_bf16 v[96:111], a[8:11], v[132:135], v[96:111]
v_mul_f32 v8, v64, v64
v_mul_f32 v9, v65, v65
v_fma_f32 v8, v8, s25, v6
v_fma_f32 v9, v9, s25, v6
v_mfma_f32_32x32x16_bf16 v[112:127], a[12:15], v[132:135], v[112:127]
ds_read_b128 v[128:131], v7 offset:4096
v_mul_f32 v8, v8, v64
v_mul_f32 v9, v9, v65
v_exp_f32 v8, v8
v_exp_f32 v9, v9
s_waitcnt lgkmcnt(2)
v_mfma_f32_32x32x16_bf16 v[96:111], a[16:19], v[136:139], v[96:111]
v_add_f32 v8, 1.0, v8
v_add_f32 v9, 1.0, v9
v_rcp_f32 v8, v8
v_rcp_f32 v9, v9
v_mfma_f32_32x32x16_bf16 v[112:127], a[20:23], v[136:139], v[112:127]
ds_read_b128 v[132:135], v7 offset:5120
v_mul_f32 v64, v64, v8
v_mul_f32 v65, v65, v9
v_mul_f32 v10, v66, v66
v_mul_f32 v11, v67, v67
s_waitcnt lgkmcnt(2)
v_mfma_f32_32x32x16_bf16 v[96:111], a[24:27], v[140:143], v[96:111]
v_fma_f32 v10, v10, s25, v6
v_fma_f32 v11, v11, s25, v6
v_mul_f32 v10, v10, v66
v_mul_f32 v11, v11, v67
v_mfma_f32_32x32x16_bf16 v[112:127], a[28:31], v[140:143], v[112:127]
ds_read_b128 v[136:139], v7 offset:6144
v_exp_f32 v10, v10
v_exp_f32 v11, v11
v_add_f32 v10, 1.0, v10
v_add_f32 v11, 1.0, v11
s_waitcnt lgkmcnt(2)
v_mfma_f32_32x32x16_bf16 v[96:111], a[32:35], v[128:131], v[96:111]
v_rcp_f32 v10, v10
v_rcp_f32 v11, v11
v_mul_f32 v66, v66, v10
v_mul_f32 v67, v67, v11
v_mfma_f32_32x32x16_bf16 v[112:127], a[36:39], v[128:131], v[112:127]
ds_read_b128 v[140:143], v7 offset:7168
v_mul_f32 v8, v68, v68
v_mul_f32 v9, v69, v69
v_fma_f32 v8, v8, s25, v6
v_fma_f32 v9, v9, s25, v6
s_waitcnt lgkmcnt(2)
v_mfma_f32_32x32x16_bf16 v[96:111], a[40:43], v[132:135], v[96:111]
v_mul_f32 v8, v8, v68
v_mul_f32 v9, v9, v69
v_exp_f32 v8, v8
v_exp_f32 v9, v9
v_mfma_f32_32x32x16_bf16 v[112:127], a[44:47], v[132:135], v[112:127]
ds_read_b128 v[128:131], v7 offset:8192
v_add_f32 v8, 1.0, v8
v_add_f32 v9, 1.0, v9
v_rcp_f32 v8, v8
v_rcp_f32 v9, v9
s_waitcnt lgkmcnt(2)
v_mfma_f32_32x32x16_bf16 v[96:111], a[48:51], v[136:139], v[96:111]
v_mul_f32 v68, v68, v8
v_mul_f32 v69, v69, v9
v_mul_f32 v10, v70, v70
v_mul_f32 v11, v71, v71
v_mfma_f32_32x32x16_bf16 v[112:127], a[52:55], v[136:139], v[112:127]
ds_read_b128 v[132:135], v7 offset:9216
v_fma_f32 v10, v10, s25, v6
v_fma_f32 v11, v11, s25, v6
v_mul_f32 v10, v10, v70
v_mul_f32 v11, v11, v71
s_waitcnt lgkmcnt(2)
v_mfma_f32_32x32x16_bf16 v[96:111], a[56:59], v[140:143], v[96:111]
v_exp_f32 v10, v10
v_exp_f32 v11, v11
v_add_f32 v10, 1.0, v10
v_add_f32 v11, 1.0, v11
v_mfma_f32_32x32x16_bf16 v[112:127], a[60:63], v[140:143], v[112:127]
ds_read_b128 v[136:139], v7 offset:10240
v_rcp_f32 v10, v10
v_rcp_f32 v11, v11
v_mul_f32 v70, v70, v10
v_mul_f32 v71, v71, v11
s_waitcnt lgkmcnt(2)
v_mfma_f32_32x32x16_bf16 v[96:111], a[64:67], v[128:131], v[96:111]
v_mul_f32 v8, v72, v72
v_mul_f32 v9, v73, v73
v_fma_f32 v8, v8, s25, v6
v_fma_f32 v9, v9, s25, v6
v_mfma_f32_32x32x16_bf16 v[112:127], a[68:71], v[128:131], v[112:127]
ds_read_b128 v[140:143], v7 offset:11264
v_mul_f32 v8, v8, v72
v_mul_f32 v9, v9, v73
v_exp_f32 v8, v8
v_exp_f32 v9, v9
s_waitcnt lgkmcnt(2)
v_mfma_f32_32x32x16_bf16 v[96:111], a[72:75], v[132:135], v[96:111]
v_add_f32 v8, 1.0, v8
v_add_f32 v9, 1.0, v9
v_rcp_f32 v8, v8
v_rcp_f32 v9, v9
v_mfma_f32_32x32x16_bf16 v[112:127], a[76:79], v[132:135], v[112:127]
ds_read_b128 v[128:131], v7 offset:12288
v_mul_f32 v72, v72, v8
v_mul_f32 v73, v73, v9
v_mul_f32 v10, v74, v74
v_mul_f32 v11, v75, v75
s_waitcnt lgkmcnt(2)
v_mfma_f32_32x32x16_bf16 v[96:111], a[80:83], v[136:139], v[96:111]
v_fma_f32 v10, v10, s25, v6
v_fma_f32 v11, v11, s25, v6
v_mul_f32 v10, v10, v74
v_mul_f32 v11, v11, v75
v_mfma_f32_32x32x16_bf16 v[112:127], a[84:87], v[136:139], v[112:127]
ds_read_b128 v[132:135], v7 offset:13312
v_exp_f32 v10, v10
v_exp_f32 v11, v11
v_add_f32 v10, 1.0, v10
v_add_f32 v11, 1.0, v11
s_waitcnt lgkmcnt(2)
v_mfma_f32_32x32x16_bf16 v[96:111], a[88:91], v[140:143], v[96:111]
v_rcp_f32 v10, v10
v_rcp_f32 v11, v11
v_mul_f32 v74, v74, v10
v_mul_f32 v75, v75, v11
v_mfma_f32_32x32x16_bf16 v[112:127], a[92:95], v[140:143], v[112:127]
ds_read_b128 v[136:139], v7 offset:14336
v_mul_f32 v8, v76, v76
v_mul_f32 v9, v77, v77
v_fma_f32 v8, v8, s25, v6
v_fma_f32 v9, v9, s25, v6
s_waitcnt lgkmcnt(2)
v_mfma_f32_32x32x16_bf16 v[96:111], a[96:99], v[128:131], v[96:111]
v_mul_f32 v8, v8, v76
v_mul_f32 v9, v9, v77
v_exp_f32 v8, v8
v_exp_f32 v9, v9
v_mfma_f32_32x32x16_bf16 v[112:127], a[100:103], v[128:131], v[112:127]
ds_read_b128 v[140:143], v7 offset:15360
v_add_f32 v8, 1.0, v8
v_add_f32 v9, 1.0, v9
v_rcp_f32 v8, v8
v_rcp_f32 v9, v9
s_waitcnt lgkmcnt(2)
v_mfma_f32_32x32x16_bf16 v[96:111], a[104:107], v[132:135], v[96:111]
v_mul_f32 v76, v76, v8
v_mul_f32 v77, v77, v9
v_mul_f32 v10, v78, v78
v_mul_f32 v11, v79, v79
v_mfma_f32_32x32x16_bf16 v[112:127], a[108:111], v[132:135], v[112:127]
ds_read_b128 v[128:131], v7 offset:16384
v_fma_f32 v10, v10, s25, v6
v_fma_f32 v11, v11, s25, v6
v_mul_f32 v10, v10, v78
v_mul_f32 v11, v11, v79
s_waitcnt lgkmcnt(2)
v_mfma_f32_32x32x16_bf16 v[96:111], a[112:115], v[136:139], v[96:111]
v_exp_f32 v10, v10
v_exp_f32 v11, v11
v_add_f32 v10, 1.0, v10
v_add_f32 v11, 1.0, v11
v_mfma_f32_32x32x16_bf16 v[112:127], a[116:119], v[136:139], v[112:127]
ds_read_b128 v[132:135], v7 offset:17408
v_rcp_f32 v10, v10
v_rcp_f32 v11, v11
v_mul_f32 v78, v78, v10
v_mul_f32 v79, v79, v11
s_waitcnt lgkmcnt(2)
v_mfma_f32_32x32x16_bf16 v[96:111], a[120:123], v[140:143], v[96:111]
v_cvt_pk_bf16_f32 v144, v64, v65
v_cvt_pk_bf16_f32 v145, v66, v67
v_cvt_pk_bf16_f32 v146, v68, v69
v_cvt_pk_bf16_f32 v147, v70, v71
v_mfma_f32_32x32x16_bf16 v[112:127], a[124:127], v[140:143], v[112:127]
ds_read_b128 v[136:139], v7 offset:18432
buffer_store_dwordx4 v[144:147], v1, s[4:7], s18 offen offset:0 sc1
v_cvt_pk_bf16_f32 v148, v72, v73
v_cvt_pk_bf16_f32 v149, v74, v75
v_cvt_pk_bf16_f32 v150, v76, v77
s_waitcnt lgkmcnt(2)
v_mfma_f32_32x32x16_bf16 v[96:111], a[128:131], v[128:131], v[96:111]
v_cvt_pk_bf16_f32 v151, v78, v79
buffer_store_dwordx4 v[148:151], v1, s[4:7], s18 offen offset:1024 sc1
v_mul_f32 v8, v80, v80
v_mul_f32 v9, v81, v81
v_mfma_f32_32x32x16_bf16 v[112:127], a[132:135], v[128:131], v[112:127]
ds_read_b128 v[140:143], v7 offset:19456
v_fma_f32 v8, v8, s25, v6
v_fma_f32 v9, v9, s25, v6
v_mul_f32 v8, v8, v80
v_mul_f32 v9, v9, v81
s_waitcnt lgkmcnt(2)
v_mfma_f32_32x32x16_bf16 v[96:111], a[136:139], v[132:135], v[96:111]
v_exp_f32 v8, v8
v_exp_f32 v9, v9
v_add_f32 v8, 1.0, v8
v_add_f32 v9, 1.0, v9
v_mfma_f32_32x32x16_bf16 v[112:127], a[140:143], v[132:135], v[112:127]
ds_read_b128 v[128:131], v7 offset:20480
v_rcp_f32 v8, v8
v_rcp_f32 v9, v9
v_mul_f32 v80, v80, v8
v_mul_f32 v81, v81, v9
s_waitcnt lgkmcnt(2)
v_mfma_f32_32x32x16_bf16 v[96:111], a[144:147], v[136:139], v[96:111]
v_mul_f32 v10, v82, v82
v_mul_f32 v11, v83, v83
v_fma_f32 v10, v10, s25, v6
v_fma_f32 v11, v11, s25, v6
v_mfma_f32_32x32x16_bf16 v[112:127], a[148:151], v[136:139], v[112:127]
ds_read_b128 v[132:135], v7 offset:21504
v_mul_f32 v10, v10, v82
v_mul_f32 v11, v11, v83
v_exp_f32 v10, v10
v_exp_f32 v11, v11
s_waitcnt lgkmcnt(2)
v_mfma_f32_32x32x16_bf16 v[96:111], a[152:155], v[140:143], v[96:111]
v_add_f32 v10, 1.0, v10
v_add_f32 v11, 1.0, v11
v_rcp_f32 v10, v10
v_rcp_f32 v11, v11
v_mfma_f32_32x32x16_bf16 v[112:127], a[156:159], v[140:143], v[112:127]
ds_read_b128 v[136:139], v7 offset:22528
v_mul_f32 v82, v82, v10
v_mul_f32 v83, v83, v11
v_mul_f32 v8, v84, v84
v_mul_f32 v9, v85, v85
s_waitcnt lgkmcnt(2)
v_mfma_f32_32x32x16_bf16 v[96:111], a[160:163], v[128:131], v[96:111]
v_fma_f32 v8, v8, s25, v6
v_fma_f32 v9, v9, s25, v6
v_mul_f32 v8, v8, v84
v_mul_f32 v9, v9, v85
v_mfma_f32_32x32x16_bf16 v[112:127], a[164:167], v[128:131], v[112:127]
ds_read_b128 v[140:143], v7 offset:23552
v_exp_f32 v8, v8
v_exp_f32 v9, v9
v_add_f32 v8, 1.0, v8
v_add_f32 v9, 1.0, v9
s_waitcnt lgkmcnt(2)
v_mfma_f32_32x32x16_bf16 v[96:111], a[168:171], v[132:135], v[96:111]
v_rcp_f32 v8, v8
v_rcp_f32 v9, v9
v_mul_f32 v84, v84, v8
v_mul_f32 v85, v85, v9
v_mfma_f32_32x32x16_bf16 v[112:127], a[172:175], v[132:135], v[112:127]
ds_read_b128 v[128:131], v7 offset:24576
v_mul_f32 v10, v86, v86
v_mul_f32 v11, v87, v87
v_fma_f32 v10, v10, s25, v6
v_fma_f32 v11, v11, s25, v6
s_waitcnt lgkmcnt(2)
v_mfma_f32_32x32x16_bf16 v[96:111], a[176:179], v[136:139], v[96:111]
v_mul_f32 v10, v10, v86
v_mul_f32 v11, v11, v87
v_exp_f32 v10, v10
v_exp_f32 v11, v11
v_mfma_f32_32x32x16_bf16 v[112:127], a[180:183], v[136:139], v[112:127]
ds_read_b128 v[132:135], v7 offset:25600
v_add_f32 v10, 1.0, v10
v_add_f32 v11, 1.0, v11
v_rcp_f32 v10, v10
v_rcp_f32 v11, v11
s_waitcnt lgkmcnt(2)
v_mfma_f32_32x32x16_bf16 v[96:111], a[184:187], v[140:143], v[96:111]
v_mul_f32 v86, v86, v10
v_mul_f32 v87, v87, v11
v_mul_f32 v8, v88, v88
v_mul_f32 v9, v89, v89
v_mfma_f32_32x32x16_bf16 v[112:127], a[188:191], v[140:143], v[112:127]
ds_read_b128 v[136:139], v7 offset:26624
v_fma_f32 v8, v8, s25, v6
v_fma_f32 v9, v9, s25, v6
v_mul_f32 v8, v8, v88
v_mul_f32 v9, v9, v89
s_waitcnt lgkmcnt(2)
v_mfma_f32_32x32x16_bf16 v[96:111], a[192:195], v[128:131], v[96:111]
v_exp_f32 v8, v8
v_exp_f32 v9, v9
v_add_f32 v8, 1.0, v8
v_add_f32 v9, 1.0, v9
v_mfma_f32_32x32x16_bf16 v[112:127], a[196:199], v[128:131], v[112:127]
ds_read_b128 v[140:143], v7 offset:27648
v_rcp_f32 v8, v8
v_rcp_f32 v9, v9
v_mul_f32 v88, v88, v8
v_mul_f32 v89, v89, v9
s_waitcnt lgkmcnt(2)
v_mfma_f32_32x32x16_bf16 v[96:111], a[200:203], v[132:135], v[96:111]
v_mul_f32 v10, v90, v90
v_mul_f32 v11, v91, v91
v_fma_f32 v10, v10, s25, v6
v_fma_f32 v11, v11, s25, v6
v_mfma_f32_32x32x16_bf16 v[112:127], a[204:207], v[132:135], v[112:127]
ds_read_b128 v[128:131], v7 offset:28672
v_mul_f32 v10, v10, v90
v_mul_f32 v11, v11, v91
v_exp_f32 v10, v10
v_exp_f32 v11, v11
s_waitcnt lgkmcnt(2)
v_mfma_f32_32x32x16_bf16 v[96:111], a[208:211], v[136:139], v[96:111]
v_add_f32 v10, 1.0, v10
v_add_f32 v11, 1.0, v11
v_rcp_f32 v10, v10
v_rcp_f32 v11, v11
v_mfma_f32_32x32x16_bf16 v[112:127], a[212:215], v[136:139], v[112:127]
ds_read_b128 v[132:135], v7 offset:29696
v_mul_f32 v90, v90, v10
v_mul_f32 v91, v91, v11
v_mul_f32 v8, v92, v92
v_mul_f32 v9, v93, v93
s_waitcnt lgkmcnt(2)
v_mfma_f32_32x32x16_bf16 v[96:111], a[216:219], v[140:143], v[96:111]
v_fma_f32 v8, v8, s25, v6
v_fma_f32 v9, v9, s25, v6
v_mul_f32 v8, v8, v92
v_mul_f32 v9, v9, v93
v_mfma_f32_32x32x16_bf16 v[112:127], a[220:223], v[140:143], v[112:127]
ds_read_b128 v[136:139], v7 offset:30720
v_exp_f32 v8, v8
v_exp_f32 v9, v9
v_add_f32 v8, 1.0, v8
v_add_f32 v9, 1.0, v9
s_waitcnt lgkmcnt(2)
v_mfma_f32_32x32x16_bf16 v[96:111], a[224:227], v[128:131], v[96:111]
v_rcp_f32 v8, v8
v_rcp_f32 v9, v9
v_mul_f32 v92, v92, v8
v_mul_f32 v93, v93, v9
v_mfma_f32_32x32x16_bf16 v[112:127], a[228:231], v[128:131], v[112:127]
ds_read_b128 v[140:143], v7 offset:31744
v_mul_f32 v10, v94, v94
v_mul_f32 v11, v95, v95
v_fma_f32 v10, v10, s25, v6
v_fma_f32 v11, v11, s25, v6
s_waitcnt lgkmcnt(2)
v_mfma_f32_32x32x16_bf16 v[96:111], a[232:235], v[132:135], v[96:111]
v_mul_f32 v10, v10, v94
v_mul_f32 v11, v11, v95
v_exp_f32 v10, v10
v_exp_f32 v11, v11
v_mfma_f32_32x32x16_bf16 v[112:127], a[236:239], v[132:135], v[112:127]
ds_read_b128 v[128:131], v7 offset:32768
v_add_f32 v10, 1.0, v10
v_add_f32 v11, 1.0, v11
v_rcp_f32 v10, v10
v_rcp_f32 v11, v11
s_waitcnt lgkmcnt(2)
v_mfma_f32_32x32x16_bf16 v[96:111], a[240:243], v[136:139], v[96:111]
v_mul_f32 v94, v94, v10
v_mul_f32 v95, v95, v11
v_cvt_pk_bf16_f32 v152, v80, v81
v_cvt_pk_bf16_f32 v153, v82, v83
v_mfma_f32_32x32x16_bf16 v[112:127], a[244:247], v[136:139], v[112:127]
ds_read_b128 v[132:135], v7 offset:33792
v_cvt_pk_bf16_f32 v154, v84, v85
v_cvt_pk_bf16_f32 v155, v86, v87
buffer_store_dwordx4 v[152:155], v1, s[4:7], s18 offen offset:2048 sc1
v_cvt_pk_bf16_f32 v156, v88, v89
s_waitcnt lgkmcnt(2)
v_mfma_f32_32x32x16_bf16 v[96:111], a[248:251], v[140:143], v[96:111]
v_cvt_pk_bf16_f32 v157, v90, v91
v_cvt_pk_bf16_f32 v158, v92, v93
v_cvt_pk_bf16_f32 v159, v94, v95
buffer_store_dwordx4 v[156:159], v1, s[4:7], s18 offen offset:3072 sc1
v_mfma_f32_32x32x16_bf16 v[112:127], a[252:255], v[140:143], v[112:127]
ds_read_b128 v[136:139], v7 offset:34816
s_add_u32 s18, s18, 114688
s_add_u32 m0, s37, 0
s_add_u32 s35, s36, 0
buffer_load_dwordx4 v1, s[4:7], s35 offen sc1 lds
s_add_u32 m0, s37, 1024
s_add_u32 s35, s36, 1024
buffer_load_dwordx4 v1, s[4:7], s35 offen sc1 lds
s_add_u32 m0, s37, 2048
s_add_u32 s35, s36, 2048
buffer_load_dwordx4 v1, s[4:7], s35 offen sc1 lds
s_waitcnt lgkmcnt(2)
v_mfma_f32_32x32x16_bf16 v[96:111], v[192:195], v[128:131], v[96:111]
s_add_u32 m0, s37, 3072
s_add_u32 s35, s36, 3072
buffer_load_dwordx4 v1, s[4:7], s35 offen sc1 lds
s_add_u32 m0, s37, 4096
s_add_u32 s35, s36, 4096
buffer_load_dwordx4 v1, s[4:7], s35 offen sc1 lds
s_add_u32 m0, s37, 5120
s_add_u32 s35, s36, 5120
buffer_load_dwordx4 v1, s[4:7], s35 offen sc1 lds
s_add_u32 m0, s37, 6144
s_add_u32 s35, s36, 6144
buffer_load_dwordx4 v1, s[4:7], s35 offen sc1 lds
v_mfma_f32_32x32x16_bf16 v[112:127], v[196:199], v[128:131], v[112:127]
ds_read_b128 v[140:143], v7 offset:35840
s_add_u32 m0, s37, 7168
s_add_u32 s35, s36, 7168
buffer_load_dwordx4 v1, s[4:7], s35 offen sc1 lds
s_add_u32 m0, s37, 8192
s_add_u32 s35, s36, 8192
buffer_load_dwordx4 v1, s[4:7], s35 offen sc1 lds
s_add_u32 m0, s37, 9216
s_add_u32 s35, s36, 9216
buffer_load_dwordx4 v1, s[4:7], s35 offen sc1 lds
s_waitcnt lgkmcnt(2)
v_mfma_f32_32x32x16_bf16 v[96:111], v[200:203], v[132:135], v[96:111]
v_mfma_f32_32x32x16_bf16 v[112:127], v[204:207], v[132:135], v[112:127]
ds_read_b128 v[128:131], v7 offset:36864
s_waitcnt lgkmcnt(2)
v_mfma_f32_32x32x16_bf16 v[96:111], v[208:211], v[136:139], v[96:111]
v_mfma_f32_32x32x16_bf16 v[112:127], v[212:215], v[136:139], v[112:127]
ds_read_b128 v[132:135], v7 offset:37888
s_waitcnt lgkmcnt(2)
v_mfma_f32_32x32x16_bf16 v[96:111], v[216:219], v[140:143], v[96:111]
v_mfma_f32_32x32x16_bf16 v[112:127], v[220:223], v[140:143], v[112:127]
ds_read_b128 v[136:139], v7 offset:38912
s_waitcnt lgkmcnt(2)
v_mfma_f32_32x32x16_bf16 v[96:111], v[224:227], v[128:131], v[96:111]
v_mfma_f32_32x32x16_bf16 v[112:127], v[228:231], v[128:131], v[112:127]
ds_read_b128 v[140:143], v7 offset:39936
s_waitcnt lgkmcnt(2)
v_mfma_f32_32x32x16_bf16 v[96:111], v[232:235], v[132:135], v[96:111]
v_mfma_f32_32x32x16_bf16 v[112:127], v[236:239], v[132:135], v[112:127]
s_waitcnt lgkmcnt(1)
v_mfma_f32_32x32x16_bf16 v[96:111], v[240:243], v[136:139], v[96:111]
v_mfma_f32_32x32x16_bf16 v[112:127], v[244:247], v[136:139], v[112:127]
s_waitcnt lgkmcnt(0)
v_mfma_f32_32x32x16_bf16 v[96:111], v[248:251], v[140:143], v[96:111]
v_mfma_f32_32x32x16_bf16 v[112:127], v[252:255], v[140:143], v[112:127]
s_waitcnt vmcnt(10)
v_mov_b32 v4, s17
s_mov_b64 exec, 1
buffer_store_dword v4, off, s[4:7], s19 sc1
s_mov_b64 exec, -1
s_add_u32 s20, s20, 40960
s_cmp_ge_u32 s20, 122880
s_cselect_b32 s20, 0, s20
s_add_u32 s17, s17, 1
s_barrier
s_cmp_lt_u32 s17, s21
s_cbranch_scc1 L_h_loop
v_mul_f32 v8, v96, v96
v_mul_f32 v9, v97, v97
v_fma_f32 v8, v8, s25, v6
v_fma_f32 v9, v9, s25, v6
v_mul_f32 v8, v8, v96
v_mul_f32 v9, v9, v97
v_exp_f32 v8, v8
v_exp_f32 v9, v9
v_add_f32 v8, 1.0, v8
v_add_f32 v9, 1.0, v9
v_rcp_f32 v8, v8
v_rcp_f32 v9, v9
v_mul_f32 v96, v96, v8
v_mul_f32 v97, v97, v9
v_mul_f32 v10, v98, v98
v_mul_f32 v11, v99, v99
v_fma_f32 v10, v10, s25, v6
v_fma_f32 v11, v11, s25, v6
v_mul_f32 v10, v10, v98
v_mul_f32 v11, v11, v99
v_exp_f32 v10, v10
v_exp_f32 v11, v11
v_add_f32 v10, 1.0, v10
v_add_f32 v11, 1.0, v11
v_rcp_f32 v10, v10
v_rcp_f32 v11, v11
v_mul_f32 v98, v98, v10
v_mul_f32 v99, v99, v11
v_mul_f32 v8, v100, v100
v_mul_f32 v9, v101, v101
v_fma_f32 v8, v8, s25, v6
v_fma_f32 v9, v9, s25, v6
v_mul_f32 v8, v8, v100
v_mul_f32 v9, v9, v101
v_exp_f32 v8, v8
v_exp_f32 v9, v9
v_add_f32 v8, 1.0, v8
v_add_f32 v9, 1.0, v9
v_rcp_f32 v8, v8
v_rcp_f32 v9, v9
v_mul_f32 v100, v100, v8
v_mul_f32 v101, v101, v9
v_mul_f32 v10, v102, v102
v_mul_f32 v11, v103, v103
v_fma_f32 v10, v10, s25, v6
v_fma_f32 v11, v11, s25, v6
v_mul_f32 v10, v10, v102
v_mul_f32 v11, v11, v103
v_exp_f32 v10, v10
v_exp_f32 v11, v11
v_add_f32 v10, 1.0, v10
v_add_f32 v11, 1.0, v11
v_rcp_f32 v10, v10
v_rcp_f32 v11, v11
v_mul_f32 v102, v102, v10
v_mul_f32 v103, v103, v11
v_mul_f32 v8, v104, v104
v_mul_f32 v9, v105, v105
v_fma_f32 v8, v8, s25, v6
v_fma_f32 v9, v9, s25, v6
v_mul_f32 v8, v8, v104
v_mul_f32 v9, v9, v105
v_exp_f32 v8, v8
v_exp_f32 v9, v9
v_add_f32 v8, 1.0, v8
v_add_f32 v9, 1.0, v9
v_rcp_f32 v8, v8
v_rcp_f32 v9, v9
v_mul_f32 v104, v104, v8
v_mul_f32 v105, v105, v9
v_mul_f32 v10, v106, v106
v_mul_f32 v11, v107, v107
v_fma_f32 v10, v10, s25, v6
v_fma_f32 v11, v11, s25, v6
v_mul_f32 v10, v10, v106
v_mul_f32 v11, v11, v107
v_exp_f32 v10, v10
v_exp_f32 v11, v11
v_add_f32 v10, 1.0, v10
v_add_f32 v11, 1.0, v11
v_rcp_f32 v10, v10
v_rcp_f32 v11, v11
v_mul_f32 v106, v106, v10
v_mul_f32 v107, v107, v11
v_mul_f32 v8, v108, v108
v_mul_f32 v9, v109, v109
v_fma_f32 v8, v8, s25, v6
v_fma_f32 v9, v9, s25, v6
v_mul_f32 v8, v8, v108
v_mul_f32 v9, v9, v109
v_exp_f32 v8, v8
v_exp_f32 v9, v9
v_add_f32 v8, 1.0, v8
v_add_f32 v9, 1.0, v9
v_rcp_f32 v8, v8
v_rcp_f32 v9, v9
v_mul_f32 v108, v108, v8
v_mul_f32 v109, v109, v9
v_mul_f32 v10, v110, v110
v_mul_f32 v11, v111, v111
v_fma_f32 v10, v10, s25, v6
v_fma_f32 v11, v11, s25, v6
v_mul_f32 v10, v10, v110
v_mul_f32 v11, v11, v111
v_exp_f32 v10, v10
v_exp_f32 v11, v11
v_add_f32 v10, 1.0, v10
v_add_f32 v11, 1.0, v11
v_rcp_f32 v10, v10
v_rcp_f32 v11, v11
v_mul_f32 v110, v110, v10
v_mul_f32 v111, v111, v11
v_cvt_pk_bf16_f32 v144, v96, v97
v_cvt_pk_bf16_f32 v145, v98, v99
v_cvt_pk_bf16_f32 v146, v100, v101
v_cvt_pk_bf16_f32 v147, v102, v103
buffer_store_dwordx4 v[144:147], v1, s[4:7], s18 offen offset:0 sc1
v_cvt_pk_bf16_f32 v148, v104, v105
v_cvt_pk_bf16_f32 v149, v106, v107
v_cvt_pk_bf16_f32 v150, v108, v109
v_cvt_pk_bf16_f32 v151, v110, v111
buffer_store_dwordx4 v[148:151], v1, s[4:7], s18 offen offset:1024 sc1
v_mul_f32 v8, v112, v112
v_mul_f32 v9, v113, v113
v_fma_f32 v8, v8, s25, v6
v_fma_f32 v9, v9, s25, v6
v_mul_f32 v8, v8, v112
v_mul_f32 v9, v9, v113
v_exp_f32 v8, v8
v_exp_f32 v9, v9
v_add_f32 v8, 1.0, v8
v_add_f32 v9, 1.0, v9
v_rcp_f32 v8, v8
v_rcp_f32 v9, v9
v_mul_f32 v112, v112, v8
v_mul_f32 v113, v113, v9
v_mul_f32 v10, v114, v114
v_mul_f32 v11, v115, v115
v_fma_f32 v10, v10, s25, v6
v_fma_f32 v11, v11, s25, v6
v_mul_f32 v10, v10, v114
v_mul_f32 v11, v11, v115
v_exp_f32 v10, v10
v_exp_f32 v11, v11
v_add_f32 v10, 1.0, v10
v_add_f32 v11, 1.0, v11
v_rcp_f32 v10, v10
v_rcp_f32 v11, v11
v_mul_f32 v114, v114, v10
v_mul_f32 v115, v115, v11
v_mul_f32 v8, v116, v116
v_mul_f32 v9, v117, v117
v_fma_f32 v8, v8, s25, v6
v_fma_f32 v9, v9, s25, v6
v_mul_f32 v8, v8, v116
v_mul_f32 v9, v9, v117
v_exp_f32 v8, v8
v_exp_f32 v9, v9
v_add_f32 v8, 1.0, v8
v_add_f32 v9, 1.0, v9
v_rcp_f32 v8, v8
v_rcp_f32 v9, v9
v_mul_f32 v116, v116, v8
v_mul_f32 v117, v117, v9
v_mul_f32 v10, v118, v118
v_mul_f32 v11, v119, v119
v_fma_f32 v10, v10, s25, v6
v_fma_f32 v11, v11, s25, v6
v_mul_f32 v10, v10, v118
v_mul_f32 v11, v11, v119
v_exp_f32 v10, v10
v_exp_f32 v11, v11
v_add_f32 v10, 1.0, v10
v_add_f32 v11, 1.0, v11
v_rcp_f32 v10, v10
v_rcp_f32 v11, v11
v_mul_f32 v118, v118, v10
v_mul_f32 v119, v119, v11
v_mul_f32 v8, v120, v120
v_mul_f32 v9, v121, v121
v_fma_f32 v8, v8, s25, v6
v_fma_f32 v9, v9, s25, v6
v_mul_f32 v8, v8, v120
v_mul_f32 v9, v9, v121
v_exp_f32 v8, v8
v_exp_f32 v9, v9
v_add_f32 v8, 1.0, v8
v_add_f32 v9, 1.0, v9
v_rcp_f32 v8, v8
v_rcp_f32 v9, v9
v_mul_f32 v120, v120, v8
v_mul_f32 v121, v121, v9
v_mul_f32 v10, v122, v122
v_mul_f32 v11, v123, v123
v_fma_f32 v10, v10, s25, v6
v_fma_f32 v11, v11, s25, v6
v_mul_f32 v10, v10, v122
v_mul_f32 v11, v11, v123
v_exp_f32 v10, v10
v_exp_f32 v11, v11
v_add_f32 v10, 1.0, v10
v_add_f32 v11, 1.0, v11
v_rcp_f32 v10, v10
v_rcp_f32 v11, v11
v_mul_f32 v122, v122, v10
v_mul_f32 v123, v123, v11
v_mul_f32 v8, v124, v124
v_mul_f32 v9, v125, v125
v_fma_f32 v8, v8, s25, v6
v_fma_f32 v9, v9, s25, v6
v_mul_f32 v8, v8, v124
v_mul_f32 v9, v9, v125
v_exp_f32 v8, v8
v_exp_f32 v9, v9
v_add_f32 v8, 1.0, v8
v_add_f32 v9, 1.0, v9
v_rcp_f32 v8, v8
v_rcp_f32 v9, v9
v_mul_f32 v124, v124, v8
v_mul_f32 v125, v125, v9
v_mul_f32 v10, v126, v126
v_mul_f32 v11, v127, v127
v_fma_f32 v10, v10, s25, v6
v_fma_f32 v11, v11, s25, v6
v_mul_f32 v10, v10, v126
v_mul_f32 v11, v11, v127
v_exp_f32 v10, v10
v_exp_f32 v11, v11
v_add_f32 v10, 1.0, v10
v_add_f32 v11, 1.0, v11
v_rcp_f32 v10, v10
v_rcp_f32 v11, v11
v_mul_f32 v126, v126, v10
v_mul_f32 v127, v127, v11
v_cvt_pk_bf16_f32 v152, v112, v113
v_cvt_pk_bf16_f32 v153, v114, v115
v_cvt_pk_bf16_f32 v154, v116, v117
v_cvt_pk_bf16_f32 v155, v118, v119
buffer_store_dwordx4 v[152:155], v1, s[4:7], s18 offen offset:2048 sc1
v_cvt_pk_bf16_f32 v156, v120, v121
v_cvt_pk_bf16_f32 v157, v122, v123
v_cvt_pk_bf16_f32 v158, v124, v125
v_cvt_pk_bf16_f32 v159, v126, v127
buffer_store_dwordx4 v[156:159], v1, s[4:7], s18 offen offset:3072 sc1
s_add_u32 s18, s18, 114688
s_waitcnt vmcnt(0)
v_mov_b32 v4, s17
s_mov_b64 exec, 1
buffer_store_dword v4, off, s[4:7], s19 sc1
s_mov_b64 exec, -1
s_waitcnt vmcnt(0)
s_branch L_done
L_role_near:
s_cmp_eq_u32 s12, 0
s_cbranch_scc0 L_done
s_mov_b64 exec, 1
v_mov_b32 v1, 0
s_mov_b32 s16, -1
s_mov_b32 s17, -1
s_mov_b32 s18, 2103296
s_memtime s[20:21]
s_waitcnt lgkmcnt(0)
buffer_store_dword v1, off, s[4:7], s18 sc1
s_waitcnt vmcnt(0)
s_memtime s[22:23]
s_waitcnt lgkmcnt(0)
s_sub_u32 s22, s22, s20
s_min_u32 s16, s16, s22
s_add_u32 s18, s18, 8192
s_memtime s[20:21]
s_waitcnt lgkmcnt(0)
buffer_store_dword v1, off, s[4:7], s18 sc1
s_waitcnt vmcnt(0)
s_memtime s[22:23]
s_waitcnt lgkmcnt(0)
s_sub_u32 s22, s22, s20
s_min_u32 s17, s17, s22
s_add_u32 s18, s18, 8192
s_memtime s[20:21]
s_waitcnt lgkmcnt(0)
buffer_store_dword v1, off, s[4:7], s18 sc1
s_waitcnt vmcnt(0)
s_memtime s[22:23]
s_waitcnt lgkmcnt(0)
s_sub_u32 s22, s22, s20
s_min_u32 s16, s16, s22
s_add_u32 s18, s18, 8192
s_memtime s[20:21]
s_waitcnt lgkmcnt(0)
buffer_store_dword v1, off, s[4:7], s18 sc1
s_waitcnt vmcnt(0)
s_memtime s[22:23]
s_waitcnt lgkmcnt(0)
s_sub_u32 s22, s22, s20
s_min_u32 s17, s17, s22
s_add_u32 s18, s18, 8192
s_memtime s[20:21]
s_waitcnt lgkmcnt(0)
buffer_store_dword v1, off, s[4:7], s18 sc1
s_waitcnt vmcnt(0)
s_memtime s[22:23]
s_waitcnt lgkmcnt(0)
s_sub_u32 s22, s22, s20
s_min_u32 s16, s16, s22
s_add_u32 s18, s18, 8192
s_memtime s[20:21]
s_waitcnt lgkmcnt(0)
buffer_store_dword v1, off, s[4:7], s18 sc1
s_waitcnt vmcnt(0)
s_memtime s[22:23]
s_waitcnt lgkmcnt(0)
s_sub_u32 s22, s22, s20
s_min_u32 s17, s17, s22
s_add_u32 s18, s18, 8192
s_memtime s[20:21]
s_waitcnt lgkmcnt(0)
buffer_store_dword v1, off, s[4:7], s18 sc1
s_waitcnt vmcnt(0)
s_memtime s[22:23]
s_waitcnt lgkmcnt(0)
s_sub_u32 s22, s22, s20
s_min_u32 s16, s16, s22
s_add_u32 s18, s18, 8192
s_memtime s[20:21]
s_waitcnt lgkmcnt(0)
buffer_store_dword v1, off, s[4:7], s18 sc1
s_waitcnt vmcnt(0)
s_memtime s[22:23]
s_waitcnt lgkmcnt(0)
s_sub_u32 s22, s22, s20
s_min_u32 s17, s17, s22
s_add_u32 s18, s18, 8192
s_cmp_lt_u32 s16, s17
s_cselect_b32 s16, 2, 1
v_mov_b32 v1, s16
buffer_store_dword v1, off, s[8:11], 0 offset:136 sc1
s_mov_b64 exec, -1
s_branch L_done
L_role_chain:
v_mov_b32 v79, v0
s_load_dwordx4 s[72:75], s[0:1], 16
s_load_dwordx4 s[76:79], s[0:1], 32
v_bfe_u32 v76, v79, 4, 2
v_add_u32 v76, 0, v76
v_bfe_u32 v77, v79, 1, 3
v_xor_b32 v76, v76, v77
v_lshlrev_b32 v76, 5, v76
v_bfe_u32 v78, v79, 5, 1
v_mul_u32_u24 v70, 65536, v78
v_bfe_u32 v78, v79, 4, 1
v_mul_u32_u24 v78, 8192, v78
v_add_u32 v70, v70, v78
v_bfe_u32 v78, v79, 0, 1
v_mul_u32_u24 v78, 16, v78
v_add_u32 v70, v70, v78
v_add_u32 v70, v70, v76
v_bfe_u32 v78, v79, 5, 1
v_mul_u32_u24 v72, 10240, v78
v_bfe_u32 v78, v79, 4, 1
v_mul_u32_u24 v78, 1280, v78
v_add_u32 v72, v72, v78
v_bfe_u32 v78, v79, 0, 1
v_mul_u32_u24 v78, 16, v78
v_add_u32 v72, v72, v78
v_add_u32 v72, v72, v76
v_bfe_u32 v76, v79, 4, 2
v_add_u32 v76, 4, v76
v_bfe_u32 v77, v79, 1, 3
v_xor_b32 v76, v76, v77
v_lshlrev_b32 v76, 5, v76
v_bfe_u32 v78, v79, 5, 1
v_mul_u32_u24 v71, 65536, v78
v_bfe_u32 v78, v79, 4, 1
v_mul_u32_u24 v78, 8192, v78
v_add_u32 v71, v71, v78
v_bfe_u32 v78, v79, 0, 1
v_mul_u32_u24 v78, 16, v78
v_add_u32 v71, v71, v78
v_add_u32 v71, v71, v76
v_bfe_u32 v78, v79, 5, 1
v_mul_u32_u24 v73, 10240, v78
v_bfe_u32 v78, v79, 4, 1
v_mul_u32_u24 v78, 1280, v78
v_add_u32 v73, v73, v78
v_bfe_u32 v78, v79, 0, 1
v_mul_u32_u24 v78, 16, v78
v_add_u32 v73, v73, v78
v_add_u32 v73, v73, v76
v_bfe_u32 v78, v79, 5, 1
v_mul_u32_u24 v74, 5120, v78
v_bfe_u32 v78, v79, 4, 1
v_mul_u32_u24 v78, 10240, v78
v_add_u32 v74, v74, v78
v_bfe_u32 v78, v79, 3, 1
v_mul_u32_u24 v78, 1280, v78
v_add_u32 v74, v74, v78
v_bfe_u32 v78, v79, 0, 1
v_mul_u32_u24 v78, 16, v78
v_add_u32 v74, v74, v78
v_bfe_u32 v76, v79, 4, 2
v_bfe_u32 v77, v79, 1, 2
v_xor_b32 v76, v76, v77
v_lshl_add_u32 v74, v76, 5, v74
s_waitcnt lgkmcnt(0)
s_mov_b32 s80, s72
s_mov_b32 s81, s73
s_mov_b32 s82, 5242880
s_mov_b32 s83, 0x20000
s_mov_b32 s84, s74
s_mov_b32 s85, s75
s_mov_b32 s86, 5242880
s_mov_b32 s87, 0x20000
s_mov_b32 s88, s76
s_mov_b32 s89, s77
s_mov_b32 s90, 5242880
s_mov_b32 s91, 0x20000
s_mov_b32 s92, s78
s_mov_b32 s93, s79
s_mov_b32 s94, 5242880
s_mov_b32 s95, 0x20000
s_lshr_b32 s35, s12, 1
s_and_b32 s36, s12, 1
s_lshl_b32 s36, s36, 1
s_lshl_b32 s37, s35, 7
s_add_u32 s37, s37, s36
s_lshl_b32 s96, s37, 13
s_lshl_b32 s37, s35, 5
s_add_u32 s37, s37, s36
s_lshl_b32 s56, s37, 13
s_mul_i32 s98, s37, 1280
s_lshl_b32 s35, s13, 8
s_mul_i32 s36, s14, 2621440
s_add_u32 s37, s35, s36
s_sub_u32 s36, 2621440, s36
s_add_u32 s36, s35, s36
s_add_u32 s97, s96, s36
s_add_u32 s96, s96, s37
s_add_u32 s57, s56, s36
s_add_u32 s56, s56, s37
s_mul_i32 s35, s13, 163840
s_mul_i32 s36, s14, 640
s_add_u32 s35, s35, s36
s_add_u32 s98, s98, s35
s_lshl_b32 s100, s12, 12
s_add_u32 m0, s100, 81920
s_add_u32 s35, s96, 0
buffer_load_dwordx4 v70, s[80:83], s35 offen lds
s_add_u32 m0, s100, 82944
s_add_u32 s35, s96, 32768
buffer_load_dwordx4 v71, s[80:83], s35 offen lds
s_add_u32 m0, s100, 83968
s_add_u32 s35, s96, 131072
buffer_load_dwordx4 v70, s[80:83], s35 offen lds
s_add_u32 m0, s100, 84992
s_add_u32 s35, s96, 163840
buffer_load_dwordx4 v71, s[80:83], s35 offen lds
s_add_u32 m0, s100, 98304
s_add_u32 s35, s96, 262144
buffer_load_dwordx4 v70, s[80:83], s35 offen lds
s_add_u32 m0, s100, 99328
s_add_u32 s35, s96, 294912
buffer_load_dwordx4 v71, s[80:83], s35 offen lds
s_add_u32 m0, s100, 100352
s_add_u32 s35, s96, 393216
buffer_load_dwordx4 v70, s[80:83], s35 offen lds
s_add_u32 m0, s100, 101376
s_add_u32 s35, s96, 425984
buffer_load_dwordx4 v71, s[80:83], s35 offen lds
s_add_u32 m0, s100, 114688
s_add_u32 s35, s96, 524288
buffer_load_dwordx4 v70, s[80:83], s35 offen lds
s_add_u32 m0, s100, 115712
s_add_u32 s35, s96, 557056
buffer_load_dwordx4 v71, s[80:83], s35 offen lds
s_add_u32 m0, s100, 116736
s_add_u32 s35, s96, 655360
buffer_load_dwordx4 v70, s[80:83], s35 offen lds
s_add_u32 m0, s100, 117760
s_add_u32 s35, s96, 688128
buffer_load_dwordx4 v71, s[80:83], s35 offen lds
s_add_u32 m0, s100, 0
s_add_u32 s35, s96, 786432
buffer_load_dwordx4 v70, s[80:83], s35 offen lds
s_add_u32 m0, s100, 1024
s_add_u32 s35, s96, 819200
buffer_load_dwordx4 v71, s[80:83], s35 offen lds
s_add_u32 m0, s100, 2048
s_add_u32 s35, s96, 917504
buffer_load_dwordx4 v70, s[80:83], s35 offen lds
s_add_u32 m0, s100, 3072
s_add_u32 s35, s96, 950272
buffer_load_dwordx4 v71, s[80:83], s35 offen lds
s_mov_b32 s34, 0x3e0293ee
s_mov_b32 s40, 0x00ff00ff
s_mov_b32 s41, 0x00ff00ff
s_mov_b32 s42, 0xff00ff00
s_mov_b32 s43, 0xff00ff00
s_mov_b32 s44, 0x33333333
s_mov_b32 s45, 0x33333333
s_mov_b32 s39, 4294830080
v_bfe_u32 v78, v79, 1, 1
v_mul_u32_u24 v78, 0xaaaa, v78
v_add_u32 v0, 0x4444, v78
v_lshlrev_b32 v1, 4, v79
s_lshl_b32 s35, s12, 12
v_add_u32 v2, s35, v1
v_add_u32 v1, 131072, v1
s_lshl_b32 s35, s12, 10
v_add_u32 v11, s35, v1
s_lshl_b32 s35, s12, 8
s_add_u32 s35, s35, 135168
v_lshl_add_u32 v12, v79, 2, s35
v_bfe_u32 v78, v79, 4, 2
v_mul_u32_u24 v9, 256, v78
v_bfe_u32 v78, v79, 1, 1
v_mul_u32_u24 v78, 128, v78
v_add_u32 v9, v9, v78
v_bfe_u32 v78, v79, 2, 2
v_mul_u32_u24 v78, 32, v78
v_add_u32 v9, v9, v78
v_bfe_u32 v78, v79, 0, 1
v_mul_u32_u24 v78, 16, v78
v_add_u32 v9, v9, v78
v_add_u32 v9, 147456, v9
v_bfe_u32 v78, v79, 2, 2
v_mul_u32_u24 v3, 256, v78
v_bfe_u32 v78, v79, 1, 1
v_mul_u32_u24 v78, 128, v78
v_add_u32 v3, v3, v78
v_bfe_u32 v78, v79, 0, 1
v_mul_u32_u24 v78, 16, v78
v_add_u32 v3, v3, v78
v_add_u32 v3, 147456, v3
v_bfe_u32 v77, v79, 3, 1
v_bfe_u32 v76, v79, 2, 1
v_xor_b32 v76, v76, v77
v_lshl_add_u32 v77, v76, 1, v77
v_bfe_u32 v76, v79, 4, 2
v_xor_b32 v77, v77, v76
v_lshl_add_u32 v3, v77, 5, v3
v_bfe_u32 v78, v79, 5, 1
v_mul_u32_u24 v4, 256, v78
v_bfe_u32 v78, v79, 4, 1
v_mul_u32_u24 v78, 64, v78
v_add_u32 v4, v4, v78
v_bfe_u32 v78, v79, 2, 2
v_mul_u32_u24 v78, 16, v78
v_add_u32 v4, v4, v78
v_bfe_u32 v78, v79, 0, 1
v_mul_u32_u24 v78, 8, v78
v_add_u32 v4, v4, v78
v_add_u32 v4, 147456, v4
v_bfe_u32 v78, v79, 5, 1
v_mul_u32_u24 v5, 512, v78
v_bfe_u32 v78, v79, 0, 5
v_mul_u32_u24 v78, 8, v78
v_add_u32 v5, v5, v78
v_add_u32 v5, 157696, v5
v_bfe_u32 v78, v79, 0, 4
v_mul_u32_u24 v6, 16, v78
v_bfe_u32 v78, v79, 4, 2
v_mul_u32_u24 v78, 4, v78
v_add_u32 v6, v6, v78
v_add_u32 v6, 147456, v6
v_bfe_u32 v78, v79, 3, 1
v_mul_u32_u24 v7, 256, v78
v_bfe_u32 v78, v79, 5, 1
v_mul_u32_u24 v78, 128, v78
v_add_u32 v7, v7, v78
v_bfe_u32 v78, v79, 0, 3
v_mul_u32_u24 v78, 16, v78
v_add_u32 v7, v7, v78
v_bfe_u32 v78, v79, 4, 1
v_mul_u32_u24 v78, 8, v78
v_add_u32 v7, v7, v78
v_add_u32 v7, 149504, v7
s_lshl_b32 s35, s12, 9
v_add_u32 v6, s35, v6
v_add_u32 v7, s35, v7
v_bfe_u32 v78, v79, 3, 1
v_mul_u32_u24 v8, 4096, v78
v_bfe_u32 v78, v79, 0, 3
v_mul_u32_u24 v78, 16, v78
v_add_u32 v8, v8, v78
v_bfe_u32 v78, v79, 4, 2
v_mul_u32_u24 v78, 8192, v78
v_add_u32 v8, v8, v78
v_bfe_u32 v78, v79, 4, 2
v_mul_u32_u24 v10, 512, v78
v_bfe_u32 v78, v79, 0, 4
v_mul_u32_u24 v78, 16, v78
v_add_u32 v10, v10, v78
s_mov_b32 s16, s13
s_cmp_eq_u32 s12, 0
s_cbranch_scc1 L_ch_task
s_mov_b32 s16, -1
s_cmp_eq_u32 s12, 1
s_cbranch_scc0 L_ch_task
s_and_b32 s35, s13, 3
s_cmp_eq_u32 s35, 0
s_cbranch_scc0 L_ch_task
s_lshr_b32 s16, s13, 2
s_add_u32 s16, s16, 32
L_ch_task:
s_bfe_u32 s35, s16, 65538
s_bfe_u32 s36, s16, 65537
s_xor_b32 s36, s36, s35
s_lshl_b32 s36, s36, 1
s_add_u32 s35, s35, s36
s_lshl_b32 s35, s35, 5
s_cmp_ge_u32 s16, 32
s_cselect_b32 s35, 0, s35
v_bfe_u32 v78, v79, 0, 3
v_mul_u32_u24 v13, 16, v78
v_bfe_u32 v78, v79, 4, 1
v_mul_u32_u24 v78, 8, v78
v_add_u32 v13, v13, v78
v_bfe_u32 v78, v79, 5, 1
v_mul_u32_u24 v78, 4, v78
v_add_u32 v13, v13, v78
v_bfe_u32 v78, v79, 3, 1
v_mul_u32_u24 v78, 8192, v78
v_add_u32 v13, v13, v78
v_xor_b32 v13, s35, v13
v_bfe_u32 v78, v79, 4, 2
v_mul_u32_u24 v68, 1024, v78
v_bfe_u32 v78, v79, 2, 2
v_mul_u32_u24 v78, 256, v78
v_add_u32 v68, v68, v78
v_bfe_u32 v78, v79, 0, 2
v_mul_u32_u24 v78, 8, v78
v_add_u32 v68, v68, v78
v_bfe_u32 v78, v79, 4, 1
v_mul_u32_u24 v76, 4, v78
v_bfe_u32 v78, v79, 2, 2
v_mul_u32_u24 v78, 1, v78
v_add_u32 v76, v76, v78
s_lshl_b32 s35, s12, 1
v_xor_b32 v76, s35, v76
v_lshl_add_u32 v68, v76, 5, v68
v_xor_b32 v69, 32, v68
v_bfe_u32 v78, v79, 4, 2
v_mul_u32_u24 v67, 512, v78
v_bfe_u32 v78, v79, 2, 2
v_mul_u32_u24 v78, 128, v78
v_add_u32 v67, v67, v78
v_bfe_u32 v78, v79, 0, 2
v_mul_u32_u24 v78, 8, v78
v_add_u32 v67, v67, v78
v_bfe_u32 v78, v79, 4, 1
v_mul_u32_u24 v76, 2, v78
v_bfe_u32 v78, v79, 3, 1
v_mul_u32_u24 v78, 1, v78
v_add_u32 v76, v76, v78
v_xor_b32 v76, s12, v76
v_lshl_add_u32 v67, v76, 5, v67
v_and_b32 v76, 7, v79
v_mov_b32 v77, 0x3f80
v_mov_b32 v78, 0x3f800000
v_cmp_eq_u32 vcc, 0, v76
s_nop 1
v_cndmask_b32 v22, 0, v77, vcc
v_cmp_eq_u32 vcc, 1, v76
s_nop 1
v_cndmask_b32 v22, v22, v78, vcc
v_cmp_eq_u32 vcc, 2, v76
s_nop 1
v_cndmask_b32 v23, 0, v77, vcc
v_cmp_eq_u32 vcc, 3, v76
s_nop 1
v_cndmask_b32 v23, v23, v78, vcc
v_cmp_eq_u32 vcc, 4, v76
s_nop 1
v_cndmask_b32 v24, 0, v77, vcc
v_cmp_eq_u32 vcc, 5, v76
s_nop 1
v_cndmask_b32 v24, v24, v78, vcc
v_cmp_eq_u32 vcc, 6, v76
s_nop 1
v_cndmask_b32 v25, 0, v77, vcc
v_cmp_eq_u32 vcc, 7, v76
s_nop 1
v_cndmask_b32 v25, v25, v78, vcc
v_mov_b32 v76, 0
v_mov_b32 v77, 162880
ds_write_b128 v1, v[22:25] offset:30720
ds_write_b32 v77, v76
ds_write_b32 v77, v76 offset:4
ds_write_b32 v77, v76 offset:8
s_waitcnt lgkmcnt(0)
s_waitcnt vmcnt(12)
s_barrier
s_cmp_lg_u32 s12, 0
s_cbranch_scc1 L_arr
v_mov_b32 v66, 1
s_mov_b64 exec, 1
buffer_atomic_add v66, off, s[8:11], 0 offset:132 sc1
s_mov_b64 exec, -1
L_arr:
s_add_u32 m0, s100, 16384
s_add_u32 s35, s56, 2097152
buffer_load_dwordx4 v70, s[80:83], s35 offen lds
s_add_u32 m0, s100, 17408
s_add_u32 s35, s56, 2129920
buffer_load_dwordx4 v71, s[80:83], s35 offen lds
s_add_u32 m0, s100, 18432
s_add_u32 s35, s56, 2228224
buffer_load_dwordx4 v70, s[80:83], s35 offen lds
s_add_u32 m0, s100, 19456
s_add_u32 s35, s56, 2260992
buffer_load_dwordx4 v71, s[80:83], s35 offen lds
v_xor_b32 v67, 0x10000, v67
v_xor_b32 v68, 0x10000, v68
v_xor_b32 v69, 0x10000, v69
ds_read_b64_tr_b16 a[0:1], v68 offset:16384
ds_read_b64_tr_b16 a[2:3], v68 offset:20480
ds_read_b64_tr_b16 a[4:5], v68 offset:24576
ds_read_b64_tr_b16 a[6:7], v68 offset:28672
ds_read_b64_tr_b16 a[8:9], v69 offset:16384
ds_read_b64_tr_b16 a[10:11], v69 offset:20480
ds_read_b64_tr_b16 a[12:13], v69 offset:24576
ds_read_b64_tr_b16 a[14:15], v69 offset:28672
s_waitcnt lgkmcnt(0)
s_waitcnt vmcnt(12)
s_barrier
s_add_u32 m0, s100, 32768
s_add_u32 s35, s96, 262144
buffer_load_dwordx4 v70, s[84:87], s35 offen lds
s_add_u32 m0, s100, 33792
s_add_u32 s35, s96, 294912
buffer_load_dwordx4 v71, s[84:87], s35 offen lds
s_add_u32 m0, s100, 34816
s_add_u32 s35, s96, 393216
buffer_load_dwordx4 v70, s[84:87], s35 offen lds
s_add_u32 m0, s100, 35840
s_add_u32 s35, s96, 425984
buffer_load_dwordx4 v71, s[84:87], s35 offen lds
ds_read_b64_tr_b16 a[16:17], v68 offset:32768
ds_read_b64_tr_b16 a[18:19], v68 offset:36864
ds_read_b64_tr_b16 a[20:21], v68 offset:40960
ds_read_b64_tr_b16 a[22:23], v68 offset:45056
ds_read_b64_tr_b16 a[24:25], v69 offset:32768
ds_read_b64_tr_b16 a[26:27], v69 offset:36864
ds_read_b64_tr_b16 a[28:29], v69 offset:40960
ds_read_b64_tr_b16 a[30:31], v69 offset:45056
s_waitcnt lgkmcnt(0)
s_waitcnt vmcnt(12)
s_barrier
s_add_u32 m0, s100, 49152
s_add_u32 s35, s96, 786432
buffer_load_dwordx4 v70, s[84:87], s35 offen lds
s_add_u32 m0, s100, 50176
s_add_u32 s35, s96, 819200
buffer_load_dwordx4 v71, s[84:87], s35 offen lds
s_add_u32 m0, s100, 51200
s_add_u32 s35, s96, 917504
buffer_load_dwordx4 v70, s[84:87], s35 offen lds
s_add_u32 m0, s100, 52224
s_add_u32 s35, s96, 950272
buffer_load_dwordx4 v71, s[84:87], s35 offen lds
ds_read_b64_tr_b16 a[32:33], v68 offset:49152
ds_read_b64_tr_b16 a[34:35], v68 offset:53248
ds_read_b64_tr_b16 a[36:37], v68 offset:57344
ds_read_b64_tr_b16 a[38:39], v68 offset:61440
ds_read_b64_tr_b16 a[40:41], v69 offset:49152
ds_read_b64_tr_b16 a[42:43], v69 offset:53248
ds_read_b64_tr_b16 a[44:45], v69 offset:57344
ds_read_b64_tr_b16 a[46:47], v69 offset:61440
s_waitcnt lgkmcnt(0)
s_waitcnt vmcnt(12)
s_barrier
s_add_u32 m0, s100, 65536
s_add_u32 s35, s97, 0
buffer_load_dwordx4 v70, s[80:83], s35 offen lds
s_add_u32 m0, s100, 66560
s_add_u32 s35, s97, 32768
buffer_load_dwordx4 v71, s[80:83], s35 offen lds
s_add_u32 m0, s100, 67584
s_add_u32 s35, s97, 131072
buffer_load_dwordx4 v70, s[80:83], s35 offen lds
s_add_u32 m0, s100, 68608
s_add_u32 s35, s97, 163840
buffer_load_dwordx4 v71, s[80:83], s35 offen lds
v_xor_b32 v67, 0x10000, v67
v_xor_b32 v68, 0x10000, v68
v_xor_b32 v69, 0x10000, v69
ds_read_b64_tr_b16 a[48:49], v68 offset:0
ds_read_b64_tr_b16 a[50:51], v68 offset:4096
ds_read_b64_tr_b16 a[52:53], v68 offset:8192
ds_read_b64_tr_b16 a[54:55], v68 offset:12288
ds_read_b64_tr_b16 a[56:57], v69 offset:0
ds_read_b64_tr_b16 a[58:59], v69 offset:4096
ds_read_b64_tr_b16 a[60:61], v69 offset:8192
ds_read_b64_tr_b16 a[62:63], v69 offset:12288
s_waitcnt lgkmcnt(0)
s_waitcnt vmcnt(12)
s_barrier
s_add_u32 m0, s100, 81920
s_add_u32 s35, s97, 262144
buffer_load_dwordx4 v70, s[80:83], s35 offen lds
s_add_u32 m0, s100, 82944
s_add_u32 s35, s97, 294912
buffer_load_dwordx4 v71, s[80:83], s35 offen lds
s_add_u32 m0, s100, 83968
s_add_u32 s35, s97, 393216
buffer_load_dwordx4 v70, s[80:83], s35 offen lds
s_add_u32 m0, s100, 84992
s_add_u32 s35, s97, 425984
buffer_load_dwordx4 v71, s[80:83], s35 offen lds
ds_read_b64_tr_b16 a[64:65], v68 offset:16384
ds_read_b64_tr_b16 a[66:67], v68 offset:20480
ds_read_b64_tr_b16 a[68:69], v68 offset:24576
ds_read_b64_tr_b16 a[70:71], v68 offset:28672
ds_read_b64_tr_b16 a[72:73], v69 offset:16384
ds_read_b64_tr_b16 a[74:75], v69 offset:20480
ds_read_b64_tr_b16 a[76:77], v69 offset:24576
ds_read_b64_tr_b16 a[78:79], v69 offset:28672
s_waitcnt lgkmcnt(0)
s_waitcnt vmcnt(12)
s_barrier
s_add_u32 m0, s100, 98304
s_add_u32 s35, s97, 524288
buffer_load_dwordx4 v70, s[80:83], s35 offen lds
s_add_u32 m0, s100, 99328
s_add_u32 s35, s97, 557056
buffer_load_dwordx4 v71, s[80:83], s35 offen lds
s_add_u32 m0, s100, 100352
s_add_u32 s35, s97, 655360
buffer_load_dwordx4 v70, s[80:83], s35 offen lds
s_add_u32 m0, s100, 101376
s_add_u32 s35, s97, 688128
buffer_load_dwordx4 v71, s[80:83], s35 offen lds
ds_read_b64_tr_b16 a[80:81], v68 offset:32768
ds_read_b64_tr_b16 a[82:83], v68 offset:36864
ds_read_b64_tr_b16 a[84:85], v68 offset:40960
ds_read_b64_tr_b16 a[86:87], v68 offset:45056
ds_read_b64_tr_b16 a[88:89], v69 offset:32768
ds_read_b64_tr_b16 a[90:91], v69 offset:36864
ds_read_b64_tr_b16 a[92:93], v69 offset:40960
ds_read_b64_tr_b16 a[94:95], v69 offset:45056
s_waitcnt lgkmcnt(0)
s_waitcnt vmcnt(12)
s_barrier
s_add_u32 m0, s100, 114688
s_add_u32 s35, s97, 786432
buffer_load_dwordx4 v70, s[80:83], s35 offen lds
s_add_u32 m0, s100, 115712
s_add_u32 s35, s97, 819200
buffer_load_dwordx4 v71, s[80:83], s35 offen lds
s_add_u32 m0, s100, 116736
s_add_u32 s35, s97, 917504
buffer_load_dwordx4 v70, s[80:83], s35 offen lds
s_add_u32 m0, s100, 117760
s_add_u32 s35, s97, 950272
buffer_load_dwordx4 v71, s[80:83], s35 offen lds
ds_read_b64_tr_b16 a[96:97], v68 offset:49152
ds_read_b64_tr_b16 a[98:99], v68 offset:53248
ds_read_b64_tr_b16 a[100:101], v68 offset:57344
ds_read_b64_tr_b16 a[102:103], v68 offset:61440
ds_read_b64_tr_b16 a[104:105], v69 offset:49152
ds_read_b64_tr_b16 a[106:107], v69 offset:53248
ds_read_b64_tr_b16 a[108:109], v69 offset:57344
ds_read_b64_tr_b16 a[110:111], v69 offset:61440
s_waitcnt lgkmcnt(0)
s_waitcnt vmcnt(12)
s_barrier
s_add_u32 m0, s100, 0
s_add_u32 s35, s57, 2097152
buffer_load_dwordx4 v70, s[80:83], s35 offen lds
s_add_u32 m0, s100, 1024
s_add_u32 s35, s57, 2129920
buffer_load_dwordx4 v71, s[80:83], s35 offen lds
s_add_u32 m0, s100, 2048
s_add_u32 s35, s57, 2228224
buffer_load_dwordx4 v70, s[80:83], s35 offen lds
s_add_u32 m0, s100, 3072
s_add_u32 s35, s57, 2260992
buffer_load_dwordx4 v71, s[80:83], s35 offen lds
v_xor_b32 v67, 0x10000, v67
v_xor_b32 v68, 0x10000, v68
v_xor_b32 v69, 0x10000, v69
ds_read_b64_tr_b16 a[112:113], v68 offset:0
ds_read_b64_tr_b16 a[114:115], v68 offset:4096
ds_read_b64_tr_b16 a[116:117], v68 offset:8192
ds_read_b64_tr_b16 a[118:119], v68 offset:12288
ds_read_b64_tr_b16 a[120:121], v69 offset:0
ds_read_b64_tr_b16 a[122:123], v69 offset:4096
ds_read_b64_tr_b16 a[124:125], v69 offset:8192
ds_read_b64_tr_b16 a[126:127], v69 offset:12288
s_waitcnt lgkmcnt(0)
s_waitcnt vmcnt(12)
s_barrier
s_add_u32 m0, s100, 16384
s_add_u32 s35, s97, 0
buffer_load_dwordx4 v70, s[84:87], s35 offen lds
s_add_u32 m0, s100, 17408
s_add_u32 s35, s97, 32768
buffer_load_dwordx4 v71, s[84:87], s35 offen lds
s_add_u32 m0, s100, 18432
s_add_u32 s35, s97, 131072
buffer_load_dwordx4 v70, s[84:87], s35 offen lds
s_add_u32 m0, s100, 19456
s_add_u32 s35, s97, 163840
buffer_load_dwordx4 v71, s[84:87], s35 offen lds
ds_read_b64_tr_b16 a[128:129], v68 offset:16384
ds_read_b64_tr_b16 a[130:131], v68 offset:20480
ds_read_b64_tr_b16 a[132:133], v68 offset:24576
ds_read_b64_tr_b16 a[134:135], v68 offset:28672
ds_read_b64_tr_b16 a[136:137], v69 offset:16384
ds_read_b64_tr_b16 a[138:139], v69 offset:20480
ds_read_b64_tr_b16 a[140:141], v69 offset:24576
ds_read_b64_tr_b16 a[142:143], v69 offset:28672
s_waitcnt lgkmcnt(0)
s_waitcnt vmcnt(12)
s_barrier
s_add_u32 m0, s100, 32768
s_add_u32 s35, s97, 262144
buffer_load_dwordx4 v70, s[84:87], s35 offen lds
s_add_u32 m0, s100, 33792
s_add_u32 s35, s97, 294912
buffer_load_dwordx4 v71, s[84:87], s35 offen lds
s_add_u32 m0, s100, 34816
s_add_u32 s35, s97, 393216
buffer_load_dwordx4 v70, s[84:87], s35 offen lds
s_add_u32 m0, s100, 35840
s_add_u32 s35, s97, 425984
buffer_load_dwordx4 v71, s[84:87], s35 offen lds
ds_read_b64_tr_b16 a[144:145], v68 offset:32768
ds_read_b64_tr_b16 a[146:147], v68 offset:36864
ds_read_b64_tr_b16 a[148:149], v68 offset:40960
ds_read_b64_tr_b16 a[150:151], v68 offset:45056
ds_read_b64_tr_b16 a[152:153], v69 offset:32768
ds_read_b64_tr_b16 a[154:155], v69 offset:36864
ds_read_b64_tr_b16 a[156:157], v69 offset:40960
ds_read_b64_tr_b16 a[158:159], v69 offset:45056
s_waitcnt lgkmcnt(0)
s_waitcnt vmcnt(12)
s_barrier
s_add_u32 m0, s100, 49152
s_add_u32 s35, s97, 524288
buffer_load_dwordx4 v70, s[84:87], s35 offen lds
s_add_u32 m0, s100, 50176
s_add_u32 s35, s97, 557056
buffer_load_dwordx4 v71, s[84:87], s35 offen lds
s_add_u32 m0, s100, 51200
s_add_u32 s35, s97, 655360
buffer_load_dwordx4 v70, s[84:87], s35 offen lds
s_add_u32 m0, s100, 52224
s_add_u32 s35, s97, 688128
buffer_load_dwordx4 v71, s[84:87], s35 offen lds
ds_read_b64_tr_b16 a[160:161], v68 offset:49152
ds_read_b64_tr_b16 a[162:163], v68 offset:53248
ds_read_b64_tr_b16 a[164:165], v68 offset:57344
ds_read_b64_tr_b16 a[166:167], v68 offset:61440
ds_read_b64_tr_b16 a[168:169], v69 offset:49152
ds_read_b64_tr_b16 a[170:171], v69 offset:53248
ds_read_b64_tr_b16 a[172:173], v69 offset:57344
ds_read_b64_tr_b16 a[174:175], v69 offset:61440
s_waitcnt lgkmcnt(0)
s_waitcnt vmcnt(12)
s_barrier
s_add_u32 m0, s100, 65536
s_add_u32 s35, s97, 786432
buffer_load_dwordx4 v70, s[84:87], s35 offen lds
s_add_u32 m0, s100, 66560
s_add_u32 s35, s97, 819200
buffer_load_dwordx4 v71, s[84:87], s35 offen lds
s_add_u32 m0, s100, 67584
s_add_u32 s35, s97, 917504
buffer_load_dwordx4 v70, s[84:87], s35 offen lds
s_add_u32 m0, s100, 68608
s_add_u32 s35, s97, 950272
buffer_load_dwordx4 v71, s[84:87], s35 offen lds
v_xor_b32 v67, 0x10000, v67
v_xor_b32 v68, 0x10000, v68
v_xor_b32 v69, 0x10000, v69
ds_read_b64_tr_b16 a[176:177], v68 offset:0
ds_read_b64_tr_b16 a[178:179], v68 offset:4096
ds_read_b64_tr_b16 a[180:181], v68 offset:8192
ds_read_b64_tr_b16 a[182:183], v68 offset:12288
ds_read_b64_tr_b16 a[184:185], v69 offset:0
ds_read_b64_tr_b16 a[186:187], v69 offset:4096
ds_read_b64_tr_b16 a[188:189], v69 offset:8192
ds_read_b64_tr_b16 a[190:191], v69 offset:12288
s_waitcnt lgkmcnt(0)
s_waitcnt vmcnt(12)
s_barrier
s_add_u32 m0, s100, 81920
s_add_u32 s35, s57, 2097152
buffer_load_dwordx4 v70, s[84:87], s35 offen lds
s_add_u32 m0, s100, 82944
s_add_u32 s35, s57, 2129920
buffer_load_dwordx4 v71, s[84:87], s35 offen lds
s_add_u32 m0, s100, 83968
s_add_u32 s35, s57, 2228224
buffer_load_dwordx4 v70, s[84:87], s35 offen lds
s_add_u32 m0, s100, 84992
s_add_u32 s35, s57, 2260992
buffer_load_dwordx4 v71, s[84:87], s35 offen lds
ds_read_b64_tr_b16 a[192:193], v68 offset:16384
ds_read_b64_tr_b16 a[194:195], v68 offset:20480
ds_read_b64_tr_b16 a[196:197], v68 offset:24576
ds_read_b64_tr_b16 a[198:199], v68 offset:28672
ds_read_b64_tr_b16 a[200:201], v69 offset:16384
ds_read_b64_tr_b16 a[202:203], v69 offset:20480
ds_read_b64_tr_b16 a[204:205], v69 offset:24576
ds_read_b64_tr_b16 a[206:207], v69 offset:28672
s_waitcnt lgkmcnt(0)
s_waitcnt vmcnt(12)
s_barrier
s_add_u32 m0, s100, 98304
s_add_u32 s35, s97, 0
buffer_load_dwordx4 v70, s[88:91], s35 offen lds
s_add_u32 m0, s100, 99328
s_add_u32 s35, s97, 32768
buffer_load_dwordx4 v71, s[88:91], s35 offen lds
s_add_u32 m0, s100, 100352
s_add_u32 s35, s97, 131072
buffer_load_dwordx4 v70, s[88:91], s35 offen lds
s_add_u32 m0, s100, 101376
s_add_u32 s35, s97, 163840
buffer_load_dwordx4 v71, s[88:91], s35 offen lds
ds_read_b64_tr_b16 a[208:209], v68 offset:32768
ds_read_b64_tr_b16 a[210:211], v68 offset:36864
ds_read_b64_tr_b16 a[212:213], v68 offset:40960
ds_read_b64_tr_b16 a[214:215], v68 offset:45056
ds_read_b64_tr_b16 a[216:217], v69 offset:32768
ds_read_b64_tr_b16 a[218:219], v69 offset:36864
ds_read_b64_tr_b16 a[220:221], v69 offset:40960
ds_read_b64_tr_b16 a[222:223], v69 offset:45056
s_waitcnt lgkmcnt(0)
s_waitcnt vmcnt(12)
s_barrier
s_add_u32 m0, s100, 114688
s_add_u32 s35, s97, 262144
buffer_load_dwordx4 v70, s[88:91], s35 offen lds
s_add_u32 m0, s100, 115712
s_add_u32 s35, s97, 294912
buffer_load_dwordx4 v71, s[88:91], s35 offen lds
s_add_u32 m0, s100, 116736
s_add_u32 s35, s97, 393216
buffer_load_dwordx4 v70, s[88:91], s35 offen lds
s_add_u32 m0, s100, 117760
s_add_u32 s35, s97, 425984
buffer_load_dwordx4 v71, s[88:91], s35 offen lds
buffer_load_dwordx4 v[60:63], off, s[8:11], 0 offset:128 sc1
s_load_dwordx2 s[72:73], s[0:1], 8
s_waitcnt lgkmcnt(0)
s_mov_b32 s74, 10240
s_mov_b32 s75, 0x20000
v_bfe_u32 v59, v79, 0, 3
v_mul_u32_u24 v58, 1280, v59
v_bfe_u32 v59, v79, 4, 1
v_mul_u32_u24 v59, 8, v59
v_add_u32 v58, v58, v59
v_bfe_u32 v59, v79, 5, 1
v_mul_u32_u24 v59, 4, v59
v_add_u32 v58, v58, v59
v_bfe_u32 v59, v79, 0, 1
v_mul_u32_u24 v57, 1280, v59
v_bfe_u32 v59, v79, 1, 1
v_mul_u32_u24 v59, 32, v59
v_add_u32 v57, v57, v59
v_bfe_u32 v59, v79, 2, 1
v_mul_u32_u24 v59, 256, v59
v_add_u32 v57, v57, v59
v_bfe_u32 v59, v79, 4, 1
v_mul_u32_u24 v59, 8, v59
v_add_u32 v57, v57, v59
v_bfe_u32 v59, v79, 5, 1
v_mul_u32_u24 v59, 4, v59
v_add_u32 v57, v57, v59
s_min_u32 s37, s16, 39
s_lshl_b32 s36, s37, 4
s_cmp_ge_u32 s37, 32
s_cbranch_scc1 L_ch_m0b
v_mov_b32 v58, v57
s_lshr_b32 s36, s37, 3
s_lshl_b32 s36, s36, 6
s_and_b32 s35, s37, 1
s_lshl_b32 s35, s35, 4
s_add_u32 s36, s36, s35
s_bfe_u32 s35, s37, 131073
s_mul_i32 s35, s35, 2560
s_add_u32 s36, s36, s35
L_ch_m0b:
s_mul_i32 s35, s14, 640
s_add_u32 s35, s35, s36
buffer_load_dword v64, v58, s[72:75], s35 offen
ds_read_b64_tr_b16 a[224:225], v68 offset:49152
ds_read_b64_tr_b16 a[226:227], v68 offset:53248
ds_read_b64_tr_b16 a[228:229], v68 offset:57344
ds_read_b64_tr_b16 a[230:231], v68 offset:61440
ds_read_b64_tr_b16 a[232:233], v69 offset:49152
ds_read_b64_tr_b16 a[234:235], v69 offset:53248
ds_read_b64_tr_b16 a[236:237], v69 offset:57344
ds_read_b64_tr_b16 a[238:239], v69 offset:61440
s_waitcnt lgkmcnt(0)
s_waitcnt vmcnt(12)
s_barrier
s_add_u32 m0, s100, 0
s_add_u32 s35, s97, 524288
buffer_load_dwordx4 v70, s[88:91], s35 offen lds
s_add_u32 m0, s100, 1024
s_add_u32 s35, s97, 557056
buffer_load_dwordx4 v71, s[88:91], s35 offen lds
s_add_u32 m0, s100, 2048
s_add_u32 s35, s97, 655360
buffer_load_dwordx4 v70, s[88:91], s35 offen lds
s_add_u32 m0, s100, 3072
s_add_u32 s35, s97, 688128
buffer_load_dwordx4 v71, s[88:91], s35 offen lds
v_xor_b32 v67, 0x10000, v67
v_xor_b32 v68, 0x10000, v68
v_xor_b32 v69, 0x10000, v69
ds_read_b64_tr_b16 a[240:241], v68 offset:0
ds_read_b64_tr_b16 a[242:243], v68 offset:4096
ds_read_b64_tr_b16 a[244:245], v68 offset:8192
ds_read_b64_tr_b16 a[246:247], v68 offset:12288
ds_read_b64_tr_b16 a[248:249], v69 offset:0
ds_read_b64_tr_b16 a[250:251], v69 offset:4096
ds_read_b64_tr_b16 a[252:253], v69 offset:8192
ds_read_b64_tr_b16 a[254:255], v69 offset:12288
s_waitcnt lgkmcnt(0)
s_waitcnt vmcnt(12)
s_barrier
s_add_u32 m0, s100, 16384
s_add_u32 s35, s97, 786432
buffer_load_dwordx4 v70, s[88:91], s35 offen lds
s_add_u32 m0, s100, 17408
s_add_u32 s35, s97, 819200
buffer_load_dwordx4 v71, s[88:91], s35 offen lds
s_add_u32 m0, s100, 18432
s_add_u32 s35, s97, 917504
buffer_load_dwordx4 v70, s[88:91], s35 offen lds
s_add_u32 m0, s100, 19456
s_add_u32 s35, s97, 950272
buffer_load_dwordx4 v71, s[88:91], s35 offen lds
ds_read_b64_tr_b16 v[80:81], v68 offset:16384
ds_read_b64_tr_b16 v[82:83], v68 offset:20480
ds_read_b64_tr_b16 v[84:85], v68 offset:24576
ds_read_b64_tr_b16 v[86:87], v68 offset:28672
ds_read_b64_tr_b16 v[88:89], v69 offset:16384
ds_read_b64_tr_b16 v[90:91], v69 offset:20480
ds_read_b64_tr_b16 v[92:93], v69 offset:24576
ds_read_b64_tr_b16 v[94:95], v69 offset:28672
s_waitcnt lgkmcnt(0)
s_waitcnt vmcnt(12)
s_barrier
s_add_u32 m0, s100, 32768
s_add_u32 s35, s57, 2097152
buffer_load_dwordx4 v70, s[88:91], s35 offen lds
s_add_u32 m0, s100, 33792
s_add_u32 s35, s57, 2129920
buffer_load_dwordx4 v71, s[88:91], s35 offen lds
s_add_u32 m0, s100, 34816
s_add_u32 s35, s57, 2228224
buffer_load_dwordx4 v70, s[88:91], s35 offen lds
s_add_u32 m0, s100, 35840
s_add_u32 s35, s57, 2260992
buffer_load_dwordx4 v71, s[88:91], s35 offen lds
ds_read_b64_tr_b16 v[96:97], v68 offset:32768
ds_read_b64_tr_b16 v[98:99], v68 offset:36864
ds_read_b64_tr_b16 v[100:101], v68 offset:40960
ds_read_b64_tr_b16 v[102:103], v68 offset:45056
ds_read_b64_tr_b16 v[104:105], v69 offset:32768
ds_read_b64_tr_b16 v[106:107], v69 offset:36864
ds_read_b64_tr_b16 v[108:109], v69 offset:40960
ds_read_b64_tr_b16 v[110:111], v69 offset:45056
s_waitcnt lgkmcnt(0)
s_waitcnt vmcnt(12)
s_barrier
s_add_u32 m0, s100, 49152
s_add_u32 s35, s98, 0
buffer_load_dwordx4 v72, s[92:95], s35 offen lds
s_add_u32 m0, s100, 50176
s_add_u32 s35, s98, 5120
buffer_load_dwordx4 v73, s[92:95], s35 offen lds
s_add_u32 m0, s100, 51200
s_add_u32 s35, s98, 20480
buffer_load_dwordx4 v72, s[92:95], s35 offen lds
s_add_u32 m0, s100, 52224
s_add_u32 s35, s98, 25600
buffer_load_dwordx4 v73, s[92:95], s35 offen lds
ds_read_b64_tr_b16 v[112:113], v68 offset:49152
ds_read_b64_tr_b16 v[114:115], v68 offset:53248
ds_read_b64_tr_b16 v[116:117], v68 offset:57344
ds_read_b64_tr_b16 v[118:119], v68 offset:61440
ds_read_b64_tr_b16 v[120:121], v69 offset:49152
ds_read_b64_tr_b16 v[122:123], v69 offset:53248
ds_read_b64_tr_b16 v[124:125], v69 offset:57344
ds_read_b64_tr_b16 v[126:127], v69 offset:61440
s_waitcnt lgkmcnt(0)
s_waitcnt vmcnt(12)
s_barrier
s_add_u32 m0, s100, 65536
s_add_u32 s35, s98, 256
buffer_load_dwordx4 v72, s[92:95], s35 offen lds
s_add_u32 m0, s100, 66560
s_add_u32 s35, s98, 5376
buffer_load_dwordx4 v73, s[92:95], s35 offen lds
s_add_u32 m0, s100, 67584
s_add_u32 s35, s98, 20736
buffer_load_dwordx4 v72, s[92:95], s35 offen lds
s_add_u32 m0, s100, 68608
s_add_u32 s35, s98, 25856
buffer_load_dwordx4 v73, s[92:95], s35 offen lds
v_xor_b32 v67, 0x10000, v67
v_xor_b32 v68, 0x10000, v68
v_xor_b32 v69, 0x10000, v69
ds_read_b64_tr_b16 v[128:129], v68 offset:0
ds_read_b64_tr_b16 v[130:131], v68 offset:4096
ds_read_b64_tr_b16 v[132:133], v68 offset:8192
ds_read_b64_tr_b16 v[134:135], v68 offset:12288
ds_read_b64_tr_b16 v[136:137], v69 offset:0
ds_read_b64_tr_b16 v[138:139], v69 offset:4096
ds_read_b64_tr_b16 v[140:141], v69 offset:8192
ds_read_b64_tr_b16 v[142:143], v69 offset:12288
s_waitcnt lgkmcnt(0)
s_waitcnt vmcnt(12)
s_barrier
s_add_u32 m0, s100, 81920
s_add_u32 s35, s98, 81920
buffer_load_dwordx4 v72, s[92:95], s35 offen lds
s_add_u32 m0, s100, 82944
s_add_u32 s35, s98, 87040
buffer_load_dwordx4 v73, s[92:95], s35 offen lds
s_add_u32 m0, s100, 83968
s_add_u32 s35, s98, 102400
buffer_load_dwordx4 v72, s[92:95], s35 offen lds
s_add_u32 m0, s100, 84992
s_add_u32 s35, s98, 107520
buffer_load_dwordx4 v73, s[92:95], s35 offen lds
ds_read_b64_tr_b16 v[144:145], v68 offset:16384
ds_read_b64_tr_b16 v[146:147], v68 offset:20480
ds_read_b64_tr_b16 v[148:149], v68 offset:24576
ds_read_b64_tr_b16 v[150:151], v68 offset:28672
ds_read_b64_tr_b16 v[152:153], v69 offset:16384
ds_read_b64_tr_b16 v[154:155], v69 offset:20480
ds_read_b64_tr_b16 v[156:157], v69 offset:24576
ds_read_b64_tr_b16 v[158:159], v69 offset:28672
s_waitcnt lgkmcnt(0)
s_waitcnt vmcnt(12)
s_barrier
s_add_u32 m0, s100, 98304
s_add_u32 s35, s98, 82176
buffer_load_dwordx4 v72, s[92:95], s35 offen lds
s_add_u32 m0, s100, 99328
s_add_u32 s35, s98, 87296
buffer_load_dwordx4 v73, s[92:95], s35 offen lds
s_add_u32 m0, s100, 100352
s_add_u32 s35, s98, 102656
buffer_load_dwordx4 v72, s[92:95], s35 offen lds
s_add_u32 m0, s100, 101376
s_add_u32 s35, s98, 107776
buffer_load_dwordx4 v73, s[92:95], s35 offen lds
ds_read_b64_tr_b16 v[160:161], v68 offset:32768
ds_read_b64_tr_b16 v[162:163], v68 offset:36864
ds_read_b64_tr_b16 v[164:165], v68 offset:40960
ds_read_b64_tr_b16 v[166:167], v68 offset:45056
ds_read_b64_tr_b16 v[168:169], v69 offset:32768
ds_read_b64_tr_b16 v[170:171], v69 offset:36864
ds_read_b64_tr_b16 v[172:173], v69 offset:40960
ds_read_b64_tr_b16 v[174:175], v69 offset:45056
s_waitcnt lgkmcnt(0)
s_waitcnt vmcnt(12)
s_barrier
s_lshr_b32 s36, s100, 1
s_add_u32 m0, s36, 114688
s_add_u32 s35, s98, 512
buffer_load_dwordx4 v74, s[92:95], s35 offen lds
s_lshr_b32 s36, s100, 1
s_add_u32 m0, s36, 115712
s_add_u32 s35, s98, 20992
buffer_load_dwordx4 v74, s[92:95], s35 offen lds
s_lshr_b32 s36, s100, 1
s_add_u32 m0, s36, 122880
s_add_u32 s35, s98, 82432
buffer_load_dwordx4 v74, s[92:95], s35 offen lds
s_lshr_b32 s36, s100, 1
s_add_u32 m0, s36, 123904
s_add_u32 s35, s98, 102912
buffer_load_dwordx4 v74, s[92:95], s35 offen lds
s_mov_b32 s38, 0
s_mov_b32 s35, 104
L_ch_st:
v_min_u32 v59, v60, v62
v_cmp_gt_u32 vcc, 1, v59
s_cbranch_vccnz L_ch_st2
v_cmp_gt_u32 vcc, s35, v61
s_cbranch_vccz L_ch_st3
L_ch_st2:
buffer_load_dwordx4 v[60:63], off, s[8:11], 0 offset:128 sc1
s_add_u32 s38, s38, 1
s_cmp_ge_u32 s38, 524288
s_cbranch_scc1 L_err
s_waitcnt vmcnt(0)
s_branch L_ch_st
L_ch_st3:
v_readfirstlane_b32 s17, v62
s_nop 0
s_sub_u32 s17, s17, 1
s_lshl_b32 s17, s17, 13
s_cmp_eq_u32 s16, -1
s_cbranch_scc1 L_ch_nom0
s_lshl_b32 s37, s16, 7
s_lshl_b32 s35, s14, 16
s_add_u32 s35, s35, s37
s_add_u32 s35, s35, 524288
s_lshl_b32 s36, s14, 14
s_add_u32 s36, s36, s37
s_add_u32 s36, s36, 2097152
s_add_u32 s36, s36, s17
v_min_u32 v64, -2, v64
buffer_store_dword v64, v13, s[4:7], s35 offen sc1
s_mov_b64 exec, s[40:41]
buffer_store_dword v64, v13, s[4:7], s36 offen sc1
s_mov_b64 exec, -1
L_ch_nom0:
ds_read_b64_tr_b16 v[176:177], v68 offset:49152
ds_read_b64_tr_b16 v[178:179], v68 offset:53248
ds_read_b64_tr_b16 v[180:181], v68 offset:57344
ds_read_b64_tr_b16 v[182:183], v68 offset:61440
ds_read_b64_tr_b16 v[184:185], v69 offset:49152
ds_read_b64_tr_b16 v[186:187], v69 offset:53248
ds_read_b64_tr_b16 v[188:189], v69 offset:57344
ds_read_b64_tr_b16 v[190:191], v69 offset:61440
s_waitcnt lgkmcnt(0)
s_waitcnt vmcnt(12)
s_barrier
s_add_u32 m0, s100, 0
s_add_u32 s35, s96, 0
buffer_load_dwordx4 v70, s[84:87], s35 offen lds
s_add_u32 m0, s100, 1024
s_add_u32 s35, s96, 32768
buffer_load_dwordx4 v71, s[84:87], s35 offen lds
s_add_u32 m0, s100, 2048
s_add_u32 s35, s96, 131072
buffer_load_dwordx4 v70, s[84:87], s35 offen lds
s_add_u32 m0, s100, 3072
s_add_u32 s35, s96, 163840
buffer_load_dwordx4 v71, s[84:87], s35 offen lds
v_xor_b32 v67, 0x10000, v67
v_xor_b32 v68, 0x10000, v68
v_xor_b32 v69, 0x10000, v69
ds_read_b64_tr_b16 v[192:193], v68 offset:0
ds_read_b64_tr_b16 v[194:195], v68 offset:4096
ds_read_b64_tr_b16 v[196:197], v68 offset:8192
ds_read_b64_tr_b16 v[198:199], v68 offset:12288
ds_read_b64_tr_b16 v[200:201], v69 offset:0
ds_read_b64_tr_b16 v[202:203], v69 offset:4096
ds_read_b64_tr_b16 v[204:205], v69 offset:8192
ds_read_b64_tr_b16 v[206:207], v69 offset:12288
s_waitcnt lgkmcnt(0)
s_waitcnt vmcnt(12)
s_barrier
s_add_u32 m0, s100, 16384
s_add_u32 s35, s96, 0
buffer_load_dwordx4 v70, s[88:91], s35 offen lds
s_add_u32 m0, s100, 17408
s_add_u32 s35, s96, 32768
buffer_load_dwordx4 v71, s[88:91], s35 offen lds
s_add_u32 m0, s100, 18432
s_add_u32 s35, s96, 131072
buffer_load_dwordx4 v70, s[88:91], s35 offen lds
s_add_u32 m0, s100, 19456
s_add_u32 s35, s96, 163840
buffer_load_dwordx4 v71, s[88:91], s35 offen lds
ds_read_b64_tr_b16 v[208:209], v68 offset:16384
ds_read_b64_tr_b16 v[210:211], v68 offset:20480
ds_read_b64_tr_b16 v[212:213], v68 offset:24576
ds_read_b64_tr_b16 v[214:215], v68 offset:28672
ds_read_b64_tr_b16 v[216:217], v69 offset:16384
ds_read_b64_tr_b16 v[218:219], v69 offset:20480
ds_read_b64_tr_b16 v[220:221], v69 offset:24576
ds_read_b64_tr_b16 v[222:223], v69 offset:28672
s_waitcnt lgkmcnt(0)
s_waitcnt vmcnt(12)
s_barrier
s_add_u32 m0, s100, 32768
s_add_u32 s35, s96, 262144
buffer_load_dwordx4 v70, s[88:91], s35 offen lds
s_add_u32 m0, s100, 33792
s_add_u32 s35, s96, 294912
buffer_load_dwordx4 v71, s[88:91], s35 offen lds
s_add_u32 m0, s100, 34816
s_add_u32 s35, s96, 393216
buffer_load_dwordx4 v70, s[88:91], s35 offen lds
s_add_u32 m0, s100, 35840
s_add_u32 s35, s96, 425984
buffer_load_dwordx4 v71, s[88:91], s35 offen lds
ds_read_b64_tr_b16 v[224:225], v68 offset:32768
ds_read_b64_tr_b16 v[226:227], v68 offset:36864
ds_read_b64_tr_b16 v[228:229], v68 offset:40960
ds_read_b64_tr_b16 v[230:231], v68 offset:45056
ds_read_b64_tr_b16 v[232:233], v69 offset:32768
ds_read_b64_tr_b16 v[234:235], v69 offset:36864
ds_read_b64_tr_b16 v[236:237], v69 offset:40960
ds_read_b64_tr_b16 v[238:239], v69 offset:45056
s_waitcnt lgkmcnt(0)
s_waitcnt vmcnt(12)
s_barrier
s_add_u32 m0, s100, 49152
s_add_u32 s35, s96, 524288
buffer_load_dwordx4 v70, s[84:87], s35 offen lds
s_add_u32 m0, s100, 50176
s_add_u32 s35, s96, 557056
buffer_load_dwordx4 v71, s[84:87], s35 offen lds
s_add_u32 m0, s100, 51200
s_add_u32 s35, s96, 655360
buffer_load_dwordx4 v70, s[84:87], s35 offen lds
s_add_u32 m0, s100, 52224
s_add_u32 s35, s96, 688128
buffer_load_dwordx4 v71, s[84:87], s35 offen lds
ds_read_b64_tr_b16 v[240:241], v67 offset:49152
ds_read_b64_tr_b16 v[242:243], v67 offset:51200
ds_read_b64_tr_b16 v[244:245], v67 offset:53248
ds_read_b64_tr_b16 v[246:247], v67 offset:55296
ds_read_b64_tr_b16 v[248:249], v67 offset:57344
ds_read_b64_tr_b16 v[250:251], v67 offset:59392
ds_read_b64_tr_b16 v[252:253], v67 offset:61440
ds_read_b64_tr_b16 v[254:255], v67 offset:63488
s_waitcnt lgkmcnt(0)
s_waitcnt vmcnt(12)
s_barrier
s_add_u32 m0, s100, 65536
s_add_u32 s35, s96, 524288
buffer_load_dwordx4 v70, s[88:91], s35 offen lds
s_add_u32 m0, s100, 66560
s_add_u32 s35, s96, 557056
buffer_load_dwordx4 v71, s[88:91], s35 offen lds
s_add_u32 m0, s100, 67584
s_add_u32 s35, s96, 655360
buffer_load_dwordx4 v70, s[88:91], s35 offen lds
s_add_u32 m0, s100, 68608
s_add_u32 s35, s96, 688128
buffer_load_dwordx4 v71, s[88:91], s35 offen lds
s_mov_b32 s15, 0
s_lshl_b32 s31, s13, 7
s_add_u32 s31, s31, 1572864
s_mov_b32 s30, 162816
s_lshl_b32 s35, s13, 1
s_add_u32 s35, s35, s14
s_lshl_b32 s33, s35, 7
s_add_u32 s33, s33, 1581056
s_mov_b32 s0, 0
s_mov_b32 s78, s34
s_mov_b32 s79, s34
s_mov_b32 s97, 0
s_and_b32 s35, s15, 3
s_lshl_b32 s36, s14, 2
s_add_u32 s37, s35, s36
s_lshl_b32 s18, s37, 14
s_and_b32 s35, s13, 0
s_lshl_b32 s35, s35, 13
s_add_u32 s18, s18, s35
s_add_u32 s18, s18, 393216
s_add_u32 s35, s15, 1
s_and_b32 s35, s35, 3
s_add_u32 s37, s35, s36
s_lshl_b32 s20, s37, 14
s_xor_b32 s37, s37, 2
s_lshl_b32 s29, s37, 14
s_lshl_b32 s35, s16, 7
s_add_u32 s36, s35, 524288
s_add_u32 s20, s20, s36
s_add_u32 s29, s29, s36
s_lshl_b32 s36, s15, 1
s_add_u32 s36, s36, s14
s_lshl_b32 s36, s36, 14
s_add_u32 s36, s36, s17
s_add_u32 s21, s36, s35
s_add_u32 s21, s21, 2129920
s_xor_b32 s26, s36, 16384
s_add_u32 s26, s26, 1966080
s_and_b32 s35, s15, 1
s_lshl_b32 s19, s35, 13
s_lshl_b32 s36, s14, 1
s_add_u32 s35, s35, s36
s_mul_i32 s35, s35, 163840
s_lshl_b32 s37, s16, 12
s_add_u32 s37, s37, 524288
s_add_u32 s27, s35, s37
s_lshl_b32 s37, s13, 7
s_add_u32 s35, s35, s37
s_add_u32 s35, s35, 655360
s_lshl_b32 s37, s12, 15
s_add_u32 s24, s35, s37
s_lshl_b32 s37, s12, 13
s_add_u32 s25, s35, s37
s_add_u32 s25, s25, 131072
s_lshl_b32 s35, s15, 5
s_add_u32 s35, s35, s13
s_lshl_b32 s51, s35, 14
s_lshl_b32 s37, s12, 11
s_add_u32 s51, s51, s37
s_add_u32 s51, s51, 16777216
s_add_u32 s47, s51, 8192
s_add_u32 s46, s51, 524288
s_xor_b32 s28, s19, 8192
s_add_u32 s28, s28, s37
s_add_u32 s28, s28, 131072
s_lshl_b32 s32, s35, 12
s_add_u32 s32, s32, 50331648
s_lshl_b32 s37, s12, 9
s_add_u32 s57, s32, s37
s_lshl_b32 s37, s14, 11
s_add_u32 s57, s57, s37
s_sub_u32 s57, s57, 65536
s_mov_b32 s32, s18
s_sub_u32 s44, s20, 16384
s_mov_b32 s45, 163840
s_lshl_b32 s35, s12, 10
s_add_u32 s1, s35, 152576
s_lshl_b32 s35, s12, 8
s_add_u32 s2, s35, 156672
buffer_load_dwordx4 v[50:53], off, s[4:7], s31 sc1
buffer_load_dwordx4 v[54:57], off, s[4:7], s31 offset:16 sc1
v_xor_b32 v67, 0x10000, v67
v_xor_b32 v68, 0x10000, v68
v_xor_b32 v69, 0x10000, v69
ds_read_b64_tr_b16 v[30:31], v68 offset:0
ds_read_b64_tr_b16 v[32:33], v68 offset:4096
ds_read_b64_tr_b16 v[34:35], v68 offset:8192
ds_read_b64_tr_b16 v[36:37], v68 offset:12288
ds_read_b64_tr_b16 v[38:39], v69 offset:0
ds_read_b64_tr_b16 v[40:41], v69 offset:4096
ds_read_b64_tr_b16 v[42:43], v69 offset:8192
ds_read_b64_tr_b16 v[44:45], v69 offset:12288
s_waitcnt lgkmcnt(0)
s_waitcnt vmcnt(12)
s_barrier
s_add_u32 m0, s100, 81920
s_add_u32 s35, s96, 786432
buffer_load_dwordx4 v70, s[88:91], s35 offen lds
s_add_u32 m0, s100, 82944
s_add_u32 s35, s96, 819200
buffer_load_dwordx4 v71, s[88:91], s35 offen lds
s_add_u32 m0, s100, 83968
s_add_u32 s35, s96, 917504
buffer_load_dwordx4 v70, s[88:91], s35 offen lds
s_add_u32 m0, s100, 84992
s_add_u32 s35, s96, 950272
buffer_load_dwordx4 v71, s[88:91], s35 offen lds
ds_write_b128 v2, v[30:33] offset:0
ds_write_b128 v2, v[34:37] offset:1024
ds_write_b128 v2, v[38:41] offset:2048
ds_write_b128 v2, v[42:45] offset:3072
ds_read_b64_tr_b16 v[14:15], v68 offset:16384
ds_read_b64_tr_b16 v[16:17], v68 offset:20480
ds_read_b64_tr_b16 v[18:19], v68 offset:24576
ds_read_b64_tr_b16 v[20:21], v68 offset:28672
ds_read_b64_tr_b16 v[22:23], v69 offset:16384
ds_read_b64_tr_b16 v[24:25], v69 offset:20480
ds_read_b64_tr_b16 v[26:27], v69 offset:24576
ds_read_b64_tr_b16 v[28:29], v69 offset:28672
s_waitcnt lgkmcnt(0)
s_waitcnt vmcnt(12)
s_barrier
s_add_u32 m0, s100, 98304
s_add_u32 s35, s56, 2097152
buffer_load_dwordx4 v70, s[84:87], s35 offen lds
s_add_u32 m0, s100, 99328
s_add_u32 s35, s56, 2129920
buffer_load_dwordx4 v71, s[84:87], s35 offen lds
s_add_u32 m0, s100, 100352
s_add_u32 s35, s56, 2228224
buffer_load_dwordx4 v70, s[84:87], s35 offen lds
s_add_u32 m0, s100, 101376
s_add_u32 s35, s56, 2260992
buffer_load_dwordx4 v71, s[84:87], s35 offen lds
ds_write_b128 v2, v[14:17] offset:16384
ds_write_b128 v2, v[18:21] offset:17408
ds_write_b128 v2, v[22:25] offset:18432
ds_write_b128 v2, v[26:29] offset:19456
ds_read_b64_tr_b16 v[30:31], v68 offset:32768
ds_read_b64_tr_b16 v[32:33], v68 offset:36864
ds_read_b64_tr_b16 v[34:35], v68 offset:40960
ds_read_b64_tr_b16 v[36:37], v68 offset:45056
ds_read_b64_tr_b16 v[38:39], v69 offset:32768
ds_read_b64_tr_b16 v[40:41], v69 offset:36864
ds_read_b64_tr_b16 v[42:43], v69 offset:40960
ds_read_b64_tr_b16 v[44:45], v69 offset:45056
s_waitcnt lgkmcnt(0)
s_waitcnt vmcnt(12)
s_barrier
s_add_u32 m0, s100, 114688
s_add_u32 s35, s56, 2097152
buffer_load_dwordx4 v70, s[88:91], s35 offen lds
s_add_u32 m0, s100, 115712
s_add_u32 s35, s56, 2129920
buffer_load_dwordx4 v71, s[88:91], s35 offen lds
s_add_u32 m0, s100, 116736
s_add_u32 s35, s56, 2228224
buffer_load_dwordx4 v70, s[88:91], s35 offen lds
s_add_u32 m0, s100, 117760
s_add_u32 s35, s56, 2260992
buffer_load_dwordx4 v71, s[88:91], s35 offen lds
ds_write_b128 v2, v[30:33] offset:32768
ds_write_b128 v2, v[34:37] offset:33792
ds_write_b128 v2, v[38:41] offset:34816
ds_write_b128 v2, v[42:45] offset:35840
ds_read_b64_tr_b16 v[14:15], v68 offset:49152
ds_read_b64_tr_b16 v[16:17], v68 offset:53248
ds_read_b64_tr_b16 v[18:19], v68 offset:57344
ds_read_b64_tr_b16 v[20:21], v68 offset:61440
ds_read_b64_tr_b16 v[22:23], v69 offset:49152
ds_read_b64_tr_b16 v[24:25], v69 offset:53248
ds_read_b64_tr_b16 v[26:27], v69 offset:57344
ds_read_b64_tr_b16 v[28:29], v69 offset:61440
s_waitcnt lgkmcnt(0)
s_waitcnt vmcnt(12)
s_barrier
ds_write_b128 v2, v[14:17] offset:49152
ds_write_b128 v2, v[18:21] offset:50176
ds_write_b128 v2, v[22:25] offset:51200
ds_write_b128 v2, v[26:29] offset:52224
v_xor_b32 v67, 0x10000, v67
v_xor_b32 v68, 0x10000, v68
v_xor_b32 v69, 0x10000, v69
ds_read_b64_tr_b16 v[30:31], v68 offset:0
ds_read_b64_tr_b16 v[32:33], v68 offset:4096
ds_read_b64_tr_b16 v[34:35], v68 offset:8192
ds_read_b64_tr_b16 v[36:37], v68 offset:12288
ds_read_b64_tr_b16 v[38:39], v69 offset:0
ds_read_b64_tr_b16 v[40:41], v69 offset:4096
ds_read_b64_tr_b16 v[42:43], v69 offset:8192
ds_read_b64_tr_b16 v[44:45], v69 offset:12288
s_waitcnt lgkmcnt(0)
s_waitcnt vmcnt(8)
s_barrier
v_xor_b32 v2, 0x10000, v2
ds_write_b128 v2, v[30:33] offset:0
ds_write_b128 v2, v[34:37] offset:1024
ds_write_b128 v2, v[38:41] offset:2048
ds_write_b128 v2, v[42:45] offset:3072
ds_read_b64_tr_b16 v[14:15], v68 offset:16384
ds_read_b64_tr_b16 v[16:17], v68 offset:20480
ds_read_b64_tr_b16 v[18:19], v68 offset:24576
ds_read_b64_tr_b16 v[20:21], v68 offset:28672
ds_read_b64_tr_b16 v[22:23], v69 offset:16384
ds_read_b64_tr_b16 v[24:25], v69 offset:20480
ds_read_b64_tr_b16 v[26:27], v69 offset:24576
ds_read_b64_tr_b16 v[28:29], v69 offset:28672
s_waitcnt lgkmcnt(0)
s_waitcnt vmcnt(4)
s_barrier
v_min3_u32 v50, v50, v51, v52
v_min3_u32 v54, v54, v55, v56
v_min_u32 v50, v50, v53
v_min_u32 v54, v54, v57
v_lshlrev_b32 v50, 1, v50
v_lshl_add_u32 v54, v54, 1, 1
v_min_u32 v50, v50, v54
s_nop 0
v_readfirstlane_b32 s35, v50
s_nop 0
s_max_u32 s0, s0, s35
s_mov_b32 s36, 2
s_mov_b32 s38, 0
L_fw_k0:
s_cmp_ge_u32 s0, s36
s_cbranch_scc1 L_fw_k0_ok
buffer_load_dwordx4 v[50:53], off, s[4:7], s31 sc1
buffer_load_dwordx4 v[54:57], off, s[4:7], s31 offset:16 sc1
s_add_u32 s38, s38, 1
s_cmp_ge_u32 s38, 524288
s_cbranch_scc1 L_err
s_waitcnt vmcnt(0)
v_min3_u32 v50, v50, v51, v52
v_min3_u32 v54, v54, v55, v56
v_min_u32 v50, v50, v53
v_min_u32 v54, v54, v57
v_lshlrev_b32 v50, 1, v50
v_lshl_add_u32 v54, v54, 1, 1
v_min_u32 v50, v50, v54
s_nop 0
v_readfirstlane_b32 s35, v50
s_nop 0
s_max_u32 s0, s0, s35
s_branch L_fw_k0
L_fw_k0_ok:
v_and_b32 v78, 128, v10
v_add_u32 v78, v78, v10
s_xor_b32 m0, s28, 8192
s_add_u32 s36, s51, 128
buffer_load_dwordx4 v78, s[4:7], s51 offen sc1 lds
s_add_u32 m0, m0, 1024
v_mov_b32 v51, s30
buffer_load_dwordx4 v78, s[4:7], s36 offen sc1 lds
v_mov_b32 v50, 0
ds_write_b32 v51, v50
ds_write_b32 v51, v50 offset:16
s_cmp_eq_u32 s12, 3
s_cselect_b64 s[22:23], 1, 0
s_cmp_eq_u32 s12, 2
s_cselect_b32 s0, s0, 64
ds_write_b128 v2, v[14:17] offset:16384
ds_write_b128 v2, v[18:21] offset:17408
ds_write_b128 v2, v[22:25] offset:18432
ds_write_b128 v2, v[26:29] offset:19456
ds_read_b64_tr_b16 v[30:31], v68 offset:32768
ds_read_b64_tr_b16 v[32:33], v68 offset:36864
ds_read_b64_tr_b16 v[34:35], v68 offset:40960
ds_read_b64_tr_b16 v[36:37], v68 offset:45056
ds_read_b64_tr_b16 v[38:39], v69 offset:32768
ds_read_b64_tr_b16 v[40:41], v69 offset:36864
ds_read_b64_tr_b16 v[42:43], v69 offset:40960
ds_read_b64_tr_b16 v[44:45], v69 offset:45056
s_waitcnt lgkmcnt(0)
s_waitcnt vmcnt(0)
s_barrier
ds_write_b128 v2, v[30:33] offset:32768
ds_write_b128 v2, v[34:37] offset:33792
ds_write_b128 v2, v[38:41] offset:34816
ds_write_b128 v2, v[42:45] offset:35840
ds_read_b64_tr_b16 v[14:15], v68 offset:49152
ds_read_b64_tr_b16 v[16:17], v68 offset:53248
ds_read_b64_tr_b16 v[18:19], v68 offset:57344
ds_read_b64_tr_b16 v[20:21], v68 offset:61440
ds_read_b64_tr_b16 v[22:23], v69 offset:49152
ds_read_b64_tr_b16 v[24:25], v69 offset:53248
ds_read_b64_tr_b16 v[26:27], v69 offset:57344
ds_read_b64_tr_b16 v[28:29], v69 offset:61440
s_waitcnt lgkmcnt(0)
s_barrier
ds_write_b128 v2, v[14:17] offset:49152
ds_write_b128 v2, v[18:21] offset:50176
ds_write_b128 v2, v[22:25] offset:51200
ds_write_b128 v2, v[26:29] offset:52224
s_waitcnt lgkmcnt(0)
v_xor_b32 v2, 0x10000, v2
s_mov_b32 s98, s57
v_cmp_ne_u32 vcc, 0, v63
s_cbranch_vccnz L_chain_safe
s_cmp_eq_u32 s14, 1
s_cbranch_scc1 L_chain_c1
ds_read_b128 v[46:49], v2 offset:0
ds_read_b128 v[50:53], v2 offset:1024
ds_read_b128 v[54:57], v2 offset:2048
ds_read_b128 v[58:61], v2 offset:3072
ds_read_b128 v[62:65], v2 offset:16384
ds_read_b128 v[66:69], v2 offset:17408
v_mov_b64 v[14:15], 0
v_mov_b64 v[16:17], 0
v_mov_b64 v[18:19], 0
v_mov_b64 v[20:21], 0
v_mov_b64 v[22:23], 0
v_mov_b64 v[24:25], 0
v_mov_b64 v[26:27], 0
v_mov_b64 v[28:29], 0
v_mov_b64 v[30:31], 0
v_mov_b64 v[32:33], 0
v_mov_b64 v[34:35], 0
v_mov_b64 v[36:37], 0
v_and_b32 v79, 128, v10
v_add_u32 v79, v79, v10
s_branch L_c0_step
.p2align 6
s_nop 0
s_nop 0
s_nop 0
s_nop 0
L_c0_step:
s_sleep 1
s_mov_b32 s38, 0
L_c0_p1:
buffer_load_dwordx4 v[70:73], v11, s[4:7], s18 offen sc1
buffer_load_dword v78, v12, s[4:7], s18 offen sc1
s_add_u32 s38, s38, 1
s_cmp_ge_u32 s38, 524288
s_cbranch_scc1 L_err
L_c0_p1w:
s_waitcnt vmcnt(1)
ds_write_b128 v11, v[70:73] offset:16384
v_max3_u32 v74, v70, v71, v72
s_waitcnt vmcnt(0)
ds_write_b32 v12, v78 offset:16384
v_max3_u32 v74, v74, v73, v78
v_cmp_eq_u32 vcc, -1, v74
s_cbranch_vccnz L_c0_p1
L_c0_p1d:
s_add_u32 s36, s46, 128
s_mov_b32 m0, s1
s_waitcnt lgkmcnt(0)
L_c0_barA:
s_barrier
ds_read_b128 v[38:41], v3 offset:0
buffer_load_dwordx4 v11, s[4:7], s26 offen sc1 lds
s_mov_b32 m0, s2
ds_read_b128 v[42:45], v3 offset:1024
buffer_load_dword v12, s[4:7], s26 offen sc1 lds
s_waitcnt lgkmcnt(1)
v_smfmac_f32_16x16x64_bf16 v[14:17], v[38:41], a[0:7], v0
v_smfmac_f32_16x16x64_bf16 v[22:25], v[38:41], v[46:53], v0
ds_read_b128 v[46:49], v2 offset:18432
ds_read_b128 v[50:53], v2 offset:19456
v_smfmac_f32_16x16x64_bf16 v[18:21], v[38:41], a[8:15], v0
s_mov_b32 m0, s28
s_nop 0
buffer_load_dwordx4 v79, s[4:7], s46 offen sc1 lds
v_smfmac_f32_16x16x64_bf16 v[26:29], v[38:41], v[54:61], v0
ds_read_b128 v[54:57], v2 offset:32768
ds_read_b128 v[58:61], v2 offset:33792
s_add_u32 m0, s28, 1024
s_nop 0
buffer_load_dwordx4 v79, s[4:7], s36 offen sc1 lds
s_waitcnt lgkmcnt(4)
v_smfmac_f32_16x16x64_bf16 v[14:17], v[42:45], a[16:23], v0
v_smfmac_f32_16x16x64_bf16 v[30:33], v[38:41], v[62:69], v0
ds_read_b128 v[62:65], v2 offset:34816
ds_read_b128 v[66:69], v2 offset:35840
v_smfmac_f32_16x16x64_bf16 v[18:21], v[42:45], a[24:31], v0
s_waitcnt lgkmcnt(4)
v_smfmac_f32_16x16x64_bf16 v[34:37], v[38:41], v[46:53], v0
ds_read_b128 v[38:41], v3 offset:2048
ds_read_b128 v[46:49], v2 offset:49152
ds_read_b128 v[50:53], v2 offset:50176
v_smfmac_f32_16x16x64_bf16 v[22:25], v[42:45], a[80:87], v0
s_waitcnt lgkmcnt(5)
v_smfmac_f32_16x16x64_bf16 v[30:33], v[42:45], v[54:61], v0
ds_read_b128 v[54:57], v2 offset:51200
ds_read_b128 v[58:61], v2 offset:52224
v_smfmac_f32_16x16x64_bf16 v[26:29], v[42:45], a[88:95], v0
s_waitcnt lgkmcnt(5)
v_smfmac_f32_16x16x64_bf16 v[34:37], v[42:45], v[62:69], v0
ds_read_b128 v[42:45], v3 offset:3072
v_xor_b32 v2, 0x10000, v2
ds_read_b128 v[62:65], v2 offset:0
ds_read_b128 v[66:69], v2 offset:1024
s_waitcnt lgkmcnt(7)
v_smfmac_f32_16x16x64_bf16 v[14:17], v[38:41], a[32:39], v0
s_waitcnt lgkmcnt(5)
v_smfmac_f32_16x16x64_bf16 v[22:25], v[38:41], v[46:53], v0
ds_read_b128 v[46:49], v2 offset:2048
ds_read_b128 v[50:53], v2 offset:3072
v_smfmac_f32_16x16x64_bf16 v[18:21], v[38:41], a[40:47], v0
s_waitcnt lgkmcnt(5)
v_smfmac_f32_16x16x64_bf16 v[26:29], v[38:41], v[54:61], v0
ds_read_b128 v[54:57], v2 offset:16384
ds_read_b128 v[58:61], v2 offset:17408
s_waitcnt lgkmcnt(6)
v_smfmac_f32_16x16x64_bf16 v[14:17], v[42:45], a[48:55], v0
s_waitcnt lgkmcnt(4)
v_smfmac_f32_16x16x64_bf16 v[30:33], v[38:41], v[62:69], v0
ds_read_b128 v[62:65], v2 offset:18432
ds_read_b128 v[66:69], v2 offset:19456
v_smfmac_f32_16x16x64_bf16 v[18:21], v[42:45], a[56:63], v0
s_waitcnt vmcnt(2)
ds_read_b128 v[70:73], v11 offset:21504
ds_read_b32 v78, v12 offset:21504
s_waitcnt lgkmcnt(6)
v_smfmac_f32_16x16x64_bf16 v[34:37], v[38:41], v[46:53], v0
ds_read_b128 v[38:41], v9 offset:4096
ds_read_b128 v[46:49], v2 offset:32768
ds_read_b128 v[50:53], v2 offset:33792
v_smfmac_f32_16x16x64_bf16 v[22:25], v[42:45], a[96:103], v0
s_waitcnt lgkmcnt(7)
v_smfmac_f32_16x16x64_bf16 v[30:33], v[42:45], v[54:61], v0
ds_read_b128 v[54:57], v2 offset:34816
ds_read_b128 v[58:61], v2 offset:35840
s_waitcnt lgkmcnt(5)
v_max3_u32 v74, v70, v71, v72
v_smfmac_f32_16x16x64_bf16 v[26:29], v[42:45], a[104:111], v0
v_max3_u32 v74, v74, v73, v78
v_smfmac_f32_16x16x64_bf16 v[34:37], v[42:45], v[62:69], v0
ds_read_b128 v[62:65], v2 offset:49152
ds_read_b128 v[66:69], v2 offset:50176
v_cmp_eq_u32 vcc, -1, v74
s_waitcnt lgkmcnt(6)
s_waitcnt lgkmcnt(4)
v_smfmac_f32_16x16x64_bf16 v[22:25], v[38:41], v[46:53], v0
ds_read_b128 v[46:49], v2 offset:51200
ds_read_b128 v[50:53], v2 offset:52224
v_xor_b32 v2, 0x10000, v2
s_cbranch_vccnz L_c0_p2slow
L_c0_p2ok:
s_barrier
ds_read_b128 v[70:73], v3 offset:5120
ds_read_b128 v[74:77], v3 offset:6144
ds_read_b128 v[42:45], v3 offset:7168
s_waitcnt lgkmcnt(7)
v_smfmac_f32_16x16x64_bf16 v[26:29], v[38:41], v[54:61], v0
ds_read_b128 v[54:57], v3 offset:8192
ds_read_b128 v[58:61], v9 offset:9216
s_waitcnt lgkmcnt(7)
v_smfmac_f32_16x16x64_bf16 v[30:33], v[38:41], v[62:69], v0
v_smfmac_f32_16x16x64_bf16 v[14:17], v[38:41], a[64:71], v0
s_waitcnt lgkmcnt(5)
v_smfmac_f32_16x16x64_bf16 v[34:37], v[38:41], v[46:53], v0
v_smfmac_f32_16x16x64_bf16 v[18:21], v[38:41], a[72:79], v0
buffer_load_dwordx4 v[62:65], v10, s[4:7], s47 offen sc1
buffer_load_dwordx4 v[66:69], v10, s[4:7], s47 offen offset:256 sc1
s_waitcnt lgkmcnt(4)
v_smfmac_f32_16x16x64_bf16 v[14:17], v[70:73], a[112:119], v0
v_mov_b32 v78, s15
s_mov_b64 exec, s[22:23]
v_smfmac_f32_16x16x64_bf16 v[18:21], v[70:73], a[120:127], v0
s_waitcnt lgkmcnt(3)
v_smfmac_f32_16x16x64_bf16 v[14:17], v[74:77], a[128:135], v0
buffer_store_dword v78, off, s[4:7], s33 sc1
s_mov_b64 exec, -1
v_smfmac_f32_16x16x64_bf16 v[18:21], v[74:77], a[136:143], v0
s_waitcnt lgkmcnt(2)
v_smfmac_f32_16x16x64_bf16 v[14:17], v[42:45], a[144:151], v0
s_cmp_eq_u32 s97, 1
s_cbranch_scc1 L_c0_refresh
L_c0_refd:
v_smfmac_f32_16x16x64_bf16 v[18:21], v[42:45], a[152:159], v0
s_waitcnt lgkmcnt(1)
v_smfmac_f32_16x16x64_bf16 v[14:17], v[54:57], a[160:167], v0
v_add_u32 v79, s19, v1
v_smfmac_f32_16x16x64_bf16 v[18:21], v[54:57], a[168:175], v0
s_waitcnt lgkmcnt(0)
v_smfmac_f32_16x16x64_bf16 v[14:17], v[58:61], a[176:183], v0
v_smfmac_f32_16x16x64_bf16 v[18:21], v[58:61], a[184:191], v0
v_smfmac_f32_16x16x64_bf16 v[22:25], v[70:73], a[192:199], v0
v_lshl_add_u32 v78, v6, 1, s39
v_smfmac_f32_16x16x64_bf16 v[26:29], v[70:73], a[200:207], v0
v_add_f32 v14, v14, v16
v_smfmac_f32_16x16x64_bf16 v[22:25], v[74:77], a[208:215], v0
v_add_f32 v15, v15, v17
v_smfmac_f32_16x16x64_bf16 v[26:29], v[74:77], a[216:223], v0
v_add_f32 v18, v18, v20
v_smfmac_f32_16x16x64_bf16 v[22:25], v[42:45], a[224:231], v0
v_add_f32 v19, v19, v21
v_smfmac_f32_16x16x64_bf16 v[26:29], v[42:45], a[232:239], v0
v_cvt_pk_bf16_f32 v14, v14, v15
v_smfmac_f32_16x16x64_bf16 v[22:25], v[54:57], a[240:247], v0
v_cvt_pk_bf16_f32 v15, v18, v19
ds_write2_b32 v6, v14, v15 offset0:0 offset1:64
v_smfmac_f32_16x16x64_bf16 v[26:29], v[54:57], a[248:255], v0
v_smfmac_f32_16x16x64_bf16 v[22:25], v[58:61], v[80:87], v0
v_smfmac_f32_16x16x64_bf16 v[26:29], v[58:61], v[88:95], v0
v_smfmac_f32_16x16x64_bf16 v[30:33], v[70:73], v[96:103], v0
s_waitcnt lgkmcnt(0)
ds_read_b128 v[14:17], v79 offset:0
v_smfmac_f32_16x16x64_bf16 v[34:37], v[70:73], v[104:111], v0
v_add_f32 v22, v22, v24
v_add_f32 v23, v23, v25
v_add_f32 v26, v26, v28
v_add_f32 v27, v27, v29
v_cvt_pk_bf16_f32 v22, v22, v23
v_cvt_pk_bf16_f32 v23, v26, v27
ds_write2_b32 v78, v22, v23 offset0:0 offset1:128
v_smfmac_f32_16x16x64_bf16 v[30:33], v[74:77], v[112:119], v0
v_lshrrev_b32 v78, 1, v1
v_smfmac_f32_16x16x64_bf16 v[34:37], v[74:77], v[120:127], v0
buffer_store_dwordx2 v[22:23], v78, s[4:7], s98 offen sc1
v_smfmac_f32_16x16x64_bf16 v[30:33], v[42:45], v[128:135], v0
v_smfmac_f32_16x16x64_bf16 v[34:37], v[42:45], v[136:143], v0
ds_read_b128 v[26:29], v79 offset:1024
ds_read_b128 v[42:45], v79 offset:2048
v_smfmac_f32_16x16x64_bf16 v[30:33], v[54:57], v[144:151], v0
s_waitcnt lgkmcnt(2)
s_barrier
ds_read_b64_tr_b16 v[38:39], v4 offset:0
ds_read_b64_tr_b16 v[40:41], v4 offset:128
ds_read_b128 v[22:25], v79 offset:5120
v_smfmac_f32_16x16x64_bf16 v[34:37], v[54:57], v[152:159], v0
ds_read_b64_tr_b16 v[46:47], v4 offset:512
ds_read_b64_tr_b16 v[48:49], v4 offset:640
ds_read_b128 v[54:57], v79 offset:3072
v_smfmac_f32_16x16x64_bf16 v[30:33], v[58:61], v[160:167], v0
ds_read_b64_tr_b16 v[50:51], v4 offset:1024
ds_read_b64_tr_b16 v[52:53], v4 offset:1152
s_cmp_eq_u32 s15, 63
v_smfmac_f32_16x16x64_bf16 v[34:37], v[58:61], v[168:175], v0
ds_read_b64_tr_b16 v[18:19], v4 offset:1536
ds_read_b64_tr_b16 v[20:21], v4 offset:1664
ds_read_b128 v[58:61], v79 offset:4096
s_cbranch_scc1 L_c0_last
s_waitcnt lgkmcnt(12)
s_waitcnt lgkmcnt(9)
v_mfma_f32_16x16x32_bf16 v[70:73], v[14:17], v[38:41], 0
ds_read_b128 v[14:17], v79 offset:6144
v_mfma_f32_16x16x32_bf16 v[74:77], v[26:29], v[38:41], 0
ds_read_b128 v[26:29], v79 offset:7168
v_add_f32 v30, v30, v32
s_waitcnt lgkmcnt(8)
v_mfma_f32_16x16x32_bf16 v[70:73], v[42:45], v[46:49], v[70:73]
ds_read_b64_tr_b16 v[42:43], v5 offset:0
ds_read_b64_tr_b16 v[44:45], v5 offset:256
v_add_f32 v31, v31, v33
s_waitcnt lgkmcnt(4)
v_mfma_f32_16x16x32_bf16 v[74:77], v[54:57], v[46:49], v[74:77]
ds_read_b64_tr_b16 v[54:55], v5 offset:1024
ds_read_b64_tr_b16 v[56:57], v5 offset:1280
v_add_f32 v34, v34, v36
v_mfma_f32_16x16x32_bf16 v[70:73], v[58:61], v[50:53], v[70:73]
ds_read_b64_tr_b16 v[58:59], v5 offset:2048
ds_read_b64_tr_b16 v[60:61], v5 offset:2304
v_add_f32 v35, v35, v37
s_waitcnt lgkmcnt(6)
v_mfma_f32_16x16x32_bf16 v[74:77], v[22:25], v[50:53], v[74:77]
ds_read_b64_tr_b16 v[22:23], v5 offset:3072
ds_read_b64_tr_b16 v[24:25], v5 offset:3328
v_cvt_pk_bf16_f32 v30, v30, v31
v_mfma_f32_16x16x32_bf16 v[70:73], v[14:17], v[18:21], v[70:73]
v_cvt_pk_bf16_f32 v31, v34, v35
v_mfma_f32_16x16x32_bf16 v[74:77], v[26:29], v[18:21], v[74:77]
v_mov_b32 v14, 0x3f803f80
v_mov_b32 v15, 0x3f803f80
s_waitcnt lgkmcnt(4)
v_mfma_f32_16x16x32_bf16 v[34:37], v[42:45], v[38:41], 0
v_mov_b64 v[16:17], v[14:15]
v_max3_f32 v78, v70, v71, v72
v_mfma_f32_16x16x32_bf16 v[34:37], v[54:57], v[46:49], v[34:37]
v_max3_f32 v78, v78, v73, v74
v_max3_f32 v78, v78, v75, v76
s_waitcnt lgkmcnt(0)
v_max_f32 v78, v78, v77
v_mov_b32 v79, v78
v_mfma_f32_16x16x32_bf16 v[34:37], v[58:61], v[50:53], v[34:37]
v_mov_b32 v43, 0
v_permlane16_swap_b32 v78, v79
v_max_f32 v78, v78, v79
v_mov_b32 v79, v78
v_mfma_f32_16x16x32_bf16 v[34:37], v[22:25], v[18:21], v[34:37]
v_mov_b32 v44, 0
v_permlane32_swap_b32 v78, v79
v_max_f32 v79, v78, v79
v_mul_f32 v78, s34, v79
v_pk_fma_f32 v[70:71], v[70:71], s[78:79], v[78:79] op_sel_hi:[1,1,0] neg_lo:[0,0,1] neg_hi:[0,0,1]
v_pk_fma_f32 v[72:73], v[72:73], s[78:79], v[78:79] op_sel_hi:[1,1,0] neg_lo:[0,0,1] neg_hi:[0,0,1]
v_pk_fma_f32 v[74:75], v[74:75], s[78:79], v[78:79] op_sel_hi:[1,1,0] neg_lo:[0,0,1] neg_hi:[0,0,1]
v_pk_fma_f32 v[76:77], v[76:77], s[78:79], v[78:79] op_sel_hi:[1,1,0] neg_lo:[0,0,1] neg_hi:[0,0,1]
v_max_f32 v26, v34, v35
v_cmp_gt_f32 vcc, v26, v79
v_exp_f32 v70, v70
v_exp_f32 v71, v71
v_exp_f32 v72, v72
v_exp_f32 v73, v73
v_exp_f32 v74, v74
v_exp_f32 v75, v75
v_exp_f32 v76, v76
v_exp_f32 v77, v77
s_cbranch_vccnz L_c0_newmax
L_c0_maxok:
v_cvt_pk_bf16_f32 v22, v70, v71
v_cvt_pk_bf16_f32 v23, v72, v73
v_cvt_pk_bf16_f32 v24, v74, v75
v_cvt_pk_bf16_f32 v25, v76, v77
v_fma_f32 v34, v34, s34, -v78
v_fma_f32 v35, v35, s34, -v78
s_waitcnt vmcnt(2)
v_mfma_f32_16x16x32_bf16 v[50:53], v[14:17], v[22:25], 0
v_exp_f32 v34, v34
v_mfma_f32_16x16x32_bf16 v[38:41], v[62:65], v[22:25], 0
v_exp_f32 v35, v35
v_mfma_f32_16x16x32_bf16 v[46:49], v[66:69], v[22:25], 0
v_cvt_pk_bf16_f32 v42, v34, v35
v_cvt_pk_bf16_f32 v45, v34, v35
v_lshrrev_b32 v79, 11, v8
v_mfma_f32_16x16x16_bf16 v[50:53], v[14:15], v[42:43], v[50:53]
v_mfma_f32_16x16x16_bf16 v[38:41], v[30:31], v[42:43], v[38:41]
v_mfma_f32_16x16x16_bf16 v[46:49], v[30:31], v[44:45], v[46:49]
v_rcp_f32 v78, v50
v_mov_b64 v[70:71], 0
v_mov_b64 v[72:73], 0
v_mov_b64 v[74:75], 0
v_mov_b64 v[76:77], 0
v_mov_b64 v[34:35], 0
v_mov_b64 v[36:37], 0
v_and_b32 v79, 12, v79
v_cndmask_b32 v38, v38, v46, s[42:43]
v_cndmask_b32 v39, v39, v47, s[42:43]
v_cndmask_b32 v40, v40, v48, s[42:43]
v_cndmask_b32 v41, v41, v49, s[42:43]
v_pk_mul_f32 v[38:39], v[38:39], v[78:79] op_sel_hi:[1,0]
v_pk_mul_f32 v[40:41], v[40:41], v[78:79] op_sel_hi:[1,0]
v_cvt_pk_bf16_f32 v38, v38, v39
v_cvt_pk_bf16_f32 v39, v40, v41
ds_write_b64 v7, v[38:39]
v_and_b32 v78, 0x1fff, v8
v_add_u32 v78, v78, v79
v_mov_b64 v[18:19], 0
v_mov_b64 v[20:21], 0
v_mov_b64 v[58:59], 0
v_mov_b64 v[60:61], 0
s_waitcnt lgkmcnt(0)
s_barrier
ds_read_b128 v[62:65], v9 offset:2048
ds_read_b128 v[66:69], v9 offset:3072
ds_read_b128 v[30:33], v1 offset:30720
s_waitcnt lgkmcnt(2)
v_smfmac_f32_16x16x64_bf16 v[34:37], v[62:65], v[240:247], v0
v_smfmac_f32_16x16x64_bf16 v[18:21], v[62:65], v[176:183], v0
s_waitcnt lgkmcnt(1)
v_smfmac_f32_16x16x64_bf16 v[34:37], v[66:69], v[248:255], v0
v_smfmac_f32_16x16x64_bf16 v[18:21], v[66:69], v[208:215], v0
v_smfmac_f32_16x16x64_bf16 v[58:61], v[62:65], v[184:191], v0
v_add_f32 v34, v34, v36
v_smfmac_f32_16x16x64_bf16 v[58:61], v[66:69], v[216:223], v0
v_add_f32 v35, v35, v37
v_smfmac_f32_16x16x64_bf16 v[70:73], v[62:65], v[192:199], v0
v_cvt_pk_bf16_f32 v34, v34, v35
buffer_store_dword v34, v78, s[4:7], s25 offen
v_smfmac_f32_16x16x64_bf16 v[70:73], v[66:69], v[224:231], v0
v_add_f32 v18, v18, v20
v_smfmac_f32_16x16x64_bf16 v[74:77], v[62:65], v[200:207], v0
v_add_f32 v19, v19, v21
v_smfmac_f32_16x16x64_bf16 v[74:77], v[66:69], v[232:239], v0
v_cvt_pk_bf16_f32 v22, v18, v19
v_add_f32 v58, v58, v60
v_add_f32 v59, v59, v61
v_cvt_pk_bf16_f32 v23, v58, v59
v_add_f32 v70, v70, v72
v_add_f32 v71, v71, v73
v_cvt_pk_bf16_f32 v24, v70, v71
s_nop 0
v_add_f32 v74, v74, v76
v_add_f32 v75, v75, v77
v_cvt_pk_bf16_f32 v25, v74, v75
buffer_store_dwordx4 v[22:25], v8, s[4:7], s24 offen
s_add_u32 s15, s15, 1
s_cmp_eq_u32 s16, -1
s_cbranch_scc1 L_c0_nored
s_mov_b32 s38, 0
s_waitcnt lgkmcnt(0)
s_waitcnt vmcnt(1)
v_mov_b64 v[14:15], 0
s_and_b32 s35, s15, 3
s_lshl_b32 s35, s35, 14
v_mov_b64 v[16:17], 0
s_add_u32 s18, s32, s35
s_add_u32 s26, s26, 32768
v_mov_b64 v[18:19], 0
s_add_u32 s24, s24, s45
s_add_u32 s25, s25, s45
buffer_load_dwordx4 v[38:41], v1, s[4:7], s27 offen offset:0 sc1
buffer_load_dwordx4 v[42:45], v1, s[4:7], s27 offen offset:1024 sc1
buffer_load_dwordx4 v[70:73], v1, s[4:7], s27 offen offset:2048 sc1
buffer_load_dwordx4 v[74:77], v1, s[4:7], s27 offen offset:3072 sc1
v_mov_b64 v[20:21], 0
s_add_u32 s47, s47, 524288
s_add_u32 s46, s46, 524288
v_mov_b64 v[22:23], 0
s_xor_b32 s28, s28, 8192
s_xor_b32 s19, s19, 8192
v_mov_b64 v[24:25], 0
s_add_u32 s98, s98, 131072
v_mov_b64 v[26:27], 0
v_mov_b64 v[28:29], 0
v_and_b32 v79, 128, v10
v_add_u32 v79, v79, v10
L_c0_p5:
buffer_load_dwordx4 v[46:49], v1, s[4:7], s27 offen offset:0 sc1
buffer_load_dwordx4 v[50:53], v1, s[4:7], s27 offen offset:1024 sc1
buffer_load_dwordx4 v[54:57], v1, s[4:7], s27 offen offset:2048 sc1
buffer_load_dwordx4 v[58:61], v1, s[4:7], s27 offen offset:3072 sc1
s_add_u32 s38, s38, 1
s_cmp_ge_u32 s38, 524288
s_cbranch_scc1 L_err
s_waitcnt vmcnt(7)
v_mfma_f32_16x16x32_bf16 v[34:37], v[38:41], v[30:33], 0
v_max3_u32 v78, v38, v39, v40
v_max_u32 v78, v78, v41
s_waitcnt vmcnt(6)
v_mfma_f32_16x16x32_bf16 v[34:37], v[42:45], v[30:33], v[34:37]
v_max3_u32 v78, v78, v42, v43
v_max3_u32 v78, v78, v44, v45
s_waitcnt vmcnt(5)
v_mfma_f32_16x16x32_bf16 v[34:37], v[70:73], v[30:33], v[34:37]
v_max3_u32 v78, v78, v70, v71
v_max3_u32 v78, v78, v72, v73
s_waitcnt vmcnt(4)
v_mfma_f32_16x16x32_bf16 v[34:37], v[74:77], v[30:33], v[34:37]
v_max3_u32 v78, v78, v74, v75
v_max3_u32 v78, v78, v76, v77
v_cmp_eq_u32 vcc, -1, v78
s_cbranch_vccz L_c0_p5ok
buffer_load_dwordx4 v[38:41], v1, s[4:7], s27 offen offset:0 sc1
buffer_load_dwordx4 v[42:45], v1, s[4:7], s27 offen offset:1024 sc1
buffer_load_dwordx4 v[70:73], v1, s[4:7], s27 offen offset:2048 sc1
buffer_load_dwordx4 v[74:77], v1, s[4:7], s27 offen offset:3072 sc1
s_waitcnt vmcnt(7)
v_mfma_f32_16x16x32_bf16 v[34:37], v[46:49], v[30:33], 0
v_max3_u32 v78, v46, v47, v48
v_max_u32 v78, v78, v49
s_waitcnt vmcnt(6)
v_mfma_f32_16x16x32_bf16 v[34:37], v[50:53], v[30:33], v[34:37]
v_max3_u32 v78, v78, v50, v51
v_max3_u32 v78, v78, v52, v53
s_waitcnt vmcnt(5)
v_mfma_f32_16x16x32_bf16 v[34:37], v[54:57], v[30:33], v[34:37]
v_max3_u32 v78, v78, v54, v55
v_max3_u32 v78, v78, v56, v57
s_waitcnt vmcnt(4)
v_mfma_f32_16x16x32_bf16 v[34:37], v[58:61], v[30:33], v[34:37]
v_max3_u32 v78, v78, v58, v59
v_max3_u32 v78, v78, v60, v61
v_cmp_eq_u32 vcc, -1, v78
s_cbranch_vccnz L_c0_p5
L_c0_p5ok:
s_nop 3
v_permlane32_swap_b32 v34, v36
v_permlane32_swap_b32 v35, v37
s_cmp_eq_u64 vcc, 0
s_cselect_b64 exec, s[40:41], 0
v_add_f32 v34, v34, v36
v_add_f32 v35, v35, v37
v_cvt_pk_bf16_f32 v34, v34, v35
buffer_store_dword v34, v13, s[4:7], s20 offen
s_cselect_b64 exec, s[40:41], 0
buffer_store_dword v34, v13, s[4:7], s21 offen sc1
s_mov_b64 exec, -1
v_mov_b64 v[62:63], -1
v_mov_b64 v[64:65], -1
buffer_store_dwordx4 v[62:65], v1, s[4:7], s27 offen offset:0
buffer_store_dwordx4 v[62:65], v1, s[4:7], s27 offen offset:1024
buffer_store_dwordx4 v[62:65], v1, s[4:7], s27 offen offset:2048
buffer_store_dwordx4 v[62:65], v1, s[4:7], s27 offen offset:3072
buffer_store_dword v62, v13, s[4:7], s29 offen
s_waitcnt vmcnt(7)
v_mov_b64 v[30:31], 0
s_and_b32 s35, s15, 3
s_lshl_b32 s35, s35, 14
v_mov_b64 v[32:33], 0
s_add_u32 s35, s35, 16384
s_and_b32 s35, s35, 0xc000
v_mov_b64 v[34:35], 0
s_add_u32 s20, s44, s35
s_xor_b32 s35, s35, 32768
v_mov_b64 v[36:37], 0
s_add_u32 s29, s44, s35
s_add_u32 s21, s21, 32768
s_add_u32 s27, s27, s45
s_sub_u32 s45, 0, s45
s_waitcnt vmcnt(7)
s_branch L_c0_top
L_c0_nored:
s_add_u32 s36, s15, 2
s_min_u32 s36, s36, 64
s_cmp_ge_u32 s0, 64
s_cbranch_scc1 L_c0_fok
v_mov_b32 v70, s30
s_waitcnt vmcnt(0)
ds_read_b128 v[38:41], v70
ds_read_b128 v[42:45], v70 offset:16
s_waitcnt lgkmcnt(0)
v_min3_u32 v38, v38, v39, v40
v_min3_u32 v42, v42, v43, v44
v_min_u32 v38, v38, v41
v_min_u32 v42, v42, v45
v_lshlrev_b32 v38, 1, v38
v_lshl_add_u32 v42, v42, 1, 1
v_min_u32 v38, v38, v42
s_nop 0
v_readfirstlane_b32 s35, v38
s_nop 0
s_max_u32 s0, s0, s35
s_mov_b32 s38, 0
L_fw_c0kn:
s_cmp_ge_u32 s0, s36
s_cbranch_scc1 L_fw_c0kn_ok
buffer_load_dwordx4 v[38:41], off, s[4:7], s31 sc1
buffer_load_dwordx4 v[42:45], off, s[4:7], s31 offset:16 sc1
s_add_u32 s38, s38, 1
s_cmp_ge_u32 s38, 524288
s_cbranch_scc1 L_err
s_waitcnt vmcnt(0)
v_min3_u32 v38, v38, v39, v40
v_min3_u32 v42, v42, v43, v44
v_min_u32 v38, v38, v41
v_min_u32 v42, v42, v45
v_lshlrev_b32 v38, 1, v38
v_lshl_add_u32 v42, v42, 1, 1
v_min_u32 v38, v38, v42
s_nop 0
v_readfirstlane_b32 s35, v38
s_nop 0
s_max_u32 s0, s0, s35
s_branch L_fw_c0kn
L_fw_c0kn_ok:
s_add_u32 s35, s15, 4
s_cmp_lt_u32 s0, s35
s_cselect_b32 s97, 1, 0
s_cmp_lt_u32 s0, 64
s_cselect_b32 s97, s97, 0
L_c0_fok:
v_mov_b64 v[14:15], 0
s_and_b32 s35, s15, 3
s_lshl_b32 s35, s35, 14
v_mov_b64 v[16:17], 0
s_add_u32 s18, s32, s35
s_add_u32 s26, s26, 32768
v_mov_b64 v[18:19], 0
s_add_u32 s24, s24, s45
s_add_u32 s25, s25, s45
v_mov_b64 v[20:21], 0
s_add_u32 s47, s47, 524288
s_add_u32 s46, s46, 524288
v_mov_b64 v[22:23], 0
s_xor_b32 s28, s28, 8192
s_xor_b32 s19, s19, 8192
v_mov_b64 v[24:25], 0
s_add_u32 s98, s98, 131072
v_mov_b64 v[26:27], 0
v_mov_b64 v[28:29], 0
v_and_b32 v79, 128, v10
v_add_u32 v79, v79, v10
v_mov_b64 v[30:31], 0
s_and_b32 s35, s15, 3
s_lshl_b32 s35, s35, 14
v_mov_b64 v[32:33], 0
s_add_u32 s35, s35, 16384
s_and_b32 s35, s35, 0xc000
v_mov_b64 v[34:35], 0
s_add_u32 s20, s44, s35
s_xor_b32 s35, s35, 32768
v_mov_b64 v[36:37], 0
s_add_u32 s29, s44, s35
s_add_u32 s21, s21, 32768
s_add_u32 s27, s27, s45
s_sub_u32 s45, 0, s45
L_c0_top:
s_barrier
ds_read_b128 v[46:49], v2 offset:0
ds_read_b128 v[50:53], v2 offset:1024
ds_read_b128 v[54:57], v2 offset:2048
ds_read_b128 v[58:61], v2 offset:3072
ds_read_b128 v[62:65], v2 offset:16384
ds_read_b128 v[66:69], v2 offset:17408
s_branch L_c0_step
L_c0_p2slow:
s_mov_b32 s38, 0
L_c0_p2s:
s_mov_b32 m0, s1
s_nop 0
buffer_load_dwordx4 v11, s[4:7], s26 offen sc1 lds
s_mov_b32 m0, s2
s_nop 0
buffer_load_dword v12, s[4:7], s26 offen sc1 lds
s_add_u32 s38, s38, 1
s_cmp_ge_u32 s38, 524288
s_cbranch_scc1 L_err
s_waitcnt vmcnt(0)
ds_read_b128 v[70:73], v11 offset:21504
ds_read_b32 v78, v12 offset:21504
s_waitcnt lgkmcnt(0)
v_max3_u32 v74, v70, v71, v72
v_max3_u32 v74, v74, v73, v78
v_cmp_eq_u32 vcc, -1, v74
s_cbranch_vccnz L_c0_p2s
s_branch L_c0_p2ok
L_c0_newmax:
v_max_f32 v26, v26, v79
v_mov_b32 v79, v26
s_nop 1
v_permlane16_swap_b32 v26, v79
v_max_f32 v26, v26, v79
v_mov_b32 v79, v26
s_nop 1
v_permlane32_swap_b32 v26, v79
v_max_f32 v26, v26, v79
v_mul_f32 v26, s34, v26
v_sub_f32 v79, v78, v26
v_exp_f32 v79, v79
v_mov_b32 v78, v26
v_mul_f32 v70, v79, v70
v_mul_f32 v71, v79, v71
v_mul_f32 v72, v79, v72
v_mul_f32 v73, v79, v73
v_mul_f32 v74, v79, v74
v_mul_f32 v75, v79, v75
v_mul_f32 v76, v79, v76
v_mul_f32 v77, v79, v77
s_branch L_c0_maxok
L_c0_refresh:
s_mov_b32 s97, 0
s_mov_b32 m0, s30
v_lshrrev_b32 v78, 2, v1
s_sub_u32 s35, s31, 32768
s_mov_b64 exec, 255
buffer_load_dword v78, s[4:7], s35 offen sc1 lds
s_mov_b64 exec, -1
s_branch L_c0_refd
L_c0_last:
s_waitcnt vmcnt(0)
L_c0_done:
s_branch L_chdone
L_chain_c1:
ds_read_b128 v[46:49], v2 offset:0
ds_read_b128 v[50:53], v2 offset:1024
ds_read_b128 v[54:57], v2 offset:2048
ds_read_b128 v[58:61], v2 offset:3072
ds_read_b128 v[62:65], v2 offset:16384
ds_read_b128 v[66:69], v2 offset:17408
v_mov_b64 v[14:15], 0
v_mov_b64 v[16:17], 0
v_mov_b64 v[18:19], 0
v_mov_b64 v[20:21], 0
v_mov_b64 v[22:23], 0
v_mov_b64 v[24:25], 0
v_mov_b64 v[26:27], 0
v_mov_b64 v[28:29], 0
v_mov_b64 v[30:31], 0
v_mov_b64 v[32:33], 0
v_mov_b64 v[34:35], 0
v_mov_b64 v[36:37], 0
v_and_b32 v79, 128, v10
v_add_u32 v79, v79, v10
s_branch L_c1_step
.p2align 6
s_nop 0
s_nop 0
s_nop 0
s_nop 0
L_c1_step:
s_sleep 1
s_mov_b32 s38, 0
L_c1_p1:
buffer_load_dwordx4 v[70:73], v11, s[4:7], s18 offen sc1
buffer_load_dword v78, v12, s[4:7], s18 offen sc1
s_add_u32 s38, s38, 1
s_cmp_ge_u32 s38, 524288
s_cbranch_scc1 L_err
L_c1_p1w:
s_waitcnt vmcnt(1)
ds_write_b128 v11, v[70:73] offset:16384
v_max3_u32 v74, v70, v71, v72
s_waitcnt vmcnt(0)
ds_write_b32 v12, v78 offset:16384
v_max3_u32 v74, v74, v73, v78
v_cmp_eq_u32 vcc, -1, v74
s_cbranch_vccnz L_c1_p1
L_c1_p1d:
s_add_u32 s36, s46, 128
s_mov_b32 m0, s1
s_waitcnt lgkmcnt(0)
L_c1_barA:
s_barrier
ds_read_b128 v[38:41], v3 offset:0
buffer_load_dwordx4 v11, s[4:7], s26 offen sc1 lds
s_mov_b32 m0, s2
ds_read_b128 v[42:45], v3 offset:1024
buffer_load_dword v12, s[4:7], s26 offen sc1 lds
s_waitcnt lgkmcnt(1)
v_smfmac_f32_16x16x64_bf16 v[14:17], v[38:41], a[0:7], v0
v_smfmac_f32_16x16x64_bf16 v[22:25], v[38:41], v[46:53], v0
ds_read_b128 v[46:49], v2 offset:18432
ds_read_b128 v[50:53], v2 offset:19456
v_smfmac_f32_16x16x64_bf16 v[18:21], v[38:41], a[8:15], v0
s_mov_b32 m0, s28
s_nop 0
buffer_load_dwordx4 v79, s[4:7], s46 offen sc1 lds
v_smfmac_f32_16x16x64_bf16 v[26:29], v[38:41], v[54:61], v0
ds_read_b128 v[54:57], v2 offset:32768
ds_read_b128 v[58:61], v2 offset:33792
s_add_u32 m0, s28, 1024
s_nop 0
buffer_load_dwordx4 v79, s[4:7], s36 offen sc1 lds
s_waitcnt lgkmcnt(4)
v_smfmac_f32_16x16x64_bf16 v[14:17], v[42:45], a[16:23], v0
v_smfmac_f32_16x16x64_bf16 v[30:33], v[38:41], v[62:69], v0
ds_read_b128 v[62:65], v2 offset:34816
ds_read_b128 v[66:69], v2 offset:35840
v_smfmac_f32_16x16x64_bf16 v[18:21], v[42:45], a[24:31], v0
s_waitcnt lgkmcnt(4)
v_smfmac_f32_16x16x64_bf16 v[34:37], v[38:41], v[46:53], v0
ds_read_b128 v[38:41], v3 offset:2048
ds_read_b128 v[46:49], v2 offset:49152
ds_read_b128 v[50:53], v2 offset:50176
v_smfmac_f32_16x16x64_bf16 v[22:25], v[42:45], a[80:87], v0
s_waitcnt lgkmcnt(5)
v_smfmac_f32_16x16x64_bf16 v[30:33], v[42:45], v[54:61], v0
ds_read_b128 v[54:57], v2 offset:51200
ds_read_b128 v[58:61], v2 offset:52224
v_smfmac_f32_16x16x64_bf16 v[26:29], v[42:45], a[88:95], v0
s_waitcnt lgkmcnt(5)
v_smfmac_f32_16x16x64_bf16 v[34:37], v[42:45], v[62:69], v0
ds_read_b128 v[42:45], v3 offset:3072
v_xor_b32 v2, 0x10000, v2
ds_read_b128 v[62:65], v2 offset:0
ds_read_b128 v[66:69], v2 offset:1024
s_waitcnt lgkmcnt(7)
v_smfmac_f32_16x16x64_bf16 v[14:17], v[38:41], a[32:39], v0
s_waitcnt lgkmcnt(5)
v_smfmac_f32_16x16x64_bf16 v[22:25], v[38:41], v[46:53], v0
ds_read_b128 v[46:49], v2 offset:2048
ds_read_b128 v[50:53], v2 offset:3072
v_smfmac_f32_16x16x64_bf16 v[18:21], v[38:41], a[40:47], v0
s_waitcnt lgkmcnt(5)
v_smfmac_f32_16x16x64_bf16 v[26:29], v[38:41], v[54:61], v0
ds_read_b128 v[54:57], v2 offset:16384
ds_read_b128 v[58:61], v2 offset:17408
s_waitcnt lgkmcnt(6)
v_smfmac_f32_16x16x64_bf16 v[14:17], v[42:45], a[48:55], v0
s_waitcnt lgkmcnt(4)
v_smfmac_f32_16x16x64_bf16 v[30:33], v[38:41], v[62:69], v0
ds_read_b128 v[62:65], v2 offset:18432
ds_read_b128 v[66:69], v2 offset:19456
v_smfmac_f32_16x16x64_bf16 v[18:21], v[42:45], a[56:63], v0
s_waitcnt vmcnt(2)
ds_read_b128 v[70:73], v11 offset:21504
ds_read_b32 v78, v12 offset:21504
s_waitcnt lgkmcnt(6)
v_smfmac_f32_16x16x64_bf16 v[34:37], v[38:41], v[46:53], v0
ds_read_b128 v[38:41], v9 offset:4096
ds_read_b128 v[46:49], v2 offset:32768
ds_read_b128 v[50:53], v2 offset:33792
v_smfmac_f32_16x16x64_bf16 v[22:25], v[42:45], a[96:103], v0
s_waitcnt lgkmcnt(7)
v_smfmac_f32_16x16x64_bf16 v[30:33], v[42:45], v[54:61], v0
ds_read_b128 v[54:57], v2 offset:34816
ds_read_b128 v[58:61], v2 offset:35840
s_waitcnt lgkmcnt(5)
v_max3_u32 v74, v70, v71, v72
v_smfmac_f32_16x16x64_bf16 v[26:29], v[42:45], a[104:111], v0
v_max3_u32 v74, v74, v73, v78
v_smfmac_f32_16x16x64_bf16 v[34:37], v[42:45], v[62:69], v0
ds_read_b128 v[62:65], v2 offset:49152
ds_read_b128 v[66:69], v2 offset:50176
v_cmp_eq_u32 vcc, -1, v74
s_waitcnt lgkmcnt(6)
s_waitcnt lgkmcnt(4)
v_smfmac_f32_16x16x64_bf16 v[22:25], v[38:41], v[46:53], v0
ds_read_b128 v[46:49], v2 offset:51200
ds_read_b128 v[50:53], v2 offset:52224
v_xor_b32 v2, 0x10000, v2
s_cbranch_vccnz L_c1_p2slow
L_c1_p2ok:
s_barrier
ds_read_b128 v[70:73], v3 offset:5120
ds_read_b128 v[74:77], v3 offset:6144
ds_read_b128 v[42:45], v3 offset:7168
s_waitcnt lgkmcnt(7)
v_smfmac_f32_16x16x64_bf16 v[26:29], v[38:41], v[54:61], v0
ds_read_b128 v[54:57], v3 offset:8192
ds_read_b128 v[58:61], v9 offset:9216
s_waitcnt lgkmcnt(7)
v_smfmac_f32_16x16x64_bf16 v[30:33], v[38:41], v[62:69], v0
v_smfmac_f32_16x16x64_bf16 v[14:17], v[38:41], a[64:71], v0
s_waitcnt lgkmcnt(5)
v_smfmac_f32_16x16x64_bf16 v[34:37], v[38:41], v[46:53], v0
v_smfmac_f32_16x16x64_bf16 v[18:21], v[38:41], a[72:79], v0
buffer_load_dwordx4 v[62:65], v10, s[4:7], s47 offen sc1
buffer_load_dwordx4 v[66:69], v10, s[4:7], s47 offen offset:256 sc1
s_waitcnt lgkmcnt(4)
v_smfmac_f32_16x16x64_bf16 v[14:17], v[70:73], a[112:119], v0
v_mov_b32 v78, s15
s_mov_b64 exec, s[22:23]
v_smfmac_f32_16x16x64_bf16 v[18:21], v[70:73], a[120:127], v0
s_waitcnt lgkmcnt(3)
v_smfmac_f32_16x16x64_bf16 v[14:17], v[74:77], a[128:135], v0
buffer_store_dword v78, off, s[4:7], s33 sc1
s_mov_b64 exec, -1
v_smfmac_f32_16x16x64_bf16 v[18:21], v[74:77], a[136:143], v0
s_waitcnt lgkmcnt(2)
v_smfmac_f32_16x16x64_bf16 v[14:17], v[42:45], a[144:151], v0
s_cmp_eq_u32 s97, 1
s_cbranch_scc1 L_c1_refresh
L_c1_refd:
v_smfmac_f32_16x16x64_bf16 v[18:21], v[42:45], a[152:159], v0
s_waitcnt lgkmcnt(1)
v_smfmac_f32_16x16x64_bf16 v[14:17], v[54:57], a[160:167], v0
v_add_u32 v79, s19, v1
v_smfmac_f32_16x16x64_bf16 v[18:21], v[54:57], a[168:175], v0
s_waitcnt lgkmcnt(0)
v_smfmac_f32_16x16x64_bf16 v[14:17], v[58:61], a[176:183], v0
v_smfmac_f32_16x16x64_bf16 v[18:21], v[58:61], a[184:191], v0
v_smfmac_f32_16x16x64_bf16 v[22:25], v[70:73], a[192:199], v0
v_lshl_add_u32 v78, v6, 1, s39
v_smfmac_f32_16x16x64_bf16 v[26:29], v[70:73], a[200:207], v0
v_add_f32 v14, v14, v16
v_smfmac_f32_16x16x64_bf16 v[22:25], v[74:77], a[208:215], v0
v_add_f32 v15, v15, v17
v_smfmac_f32_16x16x64_bf16 v[26:29], v[74:77], a[216:223], v0
v_add_f32 v18, v18, v20
v_smfmac_f32_16x16x64_bf16 v[22:25], v[42:45], a[224:231], v0
v_add_f32 v19, v19, v21
v_smfmac_f32_16x16x64_bf16 v[26:29], v[42:45], a[232:239], v0
v_cvt_pk_bf16_f32 v14, v14, v15
v_smfmac_f32_16x16x64_bf16 v[22:25], v[54:57], a[240:247], v0
v_cvt_pk_bf16_f32 v15, v18, v19
ds_write2_b32 v6, v14, v15 offset0:0 offset1:64
v_smfmac_f32_16x16x64_bf16 v[26:29], v[54:57], a[248:255], v0
v_smfmac_f32_16x16x64_bf16 v[22:25], v[58:61], v[80:87], v0
v_smfmac_f32_16x16x64_bf16 v[26:29], v[58:61], v[88:95], v0
v_smfmac_f32_16x16x64_bf16 v[30:33], v[70:73], v[96:103], v0
s_waitcnt lgkmcnt(0)
ds_read_b128 v[14:17], v79 offset:0
v_smfmac_f32_16x16x64_bf16 v[34:37], v[70:73], v[104:111], v0
v_add_f32 v22, v22, v24
v_add_f32 v23, v23, v25
v_add_f32 v26, v26, v28
v_add_f32 v27, v27, v29
v_cvt_pk_bf16_f32 v22, v22, v23
v_cvt_pk_bf16_f32 v23, v26, v27
ds_write2_b32 v78, v22, v23 offset0:0 offset1:128
v_smfmac_f32_16x16x64_bf16 v[30:33], v[74:77], v[112:119], v0
v_lshrrev_b32 v78, 1, v1
v_smfmac_f32_16x16x64_bf16 v[34:37], v[74:77], v[120:127], v0
v_smfmac_f32_16x16x64_bf16 v[30:33], v[42:45], v[128:135], v0
v_smfmac_f32_16x16x64_bf16 v[34:37], v[42:45], v[136:143], v0
ds_read_b128 v[26:29], v79 offset:1024
ds_read_b128 v[42:45], v79 offset:2048
v_smfmac_f32_16x16x64_bf16 v[30:33], v[54:57], v[144:151], v0
s_waitcnt lgkmcnt(2)
s_barrier
ds_read_b64_tr_b16 v[38:39], v4 offset:0
ds_read_b64_tr_b16 v[40:41], v4 offset:128
ds_read_b128 v[22:25], v79 offset:5120
v_smfmac_f32_16x16x64_bf16 v[34:37], v[54:57], v[152:159], v0
ds_read_b64_tr_b16 v[46:47], v4 offset:512
ds_read_b64_tr_b16 v[48:49], v4 offset:640
ds_read_b128 v[54:57], v79 offset:3072
v_smfmac_f32_16x16x64_bf16 v[30:33], v[58:61], v[160:167], v0
ds_read_b64_tr_b16 v[50:51], v4 offset:1024
ds_read_b64_tr_b16 v[52:53], v4 offset:1152
s_cmp_eq_u32 s15, 63
v_smfmac_f32_16x16x64_bf16 v[34:37], v[58:61], v[168:175], v0
ds_read_b64_tr_b16 v[18:19], v4 offset:1536
ds_read_b64_tr_b16 v[20:21], v4 offset:1664
ds_read_b128 v[58:61], v79 offset:4096
s_cbranch_scc1 L_c1_last
s_waitcnt lgkmcnt(12)
s_waitcnt lgkmcnt(9)
v_mfma_f32_16x16x32_bf16 v[70:73], v[14:17], v[38:41], 0
ds_read_b128 v[14:17], v79 offset:6144
v_mfma_f32_16x16x32_bf16 v[74:77], v[26:29], v[38:41], 0
ds_read_b128 v[26:29], v79 offset:7168
v_add_f32 v30, v30, v32
s_waitcnt lgkmcnt(8)
v_mfma_f32_16x16x32_bf16 v[70:73], v[42:45], v[46:49], v[70:73]
ds_read_b64_tr_b16 v[42:43], v5 offset:0
ds_read_b64_tr_b16 v[44:45], v5 offset:256
v_add_f32 v31, v31, v33
s_waitcnt lgkmcnt(4)
v_mfma_f32_16x16x32_bf16 v[74:77], v[54:57], v[46:49], v[74:77]
ds_read_b64_tr_b16 v[54:55], v5 offset:1024
ds_read_b64_tr_b16 v[56:57], v5 offset:1280
v_add_f32 v34, v34, v36
v_mfma_f32_16x16x32_bf16 v[70:73], v[58:61], v[50:53], v[70:73]
ds_read_b64_tr_b16 v[58:59], v5 offset:2048
ds_read_b64_tr_b16 v[60:61], v5 offset:2304
v_add_f32 v35, v35, v37
s_waitcnt lgkmcnt(6)
v_mfma_f32_16x16x32_bf16 v[74:77], v[22:25], v[50:53], v[74:77]
ds_read_b64_tr_b16 v[22:23], v5 offset:3072
ds_read_b64_tr_b16 v[24:25], v5 offset:3328
v_cvt_pk_bf16_f32 v30, v30, v31
v_mfma_f32_16x16x32_bf16 v[70:73], v[14:17], v[18:21], v[70:73]
v_cvt_pk_bf16_f32 v31, v34, v35
v_mfma_f32_16x16x32_bf16 v[74:77], v[26:29], v[18:21], v[74:77]
v_mov_b32 v14, 0x3f803f80
v_mov_b32 v15, 0x3f803f80
s_waitcnt lgkmcnt(4)
v_mfma_f32_16x16x32_bf16 v[34:37], v[42:45], v[38:41], 0
v_mov_b64 v[16:17], v[14:15]
buffer_store_dwordx2 v[30:31], v78, s[4:7], s98 offen sc1
v_max3_f32 v78, v70, v71, v72
v_mfma_f32_16x16x32_bf16 v[34:37], v[54:57], v[46:49], v[34:37]
v_max3_f32 v78, v78, v73, v74
v_max3_f32 v78, v78, v75, v76
s_waitcnt lgkmcnt(0)
v_max_f32 v78, v78, v77
v_mov_b32 v79, v78
v_mfma_f32_16x16x32_bf16 v[34:37], v[58:61], v[50:53], v[34:37]
v_mov_b32 v43, 0
v_permlane16_swap_b32 v78, v79
v_max_f32 v78, v78, v79
v_mov_b32 v79, v78
v_mfma_f32_16x16x32_bf16 v[34:37], v[22:25], v[18:21], v[34:37]
v_mov_b32 v44, 0
v_permlane32_swap_b32 v78, v79
v_max_f32 v79, v78, v79
v_mul_f32 v78, s34, v79
v_pk_fma_f32 v[70:71], v[70:71], s[78:79], v[78:79] op_sel_hi:[1,1,0] neg_lo:[0,0,1] neg_hi:[0,0,1]
v_pk_fma_f32 v[72:73], v[72:73], s[78:79], v[78:79] op_sel_hi:[1,1,0] neg_lo:[0,0,1] neg_hi:[0,0,1]
v_pk_fma_f32 v[74:75], v[74:75], s[78:79], v[78:79] op_sel_hi:[1,1,0] neg_lo:[0,0,1] neg_hi:[0,0,1]
v_pk_fma_f32 v[76:77], v[76:77], s[78:79], v[78:79] op_sel_hi:[1,1,0] neg_lo:[0,0,1] neg_hi:[0,0,1]
v_max_f32 v26, v34, v35
v_cmp_gt_f32 vcc, v26, v79
v_exp_f32 v70, v70
v_exp_f32 v71, v71
v_exp_f32 v72, v72
v_exp_f32 v73, v73
v_exp_f32 v74, v74
v_exp_f32 v75, v75
v_exp_f32 v76, v76
v_exp_f32 v77, v77
s_cbranch_vccnz L_c1_newmax
L_c1_maxok:
v_cvt_pk_bf16_f32 v22, v70, v71
v_cvt_pk_bf16_f32 v23, v72, v73
v_cvt_pk_bf16_f32 v24, v74, v75
v_cvt_pk_bf16_f32 v25, v76, v77
v_fma_f32 v34, v34, s34, -v78
v_fma_f32 v35, v35, s34, -v78
s_waitcnt vmcnt(2)
v_mfma_f32_16x16x32_bf16 v[50:53], v[14:17], v[22:25], 0
v_exp_f32 v34, v34
v_mfma_f32_16x16x32_bf16 v[38:41], v[62:65], v[22:25], 0
v_exp_f32 v35, v35
v_mfma_f32_16x16x32_bf16 v[46:49], v[66:69], v[22:25], 0
v_cvt_pk_bf16_f32 v42, v34, v35
v_cvt_pk_bf16_f32 v45, v34, v35
v_lshrrev_b32 v79, 11, v8
v_mfma_f32_16x16x16_bf16 v[50:53], v[14:15], v[42:43], v[50:53]
v_mfma_f32_16x16x16_bf16 v[38:41], v[30:31], v[42:43], v[38:41]
v_mfma_f32_16x16x16_bf16 v[46:49], v[30:31], v[44:45], v[46:49]
v_rcp_f32 v78, v50
v_mov_b64 v[70:71], 0
v_mov_b64 v[72:73], 0
v_mov_b64 v[74:75], 0
v_mov_b64 v[76:77], 0
v_mov_b64 v[34:35], 0
v_mov_b64 v[36:37], 0
v_and_b32 v79, 12, v79
v_cndmask_b32 v38, v38, v46, s[42:43]
v_cndmask_b32 v39, v39, v47, s[42:43]
v_cndmask_b32 v40, v40, v48, s[42:43]
v_cndmask_b32 v41, v41, v49, s[42:43]
v_pk_mul_f32 v[38:39], v[38:39], v[78:79] op_sel_hi:[1,0]
v_pk_mul_f32 v[40:41], v[40:41], v[78:79] op_sel_hi:[1,0]
v_cvt_pk_bf16_f32 v38, v38, v39
v_cvt_pk_bf16_f32 v39, v40, v41
ds_write_b64 v7, v[38:39]
v_and_b32 v78, 0x1fff, v8
v_add_u32 v78, v78, v79
v_mov_b64 v[18:19], 0
v_mov_b64 v[20:21], 0
v_mov_b64 v[58:59], 0
v_mov_b64 v[60:61], 0
s_waitcnt lgkmcnt(0)
s_barrier
ds_read_b128 v[62:65], v9 offset:2048
ds_read_b128 v[66:69], v9 offset:3072
ds_read_b128 v[30:33], v1 offset:30720
s_waitcnt lgkmcnt(2)
v_smfmac_f32_16x16x64_bf16 v[34:37], v[62:65], v[240:247], v0
v_smfmac_f32_16x16x64_bf16 v[18:21], v[62:65], v[176:183], v0
s_waitcnt lgkmcnt(1)
v_smfmac_f32_16x16x64_bf16 v[34:37], v[66:69], v[248:255], v0
v_smfmac_f32_16x16x64_bf16 v[18:21], v[66:69], v[208:215], v0
v_smfmac_f32_16x16x64_bf16 v[58:61], v[62:65], v[184:191], v0
v_add_f32 v34, v34, v36
v_smfmac_f32_16x16x64_bf16 v[58:61], v[66:69], v[216:223], v0
v_add_f32 v35, v35, v37
v_smfmac_f32_16x16x64_bf16 v[70:73], v[62:65], v[192:199], v0
v_cvt_pk_bf16_f32 v34, v34, v35
buffer_store_dword v34, v78, s[4:7], s25 offen
v_smfmac_f32_16x16x64_bf16 v[70:73], v[66:69], v[224:231], v0
v_add_f32 v18, v18, v20
v_smfmac_f32_16x16x64_bf16 v[74:77], v[62:65], v[200:207], v0
v_add_f32 v19, v19, v21
v_smfmac_f32_16x16x64_bf16 v[74:77], v[66:69], v[232:239], v0
v_cvt_pk_bf16_f32 v22, v18, v19
v_add_f32 v58, v58, v60
v_add_f32 v59, v59, v61
v_cvt_pk_bf16_f32 v23, v58, v59
v_add_f32 v70, v70, v72
v_add_f32 v71, v71, v73
v_cvt_pk_bf16_f32 v24, v70, v71
s_nop 0
v_add_f32 v74, v74, v76
v_add_f32 v75, v75, v77
v_cvt_pk_bf16_f32 v25, v74, v75
buffer_store_dwordx4 v[22:25], v8, s[4:7], s24 offen
s_add_u32 s15, s15, 1
s_cmp_eq_u32 s16, -1
s_cbranch_scc1 L_c1_nored
s_mov_b32 s38, 0
s_waitcnt lgkmcnt(0)
s_waitcnt vmcnt(1)
v_mov_b64 v[14:15], 0
s_and_b32 s35, s15, 3
s_lshl_b32 s35, s35, 14
v_mov_b64 v[16:17], 0
s_add_u32 s18, s32, s35
s_add_u32 s26, s26, 32768
v_mov_b64 v[18:19], 0
s_add_u32 s24, s24, s45
s_add_u32 s25, s25, s45
buffer_load_dwordx4 v[38:41], v1, s[4:7], s27 offen offset:0 sc1
buffer_load_dwordx4 v[42:45], v1, s[4:7], s27 offen offset:1024 sc1
buffer_load_dwordx4 v[70:73], v1, s[4:7], s27 offen offset:2048 sc1
buffer_load_dwordx4 v[74:77], v1, s[4:7], s27 offen offset:3072 sc1
v_mov_b64 v[20:21], 0
s_add_u32 s47, s47, 524288
s_add_u32 s46, s46, 524288
v_mov_b64 v[22:23], 0
s_xor_b32 s28, s28, 8192
s_xor_b32 s19, s19, 8192
v_mov_b64 v[24:25], 0
s_add_u32 s98, s98, 131072
v_mov_b64 v[26:27], 0
v_mov_b64 v[28:29], 0
v_and_b32 v79, 128, v10
v_add_u32 v79, v79, v10
L_c1_p5:
buffer_load_dwordx4 v[46:49], v1, s[4:7], s27 offen offset:0 sc1
buffer_load_dwordx4 v[50:53], v1, s[4:7], s27 offen offset:1024 sc1
buffer_load_dwordx4 v[54:57], v1, s[4:7], s27 offen offset:2048 sc1
buffer_load_dwordx4 v[58:61], v1, s[4:7], s27 offen offset:3072 sc1
s_add_u32 s38, s38, 1
s_cmp_ge_u32 s38, 524288
s_cbranch_scc1 L_err
s_waitcnt vmcnt(7)
v_mfma_f32_16x16x32_bf16 v[34:37], v[38:41], v[30:33], 0
v_max3_u32 v78, v38, v39, v40
v_max_u32 v78, v78, v41
s_waitcnt vmcnt(6)
v_mfma_f32_16x16x32_bf16 v[34:37], v[42:45], v[30:33], v[34:37]
v_max3_u32 v78, v78, v42, v43
v_max3_u32 v78, v78, v44, v45
s_waitcnt vmcnt(5)
v_mfma_f32_16x16x32_bf16 v[34:37], v[70:73], v[30:33], v[34:37]
v_max3_u32 v78, v78, v70, v71
v_max3_u32 v78, v78, v72, v73
s_waitcnt vmcnt(4)
v_mfma_f32_16x16x32_bf16 v[34:37], v[74:77], v[30:33], v[34:37]
v_max3_u32 v78, v78, v74, v75
v_max3_u32 v78, v78, v76, v77
v_cmp_eq_u32 vcc, -1, v78
s_cbranch_vccz L_c1_p5ok
buffer_load_dwordx4 v[38:41], v1, s[4:7], s27 offen offset:0 sc1
buffer_load_dwordx4 v[42:45], v1, s[4:7], s27 offen offset:1024 sc1
buffer_load_dwordx4 v[70:73], v1, s[4:7], s27 offen offset:2048 sc1
buffer_load_dwordx4 v[74:77], v1, s[4:7], s27 offen offset:3072 sc1
s_waitcnt vmcnt(7)
v_mfma_f32_16x16x32_bf16 v[34:37], v[46:49], v[30:33], 0
v_max3_u32 v78, v46, v47, v48
v_max_u32 v78, v78, v49
s_waitcnt vmcnt(6)
v_mfma_f32_16x16x32_bf16 v[34:37], v[50:53], v[30:33], v[34:37]
v_max3_u32 v78, v78, v50, v51
v_max3_u32 v78, v78, v52, v53
s_waitcnt vmcnt(5)
v_mfma_f32_16x16x32_bf16 v[34:37], v[54:57], v[30:33], v[34:37]
v_max3_u32 v78, v78, v54, v55
v_max3_u32 v78, v78, v56, v57
s_waitcnt vmcnt(4)
v_mfma_f32_16x16x32_bf16 v[34:37], v[58:61], v[30:33], v[34:37]
v_max3_u32 v78, v78, v58, v59
v_max3_u32 v78, v78, v60, v61
v_cmp_eq_u32 vcc, -1, v78
s_cbranch_vccnz L_c1_p5
L_c1_p5ok:
s_nop 3
v_permlane32_swap_b32 v34, v36
v_permlane32_swap_b32 v35, v37
s_cmp_eq_u64 vcc, 0
s_cselect_b64 exec, s[40:41], 0
v_add_f32 v34, v34, v36
v_add_f32 v35, v35, v37
v_cvt_pk_bf16_f32 v34, v34, v35
buffer_store_dword v34, v13, s[4:7], s20 offen
s_cselect_b64 exec, s[40:41], 0
buffer_store_dword v34, v13, s[4:7], s21 offen sc1
s_mov_b64 exec, -1
v_mov_b64 v[62:63], -1
v_mov_b64 v[64:65], -1
buffer_store_dwordx4 v[62:65], v1, s[4:7], s27 offen offset:0
buffer_store_dwordx4 v[62:65], v1, s[4:7], s27 offen offset:1024
buffer_store_dwordx4 v[62:65], v1, s[4:7], s27 offen offset:2048
buffer_store_dwordx4 v[62:65], v1, s[4:7], s27 offen offset:3072
buffer_store_dword v62, v13, s[4:7], s29 offen
s_waitcnt vmcnt(7)
v_mov_b64 v[30:31], 0
s_and_b32 s35, s15, 3
s_lshl_b32 s35, s35, 14
v_mov_b64 v[32:33], 0
s_add_u32 s35, s35, 16384
s_and_b32 s35, s35, 0xc000
v_mov_b64 v[34:35], 0
s_add_u32 s20, s44, s35
s_xor_b32 s35, s35, 32768
v_mov_b64 v[36:37], 0
s_add_u32 s29, s44, s35
s_add_u32 s21, s21, 32768
s_add_u32 s27, s27, s45
s_sub_u32 s45, 0, s45
s_waitcnt vmcnt(7)
s_branch L_c1_top
L_c1_nored:
s_add_u32 s36, s15, 2
s_min_u32 s36, s36, 64
s_cmp_ge_u32 s0, 64
s_cbranch_scc1 L_c1_fok
v_mov_b32 v70, s30
s_waitcnt vmcnt(0)
ds_read_b128 v[38:41], v70
ds_read_b128 v[42:45], v70 offset:16
s_waitcnt lgkmcnt(0)
v_min3_u32 v38, v38, v39, v40
v_min3_u32 v42, v42, v43, v44
v_min_u32 v38, v38, v41
v_min_u32 v42, v42, v45
v_lshlrev_b32 v38, 1, v38
v_lshl_add_u32 v42, v42, 1, 1
v_min_u32 v38, v38, v42
s_nop 0
v_readfirstlane_b32 s35, v38
s_nop 0
s_max_u32 s0, s0, s35
s_mov_b32 s38, 0
L_fw_c1kn:
s_cmp_ge_u32 s0, s36
s_cbranch_scc1 L_fw_c1kn_ok
buffer_load_dwordx4 v[38:41], off, s[4:7], s31 sc1
buffer_load_dwordx4 v[42:45], off, s[4:7], s31 offset:16 sc1
s_add_u32 s38, s38, 1
s_cmp_ge_u32 s38, 524288
s_cbranch_scc1 L_err
s_waitcnt vmcnt(0)
v_min3_u32 v38, v38, v39, v40
v_min3_u32 v42, v42, v43, v44
v_min_u32 v38, v38, v41
v_min_u32 v42, v42, v45
v_lshlrev_b32 v38, 1, v38
v_lshl_add_u32 v42, v42, 1, 1
v_min_u32 v38, v38, v42
s_nop 0
v_readfirstlane_b32 s35, v38
s_nop 0
s_max_u32 s0, s0, s35
s_branch L_fw_c1kn
L_fw_c1kn_ok:
s_add_u32 s35, s15, 4
s_cmp_lt_u32 s0, s35
s_cselect_b32 s97, 1, 0
s_cmp_lt_u32 s0, 64
s_cselect_b32 s97, s97, 0
L_c1_fok:
v_mov_b64 v[14:15], 0
s_and_b32 s35, s15, 3
s_lshl_b32 s35, s35, 14
v_mov_b64 v[16:17], 0
s_add_u32 s18, s32, s35
s_add_u32 s26, s26, 32768
v_mov_b64 v[18:19], 0
s_add_u32 s24, s24, s45
s_add_u32 s25, s25, s45
v_mov_b64 v[20:21], 0
s_add_u32 s47, s47, 524288
s_add_u32 s46, s46, 524288
v_mov_b64 v[22:23], 0
s_xor_b32 s28, s28, 8192
s_xor_b32 s19, s19, 8192
v_mov_b64 v[24:25], 0
s_add_u32 s98, s98, 131072
v_mov_b64 v[26:27], 0
v_mov_b64 v[28:29], 0
v_and_b32 v79, 128, v10
v_add_u32 v79, v79, v10
v_mov_b64 v[30:31], 0
s_and_b32 s35, s15, 3
s_lshl_b32 s35, s35, 14
v_mov_b64 v[32:33], 0
s_add_u32 s35, s35, 16384
s_and_b32 s35, s35, 0xc000
v_mov_b64 v[34:35], 0
s_add_u32 s20, s44, s35
s_xor_b32 s35, s35, 32768
v_mov_b64 v[36:37], 0
s_add_u32 s29, s44, s35
s_add_u32 s21, s21, 32768
s_add_u32 s27, s27, s45
s_sub_u32 s45, 0, s45
L_c1_top:
s_barrier
ds_read_b128 v[46:49], v2 offset:0
ds_read_b128 v[50:53], v2 offset:1024
ds_read_b128 v[54:57], v2 offset:2048
ds_read_b128 v[58:61], v2 offset:3072
ds_read_b128 v[62:65], v2 offset:16384
ds_read_b128 v[66:69], v2 offset:17408
s_branch L_c1_step
L_c1_p2slow:
s_mov_b32 s38, 0
L_c1_p2s:
s_mov_b32 m0, s1
s_nop 0
buffer_load_dwordx4 v11, s[4:7], s26 offen sc1 lds
s_mov_b32 m0, s2
s_nop 0
buffer_load_dword v12, s[4:7], s26 offen sc1 lds
s_add_u32 s38, s38, 1
s_cmp_ge_u32 s38, 524288
s_cbranch_scc1 L_err
s_waitcnt vmcnt(0)
ds_read_b128 v[70:73], v11 offset:21504
ds_read_b32 v78, v12 offset:21504
s_waitcnt lgkmcnt(0)
v_max3_u32 v74, v70, v71, v72
v_max3_u32 v74, v74, v73, v78
v_cmp_eq_u32 vcc, -1, v74
s_cbranch_vccnz L_c1_p2s
s_branch L_c1_p2ok
L_c1_newmax:
v_max_f32 v26, v26, v79
v_mov_b32 v79, v26
s_nop 1
v_permlane16_swap_b32 v26, v79
v_max_f32 v26, v26, v79
v_mov_b32 v79, v26
s_nop 1
v_permlane32_swap_b32 v26, v79
v_max_f32 v26, v26, v79
v_mul_f32 v26, s34, v26
v_sub_f32 v79, v78, v26
v_exp_f32 v79, v79
v_mov_b32 v78, v26
v_mul_f32 v70, v79, v70
v_mul_f32 v71, v79, v71
v_mul_f32 v72, v79, v72
v_mul_f32 v73, v79, v73
v_mul_f32 v74, v79, v74
v_mul_f32 v75, v79, v75
v_mul_f32 v76, v79, v76
v_mul_f32 v77, v79, v77
s_branch L_c1_maxok
L_c1_refresh:
s_mov_b32 s97, 0
s_mov_b32 m0, s30
v_lshrrev_b32 v78, 2, v1
s_sub_u32 s35, s31, 32768
s_mov_b64 exec, 255
buffer_load_dword v78, s[4:7], s35 offen sc1 lds
s_mov_b64 exec, -1
s_branch L_c1_refd
L_c1_last:
v_add_f32 v30, v30, v32
v_add_f32 v31, v31, v33
s_nop 1
v_add_f32 v34, v34, v36
v_add_f32 v35, v35, v37
v_cvt_pk_bf16_f32 v30, v30, v31
v_cvt_pk_bf16_f32 v31, v34, v35
buffer_store_dwordx2 v[30:31], v78, s[4:7], s98 offen sc1
s_waitcnt vmcnt(0)
L_c1_done:
s_branch L_chdone
L_chain_safe:
s_cmp_eq_u32 s14, 1
s_cbranch_scc1 L_chain_d1
ds_read_b128 v[46:49], v2 offset:0
ds_read_b128 v[50:53], v2 offset:1024
ds_read_b128 v[54:57], v2 offset:2048
ds_read_b128 v[58:61], v2 offset:3072
ds_read_b128 v[62:65], v2 offset:16384
ds_read_b128 v[66:69], v2 offset:17408
v_mov_b64 v[14:15], 0
v_mov_b64 v[16:17], 0
v_mov_b64 v[18:19], 0
v_mov_b64 v[20:21], 0
v_mov_b64 v[22:23], 0
v_mov_b64 v[24:25], 0
v_mov_b64 v[26:27], 0
v_mov_b64 v[28:29], 0
v_mov_b64 v[30:31], 0
v_mov_b64 v[32:33], 0
v_mov_b64 v[34:35], 0
v_mov_b64 v[36:37], 0
v_and_b32 v79, 128, v10
v_add_u32 v79, v79, v10
s_branch L_d0_step
.p2align 6
s_nop 0
s_nop 0
s_nop 0
s_nop 0
L_d0_step:
s_sleep 1
s_mov_b32 s38, 0
L_d0_p1:
buffer_load_dwordx4 v[70:73], v11, s[4:7], s18 offen sc1
buffer_load_dword v78, v12, s[4:7], s18 offen sc1
s_add_u32 s38, s38, 1
s_cmp_ge_u32 s38, 524288
s_cbranch_scc1 L_err
L_d0_p1w:
s_waitcnt vmcnt(1)
ds_write_b128 v11, v[70:73] offset:16384
v_max3_u32 v74, v70, v71, v72
s_waitcnt vmcnt(0)
ds_write_b32 v12, v78 offset:16384
v_max3_u32 v74, v74, v73, v78
v_cmp_eq_u32 vcc, -1, v74
s_cbranch_vccnz L_d0_p1
L_d0_p1d:
s_add_u32 s36, s46, 128
s_mov_b32 m0, s1
s_waitcnt lgkmcnt(0)
L_d0_barA:
s_barrier
ds_read_b128 v[38:41], v3 offset:0
buffer_load_dwordx4 v11, s[4:7], s26 offen sc1 lds
s_mov_b32 m0, s2
ds_read_b128 v[42:45], v3 offset:1024
buffer_load_dword v12, s[4:7], s26 offen sc1 lds
s_waitcnt lgkmcnt(1)
v_smfmac_f32_16x16x64_bf16 v[14:17], v[38:41], a[0:7], v0
v_smfmac_f32_16x16x64_bf16 v[22:25], v[38:41], v[46:53], v0
ds_read_b128 v[46:49], v2 offset:18432
ds_read_b128 v[50:53], v2 offset:19456
v_smfmac_f32_16x16x64_bf16 v[18:21], v[38:41], a[8:15], v0
s_mov_b32 m0, s28
s_nop 0
buffer_load_dwordx4 v79, s[4:7], s46 offen sc1 lds
v_smfmac_f32_16x16x64_bf16 v[26:29], v[38:41], v[54:61], v0
ds_read_b128 v[54:57], v2 offset:32768
ds_read_b128 v[58:61], v2 offset:33792
s_add_u32 m0, s28, 1024
s_nop 0
buffer_load_dwordx4 v79, s[4:7], s36 offen sc1 lds
s_waitcnt lgkmcnt(4)
v_smfmac_f32_16x16x64_bf16 v[14:17], v[42:45], a[16:23], v0
v_smfmac_f32_16x16x64_bf16 v[30:33], v[38:41], v[62:69], v0
ds_read_b128 v[62:65], v2 offset:34816
ds_read_b128 v[66:69], v2 offset:35840
v_smfmac_f32_16x16x64_bf16 v[18:21], v[42:45], a[24:31], v0
s_waitcnt lgkmcnt(4)
v_smfmac_f32_16x16x64_bf16 v[34:37], v[38:41], v[46:53], v0
ds_read_b128 v[38:41], v3 offset:2048
ds_read_b128 v[46:49], v2 offset:49152
ds_read_b128 v[50:53], v2 offset:50176
v_smfmac_f32_16x16x64_bf16 v[22:25], v[42:45], a[80:87], v0
s_waitcnt lgkmcnt(5)
v_smfmac_f32_16x16x64_bf16 v[30:33], v[42:45], v[54:61], v0
ds_read_b128 v[54:57], v2 offset:51200
ds_read_b128 v[58:61], v2 offset:52224
v_smfmac_f32_16x16x64_bf16 v[26:29], v[42:45], a[88:95], v0
s_waitcnt lgkmcnt(5)
v_smfmac_f32_16x16x64_bf16 v[34:37], v[42:45], v[62:69], v0
ds_read_b128 v[42:45], v3 offset:3072
v_xor_b32 v2, 0x10000, v2
ds_read_b128 v[62:65], v2 offset:0
ds_read_b128 v[66:69], v2 offset:1024
s_waitcnt lgkmcnt(7)
v_smfmac_f32_16x16x64_bf16 v[14:17], v[38:41], a[32:39], v0
s_waitcnt lgkmcnt(5)
v_smfmac_f32_16x16x64_bf16 v[22:25], v[38:41], v[46:53], v0
ds_read_b128 v[46:49], v2 offset:2048
ds_read_b128 v[50:53], v2 offset:3072
v_smfmac_f32_16x16x64_bf16 v[18:21], v[38:41], a[40:47], v0
s_waitcnt lgkmcnt(5)
v_smfmac_f32_16x16x64_bf16 v[26:29], v[38:41], v[54:61], v0
ds_read_b128 v[54:57], v2 offset:16384
ds_read_b128 v[58:61], v2 offset:17408
s_waitcnt lgkmcnt(6)
v_smfmac_f32_16x16x64_bf16 v[14:17], v[42:45], a[48:55], v0
s_waitcnt lgkmcnt(4)
v_smfmac_f32_16x16x64_bf16 v[30:33], v[38:41], v[62:69], v0
ds_read_b128 v[62:65], v2 offset:18432
ds_read_b128 v[66:69], v2 offset:19456
v_smfmac_f32_16x16x64_bf16 v[18:21], v[42:45], a[56:63], v0
s_waitcnt vmcnt(2)
ds_read_b128 v[70:73], v11 offset:21504
ds_read_b32 v78, v12 offset:21504
s_waitcnt lgkmcnt(6)
v_smfmac_f32_16x16x64_bf16 v[34:37], v[38:41], v[46:53], v0
ds_read_b128 v[38:41], v9 offset:4096
ds_read_b128 v[46:49], v2 offset:32768
ds_read_b128 v[50:53], v2 offset:33792
v_smfmac_f32_16x16x64_bf16 v[22:25], v[42:45], a[96:103], v0
s_waitcnt lgkmcnt(7)
v_smfmac_f32_16x16x64_bf16 v[30:33], v[42:45], v[54:61], v0
ds_read_b128 v[54:57], v2 offset:34816
ds_read_b128 v[58:61], v2 offset:35840
s_waitcnt lgkmcnt(5)
v_max3_u32 v74, v70, v71, v72
v_smfmac_f32_16x16x64_bf16 v[26:29], v[42:45], a[104:111], v0
v_max3_u32 v74, v74, v73, v78
v_smfmac_f32_16x16x64_bf16 v[34:37], v[42:45], v[62:69], v0
ds_read_b128 v[62:65], v2 offset:49152
ds_read_b128 v[66:69], v2 offset:50176
v_cmp_eq_u32 vcc, -1, v74
s_waitcnt lgkmcnt(6)
s_waitcnt lgkmcnt(4)
v_smfmac_f32_16x16x64_bf16 v[22:25], v[38:41], v[46:53], v0
ds_read_b128 v[46:49], v2 offset:51200
ds_read_b128 v[50:53], v2 offset:52224
v_xor_b32 v2, 0x10000, v2
s_cbranch_vccnz L_d0_p2slow
L_d0_p2ok:
s_barrier
ds_read_b128 v[70:73], v3 offset:5120
ds_read_b128 v[74:77], v3 offset:6144
ds_read_b128 v[42:45], v3 offset:7168
s_waitcnt lgkmcnt(7)
v_smfmac_f32_16x16x64_bf16 v[26:29], v[38:41], v[54:61], v0
ds_read_b128 v[54:57], v3 offset:8192
ds_read_b128 v[58:61], v9 offset:9216
s_waitcnt lgkmcnt(7)
v_smfmac_f32_16x16x64_bf16 v[30:33], v[38:41], v[62:69], v0
v_smfmac_f32_16x16x64_bf16 v[14:17], v[38:41], a[64:71], v0
s_waitcnt lgkmcnt(5)
v_smfmac_f32_16x16x64_bf16 v[34:37], v[38:41], v[46:53], v0
v_smfmac_f32_16x16x64_bf16 v[18:21], v[38:41], a[72:79], v0
buffer_load_dwordx4 v[62:65], v10, s[4:7], s47 offen sc1
buffer_load_dwordx4 v[66:69], v10, s[4:7], s47 offen offset:256 sc1
s_waitcnt lgkmcnt(4)
v_smfmac_f32_16x16x64_bf16 v[14:17], v[70:73], a[112:119], v0
v_mov_b32 v78, s15
s_mov_b64 exec, s[22:23]
v_smfmac_f32_16x16x64_bf16 v[18:21], v[70:73], a[120:127], v0
s_waitcnt lgkmcnt(3)
v_smfmac_f32_16x16x64_bf16 v[14:17], v[74:77], a[128:135], v0
buffer_store_dword v78, off, s[4:7], s33 sc1
s_mov_b64 exec, -1
v_smfmac_f32_16x16x64_bf16 v[18:21], v[74:77], a[136:143], v0
s_waitcnt lgkmcnt(2)
v_smfmac_f32_16x16x64_bf16 v[14:17], v[42:45], a[144:151], v0
s_cmp_eq_u32 s97, 1
s_cbranch_scc1 L_d0_refresh
L_d0_refd:
v_smfmac_f32_16x16x64_bf16 v[18:21], v[42:45], a[152:159], v0
s_waitcnt lgkmcnt(1)
v_smfmac_f32_16x16x64_bf16 v[14:17], v[54:57], a[160:167], v0
v_add_u32 v79, s19, v1
v_smfmac_f32_16x16x64_bf16 v[18:21], v[54:57], a[168:175], v0
s_waitcnt lgkmcnt(0)
v_smfmac_f32_16x16x64_bf16 v[14:17], v[58:61], a[176:183], v0
v_smfmac_f32_16x16x64_bf16 v[18:21], v[58:61], a[184:191], v0
v_smfmac_f32_16x16x64_bf16 v[22:25], v[70:73], a[192:199], v0
v_lshl_add_u32 v78, v6, 1, s39
v_smfmac_f32_16x16x64_bf16 v[26:29], v[70:73], a[200:207], v0
v_add_f32 v14, v14, v16
v_smfmac_f32_16x16x64_bf16 v[22:25], v[74:77], a[208:215], v0
v_add_f32 v15, v15, v17
v_smfmac_f32_16x16x64_bf16 v[26:29], v[74:77], a[216:223], v0
v_add_f32 v18, v18, v20
v_smfmac_f32_16x16x64_bf16 v[22:25], v[42:45], a[224:231], v0
v_add_f32 v19, v19, v21
v_smfmac_f32_16x16x64_bf16 v[26:29], v[42:45], a[232:239], v0
v_cvt_pk_bf16_f32 v14, v14, v15
v_smfmac_f32_16x16x64_bf16 v[22:25], v[54:57], a[240:247], v0
v_cvt_pk_bf16_f32 v15, v18, v19
ds_write2_b32 v6, v14, v15 offset0:0 offset1:64
v_smfmac_f32_16x16x64_bf16 v[26:29], v[54:57], a[248:255], v0
v_smfmac_f32_16x16x64_bf16 v[22:25], v[58:61], v[80:87], v0
v_smfmac_f32_16x16x64_bf16 v[26:29], v[58:61], v[88:95], v0
v_smfmac_f32_16x16x64_bf16 v[30:33], v[70:73], v[96:103], v0
s_waitcnt lgkmcnt(0)
ds_read_b128 v[14:17], v79 offset:0
v_smfmac_f32_16x16x64_bf16 v[34:37], v[70:73], v[104:111], v0
v_add_f32 v22, v22, v24
v_add_f32 v23, v23, v25
v_add_f32 v26, v26, v28
v_add_f32 v27, v27, v29
v_cvt_pk_bf16_f32 v22, v22, v23
v_cvt_pk_bf16_f32 v23, v26, v27
ds_write2_b32 v78, v22, v23 offset0:0 offset1:128
v_smfmac_f32_16x16x64_bf16 v[30:33], v[74:77], v[112:119], v0
v_lshrrev_b32 v78, 1, v1
v_smfmac_f32_16x16x64_bf16 v[34:37], v[74:77], v[120:127], v0
buffer_store_dwordx2 v[22:23], v78, s[4:7], s98 offen sc1
v_smfmac_f32_16x16x64_bf16 v[30:33], v[42:45], v[128:135], v0
v_smfmac_f32_16x16x64_bf16 v[34:37], v[42:45], v[136:143], v0
ds_read_b128 v[26:29], v79 offset:1024
ds_read_b128 v[42:45], v79 offset:2048
v_smfmac_f32_16x16x64_bf16 v[30:33], v[54:57], v[144:151], v0
s_waitcnt lgkmcnt(2)
s_barrier
ds_read_b64_tr_b16 v[38:39], v4 offset:0
ds_read_b64_tr_b16 v[40:41], v4 offset:128
ds_read_b128 v[22:25], v79 offset:5120
v_smfmac_f32_16x16x64_bf16 v[34:37], v[54:57], v[152:159], v0
ds_read_b64_tr_b16 v[46:47], v4 offset:512
ds_read_b64_tr_b16 v[48:49], v4 offset:640
ds_read_b128 v[54:57], v79 offset:3072
v_smfmac_f32_16x16x64_bf16 v[30:33], v[58:61], v[160:167], v0
ds_read_b64_tr_b16 v[50:51], v4 offset:1024
ds_read_b64_tr_b16 v[52:53], v4 offset:1152
s_cmp_eq_u32 s15, 63
v_smfmac_f32_16x16x64_bf16 v[34:37], v[58:61], v[168:175], v0
ds_read_b64_tr_b16 v[18:19], v4 offset:1536
ds_read_b64_tr_b16 v[20:21], v4 offset:1664
ds_read_b128 v[58:61], v79 offset:4096
s_cbranch_scc1 L_d0_last
s_waitcnt lgkmcnt(12)
s_waitcnt lgkmcnt(9)
v_mfma_f32_16x16x32_bf16 v[70:73], v[14:17], v[38:41], 0
ds_read_b128 v[14:17], v79 offset:6144
v_mfma_f32_16x16x32_bf16 v[74:77], v[26:29], v[38:41], 0
ds_read_b128 v[26:29], v79 offset:7168
v_add_f32 v30, v30, v32
s_waitcnt lgkmcnt(8)
v_mfma_f32_16x16x32_bf16 v[70:73], v[42:45], v[46:49], v[70:73]
ds_read_b64_tr_b16 v[42:43], v5 offset:0
ds_read_b64_tr_b16 v[44:45], v5 offset:256
v_add_f32 v31, v31, v33
s_waitcnt lgkmcnt(4)
v_mfma_f32_16x16x32_bf16 v[74:77], v[54:57], v[46:49], v[74:77]
ds_read_b64_tr_b16 v[54:55], v5 offset:1024
ds_read_b64_tr_b16 v[56:57], v5 offset:1280
v_add_f32 v34, v34, v36
v_mfma_f32_16x16x32_bf16 v[70:73], v[58:61], v[50:53], v[70:73]
ds_read_b64_tr_b16 v[58:59], v5 offset:2048
ds_read_b64_tr_b16 v[60:61], v5 offset:2304
v_add_f32 v35, v35, v37
s_waitcnt lgkmcnt(6)
v_mfma_f32_16x16x32_bf16 v[74:77], v[22:25], v[50:53], v[74:77]
ds_read_b64_tr_b16 v[22:23], v5 offset:3072
ds_read_b64_tr_b16 v[24:25], v5 offset:3328
v_cvt_pk_bf16_f32 v30, v30, v31
v_mfma_f32_16x16x32_bf16 v[70:73], v[14:17], v[18:21], v[70:73]
v_cvt_pk_bf16_f32 v31, v34, v35
v_mfma_f32_16x16x32_bf16 v[74:77], v[26:29], v[18:21], v[74:77]
v_mov_b32 v14, 0x3f803f80
v_mov_b32 v15, 0x3f803f80
s_waitcnt lgkmcnt(4)
v_mfma_f32_16x16x32_bf16 v[34:37], v[42:45], v[38:41], 0
v_mov_b64 v[16:17], v[14:15]
v_max3_f32 v78, v70, v71, v72
v_mfma_f32_16x16x32_bf16 v[34:37], v[54:57], v[46:49], v[34:37]
v_max3_f32 v78, v78, v73, v74
v_max3_f32 v78, v78, v75, v76
s_waitcnt lgkmcnt(0)
v_max_f32 v78, v78, v77
v_mov_b32 v79, v78
v_mfma_f32_16x16x32_bf16 v[34:37], v[58:61], v[50:53], v[34:37]
v_mov_b32 v43, 0
v_permlane16_swap_b32 v78, v79
v_max_f32 v78, v78, v79
v_mov_b32 v79, v78
v_mfma_f32_16x16x32_bf16 v[34:37], v[22:25], v[18:21], v[34:37]
v_mov_b32 v44, 0
v_permlane32_swap_b32 v78, v79
v_max_f32 v79, v78, v79
v_mul_f32 v78, s34, v79
v_pk_fma_f32 v[70:71], v[70:71], s[78:79], v[78:79] op_sel_hi:[1,1,0] neg_lo:[0,0,1] neg_hi:[0,0,1]
v_pk_fma_f32 v[72:73], v[72:73], s[78:79], v[78:79] op_sel_hi:[1,1,0] neg_lo:[0,0,1] neg_hi:[0,0,1]
v_pk_fma_f32 v[74:75], v[74:75], s[78:79], v[78:79] op_sel_hi:[1,1,0] neg_lo:[0,0,1] neg_hi:[0,0,1]
v_pk_fma_f32 v[76:77], v[76:77], s[78:79], v[78:79] op_sel_hi:[1,1,0] neg_lo:[0,0,1] neg_hi:[0,0,1]
v_max_f32 v26, v34, v35
v_cmp_gt_f32 vcc, v26, v79
v_exp_f32 v70, v70
v_exp_f32 v71, v71
v_exp_f32 v72, v72
v_exp_f32 v73, v73
v_exp_f32 v74, v74
v_exp_f32 v75, v75
v_exp_f32 v76, v76
v_exp_f32 v77, v77
s_cbranch_vccnz L_d0_newmax
L_d0_maxok:
v_cvt_pk_bf16_f32 v22, v70, v71
v_cvt_pk_bf16_f32 v23, v72, v73
v_cvt_pk_bf16_f32 v24, v74, v75
v_cvt_pk_bf16_f32 v25, v76, v77
v_fma_f32 v34, v34, s34, -v78
v_fma_f32 v35, v35, s34, -v78
s_waitcnt vmcnt(2)
v_mfma_f32_16x16x32_bf16 v[50:53], v[14:17], v[22:25], 0
v_exp_f32 v34, v34
v_mfma_f32_16x16x32_bf16 v[38:41], v[62:65], v[22:25], 0
v_exp_f32 v35, v35
v_mfma_f32_16x16x32_bf16 v[46:49], v[66:69], v[22:25], 0
v_cvt_pk_bf16_f32 v42, v34, v35
v_cvt_pk_bf16_f32 v45, v34, v35
v_lshrrev_b32 v79, 11, v8
v_mfma_f32_16x16x16_bf16 v[50:53], v[14:15], v[42:43], v[50:53]
v_mfma_f32_16x16x16_bf16 v[38:41], v[30:31], v[42:43], v[38:41]
v_mfma_f32_16x16x16_bf16 v[46:49], v[30:31], v[44:45], v[46:49]
v_rcp_f32 v78, v50
v_mov_b64 v[70:71], 0
v_mov_b64 v[72:73], 0
v_mov_b64 v[74:75], 0
v_mov_b64 v[76:77], 0
v_mov_b64 v[34:35], 0
v_mov_b64 v[36:37], 0
v_and_b32 v79, 12, v79
v_cndmask_b32 v38, v38, v46, s[42:43]
v_cndmask_b32 v39, v39, v47, s[42:43]
v_cndmask_b32 v40, v40, v48, s[42:43]
v_cndmask_b32 v41, v41, v49, s[42:43]
v_pk_mul_f32 v[38:39], v[38:39], v[78:79] op_sel_hi:[1,0]
v_pk_mul_f32 v[40:41], v[40:41], v[78:79] op_sel_hi:[1,0]
v_cvt_pk_bf16_f32 v38, v38, v39
v_cvt_pk_bf16_f32 v39, v40, v41
ds_write_b64 v7, v[38:39]
v_and_b32 v78, 0x1fff, v8
v_add_u32 v78, v78, v79
v_mov_b64 v[18:19], 0
v_mov_b64 v[20:21], 0
v_mov_b64 v[58:59], 0
v_mov_b64 v[60:61], 0
s_waitcnt lgkmcnt(0)
s_barrier
ds_read_b128 v[62:65], v9 offset:2048
ds_read_b128 v[66:69], v9 offset:3072
ds_read_b128 v[30:33], v1 offset:30720
s_waitcnt lgkmcnt(2)
v_smfmac_f32_16x16x64_bf16 v[34:37], v[62:65], v[240:247], v0
v_smfmac_f32_16x16x64_bf16 v[18:21], v[62:65], v[176:183], v0
s_waitcnt lgkmcnt(1)
v_smfmac_f32_16x16x64_bf16 v[34:37], v[66:69], v[248:255], v0
v_smfmac_f32_16x16x64_bf16 v[18:21], v[66:69], v[208:215], v0
v_smfmac_f32_16x16x64_bf16 v[58:61], v[62:65], v[184:191], v0
v_add_f32 v34, v34, v36
v_smfmac_f32_16x16x64_bf16 v[58:61], v[66:69], v[216:223], v0
v_add_f32 v35, v35, v37
v_smfmac_f32_16x16x64_bf16 v[70:73], v[62:65], v[192:199], v0
v_cvt_pk_bf16_f32 v34, v34, v35
buffer_store_dword v34, v78, s[4:7], s25 offen sc1
v_smfmac_f32_16x16x64_bf16 v[70:73], v[66:69], v[224:231], v0
v_add_f32 v18, v18, v20
v_smfmac_f32_16x16x64_bf16 v[74:77], v[62:65], v[200:207], v0
v_add_f32 v19, v19, v21
v_smfmac_f32_16x16x64_bf16 v[74:77], v[66:69], v[232:239], v0
v_cvt_pk_bf16_f32 v22, v18, v19
v_add_f32 v58, v58, v60
v_add_f32 v59, v59, v61
v_cvt_pk_bf16_f32 v23, v58, v59
v_add_f32 v70, v70, v72
v_add_f32 v71, v71, v73
v_cvt_pk_bf16_f32 v24, v70, v71
s_nop 0
v_add_f32 v74, v74, v76
v_add_f32 v75, v75, v77
v_cvt_pk_bf16_f32 v25, v74, v75
buffer_store_dwordx4 v[22:25], v8, s[4:7], s24 offen sc1
s_add_u32 s15, s15, 1
s_cmp_eq_u32 s16, -1
s_cbranch_scc1 L_d0_nored
s_mov_b32 s38, 0
s_waitcnt lgkmcnt(0)
s_waitcnt vmcnt(1)
v_mov_b64 v[14:15], 0
s_and_b32 s35, s15, 3
s_lshl_b32 s35, s35, 14
v_mov_b64 v[16:17], 0
s_add_u32 s18, s32, s35
s_add_u32 s26, s26, 32768
v_mov_b64 v[18:19], 0
s_add_u32 s24, s24, s45
s_add_u32 s25, s25, s45
buffer_load_dwordx4 v[38:41], v1, s[4:7], s27 offen offset:0 sc1
buffer_load_dwordx4 v[42:45], v1, s[4:7], s27 offen offset:1024 sc1
buffer_load_dwordx4 v[70:73], v1, s[4:7], s27 offen offset:2048 sc1
buffer_load_dwordx4 v[74:77], v1, s[4:7], s27 offen offset:3072 sc1
v_mov_b64 v[20:21], 0
s_add_u32 s47, s47, 524288
s_add_u32 s46, s46, 524288
v_mov_b64 v[22:23], 0
s_xor_b32 s28, s28, 8192
s_xor_b32 s19, s19, 8192
v_mov_b64 v[24:25], 0
s_add_u32 s98, s98, 131072
v_mov_b64 v[26:27], 0
v_mov_b64 v[28:29], 0
v_and_b32 v79, 128, v10
v_add_u32 v79, v79, v10
L_d0_p5:
buffer_load_dwordx4 v[46:49], v1, s[4:7], s27 offen offset:0 sc1
buffer_load_dwordx4 v[50:53], v1, s[4:7], s27 offen offset:1024 sc1
buffer_load_dwordx4 v[54:57], v1, s[4:7], s27 offen offset:2048 sc1
buffer_load_dwordx4 v[58:61], v1, s[4:7], s27 offen offset:3072 sc1
s_add_u32 s38, s38, 1
s_cmp_ge_u32 s38, 524288
s_cbranch_scc1 L_err
s_waitcnt vmcnt(7)
v_mfma_f32_16x16x32_bf16 v[34:37], v[38:41], v[30:33], 0
v_max3_u32 v78, v38, v39, v40
v_max_u32 v78, v78, v41
s_waitcnt vmcnt(6)
v_mfma_f32_16x16x32_bf16 v[34:37], v[42:45], v[30:33], v[34:37]
v_max3_u32 v78, v78, v42, v43
v_max3_u32 v78, v78, v44, v45
s_waitcnt vmcnt(5)
v_mfma_f32_16x16x32_bf16 v[34:37], v[70:73], v[30:33], v[34:37]
v_max3_u32 v78, v78, v70, v71
v_max3_u32 v78, v78, v72, v73
s_waitcnt vmcnt(4)
v_mfma_f32_16x16x32_bf16 v[34:37], v[74:77], v[30:33], v[34:37]
v_max3_u32 v78, v78, v74, v75
v_max3_u32 v78, v78, v76, v77
v_cmp_eq_u32 vcc, -1, v78
s_cbranch_vccz L_d0_p5ok
buffer_load_dwordx4 v[38:41], v1, s[4:7], s27 offen offset:0 sc1
buffer_load_dwordx4 v[42:45], v1, s[4:7], s27 offen offset:1024 sc1
buffer_load_dwordx4 v[70:73], v1, s[4:7], s27 offen offset:2048 sc1
buffer_load_dwordx4 v[74:77], v1, s[4:7], s27 offen offset:3072 sc1
s_waitcnt vmcnt(7)
v_mfma_f32_16x16x32_bf16 v[34:37], v[46:49], v[30:33], 0
v_max3_u32 v78, v46, v47, v48
v_max_u32 v78, v78, v49
s_waitcnt vmcnt(6)
v_mfma_f32_16x16x32_bf16 v[34:37], v[50:53], v[30:33], v[34:37]
v_max3_u32 v78, v78, v50, v51
v_max3_u32 v78, v78, v52, v53
s_waitcnt vmcnt(5)
v_mfma_f32_16x16x32_bf16 v[34:37], v[54:57], v[30:33], v[34:37]
v_max3_u32 v78, v78, v54, v55
v_max3_u32 v78, v78, v56, v57
s_waitcnt vmcnt(4)
v_mfma_f32_16x16x32_bf16 v[34:37], v[58:61], v[30:33], v[34:37]
v_max3_u32 v78, v78, v58, v59
v_max3_u32 v78, v78, v60, v61
v_cmp_eq_u32 vcc, -1, v78
s_cbranch_vccnz L_d0_p5
L_d0_p5ok:
s_nop 3
v_permlane32_swap_b32 v34, v36
v_permlane32_swap_b32 v35, v37
s_cmp_eq_u64 vcc, 0
s_cselect_b64 exec, s[40:41], 0
v_add_f32 v34, v34, v36
v_add_f32 v35, v35, v37
v_cvt_pk_bf16_f32 v34, v34, v35
buffer_store_dword v34, v13, s[4:7], s20 offen sc1
s_cselect_b64 exec, s[40:41], 0
buffer_store_dword v34, v13, s[4:7], s21 offen sc1
s_mov_b64 exec, -1
v_mov_b64 v[62:63], -1
v_mov_b64 v[64:65], -1
buffer_store_dwordx4 v[62:65], v1, s[4:7], s27 offen offset:0 sc1
buffer_store_dwordx4 v[62:65], v1, s[4:7], s27 offen offset:1024 sc1
buffer_store_dwordx4 v[62:65], v1, s[4:7], s27 offen offset:2048 sc1
buffer_store_dwordx4 v[62:65], v1, s[4:7], s27 offen offset:3072 sc1
buffer_store_dword v62, v13, s[4:7], s29 offen sc1
s_waitcnt vmcnt(7)
v_mov_b64 v[30:31], 0
s_and_b32 s35, s15, 3
s_lshl_b32 s35, s35, 14
v_mov_b64 v[32:33], 0
s_add_u32 s35, s35, 16384
s_and_b32 s35, s35, 0xc000
v_mov_b64 v[34:35], 0
s_add_u32 s20, s44, s35
s_xor_b32 s35, s35, 32768
v_mov_b64 v[36:37], 0
s_add_u32 s29, s44, s35
s_add_u32 s21, s21, 32768
s_add_u32 s27, s27, s45
s_sub_u32 s45, 0, s45
s_waitcnt vmcnt(7)
s_branch L_d0_top
L_d0_nored:
s_add_u32 s36, s15, 2
s_min_u32 s36, s36, 64
s_cmp_ge_u32 s0, 64
s_cbranch_scc1 L_d0_fok
v_mov_b32 v70, s30
s_waitcnt vmcnt(0)
ds_read_b128 v[38:41], v70
ds_read_b128 v[42:45], v70 offset:16
s_waitcnt lgkmcnt(0)
v_min3_u32 v38, v38, v39, v40
v_min3_u32 v42, v42, v43, v44
v_min_u32 v38, v38, v41
v_min_u32 v42, v42, v45
v_lshlrev_b32 v38, 1, v38
v_lshl_add_u32 v42, v42, 1, 1
v_min_u32 v38, v38, v42
s_nop 0
v_readfirstlane_b32 s35, v38
s_nop 0
s_max_u32 s0, s0, s35
s_mov_b32 s38, 0
L_fw_d0kn:
s_cmp_ge_u32 s0, s36
s_cbranch_scc1 L_fw_d0kn_ok
buffer_load_dwordx4 v[38:41], off, s[4:7], s31 sc1
buffer_load_dwordx4 v[42:45], off, s[4:7], s31 offset:16 sc1
s_add_u32 s38, s38, 1
s_cmp_ge_u32 s38, 524288
s_cbranch_scc1 L_err
s_waitcnt vmcnt(0)
v_min3_u32 v38, v38, v39, v40
v_min3_u32 v42, v42, v43, v44
v_min_u32 v38, v38, v41
v_min_u32 v42, v42, v45
v_lshlrev_b32 v38, 1, v38
v_lshl_add_u32 v42, v42, 1, 1
v_min_u32 v38, v38, v42
s_nop 0
v_readfirstlane_b32 s35, v38
s_nop 0
s_max_u32 s0, s0, s35
s_branch L_fw_d0kn
L_fw_d0kn_ok:
s_add_u32 s35, s15, 4
s_cmp_lt_u32 s0, s35
s_cselect_b32 s97, 1, 0
s_cmp_lt_u32 s0, 64
s_cselect_b32 s97, s97, 0
L_d0_fok:
v_mov_b64 v[14:15], 0
s_and_b32 s35, s15, 3
s_lshl_b32 s35, s35, 14
v_mov_b64 v[16:17], 0
s_add_u32 s18, s32, s35
s_add_u32 s26, s26, 32768
v_mov_b64 v[18:19], 0
s_add_u32 s24, s24, s45
s_add_u32 s25, s25, s45
v_mov_b64 v[20:21], 0
s_add_u32 s47, s47, 524288
s_add_u32 s46, s46, 524288
v_mov_b64 v[22:23], 0
s_xor_b32 s28, s28, 8192
s_xor_b32 s19, s19, 8192
v_mov_b64 v[24:25], 0
s_add_u32 s98, s98, 131072
v_mov_b64 v[26:27], 0
v_mov_b64 v[28:29], 0
v_and_b32 v79, 128, v10
v_add_u32 v79, v79, v10
v_mov_b64 v[30:31], 0
s_and_b32 s35, s15, 3
s_lshl_b32 s35, s35, 14
v_mov_b64 v[32:33], 0
s_add_u32 s35, s35, 16384
s_and_b32 s35, s35, 0xc000
v_mov_b64 v[34:35], 0
s_add_u32 s20, s44, s35
s_xor_b32 s35, s35, 32768
v_mov_b64 v[36:37], 0
s_add_u32 s29, s44, s35
s_add_u32 s21, s21, 32768
s_add_u32 s27, s27, s45
s_sub_u32 s45, 0, s45
L_d0_top:
s_barrier
ds_read_b128 v[46:49], v2 offset:0
ds_read_b128 v[50:53], v2 offset:1024
ds_read_b128 v[54:57], v2 offset:2048
ds_read_b128 v[58:61], v2 offset:3072
ds_read_b128 v[62:65], v2 offset:16384
ds_read_b128 v[66:69], v2 offset:17408
s_branch L_d0_step
L_d0_p2slow:
s_mov_b32 s38, 0
L_d0_p2s:
s_mov_b32 m0, s1
s_nop 0
buffer_load_dwordx4 v11, s[4:7], s26 offen sc1 lds
s_mov_b32 m0, s2
s_nop 0
buffer_load_dword v12, s[4:7], s26 offen sc1 lds
s_add_u32 s38, s38, 1
s_cmp_ge_u32 s38, 524288
s_cbranch_scc1 L_err
s_waitcnt vmcnt(0)
ds_read_b128 v[70:73], v11 offset:21504
ds_read_b32 v78, v12 offset:21504
s_waitcnt lgkmcnt(0)
v_max3_u32 v74, v70, v71, v72
v_max3_u32 v74, v74, v73, v78
v_cmp_eq_u32 vcc, -1, v74
s_cbranch_vccnz L_d0_p2s
s_branch L_d0_p2ok
L_d0_newmax:
v_max_f32 v26, v26, v79
v_mov_b32 v79, v26
s_nop 1
v_permlane16_swap_b32 v26, v79
v_max_f32 v26, v26, v79
v_mov_b32 v79, v26
s_nop 1
v_permlane32_swap_b32 v26, v79
v_max_f32 v26, v26, v79
v_mul_f32 v26, s34, v26
v_sub_f32 v79, v78, v26
v_exp_f32 v79, v79
v_mov_b32 v78, v26
v_mul_f32 v70, v79, v70
v_mul_f32 v71, v79, v71
v_mul_f32 v72, v79, v72
v_mul_f32 v73, v79, v73
v_mul_f32 v74, v79, v74
v_mul_f32 v75, v79, v75
v_mul_f32 v76, v79, v76
v_mul_f32 v77, v79, v77
s_branch L_d0_maxok
L_d0_refresh:
s_mov_b32 s97, 0
s_mov_b32 m0, s30
v_lshrrev_b32 v78, 2, v1
s_sub_u32 s35, s31, 32768
s_mov_b64 exec, 255
buffer_load_dword v78, s[4:7], s35 offen sc1 lds
s_mov_b64 exec, -1
s_branch L_d0_refd
L_d0_last:
s_waitcnt vmcnt(0)
L_d0_done:
s_branch L_chdone
L_chain_d1:
ds_read_b128 v[46:49], v2 offset:0
ds_read_b128 v[50:53], v2 offset:1024
ds_read_b128 v[54:57], v2 offset:2048
ds_read_b128 v[58:61], v2 offset:3072
ds_read_b128 v[62:65], v2 offset:16384
ds_read_b128 v[66:69], v2 offset:17408
v_mov_b64 v[14:15], 0
v_mov_b64 v[16:17], 0
v_mov_b64 v[18:19], 0
v_mov_b64 v[20:21], 0
v_mov_b64 v[22:23], 0
v_mov_b64 v[24:25], 0
v_mov_b64 v[26:27], 0
v_mov_b64 v[28:29], 0
v_mov_b64 v[30:31], 0
v_mov_b64 v[32:33], 0
v_mov_b64 v[34:35], 0
v_mov_b64 v[36:37], 0
v_and_b32 v79, 128, v10
v_add_u32 v79, v79, v10
s_branch L_d1_step
.p2align 6
s_nop 0
s_nop 0
s_nop 0
s_nop 0
L_d1_step:
s_sleep 1
s_mov_b32 s38, 0
L_d1_p1:
buffer_load_dwordx4 v[70:73], v11, s[4:7], s18 offen sc1
buffer_load_dword v78, v12, s[4:7], s18 offen sc1
s_add_u32 s38, s38, 1
s_cmp_ge_u32 s38, 524288
s_cbranch_scc1 L_err
L_d1_p1w:
s_waitcnt vmcnt(1)
ds_write_b128 v11, v[70:73] offset:16384
v_max3_u32 v74, v70, v71, v72
s_waitcnt vmcnt(0)
ds_write_b32 v12, v78 offset:16384
v_max3_u32 v74, v74, v73, v78
v_cmp_eq_u32 vcc, -1, v74
s_cbranch_vccnz L_d1_p1
L_d1_p1d:
s_add_u32 s36, s46, 128
s_mov_b32 m0, s1
s_waitcnt lgkmcnt(0)
L_d1_barA:
s_barrier
ds_read_b128 v[38:41], v3 offset:0
buffer_load_dwordx4 v11, s[4:7], s26 offen sc1 lds
s_mov_b32 m0, s2
ds_read_b128 v[42:45], v3 offset:1024
buffer_load_dword v12, s[4:7], s26 offen sc1 lds
s_waitcnt lgkmcnt(1)
v_smfmac_f32_16x16x64_bf16 v[14:17], v[38:41], a[0:7], v0
v_smfmac_f32_16x16x64_bf16 v[22:25], v[38:41], v[46:53], v0
ds_read_b128 v[46:49], v2 offset:18432
ds_read_b128 v[50:53], v2 offset:19456
v_smfmac_f32_16x16x64_bf16 v[18:21], v[38:41], a[8:15], v0
s_mov_b32 m0, s28
s_nop 0
buffer_load_dwordx4 v79, s[4:7], s46 offen sc1 lds
v_smfmac_f32_16x16x64_bf16 v[26:29], v[38:41], v[54:61], v0
ds_read_b128 v[54:57], v2 offset:32768
ds_read_b128 v[58:61], v2 offset:33792
s_add_u32 m0, s28, 1024
s_nop 0
buffer_load_dwordx4 v79, s[4:7], s36 offen sc1 lds
s_waitcnt lgkmcnt(4)
v_smfmac_f32_16x16x64_bf16 v[14:17], v[42:45], a[16:23], v0
v_smfmac_f32_16x16x64_bf16 v[30:33], v[38:41], v[62:69], v0
ds_read_b128 v[62:65], v2 offset:34816
ds_read_b128 v[66:69], v2 offset:35840
v_smfmac_f32_16x16x64_bf16 v[18:21], v[42:45], a[24:31], v0
s_waitcnt lgkmcnt(4)
v_smfmac_f32_16x16x64_bf16 v[34:37], v[38:41], v[46:53], v0
ds_read_b128 v[38:41], v3 offset:2048
ds_read_b128 v[46:49], v2 offset:49152
ds_read_b128 v[50:53], v2 offset:50176
v_smfmac_f32_16x16x64_bf16 v[22:25], v[42:45], a[80:87], v0
s_waitcnt lgkmcnt(5)
v_smfmac_f32_16x16x64_bf16 v[30:33], v[42:45], v[54:61], v0
ds_read_b128 v[54:57], v2 offset:51200
ds_read_b128 v[58:61], v2 offset:52224
v_smfmac_f32_16x16x64_bf16 v[26:29], v[42:45], a[88:95], v0
s_waitcnt lgkmcnt(5)
v_smfmac_f32_16x16x64_bf16 v[34:37], v[42:45], v[62:69], v0
ds_read_b128 v[42:45], v3 offset:3072
v_xor_b32 v2, 0x10000, v2
ds_read_b128 v[62:65], v2 offset:0
ds_read_b128 v[66:69], v2 offset:1024
s_waitcnt lgkmcnt(7)
v_smfmac_f32_16x16x64_bf16 v[14:17], v[38:41], a[32:39], v0
s_waitcnt lgkmcnt(5)
v_smfmac_f32_16x16x64_bf16 v[22:25], v[38:41], v[46:53], v0
ds_read_b128 v[46:49], v2 offset:2048
ds_read_b128 v[50:53], v2 offset:3072
v_smfmac_f32_16x16x64_bf16 v[18:21], v[38:41], a[40:47], v0
s_waitcnt lgkmcnt(5)
v_smfmac_f32_16x16x64_bf16 v[26:29], v[38:41], v[54:61], v0
ds_read_b128 v[54:57], v2 offset:16384
ds_read_b128 v[58:61], v2 offset:17408
s_waitcnt lgkmcnt(6)
v_smfmac_f32_16x16x64_bf16 v[14:17], v[42:45], a[48:55], v0
s_waitcnt lgkmcnt(4)
v_smfmac_f32_16x16x64_bf16 v[30:33], v[38:41], v[62:69], v0
ds_read_b128 v[62:65], v2 offset:18432
ds_read_b128 v[66:69], v2 offset:19456
v_smfmac_f32_16x16x64_bf16 v[18:21], v[42:45], a[56:63], v0
s_waitcnt vmcnt(2)
ds_read_b128 v[70:73], v11 offset:21504
ds_read_b32 v78, v12 offset:21504
s_waitcnt lgkmcnt(6)
v_smfmac_f32_16x16x64_bf16 v[34:37], v[38:41], v[46:53], v0
ds_read_b128 v[38:41], v9 offset:4096
ds_read_b128 v[46:49], v2 offset:32768
ds_read_b128 v[50:53], v2 offset:33792
v_smfmac_f32_16x16x64_bf16 v[22:25], v[42:45], a[96:103], v0
s_waitcnt lgkmcnt(7)
v_smfmac_f32_16x16x64_bf16 v[30:33], v[42:45], v[54:61], v0
ds_read_b128 v[54:57], v2 offset:34816
ds_read_b128 v[58:61], v2 offset:35840
s_waitcnt lgkmcnt(5)
v_max3_u32 v74, v70, v71, v72
v_smfmac_f32_16x16x64_bf16 v[26:29], v[42:45], a[104:111], v0
v_max3_u32 v74, v74, v73, v78
v_smfmac_f32_16x16x64_bf16 v[34:37], v[42:45], v[62:69], v0
ds_read_b128 v[62:65], v2 offset:49152
ds_read_b128 v[66:69], v2 offset:50176
v_cmp_eq_u32 vcc, -1, v74
s_waitcnt lgkmcnt(6)
s_waitcnt lgkmcnt(4)
v_smfmac_f32_16x16x64_bf16 v[22:25], v[38:41], v[46:53], v0
ds_read_b128 v[46:49], v2 offset:51200
ds_read_b128 v[50:53], v2 offset:52224
v_xor_b32 v2, 0x10000, v2
s_cbranch_vccnz L_d1_p2slow
L_d1_p2ok:
s_barrier
ds_read_b128 v[70:73], v3 offset:5120
ds_read_b128 v[74:77], v3 offset:6144
ds_read_b128 v[42:45], v3 offset:7168
s_waitcnt lgkmcnt(7)
v_smfmac_f32_16x16x64_bf16 v[26:29], v[38:41], v[54:61], v0
ds_read_b128 v[54:57], v3 offset:8192
ds_read_b128 v[58:61], v9 offset:9216
s_waitcnt lgkmcnt(7)
v_smfmac_f32_16x16x64_bf16 v[30:33], v[38:41], v[62:69], v0
v_smfmac_f32_16x16x64_bf16 v[14:17], v[38:41], a[64:71], v0
s_waitcnt lgkmcnt(5)
v_smfmac_f32_16x16x64_bf16 v[34:37], v[38:41], v[46:53], v0
v_smfmac_f32_16x16x64_bf16 v[18:21], v[38:41], a[72:79], v0
buffer_load_dwordx4 v[62:65], v10, s[4:7], s47 offen sc1
buffer_load_dwordx4 v[66:69], v10, s[4:7], s47 offen offset:256 sc1
s_waitcnt lgkmcnt(4)
v_smfmac_f32_16x16x64_bf16 v[14:17], v[70:73], a[112:119], v0
v_mov_b32 v78, s15
s_mov_b64 exec, s[22:23]
v_smfmac_f32_16x16x64_bf16 v[18:21], v[70:73], a[120:127], v0
s_waitcnt lgkmcnt(3)
v_smfmac_f32_16x16x64_bf16 v[14:17], v[74:77], a[128:135], v0
buffer_store_dword v78, off, s[4:7], s33 sc1
s_mov_b64 exec, -1
v_smfmac_f32_16x16x64_bf16 v[18:21], v[74:77], a[136:143], v0
s_waitcnt lgkmcnt(2)
v_smfmac_f32_16x16x64_bf16 v[14:17], v[42:45], a[144:151], v0
s_cmp_eq_u32 s97, 1
s_cbranch_scc1 L_d1_refresh
L_d1_refd:
v_smfmac_f32_16x16x64_bf16 v[18:21], v[42:45], a[152:159], v0
s_waitcnt lgkmcnt(1)
v_smfmac_f32_16x16x64_bf16 v[14:17], v[54:57], a[160:167], v0
v_add_u32 v79, s19, v1
v_smfmac_f32_16x16x64_bf16 v[18:21], v[54:57], a[168:175], v0
s_waitcnt lgkmcnt(0)
v_smfmac_f32_16x16x64_bf16 v[14:17], v[58:61], a[176:183], v0
v_smfmac_f32_16x16x64_bf16 v[18:21], v[58:61], a[184:191], v0
v_smfmac_f32_16x16x64_bf16 v[22:25], v[70:73], a[192:199], v0
v_lshl_add_u32 v78, v6, 1, s39
v_smfmac_f32_16x16x64_bf16 v[26:29], v[70:73], a[200:207], v0
v_add_f32 v14, v14, v16
v_smfmac_f32_16x16x64_bf16 v[22:25], v[74:77], a[208:215], v0
v_add_f32 v15, v15, v17
v_smfmac_f32_16x16x64_bf16 v[26:29], v[74:77], a[216:223], v0
v_add_f32 v18, v18, v20
v_smfmac_f32_16x16x64_bf16 v[22:25], v[42:45], a[224:231], v0
v_add_f32 v19, v19, v21
v_smfmac_f32_16x16x64_bf16 v[26:29], v[42:45], a[232:239], v0
v_cvt_pk_bf16_f32 v14, v14, v15
v_smfmac_f32_16x16x64_bf16 v[22:25], v[54:57], a[240:247], v0
v_cvt_pk_bf16_f32 v15, v18, v19
ds_write2_b32 v6, v14, v15 offset0:0 offset1:64
v_smfmac_f32_16x16x64_bf16 v[26:29], v[54:57], a[248:255], v0
v_smfmac_f32_16x16x64_bf16 v[22:25], v[58:61], v[80:87], v0
v_smfmac_f32_16x16x64_bf16 v[26:29], v[58:61], v[88:95], v0
v_smfmac_f32_16x16x64_bf16 v[30:33], v[70:73], v[96:103], v0
s_waitcnt lgkmcnt(0)
ds_read_b128 v[14:17], v79 offset:0
v_smfmac_f32_16x16x64_bf16 v[34:37], v[70:73], v[104:111], v0
v_add_f32 v22, v22, v24
v_add_f32 v23, v23, v25
v_add_f32 v26, v26, v28
v_add_f32 v27, v27, v29
v_cvt_pk_bf16_f32 v22, v22, v23
v_cvt_pk_bf16_f32 v23, v26, v27
ds_write2_b32 v78, v22, v23 offset0:0 offset1:128
v_smfmac_f32_16x16x64_bf16 v[30:33], v[74:77], v[112:119], v0
v_lshrrev_b32 v78, 1, v1
v_smfmac_f32_16x16x64_bf16 v[34:37], v[74:77], v[120:127], v0
v_smfmac_f32_16x16x64_bf16 v[30:33], v[42:45], v[128:135], v0
v_smfmac_f32_16x16x64_bf16 v[34:37], v[42:45], v[136:143], v0
ds_read_b128 v[26:29], v79 offset:1024
ds_read_b128 v[42:45], v79 offset:2048
v_smfmac_f32_16x16x64_bf16 v[30:33], v[54:57], v[144:151], v0
s_waitcnt lgkmcnt(2)
s_barrier
ds_read_b64_tr_b16 v[38:39], v4 offset:0
ds_read_b64_tr_b16 v[40:41], v4 offset:128
ds_read_b128 v[22:25], v79 offset:5120
v_smfmac_f32_16x16x64_bf16 v[34:37], v[54:57], v[152:159], v0
ds_read_b64_tr_b16 v[46:47], v4 offset:512
ds_read_b64_tr_b16 v[48:49], v4 offset:640
ds_read_b128 v[54:57], v79 offset:3072
v_smfmac_f32_16x16x64_bf16 v[30:33], v[58:61], v[160:167], v0
ds_read_b64_tr_b16 v[50:51], v4 offset:1024
ds_read_b64_tr_b16 v[52:53], v4 offset:1152
s_cmp_eq_u32 s15, 63
v_smfmac_f32_16x16x64_bf16 v[34:37], v[58:61], v[168:175], v0
ds_read_b64_tr_b16 v[18:19], v4 offset:1536
ds_read_b64_tr_b16 v[20:21], v4 offset:1664
ds_read_b128 v[58:61], v79 offset:4096
s_cbranch_scc1 L_d1_last
s_waitcnt lgkmcnt(12)
s_waitcnt lgkmcnt(9)
v_mfma_f32_16x16x32_bf16 v[70:73], v[14:17], v[38:41], 0
ds_read_b128 v[14:17], v79 offset:6144
v_mfma_f32_16x16x32_bf16 v[74:77], v[26:29], v[38:41], 0
ds_read_b128 v[26:29], v79 offset:7168
v_add_f32 v30, v30, v32
s_waitcnt lgkmcnt(8)
v_mfma_f32_16x16x32_bf16 v[70:73], v[42:45], v[46:49], v[70:73]
ds_read_b64_tr_b16 v[42:43], v5 offset:0
ds_read_b64_tr_b16 v[44:45], v5 offset:256
v_add_f32 v31, v31, v33
s_waitcnt lgkmcnt(4)
v_mfma_f32_16x16x32_bf16 v[74:77], v[54:57], v[46:49], v[74:77]
ds_read_b64_tr_b16 v[54:55], v5 offset:1024
ds_read_b64_tr_b16 v[56:57], v5 offset:1280
v_add_f32 v34, v34, v36
v_mfma_f32_16x16x32_bf16 v[70:73], v[58:61], v[50:53], v[70:73]
ds_read_b64_tr_b16 v[58:59], v5 offset:2048
ds_read_b64_tr_b16 v[60:61], v5 offset:2304
v_add_f32 v35, v35, v37
s_waitcnt lgkmcnt(6)
v_mfma_f32_16x16x32_bf16 v[74:77], v[22:25], v[50:53], v[74:77]
ds_read_b64_tr_b16 v[22:23], v5 offset:3072
ds_read_b64_tr_b16 v[24:25], v5 offset:3328
v_cvt_pk_bf16_f32 v30, v30, v31
v_mfma_f32_16x16x32_bf16 v[70:73], v[14:17], v[18:21], v[70:73]
v_cvt_pk_bf16_f32 v31, v34, v35
v_mfma_f32_16x16x32_bf16 v[74:77], v[26:29], v[18:21], v[74:77]
v_mov_b32 v14, 0x3f803f80
v_mov_b32 v15, 0x3f803f80
s_waitcnt lgkmcnt(4)
v_mfma_f32_16x16x32_bf16 v[34:37], v[42:45], v[38:41], 0
v_mov_b64 v[16:17], v[14:15]
buffer_store_dwordx2 v[30:31], v78, s[4:7], s98 offen sc1
v_max3_f32 v78, v70, v71, v72
v_mfma_f32_16x16x32_bf16 v[34:37], v[54:57], v[46:49], v[34:37]
v_max3_f32 v78, v78, v73, v74
v_max3_f32 v78, v78, v75, v76
s_waitcnt lgkmcnt(0)
v_max_f32 v78, v78, v77
v_mov_b32 v79, v78
v_mfma_f32_16x16x32_bf16 v[34:37], v[58:61], v[50:53], v[34:37]
v_mov_b32 v43, 0
v_permlane16_swap_b32 v78, v79
v_max_f32 v78, v78, v79
v_mov_b32 v79, v78
v_mfma_f32_16x16x32_bf16 v[34:37], v[22:25], v[18:21], v[34:37]
v_mov_b32 v44, 0
v_permlane32_swap_b32 v78, v79
v_max_f32 v79, v78, v79
v_mul_f32 v78, s34, v79
v_pk_fma_f32 v[70:71], v[70:71], s[78:79], v[78:79] op_sel_hi:[1,1,0] neg_lo:[0,0,1] neg_hi:[0,0,1]
v_pk_fma_f32 v[72:73], v[72:73], s[78:79], v[78:79] op_sel_hi:[1,1,0] neg_lo:[0,0,1] neg_hi:[0,0,1]
v_pk_fma_f32 v[74:75], v[74:75], s[78:79], v[78:79] op_sel_hi:[1,1,0] neg_lo:[0,0,1] neg_hi:[0,0,1]
v_pk_fma_f32 v[76:77], v[76:77], s[78:79], v[78:79] op_sel_hi:[1,1,0] neg_lo:[0,0,1] neg_hi:[0,0,1]
v_max_f32 v26, v34, v35
v_cmp_gt_f32 vcc, v26, v79
v_exp_f32 v70, v70
v_exp_f32 v71, v71
v_exp_f32 v72, v72
v_exp_f32 v73, v73
v_exp_f32 v74, v74
v_exp_f32 v75, v75
v_exp_f32 v76, v76
v_exp_f32 v77, v77
s_cbranch_vccnz L_d1_newmax
L_d1_maxok:
v_cvt_pk_bf16_f32 v22, v70, v71
v_cvt_pk_bf16_f32 v23, v72, v73
v_cvt_pk_bf16_f32 v24, v74, v75
v_cvt_pk_bf16_f32 v25, v76, v77
v_fma_f32 v34, v34, s34, -v78
v_fma_f32 v35, v35, s34, -v78
s_waitcnt vmcnt(2)
v_mfma_f32_16x16x32_bf16 v[50:53], v[14:17], v[22:25], 0
v_exp_f32 v34, v34
v_mfma_f32_16x16x32_bf16 v[38:41], v[62:65], v[22:25], 0
v_exp_f32 v35, v35
v_mfma_f32_16x16x32_bf16 v[46:49], v[66:69], v[22:25], 0
v_cvt_pk_bf16_f32 v42, v34, v35
v_cvt_pk_bf16_f32 v45, v34, v35
v_lshrrev_b32 v79, 11, v8
v_mfma_f32_16x16x16_bf16 v[50:53], v[14:15], v[42:43], v[50:53]
v_mfma_f32_16x16x16_bf16 v[38:41], v[30:31], v[42:43], v[38:41]
v_mfma_f32_16x16x16_bf16 v[46:49], v[30:31], v[44:45], v[46:49]
v_rcp_f32 v78, v50
v_mov_b64 v[70:71], 0
v_mov_b64 v[72:73], 0
v_mov_b64 v[74:75], 0
v_mov_b64 v[76:77], 0
v_mov_b64 v[34:35], 0
v_mov_b64 v[36:37], 0
v_and_b32 v79, 12, v79
v_cndmask_b32 v38, v38, v46, s[42:43]
v_cndmask_b32 v39, v39, v47, s[42:43]
v_cndmask_b32 v40, v40, v48, s[42:43]
v_cndmask_b32 v41, v41, v49, s[42:43]
v_pk_mul_f32 v[38:39], v[38:39], v[78:79] op_sel_hi:[1,0]
v_pk_mul_f32 v[40:41], v[40:41], v[78:79] op_sel_hi:[1,0]
v_cvt_pk_bf16_f32 v38, v38, v39
v_cvt_pk_bf16_f32 v39, v40, v41
ds_write_b64 v7, v[38:39]
v_and_b32 v78, 0x1fff, v8
v_add_u32 v78, v78, v79
v_mov_b64 v[18:19], 0
v_mov_b64 v[20:21], 0
v_mov_b64 v[58:59], 0
v_mov_b64 v[60:61], 0
s_waitcnt lgkmcnt(0)
s_barrier
ds_read_b128 v[62:65], v9 offset:2048
ds_read_b128 v[66:69], v9 offset:3072
ds_read_b128 v[30:33], v1 offset:30720
s_waitcnt lgkmcnt(2)
v_smfmac_f32_16x16x64_bf16 v[34:37], v[62:65], v[240:247], v0
v_smfmac_f32_16x16x64_bf16 v[18:21], v[62:65], v[176:183], v0
s_waitcnt lgkmcnt(1)
v_smfmac_f32_16x16x64_bf16 v[34:37], v[66:69], v[248:255], v0
v_smfmac_f32_16x16x64_bf16 v[18:21], v[66:69], v[208:215], v0
v_smfmac_f32_16x16x64_bf16 v[58:61], v[62:65], v[184:191], v0
v_add_f32 v34, v34, v36
v_smfmac_f32_16x16x64_bf16 v[58:61], v[66:69], v[216:223], v0
v_add_f32 v35, v35, v37
v_smfmac_f32_16x16x64_bf16 v[70:73], v[62:65], v[192:199], v0
v_cvt_pk_bf16_f32 v34, v34, v35
buffer_store_dword v34, v78, s[4:7], s25 offen sc1
v_smfmac_f32_16x16x64_bf16 v[70:73], v[66:69], v[224:231], v0
v_add_f32 v18, v18, v20
v_smfmac_f32_16x16x64_bf16 v[74:77], v[62:65], v[200:207], v0
v_add_f32 v19, v19, v21
v_smfmac_f32_16x16x64_bf16 v[74:77], v[66:69], v[232:239], v0
v_cvt_pk_bf16_f32 v22, v18, v19
v_add_f32 v58, v58, v60
v_add_f32 v59, v59, v61
v_cvt_pk_bf16_f32 v23, v58, v59
v_add_f32 v70, v70, v72
v_add_f32 v71, v71, v73
v_cvt_pk_bf16_f32 v24, v70, v71
s_nop 0
v_add_f32 v74, v74, v76
v_add_f32 v75, v75, v77
v_cvt_pk_bf16_f32 v25, v74, v75
buffer_store_dwordx4 v[22:25], v8, s[4:7], s24 offen sc1
s_add_u32 s15, s15, 1
s_cmp_eq_u32 s16, -1
s_cbranch_scc1 L_d1_nored
s_mov_b32 s38, 0
s_waitcnt lgkmcnt(0)
s_waitcnt vmcnt(1)
v_mov_b64 v[14:15], 0
s_and_b32 s35, s15, 3
s_lshl_b32 s35, s35, 14
v_mov_b64 v[16:17], 0
s_add_u32 s18, s32, s35
s_add_u32 s26, s26, 32768
v_mov_b64 v[18:19], 0
s_add_u32 s24, s24, s45
s_add_u32 s25, s25, s45
buffer_load_dwordx4 v[38:41], v1, s[4:7], s27 offen offset:0 sc1
buffer_load_dwordx4 v[42:45], v1, s[4:7], s27 offen offset:1024 sc1
buffer_load_dwordx4 v[70:73], v1, s[4:7], s27 offen offset:2048 sc1
buffer_load_dwordx4 v[74:77], v1, s[4:7], s27 offen offset:3072 sc1
v_mov_b64 v[20:21], 0
s_add_u32 s47, s47, 524288
s_add_u32 s46, s46, 524288
v_mov_b64 v[22:23], 0
s_xor_b32 s28, s28, 8192
s_xor_b32 s19, s19, 8192
v_mov_b64 v[24:25], 0
s_add_u32 s98, s98, 131072
v_mov_b64 v[26:27], 0
v_mov_b64 v[28:29], 0
v_and_b32 v79, 128, v10
v_add_u32 v79, v79, v10
L_d1_p5:
buffer_load_dwordx4 v[46:49], v1, s[4:7], s27 offen offset:0 sc1
buffer_load_dwordx4 v[50:53], v1, s[4:7], s27 offen offset:1024 sc1
buffer_load_dwordx4 v[54:57], v1, s[4:7], s27 offen offset:2048 sc1
buffer_load_dwordx4 v[58:61], v1, s[4:7], s27 offen offset:3072 sc1
s_add_u32 s38, s38, 1
s_cmp_ge_u32 s38, 524288
s_cbranch_scc1 L_err
s_waitcnt vmcnt(7)
v_mfma_f32_16x16x32_bf16 v[34:37], v[38:41], v[30:33], 0
v_max3_u32 v78, v38, v39, v40
v_max_u32 v78, v78, v41
s_waitcnt vmcnt(6)
v_mfma_f32_16x16x32_bf16 v[34:37], v[42:45], v[30:33], v[34:37]
v_max3_u32 v78, v78, v42, v43
v_max3_u32 v78, v78, v44, v45
s_waitcnt vmcnt(5)
v_mfma_f32_16x16x32_bf16 v[34:37], v[70:73], v[30:33], v[34:37]
v_max3_u32 v78, v78, v70, v71
v_max3_u32 v78, v78, v72, v73
s_waitcnt vmcnt(4)
v_mfma_f32_16x16x32_bf16 v[34:37], v[74:77], v[30:33], v[34:37]
v_max3_u32 v78, v78, v74, v75
v_max3_u32 v78, v78, v76, v77
v_cmp_eq_u32 vcc, -1, v78
s_cbranch_vccz L_d1_p5ok
buffer_load_dwordx4 v[38:41], v1, s[4:7], s27 offen offset:0 sc1
buffer_load_dwordx4 v[42:45], v1, s[4:7], s27 offen offset:1024 sc1
buffer_load_dwordx4 v[70:73], v1, s[4:7], s27 offen offset:2048 sc1
buffer_load_dwordx4 v[74:77], v1, s[4:7], s27 offen offset:3072 sc1
s_waitcnt vmcnt(7)
v_mfma_f32_16x16x32_bf16 v[34:37], v[46:49], v[30:33], 0
v_max3_u32 v78, v46, v47, v48
v_max_u32 v78, v78, v49
s_waitcnt vmcnt(6)
v_mfma_f32_16x16x32_bf16 v[34:37], v[50:53], v[30:33], v[34:37]
v_max3_u32 v78, v78, v50, v51
v_max3_u32 v78, v78, v52, v53
s_waitcnt vmcnt(5)
v_mfma_f32_16x16x32_bf16 v[34:37], v[54:57], v[30:33], v[34:37]
v_max3_u32 v78, v78, v54, v55
v_max3_u32 v78, v78, v56, v57
s_waitcnt vmcnt(4)
v_mfma_f32_16x16x32_bf16 v[34:37], v[58:61], v[30:33], v[34:37]
v_max3_u32 v78, v78, v58, v59
v_max3_u32 v78, v78, v60, v61
v_cmp_eq_u32 vcc, -1, v78
s_cbranch_vccnz L_d1_p5
L_d1_p5ok:
s_nop 3
v_permlane32_swap_b32 v34, v36
v_permlane32_swap_b32 v35, v37
s_cmp_eq_u64 vcc, 0
s_cselect_b64 exec, s[40:41], 0
v_add_f32 v34, v34, v36
v_add_f32 v35, v35, v37
v_cvt_pk_bf16_f32 v34, v34, v35
buffer_store_dword v34, v13, s[4:7], s20 offen sc1
s_cselect_b64 exec, s[40:41], 0
buffer_store_dword v34, v13, s[4:7], s21 offen sc1
s_mov_b64 exec, -1
v_mov_b64 v[62:63], -1
v_mov_b64 v[64:65], -1
buffer_store_dwordx4 v[62:65], v1, s[4:7], s27 offen offset:0 sc1
buffer_store_dwordx4 v[62:65], v1, s[4:7], s27 offen offset:1024 sc1
buffer_store_dwordx4 v[62:65], v1, s[4:7], s27 offen offset:2048 sc1
buffer_store_dwordx4 v[62:65], v1, s[4:7], s27 offen offset:3072 sc1
buffer_store_dword v62, v13, s[4:7], s29 offen sc1
s_waitcnt vmcnt(7)
v_mov_b64 v[30:31], 0
s_and_b32 s35, s15, 3
s_lshl_b32 s35, s35, 14
v_mov_b64 v[32:33], 0
s_add_u32 s35, s35, 16384
s_and_b32 s35, s35, 0xc000
v_mov_b64 v[34:35], 0
s_add_u32 s20, s44, s35
s_xor_b32 s35, s35, 32768
v_mov_b64 v[36:37], 0
s_add_u32 s29, s44, s35
s_add_u32 s21, s21, 32768
s_add_u32 s27, s27, s45
s_sub_u32 s45, 0, s45
s_waitcnt vmcnt(7)
s_branch L_d1_top
L_d1_nored:
s_add_u32 s36, s15, 2
s_min_u32 s36, s36, 64
s_cmp_ge_u32 s0, 64
s_cbranch_scc1 L_d1_fok
v_mov_b32 v70, s30
s_waitcnt vmcnt(0)
ds_read_b128 v[38:41], v70
ds_read_b128 v[42:45], v70 offset:16
s_waitcnt lgkmcnt(0)
v_min3_u32 v38, v38, v39, v40
v_min3_u32 v42, v42, v43, v44
v_min_u32 v38, v38, v41
v_min_u32 v42, v42, v45
v_lshlrev_b32 v38, 1, v38
v_lshl_add_u32 v42, v42, 1, 1
v_min_u32 v38, v38, v42
s_nop 0
v_readfirstlane_b32 s35, v38
s_nop 0
s_max_u32 s0, s0, s35
s_mov_b32 s38, 0
L_fw_d1kn:
s_cmp_ge_u32 s0, s36
s_cbranch_scc1 L_fw_d1kn_ok
buffer_load_dwordx4 v[38:41], off, s[4:7], s31 sc1
buffer_load_dwordx4 v[42:45], off, s[4:7], s31 offset:16 sc1
s_add_u32 s38, s38, 1
s_cmp_ge_u32 s38, 524288
s_cbranch_scc1 L_err
s_waitcnt vmcnt(0)
v_min3_u32 v38, v38, v39, v40
v_min3_u32 v42, v42, v43, v44
v_min_u32 v38, v38, v41
v_min_u32 v42, v42, v45
v_lshlrev_b32 v38, 1, v38
v_lshl_add_u32 v42, v42, 1, 1
v_min_u32 v38, v38, v42
s_nop 0
v_readfirstlane_b32 s35, v38
s_nop 0
s_max_u32 s0, s0, s35
s_branch L_fw_d1kn
L_fw_d1kn_ok:
s_add_u32 s35, s15, 4
s_cmp_lt_u32 s0, s35
s_cselect_b32 s97, 1, 0
s_cmp_lt_u32 s0, 64
s_cselect_b32 s97, s97, 0
L_d1_fok:
v_mov_b64 v[14:15], 0
s_and_b32 s35, s15, 3
s_lshl_b32 s35, s35, 14
v_mov_b64 v[16:17], 0
s_add_u32 s18, s32, s35
s_add_u32 s26, s26, 32768
v_mov_b64 v[18:19], 0
s_add_u32 s24, s24, s45
s_add_u32 s25, s25, s45
v_mov_b64 v[20:21], 0
s_add_u32 s47, s47, 524288
s_add_u32 s46, s46, 524288
v_mov_b64 v[22:23], 0
s_xor_b32 s28, s28, 8192
s_xor_b32 s19, s19, 8192
v_mov_b64 v[24:25], 0
s_add_u32 s98, s98, 131072
v_mov_b64 v[26:27], 0
v_mov_b64 v[28:29], 0
v_and_b32 v79, 128, v10
v_add_u32 v79, v79, v10
v_mov_b64 v[30:31], 0
s_and_b32 s35, s15, 3
s_lshl_b32 s35, s35, 14
v_mov_b64 v[32:33], 0
s_add_u32 s35, s35, 16384
s_and_b32 s35, s35, 0xc000
v_mov_b64 v[34:35], 0
s_add_u32 s20, s44, s35
s_xor_b32 s35, s35, 32768
v_mov_b64 v[36:37], 0
s_add_u32 s29, s44, s35
s_add_u32 s21, s21, 32768
s_add_u32 s27, s27, s45
s_sub_u32 s45, 0, s45
L_d1_top:
s_barrier
ds_read_b128 v[46:49], v2 offset:0
ds_read_b128 v[50:53], v2 offset:1024
ds_read_b128 v[54:57], v2 offset:2048
ds_read_b128 v[58:61], v2 offset:3072
ds_read_b128 v[62:65], v2 offset:16384
ds_read_b128 v[66:69], v2 offset:17408
s_branch L_d1_step
L_d1_p2slow:
s_mov_b32 s38, 0
L_d1_p2s:
s_mov_b32 m0, s1
s_nop 0
buffer_load_dwordx4 v11, s[4:7], s26 offen sc1 lds
s_mov_b32 m0, s2
s_nop 0
buffer_load_dword v12, s[4:7], s26 offen sc1 lds
s_add_u32 s38, s38, 1
s_cmp_ge_u32 s38, 524288
s_cbranch_scc1 L_err
s_waitcnt vmcnt(0)
ds_read_b128 v[70:73], v11 offset:21504
ds_read_b32 v78, v12 offset:21504
s_waitcnt lgkmcnt(0)
v_max3_u32 v74, v70, v71, v72
v_max3_u32 v74, v74, v73, v78
v_cmp_eq_u32 vcc, -1, v74
s_cbranch_vccnz L_d1_p2s
s_branch L_d1_p2ok
L_d1_newmax:
v_max_f32 v26, v26, v79
v_mov_b32 v79, v26
s_nop 1
v_permlane16_swap_b32 v26, v79
v_max_f32 v26, v26, v79
v_mov_b32 v79, v26
s_nop 1
v_permlane32_swap_b32 v26, v79
v_max_f32 v26, v26, v79
v_mul_f32 v26, s34, v26
v_sub_f32 v79, v78, v26
v_exp_f32 v79, v79
v_mov_b32 v78, v26
v_mul_f32 v70, v79, v70
v_mul_f32 v71, v79, v71
v_mul_f32 v72, v79, v72
v_mul_f32 v73, v79, v73
v_mul_f32 v74, v79, v74
v_mul_f32 v75, v79, v75
v_mul_f32 v76, v79, v76
v_mul_f32 v77, v79, v77
s_branch L_d1_maxok
L_d1_refresh:
s_mov_b32 s97, 0
s_mov_b32 m0, s30
v_lshrrev_b32 v78, 2, v1
s_sub_u32 s35, s31, 32768
s_mov_b64 exec, 255
buffer_load_dword v78, s[4:7], s35 offen sc1 lds
s_mov_b64 exec, -1
s_branch L_d1_refd
L_d1_last:
v_add_f32 v30, v30, v32
v_add_f32 v31, v31, v33
s_nop 1
v_add_f32 v34, v34, v36
v_add_f32 v35, v35, v37
v_cvt_pk_bf16_f32 v30, v30, v31
v_cvt_pk_bf16_f32 v31, v34, v35
buffer_store_dwordx2 v[30:31], v78, s[4:7], s98 offen sc1
s_waitcnt vmcnt(0)
L_d1_done:
L_chdone:
s_branch L_done
L_err:
s_mov_b64 exec, 1
v_mov_b32 v1, 1
buffer_atomic_add v1, off, s[8:11], 0 offset:144 sc1
s_waitcnt vmcnt(0)
L_done:
L_end:
s_endpgm
.section .rodata,"a"
.p2align 6
.amdhsa_kernel parallel_sum__memory_aug_recurrent_mem_tr__dense_activation_gelu__prompt_kernel
  .amdhsa_next_free_vgpr 512
  .amdhsa_next_free_sgpr 102
  .amdhsa_accum_offset 256
  .amdhsa_group_segment_fixed_size 0
  .amdhsa_kernarg_size 120
  .amdhsa_user_sgpr_count 2
  .amdhsa_user_sgpr_kernarg_segment_ptr 1
  .amdhsa_system_sgpr_workgroup_id_x 1
  .amdhsa_float_denorm_mode_32 3
.end_amdhsa_kernel
```
